```python
import torch

def _softmax(x, axis=-1):
    return torch.softmax(x, dim=axis)
def _gelu(x):
    return torch.nn.functional.gelu(x, approximate="tanh")
def _silu(x):
    return torch.nn.functional.silu(x)
def _sigmoid(x):
    return torch.sigmoid(x)
def _layernorm(x, axis=-1, eps=1e-5):
    m = x.mean(dim=axis, keepdim=True)
    v = x.var(dim=axis, keepdim=True, unbiased=False)
    return (x - m) / torch.sqrt(v + eps)
def _scatter_add(tgt, idx, src, axis=0):
    return tgt.clone().index_add_(axis, idx, src)
def _segment_sum(src, seg, n):
    out = torch.zeros((n,) + src.shape[1:], dtype=src.dtype)
    return out.index_add_(0, seg, src)
def _pad(x, pw):
    flat = tuple(v for pair in reversed(pw) for v in pair)
    return torch.nn.functional.pad(x, flat)

kernel_name = 'recurrent_scan__compressed_kv_cla__glu_gated_bilinear__prompt'

def setup_inputs():

    _w = (lambda a: (lambda t: t.to(torch.bfloat16) if t.is_floating_point() else t)(torch.as_tensor(a)))
    def _A_setup():
        B, H, Sq, Sk, D, M = 1, 32, 2048, 2048, 128, 640
        Dc = 4 * D
        return {
            "x": _w((lambda *s: torch.randn(*s, dtype=torch.bfloat16) * 0.05)(B, Sq, M)),
            "c_kv": _w((lambda *s: torch.randn(*s, dtype=torch.bfloat16) * 1.6)(B, Sk, Dc)),
            "w_q": _w((lambda *s: torch.randn(*s, dtype=torch.bfloat16) * 1.6)(M, H, D) * (M ** -0.5)),
            "w_uk": _w((lambda *s: torch.randn(*s, dtype=torch.bfloat16) * 1.6)(Dc, H, D) * (Dc ** -0.5)),
            "w_uv": _w((lambda *s: torch.randn(*s, dtype=torch.bfloat16) * 1.6)(Dc, H, D) * (Dc ** -0.5)),
            "w_o": _w((lambda *s: torch.randn(*s, dtype=torch.bfloat16) * 1.6)(H, D, M) * ((H * D) ** -0.5)),
        }
    _A_in = _A_setup()

    def _B_setup():
        B, S, D, F = 1, 2048, 640, 1728
        return {
            "x": _w((lambda *s: torch.randn(*s, dtype=torch.bfloat16) * 0.05)(B, S, D)),
            "w_gate": _w((lambda *s: torch.randn(*s, dtype=torch.bfloat16) * 0.2)(D, F) * (D ** -0.5)),
            "w_up": _w((lambda *s: torch.randn(*s, dtype=torch.bfloat16) * 0.2)(D, F) * (D ** -0.5)),
            "w_down": _w((lambda *s: torch.randn(*s, dtype=torch.bfloat16) * 0.2)(F, D) * (F ** -0.5)),
        }
    _B_in = _B_setup()

    return {
        "A_x": _A_in["x"],
        "A_c_kv": _A_in["c_kv"],
        "A_w_q": _A_in["w_q"],
        "A_w_uk": _A_in["w_uk"],
        "A_w_uv": _A_in["w_uv"],
        "A_w_o": _A_in["w_o"],
        "B_x": _B_in["x"],
        "B_w_gate": _B_in["w_gate"],
        "B_w_up": _B_in["w_up"],
        "B_w_down": _B_in["w_down"],
    }

def reference(A_x, A_c_kv, A_w_q, A_w_uk, A_w_uv, A_w_o, B_x, B_w_gate, B_w_up, B_w_down):
    def _A_ref(x, c_kv, w_q, w_uk, w_uv, w_o):
        B, Sq, M = x.shape[0], x.shape[1], x.shape[2]
        Sk = c_kv.shape[1]
        H, D = w_q.shape[1], w_q.shape[2]
        q = torch.einsum("bqm,mhd->bhqd", x, w_q)
        k = torch.einsum("bkc,chd->bhkd", c_kv, w_uk)
        v = torch.einsum("bkc,chd->bhkd", c_kv, w_uv)
        scores = torch.einsum("bhqd,bhkd->bhqk", q, k) * (D ** -0.5)
        off = Sk - Sq
        qi = torch.arange(Sq)[:, None]
        kj = torch.arange(Sk)[None, :]
        cmask = kj <= (qi + off)
        scores = torch.where(cmask[None, None], scores, -1e9)
        p = _softmax(scores, axis=-1)
        ctx = torch.einsum("bhqk,bhkd->bhqd", p, v)
        return torch.einsum("bhqd,hdm->bqm", ctx, w_o)

    def _B_ref(x, w_gate, w_up, w_down):
        g = torch.einsum("bsd,df->bsf", x, w_gate)
        u = torch.einsum("bsd,df->bsf", x, w_up)
        h = g * u
        return torch.einsum("bsf,fd->bsd", h, w_down)

    x = A_x
    xn = _layernorm(x, axis=-1)
    s = _A_ref(xn, A_c_kv, A_w_q, A_w_uk, A_w_uv, A_w_o)
    g = _silu(_B_ref(xn, B_w_gate, B_w_up, B_w_down))
    return x + s * g
```

```asm
; @launch grid=(256,1,1) block=(256,1,1) lds=163840
.amdgcn_target "amdgcn-amd-amdhsa--gfx950"
.macro MM p0, p1, p2, p3
v_mfma_f32_16x16x32_bf16 \p0, \p1, \p2, \p3
.endm
.macro AR p0, p1
v_accvgpr_read_b32 \p0, \p1
.endm
.macro AW p0, p1
v_accvgpr_write_b32 \p0, \p1
.endm
.macro CV p0, p1, p2
v_cvt_pk_bf16_f32 \p0, \p1, \p2
.endm
.text
.globl recurrent_scan__compressed_kv_cla__glu_gated_bilinear__prompt_kernel
.p2align 8
.type recurrent_scan__compressed_kv_cla__glu_gated_bilinear__prompt_kernel,@function
recurrent_scan__compressed_kv_cla__glu_gated_bilinear__prompt_kernel:
s_cmp_ge_u32 s2, 256
s_cbranch_scc1 L_end
s_load_dwordx16 s[4:19], s[0:1], 0
s_load_dwordx8 s[20:27], s[0:1], 64
s_load_dwordx2 s[28:29], s[0:1], 96
v_lshrrev_b32 v1, 6, v0
v_and_b32 v0, 63, v0
v_readfirstlane_b32 s30, v1
s_and_b32 s31, s2, 7
s_lshl_b32 s31, s31, 2
s_lshr_b32 s61, s2, 3
s_and_b32 s61, s61, 3
s_add_u32 s31, s31, s61
s_lshr_b32 s3, s2, 5
v_lshrrev_b32 v6, 3, v0
v_lshlrev_b32 v6, 10, v6
v_lshrrev_b32 v7, 4, v0
v_and_b32 v12, 7, v0
v_xor_b32 v12, v12, v7
v_xor_b32 v13, 4, v12
v_lshl_add_u32 v12, v12, 4, v6
v_lshl_add_u32 v13, v13, 4, v6
v_add_u32 v8, 0, v12
v_add_u32 v9, 7168, v13
v_add_u32 v10, 14336, v12
v_add_u32 v11, 21504, v13
v_bfe_u32 v16, v0, 1, 3
v_xor_b32 v16, v16, v7
v_xor_b32 v17, 4, v16
v_and_b32 v18, 1, v0
v_lshlrev_b32 v18, 4, v18
v_lshl_add_u32 v18, v7, 13, v18
v_lshl_add_u32 v16, v16, 5, v18
v_lshl_add_u32 v17, v17, 5, v18
v_add_u32 v12, 0, v16
v_add_u32 v13, 31744, v16
v_add_u32 v14, 63488, v17
v_add_u32 v15, 95232, v17
s_lshl_b32 s56, s3, 2
s_add_u32 s56, s56, s30
s_lshl_b32 s56, s56, 16
s_lshl_b32 s57, s30, 17
s_lshl_b32 s58, s31, 8
s_add_u32 s57, s57, s58
s_lshl_b32 s58, s30, 13
s_lshl_b32 s59, s30, 12
s_add_u32 s59, s59, 65536
v_lshrrev_b32 v2, 5, v0
v_and_b32 v3, 31, v0
s_lshl_b32 s61, s2, 2
s_add_u32 s61, s61, s30
s_lshl_b32 s61, s61, 1
v_add_u32 v4, s61, v2
v_mul_u32_u24 v5, 1280, v4
v_lshl_add_u32 v5, v3, 3, v5
v_lshlrev_b32 v1, 4, v0
s_waitcnt lgkmcnt(0)
s_mov_b32 s48, s4
s_mov_b32 s49, s5
s_mov_b32 s50, 0x280000
s_mov_b32 s51, 0x00020000
s_mov_b32 s36, s6
s_mov_b32 s37, s7
s_mov_b32 s38, 0x200000
s_mov_b32 s39, 0x00020000
s_mov_b32 s40, s10
s_mov_b32 s41, s11
s_mov_b32 s42, 0x400000
s_mov_b32 s43, 0x00020000
s_mov_b32 s44, s12
s_mov_b32 s45, s13
s_mov_b32 s46, 0x400000
s_mov_b32 s47, 0x00020000
s_mov_b32 s32, s28
s_mov_b32 s33, s29
s_mov_b32 s34, 0x10000000
s_mov_b32 s35, 0x00020000
v_mov_b32 v52, 0
s_mov_b32 s79, 0x7005000
buffer_load_dword v61, v52, s[32:35], s79 offen sc0 sc1
buffer_load_dwordx2 v[192:193], v5, s[48:51], 0 offen offset:0
buffer_load_dwordx2 v[194:195], v5, s[48:51], 0 offen offset:256
buffer_load_dwordx2 v[196:197], v5, s[48:51], 0 offen offset:512
buffer_load_dwordx2 v[198:199], v5, s[48:51], 0 offen offset:768
buffer_load_dwordx2 v[200:201], v5, s[48:51], 0 offen offset:1024
s_add_u32 m0, s58, 0
s_add_u32 s60, s56, 32768
buffer_load_dwordx4 v8, s[36:39], s56 offen offset:0 sc1 lds
s_lshr_b32 s61, s2, 3
s_lshl_b32 s61, s61, 2
s_add_u32 s61, s61, s30
v_bfe_u32 v20, v0, 1, 4
v_lshlrev_b32 v20, 10, v20
v_and_b32 v21, 1, v0
v_lshl_add_u32 v20, v21, 7, v20
s_lshl_b32 s62, s61, 14
v_add_u32 v48, s62, v20
buffer_load_dwordx4 v9, s[36:39], s56 offen offset:1024 sc1 lds
v_and_b32 v20, 7, v0
v_lshlrev_b32 v20, 7, v20
s_lshl_b32 s62, s61, 13
s_and_b32 s63, s2, 7
s_lshl_b32 s63, s63, 10
s_add_u32 s62, s62, s63
v_add_u32 v49, s62, v20
s_getpc_b64 s[100:101]
L_pc:
s_sub_u32 s100, s100, L_pc-recurrent_scan__compressed_kv_cla__glu_gated_bilinear__prompt_kernel
s_subb_u32 s101, s101, 0
v_and_b32 v20, 7, v0
v_lshlrev_b32 v20, 7, v20
buffer_load_dwordx4 v10, s[36:39], s56 offen offset:2048 sc1 lds
s_lshl_b32 s62, s61, 10
v_add_u32 v20, s62, v20
v_min_u32 v55, L_codeend-recurrent_scan__compressed_kv_cla__glu_gated_bilinear__prompt_kernel-4, v20
s_min_u32 s62, s61, 79
s_lshl_b32 s62, s62, 16
v_mov_b32 v56, s62
s_min_u32 s62, s61, 33
s_lshl_b32 s62, s62, 16
v_mov_b32 v57, s62
v_min_u32 v20, 39, v0
buffer_load_dwordx4 v11, s[36:39], s56 offen offset:3072 sc1 lds
v_lshrrev_b32 v21, 3, v20
s_mul_i32 s62, s61, 5
v_add_u32 v21, s62, v21
v_and_b32 v20, 7, v20
v_lshlrev_b32 v20, 7, v20
v_lshl_add_u32 v20, v21, 13, v20
v_add_u32 v53, s63, v20
v_min_u32 v20, 19, v0
v_lshrrev_b32 v21, 2, v20
v_add_u32 v21, s62, v21
s_add_u32 m0, s59, 0
s_add_u32 s56, s56, 128
buffer_load_dwordx4 v12, s[40:43], s57 offen offset:0 sc1 lds
v_mul_u32_u24 v21, 3456, v21
s_and_b32 s63, s2, 7
s_lshl_b32 s63, s63, 2
s_mul_i32 s64, s63, 37
s_lshr_b32 s64, s64, 8
s_sub_u32 s63, s63, s64
v_and_b32 v20, 3, v20
v_add_u32 v20, s63, v20
v_min_u32 v20, 26, v20
v_lshl_add_u32 v54, v20, 7, v21
buffer_load_dwordx4 v13, s[40:43], s57 offen offset:1024 sc1 lds
s_mul_i32 s62, s61, 20480
v_and_b32 v20, 31, v0
v_lshlrev_b32 v20, 7, v20
v_add_u32 v50, s62, v20
s_lshr_b32 s61, s30, 1
s_lshl_b32 s61, s61, 14
v_bfe_u32 v20, v0, 1, 3
v_xor_b32 v20, v20, v7
v_and_b32 v21, 15, v0
buffer_load_dwordx4 v14, s[40:43], s57 offen offset:2048 sc1 lds
v_lshlrev_b32 v21, 7, v21
v_add_u32 v21, s61, v21
v_lshl_add_u32 v16, v20, 4, v21
v_xor_b32 v20, 4, v20
v_lshl_add_u32 v17, v20, 4, v21
v_bfe_u32 v22, v0, 2, 2
v_lshl_add_u32 v23, v7, 3, v22
v_lshlrev_b32 v23, 8, v23
v_and_b32 v24, 3, v0
v_lshl_add_u32 v23, v24, 3, v23
buffer_load_dwordx4 v15, s[40:43], s57 offen offset:3072 sc1 lds
v_add_u32 v23, 65536, v23
v_bfe_u32 v22, v0, 2, 3
s_and_b32 s62, s30, 1
s_lshl_b32 s62, s62, 2
v_xor_b32 v22, s62, v22
v_xor_b32 v24, 0, v22
v_lshl_add_u32 v18, v24, 5, v23
v_xor_b32 v24, 1, v22
v_lshl_add_u32 v19, v24, 5, v23
v_xor_b32 v24, 2, v22
s_add_u32 m0, s58, 4096
s_nop 0
buffer_load_dwordx4 v8, s[36:39], s60 offen offset:0 sc1 lds
v_lshl_add_u32 v20, v24, 5, v23
v_xor_b32 v24, 3, v22
v_lshl_add_u32 v21, v24, 5, v23
s_sub_u32 s61, 7, s30
s_mul_i32 s61, s61, 20480
v_add_u32 v32, s61, v1
s_mul_i32 s61, s30, 20480
v_add_u32 v37, s61, v1
v_lshrrev_b32 v25, 3, v0
v_bfe_u32 v26, v0, 1, 2
buffer_load_dwordx4 v9, s[36:39], s60 offen offset:1024 sc1 lds
v_bfe_u32 v27, v0, 4, 2
v_xor_b32 v26, v26, v27
v_lshlrev_b32 v26, 5, v26
v_and_b32 v27, 1, v0
v_lshl_add_u32 v26, v27, 4, v26
v_lshl_add_u32 v33, v25, 13, v26
v_add_u32 v34, 64512, v33
v_mul_u32_u24 v25, 3456, v25
v_add_u32 v35, v25, v26
v_add_u32 v36, 26624, v35
buffer_load_dwordx4 v10, s[36:39], s60 offen offset:2048 sc1 lds
v_lshrrev_b32 v25, 2, v0
v_lshlrev_b32 v25, 7, v25
v_and_b32 v26, 3, v0
v_lshl_add_u32 v25, v26, 3, v25
v_add_u32 v25, 65536, v25
v_bfe_u32 v26, v0, 3, 2
v_xor_b32 v27, 0, v26
v_lshl_add_u32 v40, v27, 5, v25
v_add_u32 v44, 65536, v40
buffer_load_dwordx4 v11, s[36:39], s60 offen offset:3072 sc1 lds
v_xor_b32 v27, 1, v26
v_lshl_add_u32 v41, v27, 5, v25
v_add_u32 v45, 65536, v41
v_xor_b32 v27, 2, v26
v_lshl_add_u32 v42, v27, 5, v25
v_add_u32 v46, 65536, v42
v_xor_b32 v27, 3, v26
v_lshl_add_u32 v43, v27, 5, v25
v_add_u32 v47, 65536, v43
s_mul_i32 s17, s31, 37
s_add_u32 m0, s59, 16384
s_nop 0
buffer_load_dwordx4 v12, s[44:47], s57 offen offset:0 sc1 lds
s_lshr_b32 s17, s17, 8
s_sub_u32 s71, s31, s17
s_lshl_b32 s70, s30, 11
s_lshl_b32 s72, s3, 3
s_sub_u32 s73, 120, s72
s_mul_i32 s68, s72, 20480
s_mul_i32 s69, s73, 20480
s_lshl_b32 s64, s30, 17
s_lshl_b32 s65, s31, 8
s_add_u32 s64, s64, s65
buffer_load_dwordx4 v13, s[44:47], s57 offen offset:1024 sc1 lds
s_add_u32 s65, s64, 128
s_mul_i32 s66, s30, 55296
s_lshl_b32 s67, s71, 7
s_add_u32 s66, s66, s67
s_mov_b32 s67, s66
s_mul_i32 s61, s17, 7
s_sub_u32 s61, s31, s61
s_cmp_eq_u32 s61, 6
s_cselect_b32 s74, 0, 0x21c000
s_cmp_ge_u32 s71, 27
s_cselect_b32 s74, 0, s74
s_lshl_b32 s61, s30, 2
buffer_load_dwordx4 v14, s[44:47], s57 offen offset:2048 sc1 lds
s_lshl_b32 s76, s2, 4
s_add_u32 s76, s76, s61
s_add_u32 s75, s76, 0x7000000
s_add_u32 s77, s76, 0x7002000
s_and_b32 s78, s76, 0x1ff
s_add_u32 s76, s76, 0x7001000
s_sub_u32 s62, 15, s3
s_lshl_b32 s62, s62, 9
s_add_u32 s78, s78, s62
s_add_u32 s78, s78, 0x7002000
buffer_load_dwordx4 v15, s[44:47], s57 offen offset:3072 sc1 lds
s_add_u32 s57, s57, 524288
v_cmp_eq_u32 vcc, 0, v0
v_mov_b32 v25, 0x20000000
s_lshl_b32 s26, s2, 2
s_add_u32 s26, s26, 0x7004000
v_cndmask_b32 v60, v25, 0, vcc
s_cmp_eq_u32 s30, 0
s_cselect_b32 s26, s26, 0x20000000
s_lshl_b32 s27, s2, 2
s_or_b32 s27, s27, s30
s_cmp_eq_u32 s27, 0
s_cselect_b32 s27, s79, 0x20000000
s_mov_b32 s79, 0x7004000
s_add_u32 m0, s58, 32768
s_add_u32 s60, s56, 32768
buffer_load_dwordx4 v8, s[36:39], s56 offen offset:0 sc1 lds
buffer_load_dwordx4 v9, s[36:39], s56 offen offset:1024 sc1 lds
buffer_load_dwordx4 v10, s[36:39], s56 offen offset:2048 sc1 lds
buffer_load_dwordx4 v11, s[36:39], s56 offen offset:3072 sc1 lds
s_add_u32 m0, s59, 32768
s_add_u32 s56, s56, 128
buffer_load_dwordx4 v12, s[40:43], s57 offen offset:0 sc1 lds
buffer_load_dwordx4 v13, s[40:43], s57 offen offset:1024 sc1 lds
buffer_load_dwordx4 v14, s[40:43], s57 offen offset:2048 sc1 lds
buffer_load_dwordx4 v15, s[40:43], s57 offen offset:3072 sc1 lds
s_waitcnt vmcnt(8) lgkmcnt(0)
s_barrier
ds_read_b128 v[128:131], v16 offset:0
ds_read_b128 v[132:135], v17 offset:0
ds_read_b64_tr_b16 v[64:65], v18 offset:0
ds_read_b64_tr_b16 v[66:67], v18 offset:1024
ds_read_b64_tr_b16 v[68:69], v18 offset:8192
ds_read_b64_tr_b16 v[70:71], v18 offset:9216
ds_read_b64_tr_b16 v[72:73], v19 offset:0
ds_read_b64_tr_b16 v[74:75], v19 offset:1024
ds_read_b64_tr_b16 v[76:77], v19 offset:8192
ds_read_b64_tr_b16 v[78:79], v19 offset:9216
ds_read_b64_tr_b16 v[80:81], v20 offset:0
ds_read_b64_tr_b16 v[82:83], v20 offset:1024
ds_read_b64_tr_b16 v[84:85], v20 offset:8192
ds_read_b64_tr_b16 v[86:87], v20 offset:9216
ds_read_b64_tr_b16 v[88:89], v21 offset:0
ds_read_b64_tr_b16 v[90:91], v21 offset:1024
ds_read_b64_tr_b16 v[92:93], v21 offset:8192
ds_read_b64_tr_b16 v[94:95], v21 offset:9216
ds_read_b64_tr_b16 v[96:97], v18 offset:16384
ds_read_b64_tr_b16 v[98:99], v18 offset:17408
ds_read_b64_tr_b16 v[100:101], v18 offset:24576
ds_read_b64_tr_b16 v[102:103], v18 offset:25600
ds_read_b64_tr_b16 v[104:105], v19 offset:16384
ds_read_b64_tr_b16 v[106:107], v19 offset:17408
ds_read_b64_tr_b16 v[108:109], v19 offset:24576
ds_read_b64_tr_b16 v[110:111], v19 offset:25600
ds_read_b64_tr_b16 v[112:113], v20 offset:16384
ds_read_b64_tr_b16 v[114:115], v20 offset:17408
ds_read_b64_tr_b16 v[116:117], v20 offset:24576
ds_read_b64_tr_b16 v[118:119], v20 offset:25600
ds_read_b64_tr_b16 v[120:121], v21 offset:16384
ds_read_b64_tr_b16 v[122:123], v21 offset:17408
ds_read_b64_tr_b16 v[124:125], v21 offset:24576
ds_read_b64_tr_b16 v[126:127], v21 offset:25600
ds_read_b128 v[136:139], v16 offset:2048
ds_read_b128 v[140:143], v17 offset:2048
s_waitcnt lgkmcnt(15)
MM a[0:3],v[64:67],v[128:131],0
ds_read_b128 v[144:147], v16 offset:4096
s_mov_b32 s61, 0x9e3779b1
v_mul_lo_u32 v61, s61, v61
MM a[0:3],v[68:71],v[132:135],a[0:3]
s_add_u32 m0, s58, 36864
v_add_u32 v61, 0x7f4a7c15, v61
v_lshlrev_b32 v204, 16, v192
MM a[4:7],v[76:79],v[132:135],0
ds_read_b128 v[148:151], v17 offset:4096
v_and_b32 v205, 0xffff0000, v192
v_lshlrev_b32 v206, 16, v193
MM a[4:7],v[72:75],v[128:131],a[4:7]
buffer_load_dwordx4 v8, s[36:39], s60 offen offset:0 sc1 lds
v_and_b32 v207, 0xffff0000, v193
v_lshlrev_b32 v208, 16, v194
s_waitcnt lgkmcnt(15)
MM a[8:11],v[80:83],v[128:131],0
v_and_b32 v209, 0xffff0000, v194
v_lshlrev_b32 v210, 16, v195
MM a[8:11],v[84:87],v[132:135],a[8:11]
buffer_load_dwordx4 v9, s[36:39], s60 offen offset:1024 sc1 lds
v_and_b32 v211, 0xffff0000, v195
v_lshlrev_b32 v212, 16, v196
MM a[12:15],v[92:95],v[132:135],0
v_and_b32 v213, 0xffff0000, v196
v_lshlrev_b32 v214, 16, v197
MM a[12:15],v[88:91],v[128:131],a[12:15]
buffer_load_dwordx4 v10, s[36:39], s60 offen offset:2048 sc1 lds
v_and_b32 v215, 0xffff0000, v197
v_lshlrev_b32 v216, 16, v198
s_waitcnt lgkmcnt(12)
MM a[16:19],v[128:131],v[96:99],0
v_and_b32 v217, 0xffff0000, v198
v_lshlrev_b32 v218, 16, v199
MM a[16:19],v[132:135],v[100:103],a[16:19]
buffer_load_dwordx4 v11, s[36:39], s60 offen offset:3072 sc1 lds
v_and_b32 v219, 0xffff0000, v199
v_lshlrev_b32 v220, 16, v200
MM a[20:23],v[132:135],v[108:111],0
s_add_u32 m0, s59, 49152
v_and_b32 v221, 0xffff0000, v200
v_lshlrev_b32 v222, 16, v201
MM a[20:23],v[128:131],v[104:107],a[20:23]
buffer_load_dwordx4 v12, s[44:47], s57 offen offset:0 sc1 lds
v_and_b32 v223, 0xffff0000, v201
v_add_f32 v224, v204, v205
s_waitcnt lgkmcnt(4)
MM a[24:27],v[128:131],v[112:115],0
v_add_f32 v224, v224, v206
v_add_f32 v224, v224, v207
MM a[24:27],v[132:135],v[116:119],a[24:27]
buffer_load_dwordx4 v13, s[44:47], s57 offen offset:1024 sc1 lds
v_add_f32 v224, v224, v208
v_add_f32 v224, v224, v209
MM a[28:31],v[132:135],v[124:127],0
v_add_f32 v224, v224, v210
v_add_f32 v224, v224, v211
MM a[28:31],v[128:131],v[120:123],a[28:31]
buffer_load_dwordx4 v14, s[44:47], s57 offen offset:2048 sc1 lds
v_add_f32 v224, v224, v212
v_add_f32 v224, v224, v213
s_waitcnt lgkmcnt(2)
MM a[32:35],v[64:67],v[136:139],0
ds_read_b128 v[152:155], v16 offset:6144
v_add_f32 v224, v224, v214
v_add_f32 v224, v224, v215
MM a[32:35],v[68:71],v[140:143],a[32:35]
buffer_load_dwordx4 v15, s[44:47], s57 offen offset:3072 sc1 lds
v_add_f32 v224, v224, v216
v_add_f32 v224, v224, v217
MM a[36:39],v[76:79],v[140:143],0
ds_read_b128 v[156:159], v17 offset:6144
v_add_f32 v224, v224, v218
v_add_f32 v224, v224, v219
MM a[36:39],v[72:75],v[136:139],a[36:39]
s_add_u32 s57, s57, 524288
v_add_f32 v224, v224, v220
v_add_f32 v224, v224, v221
MM a[40:43],v[80:83],v[136:139],0
s_mov_b32 s16, 1048576
v_add_f32 v224, v224, v222
v_add_f32 v224, v224, v223
MM a[40:43],v[84:87],v[140:143],a[40:43]
buffer_load_dword v240, v48, s[36:39], 0 offen offset:256
s_nop 1
v_add_f32_dpp v224, v224, v224 row_ror:8 row_mask:0xf bank_mask:0xf
MM a[44:47],v[92:95],v[140:143],0
s_nop 1
v_add_f32_dpp v224, v224, v224 row_ror:4 row_mask:0xf bank_mask:0xf
MM a[44:47],v[88:91],v[136:139],a[44:47]
buffer_load_dword v241, v49, s[40:43], s16 offen
s_nop 1
v_add_f32_dpp v224, v224, v224 row_ror:2 row_mask:0xf bank_mask:0xf
MM a[48:51],v[136:139],v[96:99],0
s_nop 1
v_add_f32_dpp v224, v224, v224 row_ror:1 row_mask:0xf bank_mask:0xf
MM a[48:51],v[140:143],v[100:103],a[48:51]
buffer_load_dword v242, v49, s[44:47], s16 offen
v_mov_b32 v225, v224
s_nop 1
MM a[52:55],v[140:143],v[108:111],0
v_permlane16_swap_b32 v224, v225
s_nop 1
MM a[52:55],v[136:139],v[104:107],a[52:55]
global_load_dword v249, v55, s[100:101]
v_add_f32 v224, v224, v225
v_mul_f32 v224, 0x3acccccd, v224
MM a[56:59],v[136:139],v[112:115],0
v_sub_f32 v226, v204, v224
v_mul_f32 v227, v226, v226
MM a[56:59],v[140:143],v[116:119],a[56:59]
v_sub_f32 v226, v205, v224
v_fmac_f32 v227, v226, v226
MM a[60:63],v[140:143],v[124:127],0
v_sub_f32 v226, v206, v224
v_fmac_f32 v227, v226, v226
MM a[60:63],v[136:139],v[120:123],a[60:63]
v_sub_f32 v226, v207, v224
v_fmac_f32 v227, v226, v226
s_waitcnt lgkmcnt(2)
MM a[64:67],v[64:67],v[144:147],0
ds_read_b128 v[160:163], v16 offset:8192
v_sub_f32 v226, v208, v224
v_fmac_f32 v227, v226, v226
MM a[64:67],v[68:71],v[148:151],a[64:67]
v_sub_f32 v226, v209, v224
v_fmac_f32 v227, v226, v226
MM a[68:71],v[76:79],v[148:151],0
ds_read_b128 v[164:167], v17 offset:8192
v_sub_f32 v226, v210, v224
v_fmac_f32 v227, v226, v226
MM a[68:71],v[72:75],v[144:147],a[68:71]
v_sub_f32 v226, v211, v224
v_fmac_f32 v227, v226, v226
MM a[72:75],v[80:83],v[144:147],0
v_sub_f32 v226, v212, v224
v_fmac_f32 v227, v226, v226
MM a[72:75],v[84:87],v[148:151],a[72:75]
v_sub_f32 v226, v213, v224
v_fmac_f32 v227, v226, v226
MM a[76:79],v[92:95],v[148:151],0
v_sub_f32 v226, v214, v224
v_fmac_f32 v227, v226, v226
MM a[76:79],v[88:91],v[144:147],a[76:79]
v_sub_f32 v226, v215, v224
v_fmac_f32 v227, v226, v226
MM a[80:83],v[144:147],v[96:99],0
v_sub_f32 v226, v216, v224
v_fmac_f32 v227, v226, v226
MM a[80:83],v[148:151],v[100:103],a[80:83]
v_sub_f32 v226, v217, v224
v_fmac_f32 v227, v226, v226
MM a[84:87],v[148:151],v[108:111],0
v_sub_f32 v226, v218, v224
v_fmac_f32 v227, v226, v226
MM a[84:87],v[144:147],v[104:107],a[84:87]
v_sub_f32 v226, v219, v224
v_fmac_f32 v227, v226, v226
MM a[88:91],v[144:147],v[112:115],0
v_sub_f32 v226, v220, v224
v_fmac_f32 v227, v226, v226
MM a[88:91],v[148:151],v[116:119],a[88:91]
v_sub_f32 v226, v221, v224
v_fmac_f32 v227, v226, v226
MM a[92:95],v[148:151],v[124:127],0
v_sub_f32 v226, v222, v224
v_fmac_f32 v227, v226, v226
MM a[92:95],v[144:147],v[120:123],a[92:95]
v_sub_f32 v226, v223, v224
v_fmac_f32 v227, v226, v226
s_waitcnt lgkmcnt(2)
MM a[96:99],v[64:67],v[152:155],0
ds_read_b128 v[168:171], v16 offset:10240
s_nop 1
v_add_f32_dpp v227, v227, v227 row_ror:8 row_mask:0xf bank_mask:0xf
MM a[96:99],v[68:71],v[156:159],a[96:99]
s_nop 1
v_add_f32_dpp v227, v227, v227 row_ror:4 row_mask:0xf bank_mask:0xf
MM a[100:103],v[76:79],v[156:159],0
ds_read_b128 v[172:175], v17 offset:10240
s_nop 1
v_add_f32_dpp v227, v227, v227 row_ror:2 row_mask:0xf bank_mask:0xf
MM a[100:103],v[72:75],v[152:155],a[100:103]
s_nop 1
v_add_f32_dpp v227, v227, v227 row_ror:1 row_mask:0xf bank_mask:0xf
MM a[104:107],v[80:83],v[152:155],0
v_mov_b32 v225, v227
s_nop 1
MM a[104:107],v[84:87],v[156:159],a[104:107]
v_permlane16_swap_b32 v227, v225
s_nop 1
MM a[108:111],v[92:95],v[156:159],0
v_add_f32 v227, v227, v225
v_mul_f32 v227, 0x3acccccd, v227
MM a[108:111],v[88:91],v[152:155],a[108:111]
CV v228,v224,v227
v_lshlrev_b32 v224, 16, v228
MM a[112:115],v[152:155],v[96:99],0
v_and_b32 v227, 0xffff0000, v228
v_add_f32 v227, 0x3727c5ac, v227
MM a[112:115],v[156:159],v[100:103],a[112:115]
CV v227,v227,v227
v_and_b32 v227, 0xffff0000, v227
MM a[116:119],v[156:159],v[108:111],0
v_sqrt_f32 v227, v227
s_nop 0
MM a[116:119],v[152:155],v[104:107],a[116:119]
CV v227,v227,v227
v_and_b32 v227, 0xffff0000, v227
MM a[120:123],v[152:155],v[112:115],0
v_rcp_f32 v229, v227
s_nop 0
MM a[120:123],v[156:159],v[116:119],a[120:123]
v_fma_f32 v230, -v227, v229, 1.0
v_fma_f32 v229, v230, v229, v229
MM a[124:127],v[156:159],v[124:127],0
v_sub_f32 v204, v204, v224
v_sub_f32 v205, v205, v224
MM a[124:127],v[152:155],v[120:123],a[124:127]
CV v192,v204,v205
v_lshlrev_b32 v204, 16, v192
s_waitcnt lgkmcnt(2)
MM a[192:195],v[64:67],v[160:163],0
ds_read_b128 v[176:179], v16 offset:12288
v_and_b32 v205, 0xffff0000, v192
v_mul_f32 v204, v204, v229
MM a[192:195],v[68:71],v[164:167],a[192:195]
v_mul_f32 v205, v205, v229
CV v192,v204,v205
MM a[196:199],v[76:79],v[164:167],0
ds_read_b128 v[180:183], v17 offset:12288
v_sub_f32 v206, v206, v224
v_sub_f32 v207, v207, v224
MM a[196:199],v[72:75],v[160:163],a[196:199]
CV v193,v206,v207
v_lshlrev_b32 v206, 16, v193
MM a[200:203],v[80:83],v[160:163],0
v_and_b32 v207, 0xffff0000, v193
v_mul_f32 v206, v206, v229
MM a[200:203],v[84:87],v[164:167],a[200:203]
v_mul_f32 v207, v207, v229
CV v193,v206,v207
MM a[204:207],v[92:95],v[164:167],0
v_sub_f32 v208, v208, v224
v_sub_f32 v209, v209, v224
MM a[204:207],v[88:91],v[160:163],a[204:207]
CV v194,v208,v209
v_lshlrev_b32 v208, 16, v194
MM a[208:211],v[160:163],v[96:99],0
v_and_b32 v209, 0xffff0000, v194
v_mul_f32 v208, v208, v229
MM a[208:211],v[164:167],v[100:103],a[208:211]
v_mul_f32 v209, v209, v229
CV v194,v208,v209
MM a[212:215],v[164:167],v[108:111],0
v_sub_f32 v210, v210, v224
v_sub_f32 v211, v211, v224
MM a[212:215],v[160:163],v[104:107],a[212:215]
CV v195,v210,v211
v_lshlrev_b32 v210, 16, v195
MM a[216:219],v[160:163],v[112:115],0
v_and_b32 v211, 0xffff0000, v195
v_mul_f32 v210, v210, v229
MM a[216:219],v[164:167],v[116:119],a[216:219]
v_mul_f32 v211, v211, v229
CV v195,v210,v211
MM a[220:223],v[164:167],v[124:127],0
v_sub_f32 v212, v212, v224
v_sub_f32 v213, v213, v224
MM a[220:223],v[160:163],v[120:123],a[220:223]
CV v196,v212,v213
v_lshlrev_b32 v212, 16, v196
s_waitcnt lgkmcnt(2)
MM a[224:227],v[64:67],v[168:171],0
ds_read_b128 v[184:187], v16 offset:14336
v_and_b32 v213, 0xffff0000, v196
v_mul_f32 v212, v212, v229
MM a[224:227],v[68:71],v[172:175],a[224:227]
v_mul_f32 v213, v213, v229
CV v196,v212,v213
MM a[228:231],v[76:79],v[172:175],0
ds_read_b128 v[188:191], v17 offset:14336
v_sub_f32 v214, v214, v224
v_sub_f32 v215, v215, v224
MM a[228:231],v[72:75],v[168:171],a[228:231]
CV v197,v214,v215
v_lshlrev_b32 v214, 16, v197
MM a[232:235],v[80:83],v[168:171],0
v_and_b32 v215, 0xffff0000, v197
v_mul_f32 v214, v214, v229
MM a[232:235],v[84:87],v[172:175],a[232:235]
v_mul_f32 v215, v215, v229
CV v197,v214,v215
MM a[236:239],v[92:95],v[172:175],0
v_sub_f32 v216, v216, v224
v_sub_f32 v217, v217, v224
MM a[236:239],v[88:91],v[168:171],a[236:239]
CV v198,v216,v217
v_lshlrev_b32 v216, 16, v198
MM a[240:243],v[168:171],v[96:99],0
v_and_b32 v217, 0xffff0000, v198
v_mul_f32 v216, v216, v229
MM a[240:243],v[172:175],v[100:103],a[240:243]
v_mul_f32 v217, v217, v229
CV v198,v216,v217
MM a[244:247],v[172:175],v[108:111],0
v_sub_f32 v218, v218, v224
v_sub_f32 v219, v219, v224
MM a[244:247],v[168:171],v[104:107],a[244:247]
CV v199,v218,v219
v_lshlrev_b32 v218, 16, v199
MM a[248:251],v[168:171],v[112:115],0
v_and_b32 v219, 0xffff0000, v199
v_mul_f32 v218, v218, v229
MM a[248:251],v[172:175],v[116:119],a[248:251]
v_mul_f32 v219, v219, v229
CV v199,v218,v219
MM a[252:255],v[172:175],v[124:127],0
v_sub_f32 v220, v220, v224
v_sub_f32 v221, v221, v224
MM a[252:255],v[168:171],v[120:123],a[252:255]
CV v200,v220,v221
v_lshlrev_b32 v220, 16, v200
s_waitcnt vmcnt(4) lgkmcnt(0)
s_barrier
MM a[128:131],v[64:67],v[176:179],0
ds_read_b128 v[128:131], v16 offset:32768
v_and_b32 v221, 0xffff0000, v200
v_mul_f32 v220, v220, v229
MM a[128:131],v[68:71],v[180:183],a[128:131]
s_add_u32 m0, s58, 0
v_mul_f32 v221, v221, v229
CV v200,v220,v221
MM a[160:163],v[68:71],v[188:191],0
ds_read_b128 v[132:135], v17 offset:32768
v_sub_f32 v222, v222, v224
v_sub_f32 v223, v223, v224
MM a[160:163],v[64:67],v[184:187],a[160:163]
s_add_u32 s60, s56, 32768
CV v201,v222,v223
v_lshlrev_b32 v222, 16, v201
MM a[132:135],v[72:75],v[176:179],0
ds_read_b64_tr_b16 v[64:65], v18 offset:32768
buffer_load_dwordx4 v8, s[36:39], s56 offen offset:0 sc1 lds
v_and_b32 v223, 0xffff0000, v201
MM a[132:135],v[76:79],v[180:183],a[132:135]
ds_read_b64_tr_b16 v[66:67], v18 offset:33792
v_mul_f32 v222, v222, v229
MM a[164:167],v[76:79],v[188:191],0
ds_read_b64_tr_b16 v[68:69], v18 offset:40960
buffer_load_dwordx4 v9, s[36:39], s56 offen offset:1024 sc1 lds
v_mul_f32 v223, v223, v229
MM a[164:167],v[72:75],v[184:187],a[164:167]
ds_read_b64_tr_b16 v[70:71], v18 offset:41984
CV v201,v222,v223
MM a[136:139],v[80:83],v[176:179],0
ds_read_b64_tr_b16 v[72:73], v19 offset:32768
buffer_load_dwordx4 v10, s[36:39], s56 offen offset:2048 sc1 lds
v_lshrrev_b32 v224, 3, v3
MM a[136:139],v[84:87],v[180:183],a[136:139]
ds_read_b64_tr_b16 v[74:75], v19 offset:33792
v_lshlrev_b32 v224, 9, v224
MM a[168:171],v[84:87],v[188:191],0
ds_read_b64_tr_b16 v[76:77], v19 offset:40960
buffer_load_dwordx4 v11, s[36:39], s56 offen offset:3072 sc1 lds
v_and_b32 v225, 3, v3
MM a[168:171],v[80:83],v[184:187],a[168:171]
ds_read_b64_tr_b16 v[78:79], v19 offset:41984
s_add_u32 m0, s59, 0
v_lshl_add_u32 v224, v225, 7, v224
MM a[140:143],v[88:91],v[176:179],0
ds_read_b64_tr_b16 v[80:81], v20 offset:32768
s_add_u32 s56, s56, 128
v_and_b32 v225, 7, v4
MM a[140:143],v[92:95],v[180:183],a[140:143]
ds_read_b64_tr_b16 v[82:83], v20 offset:33792
buffer_load_dwordx4 v12, s[40:43], s57 offen offset:0 sc1 lds
v_lshl_add_u32 v224, v225, 4, v224
MM a[172:175],v[92:95],v[188:191],0
ds_read_b64_tr_b16 v[84:85], v20 offset:40960
v_bfe_u32 v225, v3, 2, 1
MM a[172:175],v[88:91],v[184:187],a[172:175]
ds_read_b64_tr_b16 v[86:87], v20 offset:41984
buffer_load_dwordx4 v13, s[40:43], s57 offen offset:1024 sc1 lds
v_lshl_add_u32 v224, v225, 3, v224
MM a[144:147],v[176:179],v[96:99],0
ds_read_b64_tr_b16 v[88:89], v21 offset:32768
ds_read_b128 v[136:139], v16 offset:34816
v_add_u32 v224, 131072, v224
MM a[144:147],v[180:183],v[100:103],a[144:147]
ds_read_b64_tr_b16 v[90:91], v21 offset:33792
buffer_load_dwordx4 v14, s[40:43], s57 offen offset:2048 sc1 lds
ds_write_b64 v224, v[192:193] offset:0
MM a[176:179],v[188:191],v[100:103],0
ds_read_b64_tr_b16 v[92:93], v21 offset:40960
ds_read_b128 v[140:143], v17 offset:34816
ds_write_b64 v224, v[194:195] offset:2048
MM a[176:179],v[184:187],v[96:99],a[176:179]
ds_read_b64_tr_b16 v[94:95], v21 offset:41984
buffer_load_dwordx4 v15, s[40:43], s57 offen offset:3072 sc1 lds
ds_write_b64 v224, v[196:197] offset:4096
MM a[148:151],v[176:179],v[104:107],0
ds_read_b64_tr_b16 v[96:97], v18 offset:49152
s_add_u32 m0, s58, 4096
ds_write_b64 v224, v[198:199] offset:6144
MM a[148:151],v[180:183],v[108:111],a[148:151]
ds_read_b64_tr_b16 v[98:99], v18 offset:50176
buffer_load_dwordx4 v8, s[36:39], s60 offen offset:0 sc1 lds
ds_write_b64 v224, v[200:201] offset:8192
MM a[180:183],v[188:191],v[108:111],0
ds_read_b64_tr_b16 v[100:101], v18 offset:57344
s_lshl_b32 s61, s30, 10
MM a[180:183],v[184:187],v[104:107],a[180:183]
ds_read_b64_tr_b16 v[102:103], v18 offset:58368
buffer_load_dwordx4 v9, s[36:39], s60 offen offset:1024 sc1 lds
s_add_u32 s61, s61, 131072
MM a[152:155],v[176:179],v[112:115],0
ds_read_b64_tr_b16 v[104:105], v19 offset:49152
v_add_u32 v225, s61, v1
MM a[152:155],v[180:183],v[116:119],a[152:155]
ds_read_b64_tr_b16 v[106:107], v19 offset:50176
buffer_load_dwordx4 v10, s[36:39], s60 offen offset:2048 sc1 lds
v_lshrrev_b32 v226, 3, v0
MM a[184:187],v[188:191],v[116:119],0
ds_read_b64_tr_b16 v[108:109], v19 offset:57344
v_lshlrev_b32 v226, 8, v226
MM a[184:187],v[184:187],v[112:115],a[184:187]
ds_read_b64_tr_b16 v[110:111], v19 offset:58368
buffer_load_dwordx4 v11, s[36:39], s60 offen offset:3072 sc1 lds
v_and_b32 v227, 7, v0
MM a[156:159],v[176:179],v[120:123],0
ds_read_b64_tr_b16 v[112:113], v20 offset:49152
s_add_u32 m0, s59, 16384
v_lshl_add_u32 v226, v227, 4, v226
MM a[156:159],v[180:183],v[124:127],a[156:159]
ds_read_b64_tr_b16 v[114:115], v20 offset:50176
buffer_load_dwordx4 v12, s[44:47], s57 offen offset:0 sc1 lds
s_lshr_b32 s61, s2, 1
MM a[188:191],v[188:191],v[124:127],0
ds_read_b64_tr_b16 v[116:117], v20 offset:57344
s_mul_i32 s61, s61, 20480
MM a[188:191],v[184:187],v[120:123],a[188:191]
ds_read_b64_tr_b16 v[118:119], v20 offset:58368
buffer_load_dwordx4 v13, s[44:47], s57 offen offset:1024 sc1 lds
s_and_b32 s62, s2, 1
ds_read_b64_tr_b16 v[120:121], v21 offset:49152
ds_read_b64_tr_b16 v[122:123], v21 offset:50176
ds_read_b64_tr_b16 v[124:125], v21 offset:57344
ds_read_b64_tr_b16 v[126:127], v21 offset:58368
s_waitcnt lgkmcnt(15)
MM a[0:3],v[64:67],v[128:131],a[0:3]
ds_read_b128 v[144:147], v16 offset:36864
s_lshl_b32 s62, s62, 7
s_add_u32 s61, s61, s62
MM a[0:3],v[68:71],v[132:135],a[0:3]
buffer_load_dwordx4 v14, s[44:47], s57 offen offset:2048 sc1 lds
s_lshl_b32 s62, s30, 11
s_add_u32 s61, s61, s62
MM a[4:7],v[76:79],v[132:135],a[4:7]
ds_read_b128 v[148:151], v17 offset:36864
s_add_u32 s62, s61, 8192
s_add_u32 s63, s61, 16384
MM a[4:7],v[72:75],v[128:131],a[4:7]
buffer_load_dwordx4 v15, s[44:47], s57 offen offset:3072 sc1 lds
s_cmp_lt_u32 s30, 2
s_cselect_b32 s63, s63, 0x20000000
s_waitcnt lgkmcnt(15)
MM a[8:11],v[80:83],v[128:131],a[8:11]
s_add_u32 s57, s57, 524288
s_mov_b32 s16, 2097152
MM a[8:11],v[84:87],v[132:135],a[8:11]
buffer_load_dword v240, v48, s[36:39], 0 offen offset:512
MM a[12:15],v[92:95],v[132:135],a[12:15]
MM a[12:15],v[88:91],v[128:131],a[12:15]
buffer_load_dword v241, v49, s[40:43], s16 offen
s_waitcnt lgkmcnt(10)
MM a[16:19],v[128:131],v[96:99],a[16:19]
MM a[16:19],v[132:135],v[100:103],a[16:19]
buffer_load_dword v242, v49, s[44:47], s16 offen
MM a[20:23],v[132:135],v[108:111],a[20:23]
MM a[20:23],v[128:131],v[104:107],a[20:23]
s_waitcnt lgkmcnt(2)
MM a[24:27],v[128:131],v[112:115],a[24:27]
MM a[24:27],v[132:135],v[116:119],a[24:27]
MM a[28:31],v[132:135],v[124:127],a[28:31]
MM a[28:31],v[128:131],v[120:123],a[28:31]
s_waitcnt lgkmcnt(15)
MM a[32:35],v[64:67],v[136:139],a[32:35]
ds_read_b128 v[152:155], v16 offset:38912
MM a[32:35],v[68:71],v[140:143],a[32:35]
MM a[36:39],v[76:79],v[140:143],a[36:39]
ds_read_b128 v[156:159], v17 offset:38912
MM a[36:39],v[72:75],v[136:139],a[36:39]
MM a[40:43],v[80:83],v[136:139],a[40:43]
MM a[40:43],v[84:87],v[140:143],a[40:43]
MM a[44:47],v[92:95],v[140:143],a[44:47]
MM a[44:47],v[88:91],v[136:139],a[44:47]
MM a[48:51],v[136:139],v[96:99],a[48:51]
MM a[48:51],v[140:143],v[100:103],a[48:51]
MM a[52:55],v[140:143],v[108:111],a[52:55]
MM a[52:55],v[136:139],v[104:107],a[52:55]
MM a[56:59],v[136:139],v[112:115],a[56:59]
MM a[56:59],v[140:143],v[116:119],a[56:59]
MM a[60:63],v[140:143],v[124:127],a[60:63]
MM a[60:63],v[136:139],v[120:123],a[60:63]
s_waitcnt lgkmcnt(2)
MM a[64:67],v[64:67],v[144:147],a[64:67]
ds_read_b128 v[160:163], v16 offset:40960
MM a[64:67],v[68:71],v[148:151],a[64:67]
MM a[68:71],v[76:79],v[148:151],a[68:71]
ds_read_b128 v[164:167], v17 offset:40960
MM a[68:71],v[72:75],v[144:147],a[68:71]
MM a[72:75],v[80:83],v[144:147],a[72:75]
MM a[72:75],v[84:87],v[148:151],a[72:75]
MM a[76:79],v[92:95],v[148:151],a[76:79]
MM a[76:79],v[88:91],v[144:147],a[76:79]
MM a[80:83],v[144:147],v[96:99],a[80:83]
MM a[80:83],v[148:151],v[100:103],a[80:83]
MM a[84:87],v[148:151],v[108:111],a[84:87]
MM a[84:87],v[144:147],v[104:107],a[84:87]
MM a[88:91],v[144:147],v[112:115],a[88:91]
MM a[88:91],v[148:151],v[116:119],a[88:91]
MM a[92:95],v[148:151],v[124:127],a[92:95]
MM a[92:95],v[144:147],v[120:123],a[92:95]
s_waitcnt lgkmcnt(2)
MM a[96:99],v[64:67],v[152:155],a[96:99]
ds_read_b128 v[168:171], v16 offset:43008
MM a[96:99],v[68:71],v[156:159],a[96:99]
MM a[100:103],v[76:79],v[156:159],a[100:103]
ds_read_b128 v[172:175], v17 offset:43008
MM a[100:103],v[72:75],v[152:155],a[100:103]
MM a[104:107],v[80:83],v[152:155],a[104:107]
MM a[104:107],v[84:87],v[156:159],a[104:107]
MM a[108:111],v[92:95],v[156:159],a[108:111]
MM a[108:111],v[88:91],v[152:155],a[108:111]
MM a[112:115],v[152:155],v[96:99],a[112:115]
MM a[112:115],v[156:159],v[100:103],a[112:115]
MM a[116:119],v[156:159],v[108:111],a[116:119]
MM a[116:119],v[152:155],v[104:107],a[116:119]
MM a[120:123],v[152:155],v[112:115],a[120:123]
MM a[120:123],v[156:159],v[116:119],a[120:123]
MM a[124:127],v[156:159],v[124:127],a[124:127]
MM a[124:127],v[152:155],v[120:123],a[124:127]
s_waitcnt lgkmcnt(2)
MM a[192:195],v[64:67],v[160:163],a[192:195]
ds_read_b128 v[176:179], v16 offset:45056
MM a[192:195],v[68:71],v[164:167],a[192:195]
MM a[196:199],v[76:79],v[164:167],a[196:199]
ds_read_b128 v[180:183], v17 offset:45056
MM a[196:199],v[72:75],v[160:163],a[196:199]
MM a[200:203],v[80:83],v[160:163],a[200:203]
MM a[200:203],v[84:87],v[164:167],a[200:203]
MM a[204:207],v[92:95],v[164:167],a[204:207]
MM a[204:207],v[88:91],v[160:163],a[204:207]
MM a[208:211],v[160:163],v[96:99],a[208:211]
MM a[208:211],v[164:167],v[100:103],a[208:211]
MM a[212:215],v[164:167],v[108:111],a[212:215]
MM a[212:215],v[160:163],v[104:107],a[212:215]
MM a[216:219],v[160:163],v[112:115],a[216:219]
MM a[216:219],v[164:167],v[116:119],a[216:219]
MM a[220:223],v[164:167],v[124:127],a[220:223]
MM a[220:223],v[160:163],v[120:123],a[220:223]
s_waitcnt lgkmcnt(2)
MM a[224:227],v[64:67],v[168:171],a[224:227]
ds_read_b128 v[184:187], v16 offset:47104
MM a[224:227],v[68:71],v[172:175],a[224:227]
MM a[228:231],v[76:79],v[172:175],a[228:231]
ds_read_b128 v[188:191], v17 offset:47104
MM a[228:231],v[72:75],v[168:171],a[228:231]
MM a[232:235],v[80:83],v[168:171],a[232:235]
MM a[232:235],v[84:87],v[172:175],a[232:235]
MM a[236:239],v[92:95],v[172:175],a[236:239]
MM a[236:239],v[88:91],v[168:171],a[236:239]
MM a[240:243],v[168:171],v[96:99],a[240:243]
MM a[240:243],v[172:175],v[100:103],a[240:243]
MM a[244:247],v[172:175],v[108:111],a[244:247]
MM a[244:247],v[168:171],v[104:107],a[244:247]
MM a[248:251],v[168:171],v[112:115],a[248:251]
MM a[248:251],v[172:175],v[116:119],a[248:251]
MM a[252:255],v[172:175],v[124:127],a[252:255]
MM a[252:255],v[168:171],v[120:123],a[252:255]
s_waitcnt vmcnt(3) lgkmcnt(0)
s_barrier
MM a[128:131],v[64:67],v[176:179],a[128:131]
ds_read_b128 v[192:195], v225 offset:0
MM a[128:131],v[68:71],v[180:183],a[128:131]
s_add_u32 m0, s58, 32768
s_add_u32 s60, s56, 32768
MM a[160:163],v[68:71],v[188:191],a[160:163]
ds_read_b128 v[196:199], v225 offset:4096
MM a[160:163],v[64:67],v[184:187],a[160:163]
buffer_load_dwordx4 v8, s[36:39], s56 offen offset:0 sc1 lds
MM a[132:135],v[72:75],v[176:179],a[132:135]
ds_read_b64_tr_b16 v[64:65], v18 offset:0
ds_read_b128 v[200:203], v225 offset:8192
MM a[132:135],v[76:79],v[180:183],a[132:135]
ds_read_b64_tr_b16 v[66:67], v18 offset:1024
buffer_load_dwordx4 v9, s[36:39], s56 offen offset:1024 sc1 lds
MM a[164:167],v[76:79],v[188:191],a[164:167]
ds_read_b64_tr_b16 v[68:69], v18 offset:8192
ds_read_b128 v[128:131], v16 offset:0
MM a[164:167],v[72:75],v[184:187],a[164:167]
ds_read_b64_tr_b16 v[70:71], v18 offset:9216
buffer_load_dwordx4 v10, s[36:39], s56 offen offset:2048 sc1 lds
MM a[136:139],v[80:83],v[176:179],a[136:139]
ds_read_b64_tr_b16 v[72:73], v19 offset:0
ds_read_b128 v[132:135], v17 offset:0
MM a[136:139],v[84:87],v[180:183],a[136:139]
ds_read_b64_tr_b16 v[74:75], v19 offset:1024
buffer_load_dwordx4 v11, s[36:39], s56 offen offset:3072 sc1 lds
MM a[168:171],v[84:87],v[188:191],a[168:171]
ds_read_b64_tr_b16 v[76:77], v19 offset:8192
s_add_u32 m0, s59, 32768
MM a[168:171],v[80:83],v[184:187],a[168:171]
ds_read_b64_tr_b16 v[78:79], v19 offset:9216
s_add_u32 s56, s56, 128
MM a[140:143],v[88:91],v[176:179],a[140:143]
ds_read_b64_tr_b16 v[80:81], v20 offset:0
buffer_load_dwordx4 v12, s[40:43], s57 offen offset:0 sc1 lds
MM a[140:143],v[92:95],v[180:183],a[140:143]
ds_read_b64_tr_b16 v[82:83], v20 offset:1024
MM a[172:175],v[92:95],v[188:191],a[172:175]
ds_read_b64_tr_b16 v[84:85], v20 offset:8192
buffer_load_dwordx4 v13, s[40:43], s57 offen offset:1024 sc1 lds
MM a[172:175],v[88:91],v[184:187],a[172:175]
ds_read_b64_tr_b16 v[86:87], v20 offset:9216
MM a[144:147],v[176:179],v[96:99],a[144:147]
ds_read_b64_tr_b16 v[88:89], v21 offset:0
ds_read_b128 v[136:139], v16 offset:2048
MM a[144:147],v[180:183],v[100:103],a[144:147]
ds_read_b64_tr_b16 v[90:91], v21 offset:1024
buffer_load_dwordx4 v14, s[40:43], s57 offen offset:2048 sc1 lds
MM a[176:179],v[188:191],v[100:103],a[176:179]
ds_read_b64_tr_b16 v[92:93], v21 offset:8192
ds_read_b128 v[140:143], v17 offset:2048
MM a[176:179],v[184:187],v[96:99],a[176:179]
ds_read_b64_tr_b16 v[94:95], v21 offset:9216
buffer_load_dwordx4 v15, s[40:43], s57 offen offset:3072 sc1 lds
MM a[148:151],v[176:179],v[104:107],a[148:151]
ds_read_b64_tr_b16 v[96:97], v18 offset:16384
s_add_u32 m0, s58, 36864
MM a[148:151],v[180:183],v[108:111],a[148:151]
ds_read_b64_tr_b16 v[98:99], v18 offset:17408
buffer_load_dwordx4 v8, s[36:39], s60 offen offset:0 sc1 lds
MM a[180:183],v[188:191],v[108:111],a[180:183]
ds_read_b64_tr_b16 v[100:101], v18 offset:24576
MM a[180:183],v[184:187],v[104:107],a[180:183]
ds_read_b64_tr_b16 v[102:103], v18 offset:25600
buffer_load_dwordx4 v9, s[36:39], s60 offen offset:1024 sc1 lds
MM a[152:155],v[176:179],v[112:115],a[152:155]
ds_read_b64_tr_b16 v[104:105], v19 offset:16384
MM a[152:155],v[180:183],v[116:119],a[152:155]
ds_read_b64_tr_b16 v[106:107], v19 offset:17408
buffer_load_dwordx4 v10, s[36:39], s60 offen offset:2048 sc1 lds
MM a[184:187],v[188:191],v[116:119],a[184:187]
ds_read_b64_tr_b16 v[108:109], v19 offset:24576
MM a[184:187],v[184:187],v[112:115],a[184:187]
ds_read_b64_tr_b16 v[110:111], v19 offset:25600
buffer_load_dwordx4 v11, s[36:39], s60 offen offset:3072 sc1 lds
MM a[156:159],v[176:179],v[120:123],a[156:159]
ds_read_b64_tr_b16 v[112:113], v20 offset:16384
s_add_u32 m0, s59, 49152
MM a[156:159],v[180:183],v[124:127],a[156:159]
ds_read_b64_tr_b16 v[114:115], v20 offset:17408
buffer_load_dwordx4 v12, s[44:47], s57 offen offset:0 sc1 lds
MM a[188:191],v[188:191],v[124:127],a[188:191]
ds_read_b64_tr_b16 v[116:117], v20 offset:24576
MM a[188:191],v[184:187],v[120:123],a[188:191]
ds_read_b64_tr_b16 v[118:119], v20 offset:25600
buffer_load_dwordx4 v13, s[44:47], s57 offen offset:1024 sc1 lds
ds_read_b64_tr_b16 v[120:121], v21 offset:16384
ds_read_b64_tr_b16 v[122:123], v21 offset:17408
ds_read_b64_tr_b16 v[124:125], v21 offset:24576
ds_read_b64_tr_b16 v[126:127], v21 offset:25600
s_waitcnt lgkmcnt(15)
MM a[0:3],v[64:67],v[128:131],a[0:3]
ds_read_b128 v[144:147], v16 offset:4096
MM a[0:3],v[68:71],v[132:135],a[0:3]
MM a[4:7],v[76:79],v[132:135],a[4:7]
ds_read_b128 v[148:151], v17 offset:4096
MM a[4:7],v[72:75],v[128:131],a[4:7]
buffer_load_dwordx4 v14, s[44:47], s57 offen offset:2048 sc1 lds
s_waitcnt lgkmcnt(15)
MM a[8:11],v[80:83],v[128:131],a[8:11]
MM a[8:11],v[84:87],v[132:135],a[8:11]
MM a[12:15],v[92:95],v[132:135],a[12:15]
MM a[12:15],v[88:91],v[128:131],a[12:15]
buffer_load_dwordx4 v15, s[44:47], s57 offen offset:3072 sc1 lds
s_add_u32 s57, s57, 524288
s_waitcnt lgkmcnt(10)
MM a[16:19],v[128:131],v[96:99],a[16:19]
s_mov_b32 s16, 3145728
MM a[16:19],v[132:135],v[100:103],a[16:19]
MM a[20:23],v[132:135],v[108:111],a[20:23]
MM a[20:23],v[128:131],v[104:107],a[20:23]
buffer_load_dword v240, v48, s[36:39], 0 offen offset:768
s_waitcnt lgkmcnt(2)
MM a[24:27],v[128:131],v[112:115],a[24:27]
MM a[24:27],v[132:135],v[116:119],a[24:27]
MM a[28:31],v[132:135],v[124:127],a[28:31]
MM a[28:31],v[128:131],v[120:123],a[28:31]
buffer_load_dword v241, v49, s[40:43], s16 offen
s_waitcnt lgkmcnt(15)
MM a[32:35],v[64:67],v[136:139],a[32:35]
ds_read_b128 v[152:155], v16 offset:6144
MM a[32:35],v[68:71],v[140:143],a[32:35]
MM a[36:39],v[76:79],v[140:143],a[36:39]
ds_read_b128 v[156:159], v17 offset:6144
MM a[36:39],v[72:75],v[136:139],a[36:39]
buffer_load_dword v242, v49, s[44:47], s16 offen
MM a[40:43],v[80:83],v[136:139],a[40:43]
MM a[40:43],v[84:87],v[140:143],a[40:43]
MM a[44:47],v[92:95],v[140:143],a[44:47]
MM a[44:47],v[88:91],v[136:139],a[44:47]
MM a[48:51],v[136:139],v[96:99],a[48:51]
MM a[48:51],v[140:143],v[100:103],a[48:51]
MM a[52:55],v[140:143],v[108:111],a[52:55]
MM a[52:55],v[136:139],v[104:107],a[52:55]
MM a[56:59],v[136:139],v[112:115],a[56:59]
MM a[56:59],v[140:143],v[116:119],a[56:59]
MM a[60:63],v[140:143],v[124:127],a[60:63]
MM a[60:63],v[136:139],v[120:123],a[60:63]
s_waitcnt lgkmcnt(2)
MM a[64:67],v[64:67],v[144:147],a[64:67]
ds_read_b128 v[160:163], v16 offset:8192
MM a[64:67],v[68:71],v[148:151],a[64:67]
buffer_store_dwordx4 v[192:195], v226, s[32:35], s61 offen sc0 sc1
MM a[68:71],v[76:79],v[148:151],a[68:71]
ds_read_b128 v[164:167], v17 offset:8192
MM a[68:71],v[72:75],v[144:147],a[68:71]
MM a[72:75],v[80:83],v[144:147],a[72:75]
MM a[72:75],v[84:87],v[148:151],a[72:75]
buffer_store_dwordx4 v[196:199], v226, s[32:35], s62 offen sc0 sc1
MM a[76:79],v[92:95],v[148:151],a[76:79]
MM a[76:79],v[88:91],v[144:147],a[76:79]
MM a[80:83],v[144:147],v[96:99],a[80:83]
MM a[80:83],v[148:151],v[100:103],a[80:83]
buffer_store_dwordx4 v[200:203], v226, s[32:35], s63 offen sc0 sc1
MM a[84:87],v[148:151],v[108:111],a[84:87]
MM a[84:87],v[144:147],v[104:107],a[84:87]
MM a[88:91],v[144:147],v[112:115],a[88:91]
MM a[88:91],v[148:151],v[116:119],a[88:91]
MM a[92:95],v[148:151],v[124:127],a[92:95]
MM a[92:95],v[144:147],v[120:123],a[92:95]
s_waitcnt lgkmcnt(2)
MM a[96:99],v[64:67],v[152:155],a[96:99]
ds_read_b128 v[168:171], v16 offset:10240
MM a[96:99],v[68:71],v[156:159],a[96:99]
MM a[100:103],v[76:79],v[156:159],a[100:103]
ds_read_b128 v[172:175], v17 offset:10240
MM a[100:103],v[72:75],v[152:155],a[100:103]
MM a[104:107],v[80:83],v[152:155],a[104:107]
MM a[104:107],v[84:87],v[156:159],a[104:107]
MM a[108:111],v[92:95],v[156:159],a[108:111]
MM a[108:111],v[88:91],v[152:155],a[108:111]
MM a[112:115],v[152:155],v[96:99],a[112:115]
MM a[112:115],v[156:159],v[100:103],a[112:115]
MM a[116:119],v[156:159],v[108:111],a[116:119]
MM a[116:119],v[152:155],v[104:107],a[116:119]
MM a[120:123],v[152:155],v[112:115],a[120:123]
MM a[120:123],v[156:159],v[116:119],a[120:123]
MM a[124:127],v[156:159],v[124:127],a[124:127]
MM a[124:127],v[152:155],v[120:123],a[124:127]
s_waitcnt lgkmcnt(2)
MM a[192:195],v[64:67],v[160:163],a[192:195]
ds_read_b128 v[176:179], v16 offset:12288
MM a[192:195],v[68:71],v[164:167],a[192:195]
MM a[196:199],v[76:79],v[164:167],a[196:199]
ds_read_b128 v[180:183], v17 offset:12288
MM a[196:199],v[72:75],v[160:163],a[196:199]
MM a[200:203],v[80:83],v[160:163],a[200:203]
MM a[200:203],v[84:87],v[164:167],a[200:203]
MM a[204:207],v[92:95],v[164:167],a[204:207]
MM a[204:207],v[88:91],v[160:163],a[204:207]
MM a[208:211],v[160:163],v[96:99],a[208:211]
MM a[208:211],v[164:167],v[100:103],a[208:211]
MM a[212:215],v[164:167],v[108:111],a[212:215]
MM a[212:215],v[160:163],v[104:107],a[212:215]
MM a[216:219],v[160:163],v[112:115],a[216:219]
MM a[216:219],v[164:167],v[116:119],a[216:219]
MM a[220:223],v[164:167],v[124:127],a[220:223]
MM a[220:223],v[160:163],v[120:123],a[220:223]
s_waitcnt lgkmcnt(2)
MM a[224:227],v[64:67],v[168:171],a[224:227]
ds_read_b128 v[184:187], v16 offset:14336
MM a[224:227],v[68:71],v[172:175],a[224:227]
MM a[228:231],v[76:79],v[172:175],a[228:231]
ds_read_b128 v[188:191], v17 offset:14336
MM a[228:231],v[72:75],v[168:171],a[228:231]
MM a[232:235],v[80:83],v[168:171],a[232:235]
MM a[232:235],v[84:87],v[172:175],a[232:235]
MM a[236:239],v[92:95],v[172:175],a[236:239]
MM a[236:239],v[88:91],v[168:171],a[236:239]
MM a[240:243],v[168:171],v[96:99],a[240:243]
MM a[240:243],v[172:175],v[100:103],a[240:243]
MM a[244:247],v[172:175],v[108:111],a[244:247]
MM a[244:247],v[168:171],v[104:107],a[244:247]
MM a[248:251],v[168:171],v[112:115],a[248:251]
MM a[248:251],v[172:175],v[116:119],a[248:251]
MM a[252:255],v[172:175],v[124:127],a[252:255]
MM a[252:255],v[168:171],v[120:123],a[252:255]
s_waitcnt vmcnt(6) lgkmcnt(0)
s_barrier
MM a[128:131],v[64:67],v[176:179],a[128:131]
ds_read_b128 v[128:131], v16 offset:32768
MM a[128:131],v[68:71],v[180:183],a[128:131]
s_add_u32 m0, s58, 0
s_add_u32 s60, s56, 32768
MM a[160:163],v[68:71],v[188:191],a[160:163]
ds_read_b128 v[132:135], v17 offset:32768
MM a[160:163],v[64:67],v[184:187],a[160:163]
buffer_load_dwordx4 v8, s[36:39], s56 offen offset:0 sc1 lds
MM a[132:135],v[72:75],v[176:179],a[132:135]
ds_read_b64_tr_b16 v[64:65], v18 offset:32768
MM a[132:135],v[76:79],v[180:183],a[132:135]
ds_read_b64_tr_b16 v[66:67], v18 offset:33792
MM a[164:167],v[76:79],v[188:191],a[164:167]
ds_read_b64_tr_b16 v[68:69], v18 offset:40960
MM a[164:167],v[72:75],v[184:187],a[164:167]
ds_read_b64_tr_b16 v[70:71], v18 offset:41984
buffer_load_dwordx4 v9, s[36:39], s56 offen offset:1024 sc1 lds
MM a[136:139],v[80:83],v[176:179],a[136:139]
ds_read_b64_tr_b16 v[72:73], v19 offset:32768
MM a[136:139],v[84:87],v[180:183],a[136:139]
ds_read_b64_tr_b16 v[74:75], v19 offset:33792
MM a[168:171],v[84:87],v[188:191],a[168:171]
ds_read_b64_tr_b16 v[76:77], v19 offset:40960
MM a[168:171],v[80:83],v[184:187],a[168:171]
ds_read_b64_tr_b16 v[78:79], v19 offset:41984
buffer_load_dwordx4 v10, s[36:39], s56 offen offset:2048 sc1 lds
MM a[140:143],v[88:91],v[176:179],a[140:143]
ds_read_b64_tr_b16 v[80:81], v20 offset:32768
MM a[140:143],v[92:95],v[180:183],a[140:143]
ds_read_b64_tr_b16 v[82:83], v20 offset:33792
MM a[172:175],v[92:95],v[188:191],a[172:175]
ds_read_b64_tr_b16 v[84:85], v20 offset:40960
MM a[172:175],v[88:91],v[184:187],a[172:175]
ds_read_b64_tr_b16 v[86:87], v20 offset:41984
buffer_load_dwordx4 v11, s[36:39], s56 offen offset:3072 sc1 lds
MM a[144:147],v[176:179],v[96:99],a[144:147]
ds_read_b64_tr_b16 v[88:89], v21 offset:32768
ds_read_b128 v[136:139], v16 offset:34816
MM a[144:147],v[180:183],v[100:103],a[144:147]
ds_read_b64_tr_b16 v[90:91], v21 offset:33792
s_add_u32 m0, s59, 0
MM a[176:179],v[188:191],v[100:103],a[176:179]
ds_read_b64_tr_b16 v[92:93], v21 offset:40960
ds_read_b128 v[140:143], v17 offset:34816
MM a[176:179],v[184:187],v[96:99],a[176:179]
ds_read_b64_tr_b16 v[94:95], v21 offset:41984
s_add_u32 s56, s56, 128
MM a[148:151],v[176:179],v[104:107],a[148:151]
ds_read_b64_tr_b16 v[96:97], v18 offset:49152
buffer_load_dwordx4 v12, s[40:43], s57 offen offset:0 sc1 lds
MM a[148:151],v[180:183],v[108:111],a[148:151]
ds_read_b64_tr_b16 v[98:99], v18 offset:50176
MM a[180:183],v[188:191],v[108:111],a[180:183]
ds_read_b64_tr_b16 v[100:101], v18 offset:57344
MM a[180:183],v[184:187],v[104:107],a[180:183]
ds_read_b64_tr_b16 v[102:103], v18 offset:58368
MM a[152:155],v[176:179],v[112:115],a[152:155]
ds_read_b64_tr_b16 v[104:105], v19 offset:49152
buffer_load_dwordx4 v13, s[40:43], s57 offen offset:1024 sc1 lds
MM a[152:155],v[180:183],v[116:119],a[152:155]
ds_read_b64_tr_b16 v[106:107], v19 offset:50176
MM a[184:187],v[188:191],v[116:119],a[184:187]
ds_read_b64_tr_b16 v[108:109], v19 offset:57344
MM a[184:187],v[184:187],v[112:115],a[184:187]
ds_read_b64_tr_b16 v[110:111], v19 offset:58368
MM a[156:159],v[176:179],v[120:123],a[156:159]
ds_read_b64_tr_b16 v[112:113], v20 offset:49152
buffer_load_dwordx4 v14, s[40:43], s57 offen offset:2048 sc1 lds
MM a[156:159],v[180:183],v[124:127],a[156:159]
ds_read_b64_tr_b16 v[114:115], v20 offset:50176
MM a[188:191],v[188:191],v[124:127],a[188:191]
ds_read_b64_tr_b16 v[116:117], v20 offset:57344
MM a[188:191],v[184:187],v[120:123],a[188:191]
ds_read_b64_tr_b16 v[118:119], v20 offset:58368
ds_read_b64_tr_b16 v[120:121], v21 offset:49152
ds_read_b64_tr_b16 v[122:123], v21 offset:50176
ds_read_b64_tr_b16 v[124:125], v21 offset:57344
ds_read_b64_tr_b16 v[126:127], v21 offset:58368
s_waitcnt lgkmcnt(15)
MM a[0:3],v[64:67],v[128:131],a[0:3]
ds_read_b128 v[144:147], v16 offset:36864
MM a[0:3],v[68:71],v[132:135],a[0:3]
buffer_load_dwordx4 v15, s[40:43], s57 offen offset:3072 sc1 lds
s_add_u32 m0, s58, 4096
MM a[4:7],v[76:79],v[132:135],a[4:7]
ds_read_b128 v[148:151], v17 offset:36864
MM a[4:7],v[72:75],v[128:131],a[4:7]
s_waitcnt lgkmcnt(15)
MM a[8:11],v[80:83],v[128:131],a[8:11]
MM a[8:11],v[84:87],v[132:135],a[8:11]
buffer_load_dwordx4 v8, s[36:39], s60 offen offset:0 sc1 lds
MM a[12:15],v[92:95],v[132:135],a[12:15]
MM a[12:15],v[88:91],v[128:131],a[12:15]
s_waitcnt lgkmcnt(10)
MM a[16:19],v[128:131],v[96:99],a[16:19]
MM a[16:19],v[132:135],v[100:103],a[16:19]
buffer_load_dwordx4 v9, s[36:39], s60 offen offset:1024 sc1 lds
MM a[20:23],v[132:135],v[108:111],a[20:23]
MM a[20:23],v[128:131],v[104:107],a[20:23]
s_waitcnt lgkmcnt(2)
MM a[24:27],v[128:131],v[112:115],a[24:27]
MM a[24:27],v[132:135],v[116:119],a[24:27]
buffer_load_dwordx4 v10, s[36:39], s60 offen offset:2048 sc1 lds
MM a[28:31],v[132:135],v[124:127],a[28:31]
MM a[28:31],v[128:131],v[120:123],a[28:31]
s_waitcnt lgkmcnt(15)
MM a[32:35],v[64:67],v[136:139],a[32:35]
ds_read_b128 v[152:155], v16 offset:38912
MM a[32:35],v[68:71],v[140:143],a[32:35]
buffer_load_dwordx4 v11, s[36:39], s60 offen offset:3072 sc1 lds
s_add_u32 m0, s59, 16384
MM a[36:39],v[76:79],v[140:143],a[36:39]
ds_read_b128 v[156:159], v17 offset:38912
MM a[36:39],v[72:75],v[136:139],a[36:39]
MM a[40:43],v[80:83],v[136:139],a[40:43]
MM a[40:43],v[84:87],v[140:143],a[40:43]
buffer_load_dwordx4 v12, s[44:47], s57 offen offset:0 sc1 lds
MM a[44:47],v[92:95],v[140:143],a[44:47]
MM a[44:47],v[88:91],v[136:139],a[44:47]
MM a[48:51],v[136:139],v[96:99],a[48:51]
MM a[48:51],v[140:143],v[100:103],a[48:51]
buffer_load_dwordx4 v13, s[44:47], s57 offen offset:1024 sc1 lds
MM a[52:55],v[140:143],v[108:111],a[52:55]
MM a[52:55],v[136:139],v[104:107],a[52:55]
MM a[56:59],v[136:139],v[112:115],a[56:59]
MM a[56:59],v[140:143],v[116:119],a[56:59]
buffer_load_dwordx4 v14, s[44:47], s57 offen offset:2048 sc1 lds
MM a[60:63],v[140:143],v[124:127],a[60:63]
MM a[60:63],v[136:139],v[120:123],a[60:63]
s_waitcnt lgkmcnt(2)
MM a[64:67],v[64:67],v[144:147],a[64:67]
ds_read_b128 v[160:163], v16 offset:40960
MM a[64:67],v[68:71],v[148:151],a[64:67]
buffer_load_dwordx4 v15, s[44:47], s57 offen offset:3072 sc1 lds
s_add_u32 s57, s57, 524288
MM a[68:71],v[76:79],v[148:151],a[68:71]
ds_read_b128 v[164:167], v17 offset:40960
MM a[68:71],v[72:75],v[144:147],a[68:71]
MM a[72:75],v[80:83],v[144:147],a[72:75]
MM a[72:75],v[84:87],v[148:151],a[72:75]
global_load_dword v240, v53, s[8:9]
MM a[76:79],v[92:95],v[148:151],a[76:79]
MM a[76:79],v[88:91],v[144:147],a[76:79]
MM a[80:83],v[144:147],v[96:99],a[80:83]
MM a[80:83],v[148:151],v[100:103],a[80:83]
MM a[84:87],v[148:151],v[108:111],a[84:87]
MM a[84:87],v[144:147],v[104:107],a[84:87]
MM a[88:91],v[144:147],v[112:115],a[88:91]
MM a[88:91],v[148:151],v[116:119],a[88:91]
MM a[92:95],v[148:151],v[124:127],a[92:95]
MM a[92:95],v[144:147],v[120:123],a[92:95]
s_waitcnt lgkmcnt(2)
MM a[96:99],v[64:67],v[152:155],a[96:99]
ds_read_b128 v[168:171], v16 offset:43008
MM a[96:99],v[68:71],v[156:159],a[96:99]
MM a[100:103],v[76:79],v[156:159],a[100:103]
ds_read_b128 v[172:175], v17 offset:43008
MM a[100:103],v[72:75],v[152:155],a[100:103]
MM a[104:107],v[80:83],v[152:155],a[104:107]
MM a[104:107],v[84:87],v[156:159],a[104:107]
MM a[108:111],v[92:95],v[156:159],a[108:111]
MM a[108:111],v[88:91],v[152:155],a[108:111]
MM a[112:115],v[152:155],v[96:99],a[112:115]
MM a[112:115],v[156:159],v[100:103],a[112:115]
MM a[116:119],v[156:159],v[108:111],a[116:119]
MM a[116:119],v[152:155],v[104:107],a[116:119]
MM a[120:123],v[152:155],v[112:115],a[120:123]
MM a[120:123],v[156:159],v[116:119],a[120:123]
MM a[124:127],v[156:159],v[124:127],a[124:127]
MM a[124:127],v[152:155],v[120:123],a[124:127]
s_waitcnt lgkmcnt(2)
MM a[192:195],v[64:67],v[160:163],a[192:195]
ds_read_b128 v[176:179], v16 offset:45056
MM a[192:195],v[68:71],v[164:167],a[192:195]
MM a[196:199],v[76:79],v[164:167],a[196:199]
ds_read_b128 v[180:183], v17 offset:45056
MM a[196:199],v[72:75],v[160:163],a[196:199]
MM a[200:203],v[80:83],v[160:163],a[200:203]
MM a[200:203],v[84:87],v[164:167],a[200:203]
MM a[204:207],v[92:95],v[164:167],a[204:207]
MM a[204:207],v[88:91],v[160:163],a[204:207]
MM a[208:211],v[160:163],v[96:99],a[208:211]
MM a[208:211],v[164:167],v[100:103],a[208:211]
MM a[212:215],v[164:167],v[108:111],a[212:215]
MM a[212:215],v[160:163],v[104:107],a[212:215]
MM a[216:219],v[160:163],v[112:115],a[216:219]
MM a[216:219],v[164:167],v[116:119],a[216:219]
MM a[220:223],v[164:167],v[124:127],a[220:223]
MM a[220:223],v[160:163],v[120:123],a[220:223]
s_waitcnt lgkmcnt(2)
MM a[224:227],v[64:67],v[168:171],a[224:227]
ds_read_b128 v[184:187], v16 offset:47104
MM a[224:227],v[68:71],v[172:175],a[224:227]
MM a[228:231],v[76:79],v[172:175],a[228:231]
ds_read_b128 v[188:191], v17 offset:47104
MM a[228:231],v[72:75],v[168:171],a[228:231]
MM a[232:235],v[80:83],v[168:171],a[232:235]
MM a[232:235],v[84:87],v[172:175],a[232:235]
MM a[236:239],v[92:95],v[172:175],a[236:239]
MM a[236:239],v[88:91],v[168:171],a[236:239]
MM a[240:243],v[168:171],v[96:99],a[240:243]
MM a[240:243],v[172:175],v[100:103],a[240:243]
MM a[244:247],v[172:175],v[108:111],a[244:247]
MM a[244:247],v[168:171],v[104:107],a[244:247]
MM a[248:251],v[168:171],v[112:115],a[248:251]
MM a[248:251],v[172:175],v[116:119],a[248:251]
MM a[252:255],v[172:175],v[124:127],a[252:255]
MM a[252:255],v[168:171],v[120:123],a[252:255]
s_waitcnt vmcnt(1) lgkmcnt(0)
s_barrier
MM a[128:131],v[64:67],v[176:179],a[128:131]
ds_read_b128 v[128:131], v16 offset:0
MM a[128:131],v[68:71],v[180:183],a[128:131]
buffer_store_dword v61, v60, s[32:35], s26 offen sc0 sc1
s_add_u32 m0, s58, 32768
MM a[160:163],v[68:71],v[188:191],a[160:163]
ds_read_b128 v[132:135], v17 offset:0
MM a[160:163],v[64:67],v[184:187],a[160:163]
s_add_u32 s60, s56, 32768
MM a[132:135],v[72:75],v[176:179],a[132:135]
ds_read_b64_tr_b16 v[64:65], v18 offset:0
MM a[132:135],v[76:79],v[180:183],a[132:135]
ds_read_b64_tr_b16 v[66:67], v18 offset:1024
buffer_load_dwordx4 v8, s[36:39], s56 offen offset:0 sc1 lds
MM a[164:167],v[76:79],v[188:191],a[164:167]
ds_read_b64_tr_b16 v[68:69], v18 offset:8192
MM a[164:167],v[72:75],v[184:187],a[164:167]
ds_read_b64_tr_b16 v[70:71], v18 offset:9216
MM a[136:139],v[80:83],v[176:179],a[136:139]
ds_read_b64_tr_b16 v[72:73], v19 offset:0
MM a[136:139],v[84:87],v[180:183],a[136:139]
ds_read_b64_tr_b16 v[74:75], v19 offset:1024
buffer_load_dwordx4 v9, s[36:39], s56 offen offset:1024 sc1 lds
MM a[168:171],v[84:87],v[188:191],a[168:171]
ds_read_b64_tr_b16 v[76:77], v19 offset:8192
MM a[168:171],v[80:83],v[184:187],a[168:171]
ds_read_b64_tr_b16 v[78:79], v19 offset:9216
MM a[140:143],v[88:91],v[176:179],a[140:143]
ds_read_b64_tr_b16 v[80:81], v20 offset:0
MM a[140:143],v[92:95],v[180:183],a[140:143]
ds_read_b64_tr_b16 v[82:83], v20 offset:1024
buffer_load_dwordx4 v10, s[36:39], s56 offen offset:2048 sc1 lds
MM a[172:175],v[92:95],v[188:191],a[172:175]
ds_read_b64_tr_b16 v[84:85], v20 offset:8192
MM a[172:175],v[88:91],v[184:187],a[172:175]
ds_read_b64_tr_b16 v[86:87], v20 offset:9216
MM a[144:147],v[176:179],v[96:99],a[144:147]
ds_read_b64_tr_b16 v[88:89], v21 offset:0
ds_read_b128 v[136:139], v16 offset:2048
MM a[144:147],v[180:183],v[100:103],a[144:147]
ds_read_b64_tr_b16 v[90:91], v21 offset:1024
buffer_load_dwordx4 v11, s[36:39], s56 offen offset:3072 sc1 lds
MM a[176:179],v[188:191],v[100:103],a[176:179]
ds_read_b64_tr_b16 v[92:93], v21 offset:8192
ds_read_b128 v[140:143], v17 offset:2048
MM a[176:179],v[184:187],v[96:99],a[176:179]
ds_read_b64_tr_b16 v[94:95], v21 offset:9216
s_add_u32 m0, s59, 32768
MM a[148:151],v[176:179],v[104:107],a[148:151]
ds_read_b64_tr_b16 v[96:97], v18 offset:16384
s_add_u32 s56, s56, 128
MM a[148:151],v[180:183],v[108:111],a[148:151]
ds_read_b64_tr_b16 v[98:99], v18 offset:17408
buffer_load_dwordx4 v12, s[40:43], s57 offen offset:0 sc1 lds
MM a[180:183],v[188:191],v[108:111],a[180:183]
ds_read_b64_tr_b16 v[100:101], v18 offset:24576
MM a[180:183],v[184:187],v[104:107],a[180:183]
ds_read_b64_tr_b16 v[102:103], v18 offset:25600
MM a[152:155],v[176:179],v[112:115],a[152:155]
ds_read_b64_tr_b16 v[104:105], v19 offset:16384
MM a[152:155],v[180:183],v[116:119],a[152:155]
ds_read_b64_tr_b16 v[106:107], v19 offset:17408
buffer_load_dwordx4 v13, s[40:43], s57 offen offset:1024 sc1 lds
MM a[184:187],v[188:191],v[116:119],a[184:187]
ds_read_b64_tr_b16 v[108:109], v19 offset:24576
MM a[184:187],v[184:187],v[112:115],a[184:187]
ds_read_b64_tr_b16 v[110:111], v19 offset:25600
MM a[156:159],v[176:179],v[120:123],a[156:159]
ds_read_b64_tr_b16 v[112:113], v20 offset:16384
MM a[156:159],v[180:183],v[124:127],a[156:159]
ds_read_b64_tr_b16 v[114:115], v20 offset:17408
buffer_load_dwordx4 v14, s[40:43], s57 offen offset:2048 sc1 lds
MM a[188:191],v[188:191],v[124:127],a[188:191]
ds_read_b64_tr_b16 v[116:117], v20 offset:24576
MM a[188:191],v[184:187],v[120:123],a[188:191]
ds_read_b64_tr_b16 v[118:119], v20 offset:25600
ds_read_b64_tr_b16 v[120:121], v21 offset:16384
ds_read_b64_tr_b16 v[122:123], v21 offset:17408
ds_read_b64_tr_b16 v[124:125], v21 offset:24576
ds_read_b64_tr_b16 v[126:127], v21 offset:25600
s_waitcnt lgkmcnt(15)
MM a[0:3],v[64:67],v[128:131],a[0:3]
ds_read_b128 v[144:147], v16 offset:4096
MM a[0:3],v[68:71],v[132:135],a[0:3]
buffer_load_dwordx4 v15, s[40:43], s57 offen offset:3072 sc1 lds
s_add_u32 m0, s58, 36864
MM a[4:7],v[76:79],v[132:135],a[4:7]
ds_read_b128 v[148:151], v17 offset:4096
MM a[4:7],v[72:75],v[128:131],a[4:7]
s_waitcnt lgkmcnt(15)
MM a[8:11],v[80:83],v[128:131],a[8:11]
MM a[8:11],v[84:87],v[132:135],a[8:11]
buffer_load_dwordx4 v8, s[36:39], s60 offen offset:0 sc1 lds
MM a[12:15],v[92:95],v[132:135],a[12:15]
MM a[12:15],v[88:91],v[128:131],a[12:15]
s_waitcnt lgkmcnt(10)
MM a[16:19],v[128:131],v[96:99],a[16:19]
MM a[16:19],v[132:135],v[100:103],a[16:19]
buffer_load_dwordx4 v9, s[36:39], s60 offen offset:1024 sc1 lds
MM a[20:23],v[132:135],v[108:111],a[20:23]
MM a[20:23],v[128:131],v[104:107],a[20:23]
s_waitcnt lgkmcnt(2)
MM a[24:27],v[128:131],v[112:115],a[24:27]
MM a[24:27],v[132:135],v[116:119],a[24:27]
buffer_load_dwordx4 v10, s[36:39], s60 offen offset:2048 sc1 lds
MM a[28:31],v[132:135],v[124:127],a[28:31]
MM a[28:31],v[128:131],v[120:123],a[28:31]
s_waitcnt lgkmcnt(15)
MM a[32:35],v[64:67],v[136:139],a[32:35]
ds_read_b128 v[152:155], v16 offset:6144
MM a[32:35],v[68:71],v[140:143],a[32:35]
buffer_load_dwordx4 v11, s[36:39], s60 offen offset:3072 sc1 lds
s_add_u32 m0, s59, 49152
MM a[36:39],v[76:79],v[140:143],a[36:39]
ds_read_b128 v[156:159], v17 offset:6144
MM a[36:39],v[72:75],v[136:139],a[36:39]
MM a[40:43],v[80:83],v[136:139],a[40:43]
MM a[40:43],v[84:87],v[140:143],a[40:43]
buffer_load_dwordx4 v12, s[44:47], s57 offen offset:0 sc1 lds
MM a[44:47],v[92:95],v[140:143],a[44:47]
MM a[44:47],v[88:91],v[136:139],a[44:47]
MM a[48:51],v[136:139],v[96:99],a[48:51]
MM a[48:51],v[140:143],v[100:103],a[48:51]
buffer_load_dwordx4 v13, s[44:47], s57 offen offset:1024 sc1 lds
MM a[52:55],v[140:143],v[108:111],a[52:55]
MM a[52:55],v[136:139],v[104:107],a[52:55]
MM a[56:59],v[136:139],v[112:115],a[56:59]
MM a[56:59],v[140:143],v[116:119],a[56:59]
buffer_load_dwordx4 v14, s[44:47], s57 offen offset:2048 sc1 lds
MM a[60:63],v[140:143],v[124:127],a[60:63]
MM a[60:63],v[136:139],v[120:123],a[60:63]
s_waitcnt lgkmcnt(2)
MM a[64:67],v[64:67],v[144:147],a[64:67]
ds_read_b128 v[160:163], v16 offset:8192
MM a[64:67],v[68:71],v[148:151],a[64:67]
buffer_load_dwordx4 v15, s[44:47], s57 offen offset:3072 sc1 lds
s_add_u32 s57, s57, 524288
MM a[68:71],v[76:79],v[148:151],a[68:71]
ds_read_b128 v[164:167], v17 offset:8192
MM a[68:71],v[72:75],v[144:147],a[68:71]
MM a[72:75],v[80:83],v[144:147],a[72:75]
MM a[72:75],v[84:87],v[148:151],a[72:75]
global_load_dword v241, v54, s[18:19]
MM a[76:79],v[92:95],v[148:151],a[76:79]
MM a[76:79],v[88:91],v[144:147],a[76:79]
MM a[80:83],v[144:147],v[96:99],a[80:83]
MM a[80:83],v[148:151],v[100:103],a[80:83]
global_load_dword v242, v54, s[20:21]
MM a[84:87],v[148:151],v[108:111],a[84:87]
MM a[84:87],v[144:147],v[104:107],a[84:87]
MM a[88:91],v[144:147],v[112:115],a[88:91]
MM a[88:91],v[148:151],v[116:119],a[88:91]
MM a[92:95],v[148:151],v[124:127],a[92:95]
MM a[92:95],v[144:147],v[120:123],a[92:95]
s_waitcnt lgkmcnt(2)
MM a[96:99],v[64:67],v[152:155],a[96:99]
ds_read_b128 v[168:171], v16 offset:10240
MM a[96:99],v[68:71],v[156:159],a[96:99]
MM a[100:103],v[76:79],v[156:159],a[100:103]
ds_read_b128 v[172:175], v17 offset:10240
MM a[100:103],v[72:75],v[152:155],a[100:103]
MM a[104:107],v[80:83],v[152:155],a[104:107]
MM a[104:107],v[84:87],v[156:159],a[104:107]
MM a[108:111],v[92:95],v[156:159],a[108:111]
MM a[108:111],v[88:91],v[152:155],a[108:111]
MM a[112:115],v[152:155],v[96:99],a[112:115]
MM a[112:115],v[156:159],v[100:103],a[112:115]
MM a[116:119],v[156:159],v[108:111],a[116:119]
MM a[116:119],v[152:155],v[104:107],a[116:119]
MM a[120:123],v[152:155],v[112:115],a[120:123]
MM a[120:123],v[156:159],v[116:119],a[120:123]
MM a[124:127],v[156:159],v[124:127],a[124:127]
MM a[124:127],v[152:155],v[120:123],a[124:127]
s_waitcnt lgkmcnt(2)
MM a[192:195],v[64:67],v[160:163],a[192:195]
ds_read_b128 v[176:179], v16 offset:12288
MM a[192:195],v[68:71],v[164:167],a[192:195]
MM a[196:199],v[76:79],v[164:167],a[196:199]
ds_read_b128 v[180:183], v17 offset:12288
MM a[196:199],v[72:75],v[160:163],a[196:199]
MM a[200:203],v[80:83],v[160:163],a[200:203]
MM a[200:203],v[84:87],v[164:167],a[200:203]
MM a[204:207],v[92:95],v[164:167],a[204:207]
MM a[204:207],v[88:91],v[160:163],a[204:207]
MM a[208:211],v[160:163],v[96:99],a[208:211]
MM a[208:211],v[164:167],v[100:103],a[208:211]
MM a[212:215],v[164:167],v[108:111],a[212:215]
MM a[212:215],v[160:163],v[104:107],a[212:215]
MM a[216:219],v[160:163],v[112:115],a[216:219]
MM a[216:219],v[164:167],v[116:119],a[216:219]
MM a[220:223],v[164:167],v[124:127],a[220:223]
MM a[220:223],v[160:163],v[120:123],a[220:223]
s_waitcnt lgkmcnt(2)
MM a[224:227],v[64:67],v[168:171],a[224:227]
ds_read_b128 v[184:187], v16 offset:14336
MM a[224:227],v[68:71],v[172:175],a[224:227]
MM a[228:231],v[76:79],v[172:175],a[228:231]
ds_read_b128 v[188:191], v17 offset:14336
MM a[228:231],v[72:75],v[168:171],a[228:231]
MM a[232:235],v[80:83],v[168:171],a[232:235]
MM a[232:235],v[84:87],v[172:175],a[232:235]
MM a[236:239],v[92:95],v[172:175],a[236:239]
MM a[236:239],v[88:91],v[168:171],a[236:239]
MM a[240:243],v[168:171],v[96:99],a[240:243]
MM a[240:243],v[172:175],v[100:103],a[240:243]
MM a[244:247],v[172:175],v[108:111],a[244:247]
MM a[244:247],v[168:171],v[104:107],a[244:247]
MM a[248:251],v[168:171],v[112:115],a[248:251]
MM a[248:251],v[172:175],v[116:119],a[248:251]
MM a[252:255],v[172:175],v[124:127],a[252:255]
MM a[252:255],v[168:171],v[120:123],a[252:255]
s_waitcnt vmcnt(2) lgkmcnt(0)
s_barrier
MM a[128:131],v[64:67],v[176:179],a[128:131]
ds_read_b128 v[128:131], v16 offset:32768
MM a[128:131],v[68:71],v[180:183],a[128:131]
s_add_u32 m0, s58, 0
s_add_u32 s60, s56, 32768
MM a[160:163],v[68:71],v[188:191],a[160:163]
ds_read_b128 v[132:135], v17 offset:32768
MM a[160:163],v[64:67],v[184:187],a[160:163]
buffer_load_dwordx4 v8, s[36:39], s56 offen offset:0 sc1 lds
MM a[132:135],v[72:75],v[176:179],a[132:135]
ds_read_b64_tr_b16 v[64:65], v18 offset:32768
MM a[132:135],v[76:79],v[180:183],a[132:135]
ds_read_b64_tr_b16 v[66:67], v18 offset:33792
MM a[164:167],v[76:79],v[188:191],a[164:167]
ds_read_b64_tr_b16 v[68:69], v18 offset:40960
MM a[164:167],v[72:75],v[184:187],a[164:167]
ds_read_b64_tr_b16 v[70:71], v18 offset:41984
buffer_load_dwordx4 v9, s[36:39], s56 offen offset:1024 sc1 lds
MM a[136:139],v[80:83],v[176:179],a[136:139]
ds_read_b64_tr_b16 v[72:73], v19 offset:32768
MM a[136:139],v[84:87],v[180:183],a[136:139]
ds_read_b64_tr_b16 v[74:75], v19 offset:33792
MM a[168:171],v[84:87],v[188:191],a[168:171]
ds_read_b64_tr_b16 v[76:77], v19 offset:40960
MM a[168:171],v[80:83],v[184:187],a[168:171]
ds_read_b64_tr_b16 v[78:79], v19 offset:41984
buffer_load_dwordx4 v10, s[36:39], s56 offen offset:2048 sc1 lds
MM a[140:143],v[88:91],v[176:179],a[140:143]
ds_read_b64_tr_b16 v[80:81], v20 offset:32768
MM a[140:143],v[92:95],v[180:183],a[140:143]
ds_read_b64_tr_b16 v[82:83], v20 offset:33792
MM a[172:175],v[92:95],v[188:191],a[172:175]
ds_read_b64_tr_b16 v[84:85], v20 offset:40960
MM a[172:175],v[88:91],v[184:187],a[172:175]
ds_read_b64_tr_b16 v[86:87], v20 offset:41984
buffer_load_dwordx4 v11, s[36:39], s56 offen offset:3072 sc1 lds
MM a[144:147],v[176:179],v[96:99],a[144:147]
ds_read_b64_tr_b16 v[88:89], v21 offset:32768
ds_read_b128 v[136:139], v16 offset:34816
MM a[144:147],v[180:183],v[100:103],a[144:147]
ds_read_b64_tr_b16 v[90:91], v21 offset:33792
s_add_u32 m0, s59, 0
MM a[176:179],v[188:191],v[100:103],a[176:179]
ds_read_b64_tr_b16 v[92:93], v21 offset:40960
ds_read_b128 v[140:143], v17 offset:34816
MM a[176:179],v[184:187],v[96:99],a[176:179]
ds_read_b64_tr_b16 v[94:95], v21 offset:41984
s_add_u32 s56, s56, 128
MM a[148:151],v[176:179],v[104:107],a[148:151]
ds_read_b64_tr_b16 v[96:97], v18 offset:49152
buffer_load_dwordx4 v12, s[40:43], s57 offen offset:0 sc1 lds
MM a[148:151],v[180:183],v[108:111],a[148:151]
ds_read_b64_tr_b16 v[98:99], v18 offset:50176
MM a[180:183],v[188:191],v[108:111],a[180:183]
ds_read_b64_tr_b16 v[100:101], v18 offset:57344
MM a[180:183],v[184:187],v[104:107],a[180:183]
ds_read_b64_tr_b16 v[102:103], v18 offset:58368
MM a[152:155],v[176:179],v[112:115],a[152:155]
ds_read_b64_tr_b16 v[104:105], v19 offset:49152
buffer_load_dwordx4 v13, s[40:43], s57 offen offset:1024 sc1 lds
MM a[152:155],v[180:183],v[116:119],a[152:155]
ds_read_b64_tr_b16 v[106:107], v19 offset:50176
MM a[184:187],v[188:191],v[116:119],a[184:187]
ds_read_b64_tr_b16 v[108:109], v19 offset:57344
MM a[184:187],v[184:187],v[112:115],a[184:187]
ds_read_b64_tr_b16 v[110:111], v19 offset:58368
MM a[156:159],v[176:179],v[120:123],a[156:159]
ds_read_b64_tr_b16 v[112:113], v20 offset:49152
buffer_load_dwordx4 v14, s[40:43], s57 offen offset:2048 sc1 lds
MM a[156:159],v[180:183],v[124:127],a[156:159]
ds_read_b64_tr_b16 v[114:115], v20 offset:50176
MM a[188:191],v[188:191],v[124:127],a[188:191]
ds_read_b64_tr_b16 v[116:117], v20 offset:57344
MM a[188:191],v[184:187],v[120:123],a[188:191]
ds_read_b64_tr_b16 v[118:119], v20 offset:58368
ds_read_b64_tr_b16 v[120:121], v21 offset:49152
ds_read_b64_tr_b16 v[122:123], v21 offset:50176
ds_read_b64_tr_b16 v[124:125], v21 offset:57344
ds_read_b64_tr_b16 v[126:127], v21 offset:58368
s_waitcnt lgkmcnt(15)
MM a[0:3],v[64:67],v[128:131],a[0:3]
ds_read_b128 v[144:147], v16 offset:36864
MM a[0:3],v[68:71],v[132:135],a[0:3]
buffer_load_dwordx4 v15, s[40:43], s57 offen offset:3072 sc1 lds
s_add_u32 m0, s58, 4096
MM a[4:7],v[76:79],v[132:135],a[4:7]
ds_read_b128 v[148:151], v17 offset:36864
MM a[4:7],v[72:75],v[128:131],a[4:7]
s_waitcnt lgkmcnt(15)
MM a[8:11],v[80:83],v[128:131],a[8:11]
MM a[8:11],v[84:87],v[132:135],a[8:11]
buffer_load_dwordx4 v8, s[36:39], s60 offen offset:0 sc1 lds
MM a[12:15],v[92:95],v[132:135],a[12:15]
MM a[12:15],v[88:91],v[128:131],a[12:15]
s_waitcnt lgkmcnt(10)
MM a[16:19],v[128:131],v[96:99],a[16:19]
MM a[16:19],v[132:135],v[100:103],a[16:19]
buffer_load_dwordx4 v9, s[36:39], s60 offen offset:1024 sc1 lds
MM a[20:23],v[132:135],v[108:111],a[20:23]
MM a[20:23],v[128:131],v[104:107],a[20:23]
s_waitcnt lgkmcnt(2)
MM a[24:27],v[128:131],v[112:115],a[24:27]
MM a[24:27],v[132:135],v[116:119],a[24:27]
buffer_load_dwordx4 v10, s[36:39], s60 offen offset:2048 sc1 lds
MM a[28:31],v[132:135],v[124:127],a[28:31]
MM a[28:31],v[128:131],v[120:123],a[28:31]
s_waitcnt lgkmcnt(15)
MM a[32:35],v[64:67],v[136:139],a[32:35]
ds_read_b128 v[152:155], v16 offset:38912
MM a[32:35],v[68:71],v[140:143],a[32:35]
buffer_load_dwordx4 v11, s[36:39], s60 offen offset:3072 sc1 lds
s_add_u32 m0, s59, 16384
MM a[36:39],v[76:79],v[140:143],a[36:39]
ds_read_b128 v[156:159], v17 offset:38912
MM a[36:39],v[72:75],v[136:139],a[36:39]
MM a[40:43],v[80:83],v[136:139],a[40:43]
MM a[40:43],v[84:87],v[140:143],a[40:43]
buffer_load_dwordx4 v12, s[44:47], s57 offen offset:0 sc1 lds
MM a[44:47],v[92:95],v[140:143],a[44:47]
MM a[44:47],v[88:91],v[136:139],a[44:47]
MM a[48:51],v[136:139],v[96:99],a[48:51]
MM a[48:51],v[140:143],v[100:103],a[48:51]
buffer_load_dwordx4 v13, s[44:47], s57 offen offset:1024 sc1 lds
MM a[52:55],v[140:143],v[108:111],a[52:55]
MM a[52:55],v[136:139],v[104:107],a[52:55]
MM a[56:59],v[136:139],v[112:115],a[56:59]
MM a[56:59],v[140:143],v[116:119],a[56:59]
buffer_load_dwordx4 v14, s[44:47], s57 offen offset:2048 sc1 lds
MM a[60:63],v[140:143],v[124:127],a[60:63]
MM a[60:63],v[136:139],v[120:123],a[60:63]
s_waitcnt lgkmcnt(2)
MM a[64:67],v[64:67],v[144:147],a[64:67]
ds_read_b128 v[160:163], v16 offset:40960
MM a[64:67],v[68:71],v[148:151],a[64:67]
buffer_load_dwordx4 v15, s[44:47], s57 offen offset:3072 sc1 lds
s_add_u32 s57, s57, 524288
MM a[68:71],v[76:79],v[148:151],a[68:71]
ds_read_b128 v[164:167], v17 offset:40960
MM a[68:71],v[72:75],v[144:147],a[68:71]
MM a[72:75],v[80:83],v[144:147],a[72:75]
MM a[72:75],v[84:87],v[148:151],a[72:75]
buffer_load_dwordx4 v[244:247], v1, s[32:35], s79 offen sc0 sc1
MM a[76:79],v[92:95],v[148:151],a[76:79]
MM a[76:79],v[88:91],v[144:147],a[76:79]
MM a[80:83],v[144:147],v[96:99],a[80:83]
MM a[80:83],v[148:151],v[100:103],a[80:83]
global_load_dword v249, v55, s[100:101]
MM a[84:87],v[148:151],v[108:111],a[84:87]
MM a[84:87],v[144:147],v[104:107],a[84:87]
MM a[88:91],v[144:147],v[112:115],a[88:91]
MM a[88:91],v[148:151],v[116:119],a[88:91]
MM a[92:95],v[148:151],v[124:127],a[92:95]
MM a[92:95],v[144:147],v[120:123],a[92:95]
s_waitcnt lgkmcnt(2)
MM a[96:99],v[64:67],v[152:155],a[96:99]
ds_read_b128 v[168:171], v16 offset:43008
MM a[96:99],v[68:71],v[156:159],a[96:99]
MM a[100:103],v[76:79],v[156:159],a[100:103]
ds_read_b128 v[172:175], v17 offset:43008
MM a[100:103],v[72:75],v[152:155],a[100:103]
MM a[104:107],v[80:83],v[152:155],a[104:107]
MM a[104:107],v[84:87],v[156:159],a[104:107]
MM a[108:111],v[92:95],v[156:159],a[108:111]
MM a[108:111],v[88:91],v[152:155],a[108:111]
MM a[112:115],v[152:155],v[96:99],a[112:115]
MM a[112:115],v[156:159],v[100:103],a[112:115]
MM a[116:119],v[156:159],v[108:111],a[116:119]
MM a[116:119],v[152:155],v[104:107],a[116:119]
MM a[120:123],v[152:155],v[112:115],a[120:123]
MM a[120:123],v[156:159],v[116:119],a[120:123]
MM a[124:127],v[156:159],v[124:127],a[124:127]
MM a[124:127],v[152:155],v[120:123],a[124:127]
s_waitcnt lgkmcnt(2)
MM a[192:195],v[64:67],v[160:163],a[192:195]
ds_read_b128 v[176:179], v16 offset:45056
MM a[192:195],v[68:71],v[164:167],a[192:195]
MM a[196:199],v[76:79],v[164:167],a[196:199]
ds_read_b128 v[180:183], v17 offset:45056
MM a[196:199],v[72:75],v[160:163],a[196:199]
MM a[200:203],v[80:83],v[160:163],a[200:203]
MM a[200:203],v[84:87],v[164:167],a[200:203]
MM a[204:207],v[92:95],v[164:167],a[204:207]
MM a[204:207],v[88:91],v[160:163],a[204:207]
MM a[208:211],v[160:163],v[96:99],a[208:211]
MM a[208:211],v[164:167],v[100:103],a[208:211]
MM a[212:215],v[164:167],v[108:111],a[212:215]
MM a[212:215],v[160:163],v[104:107],a[212:215]
MM a[216:219],v[160:163],v[112:115],a[216:219]
MM a[216:219],v[164:167],v[116:119],a[216:219]
MM a[220:223],v[164:167],v[124:127],a[220:223]
MM a[220:223],v[160:163],v[120:123],a[220:223]
s_waitcnt lgkmcnt(2)
MM a[224:227],v[64:67],v[168:171],a[224:227]
ds_read_b128 v[184:187], v16 offset:47104
MM a[224:227],v[68:71],v[172:175],a[224:227]
MM a[228:231],v[76:79],v[172:175],a[228:231]
ds_read_b128 v[188:191], v17 offset:47104
MM a[228:231],v[72:75],v[168:171],a[228:231]
MM a[232:235],v[80:83],v[168:171],a[232:235]
MM a[232:235],v[84:87],v[172:175],a[232:235]
MM a[236:239],v[92:95],v[172:175],a[236:239]
MM a[236:239],v[88:91],v[168:171],a[236:239]
MM a[240:243],v[168:171],v[96:99],a[240:243]
MM a[240:243],v[172:175],v[100:103],a[240:243]
MM a[244:247],v[172:175],v[108:111],a[244:247]
MM a[244:247],v[168:171],v[104:107],a[244:247]
MM a[248:251],v[168:171],v[112:115],a[248:251]
MM a[248:251],v[172:175],v[116:119],a[248:251]
MM a[252:255],v[172:175],v[124:127],a[252:255]
MM a[252:255],v[168:171],v[120:123],a[252:255]
s_waitcnt vmcnt(1) lgkmcnt(0)
s_barrier
v_xor_b32 v244, v244, v61
v_xor_b32 v245, v245, v61
v_xor_b32 v246, v246, v61
v_xor_b32 v247, v247, v61
v_or3_b32 v244, v244, v245, v246
v_or_b32 v244, v244, v247
v_cmp_ne_u32 vcc, 0, v244
s_nop 1
s_cbranch_vccnz L_sl_1
L_ok_2:
MM a[128:131],v[64:67],v[176:179],a[128:131]
ds_read_b128 v[128:131], v16 offset:0
MM a[128:131],v[68:71],v[180:183],a[128:131]
s_add_u32 m0, s58, 32768
s_add_u32 s60, s56, 32768
MM a[160:163],v[68:71],v[188:191],a[160:163]
ds_read_b128 v[132:135], v17 offset:0
MM a[160:163],v[64:67],v[184:187],a[160:163]
buffer_load_dwordx4 v8, s[36:39], s56 offen offset:0 sc1 lds
MM a[132:135],v[72:75],v[176:179],a[132:135]
ds_read_b64_tr_b16 v[64:65], v18 offset:0
MM a[132:135],v[76:79],v[180:183],a[132:135]
ds_read_b64_tr_b16 v[66:67], v18 offset:1024
MM a[164:167],v[76:79],v[188:191],a[164:167]
ds_read_b64_tr_b16 v[68:69], v18 offset:8192
MM a[164:167],v[72:75],v[184:187],a[164:167]
ds_read_b64_tr_b16 v[70:71], v18 offset:9216
buffer_load_dwordx4 v9, s[36:39], s56 offen offset:1024 sc1 lds
MM a[136:139],v[80:83],v[176:179],a[136:139]
ds_read_b64_tr_b16 v[72:73], v19 offset:0
MM a[136:139],v[84:87],v[180:183],a[136:139]
ds_read_b64_tr_b16 v[74:75], v19 offset:1024
MM a[168:171],v[84:87],v[188:191],a[168:171]
ds_read_b64_tr_b16 v[76:77], v19 offset:8192
MM a[168:171],v[80:83],v[184:187],a[168:171]
ds_read_b64_tr_b16 v[78:79], v19 offset:9216
buffer_load_dwordx4 v10, s[36:39], s56 offen offset:2048 sc1 lds
MM a[140:143],v[88:91],v[176:179],a[140:143]
ds_read_b64_tr_b16 v[80:81], v20 offset:0
MM a[140:143],v[92:95],v[180:183],a[140:143]
ds_read_b64_tr_b16 v[82:83], v20 offset:1024
MM a[172:175],v[92:95],v[188:191],a[172:175]
ds_read_b64_tr_b16 v[84:85], v20 offset:8192
MM a[172:175],v[88:91],v[184:187],a[172:175]
ds_read_b64_tr_b16 v[86:87], v20 offset:9216
buffer_load_dwordx4 v11, s[36:39], s56 offen offset:3072 sc1 lds
MM a[144:147],v[176:179],v[96:99],a[144:147]
ds_read_b64_tr_b16 v[88:89], v21 offset:0
ds_read_b128 v[136:139], v16 offset:2048
MM a[144:147],v[180:183],v[100:103],a[144:147]
ds_read_b64_tr_b16 v[90:91], v21 offset:1024
s_add_u32 m0, s59, 32768
MM a[176:179],v[188:191],v[100:103],a[176:179]
ds_read_b64_tr_b16 v[92:93], v21 offset:8192
ds_read_b128 v[140:143], v17 offset:2048
MM a[176:179],v[184:187],v[96:99],a[176:179]
ds_read_b64_tr_b16 v[94:95], v21 offset:9216
s_add_u32 s56, s56, 128
MM a[148:151],v[176:179],v[104:107],a[148:151]
ds_read_b64_tr_b16 v[96:97], v18 offset:16384
buffer_load_dwordx4 v12, s[40:43], s57 offen offset:0 sc1 lds
MM a[148:151],v[180:183],v[108:111],a[148:151]
ds_read_b64_tr_b16 v[98:99], v18 offset:17408
MM a[180:183],v[188:191],v[108:111],a[180:183]
ds_read_b64_tr_b16 v[100:101], v18 offset:24576
MM a[180:183],v[184:187],v[104:107],a[180:183]
ds_read_b64_tr_b16 v[102:103], v18 offset:25600
MM a[152:155],v[176:179],v[112:115],a[152:155]
ds_read_b64_tr_b16 v[104:105], v19 offset:16384
buffer_load_dwordx4 v13, s[40:43], s57 offen offset:1024 sc1 lds
MM a[152:155],v[180:183],v[116:119],a[152:155]
ds_read_b64_tr_b16 v[106:107], v19 offset:17408
MM a[184:187],v[188:191],v[116:119],a[184:187]
ds_read_b64_tr_b16 v[108:109], v19 offset:24576
MM a[184:187],v[184:187],v[112:115],a[184:187]
ds_read_b64_tr_b16 v[110:111], v19 offset:25600
MM a[156:159],v[176:179],v[120:123],a[156:159]
ds_read_b64_tr_b16 v[112:113], v20 offset:16384
buffer_load_dwordx4 v14, s[40:43], s57 offen offset:2048 sc1 lds
MM a[156:159],v[180:183],v[124:127],a[156:159]
ds_read_b64_tr_b16 v[114:115], v20 offset:17408
MM a[188:191],v[188:191],v[124:127],a[188:191]
ds_read_b64_tr_b16 v[116:117], v20 offset:24576
MM a[188:191],v[184:187],v[120:123],a[188:191]
ds_read_b64_tr_b16 v[118:119], v20 offset:25600
ds_read_b64_tr_b16 v[120:121], v21 offset:16384
ds_read_b64_tr_b16 v[122:123], v21 offset:17408
ds_read_b64_tr_b16 v[124:125], v21 offset:24576
ds_read_b64_tr_b16 v[126:127], v21 offset:25600
s_waitcnt lgkmcnt(15)
MM a[0:3],v[64:67],v[128:131],a[0:3]
ds_read_b128 v[144:147], v16 offset:4096
MM a[0:3],v[68:71],v[132:135],a[0:3]
buffer_load_dwordx4 v15, s[40:43], s57 offen offset:3072 sc1 lds
s_add_u32 m0, s58, 36864
MM a[4:7],v[76:79],v[132:135],a[4:7]
ds_read_b128 v[148:151], v17 offset:4096
MM a[4:7],v[72:75],v[128:131],a[4:7]
s_waitcnt lgkmcnt(15)
MM a[8:11],v[80:83],v[128:131],a[8:11]
MM a[8:11],v[84:87],v[132:135],a[8:11]
buffer_load_dwordx4 v8, s[36:39], s60 offen offset:0 sc1 lds
MM a[12:15],v[92:95],v[132:135],a[12:15]
MM a[12:15],v[88:91],v[128:131],a[12:15]
s_waitcnt lgkmcnt(10)
MM a[16:19],v[128:131],v[96:99],a[16:19]
MM a[16:19],v[132:135],v[100:103],a[16:19]
buffer_load_dwordx4 v9, s[36:39], s60 offen offset:1024 sc1 lds
MM a[20:23],v[132:135],v[108:111],a[20:23]
MM a[20:23],v[128:131],v[104:107],a[20:23]
s_waitcnt lgkmcnt(2)
MM a[24:27],v[128:131],v[112:115],a[24:27]
MM a[24:27],v[132:135],v[116:119],a[24:27]
buffer_load_dwordx4 v10, s[36:39], s60 offen offset:2048 sc1 lds
MM a[28:31],v[132:135],v[124:127],a[28:31]
MM a[28:31],v[128:131],v[120:123],a[28:31]
s_waitcnt lgkmcnt(15)
MM a[32:35],v[64:67],v[136:139],a[32:35]
ds_read_b128 v[152:155], v16 offset:6144
MM a[32:35],v[68:71],v[140:143],a[32:35]
buffer_load_dwordx4 v11, s[36:39], s60 offen offset:3072 sc1 lds
s_add_u32 m0, s59, 49152
MM a[36:39],v[76:79],v[140:143],a[36:39]
ds_read_b128 v[156:159], v17 offset:6144
MM a[36:39],v[72:75],v[136:139],a[36:39]
MM a[40:43],v[80:83],v[136:139],a[40:43]
MM a[40:43],v[84:87],v[140:143],a[40:43]
buffer_load_dwordx4 v12, s[44:47], s57 offen offset:0 sc1 lds
MM a[44:47],v[92:95],v[140:143],a[44:47]
MM a[44:47],v[88:91],v[136:139],a[44:47]
MM a[48:51],v[136:139],v[96:99],a[48:51]
MM a[48:51],v[140:143],v[100:103],a[48:51]
buffer_load_dwordx4 v13, s[44:47], s57 offen offset:1024 sc1 lds
MM a[52:55],v[140:143],v[108:111],a[52:55]
MM a[52:55],v[136:139],v[104:107],a[52:55]
MM a[56:59],v[136:139],v[112:115],a[56:59]
MM a[56:59],v[140:143],v[116:119],a[56:59]
buffer_load_dwordx4 v14, s[44:47], s57 offen offset:2048 sc1 lds
MM a[60:63],v[140:143],v[124:127],a[60:63]
MM a[60:63],v[136:139],v[120:123],a[60:63]
s_waitcnt lgkmcnt(2)
MM a[64:67],v[64:67],v[144:147],a[64:67]
ds_read_b128 v[160:163], v16 offset:8192
MM a[64:67],v[68:71],v[148:151],a[64:67]
buffer_load_dwordx4 v15, s[44:47], s57 offen offset:3072 sc1 lds
s_add_u32 s57, s57, 524288
MM a[68:71],v[76:79],v[148:151],a[68:71]
ds_read_b128 v[164:167], v17 offset:8192
MM a[68:71],v[72:75],v[144:147],a[68:71]
MM a[72:75],v[80:83],v[144:147],a[72:75]
MM a[72:75],v[84:87],v[148:151],a[72:75]
buffer_store_dword v61, v60, s[32:35], s27 offen sc0 sc1
s_mov_b32 s36, s8
MM a[76:79],v[92:95],v[148:151],a[76:79]
s_mov_b32 s37, s9
s_mov_b32 s38, 0x500000
MM a[76:79],v[88:91],v[144:147],a[76:79]
s_mov_b32 s39, 0x00020000
s_mov_b32 s40, s18
MM a[80:83],v[144:147],v[96:99],a[80:83]
s_mov_b32 s41, s19
s_mov_b32 s42, 0x21c000
MM a[80:83],v[148:151],v[100:103],a[80:83]
s_mov_b32 s43, 0x00020000
s_mov_b32 s44, s20
MM a[84:87],v[148:151],v[108:111],a[84:87]
s_mov_b32 s45, s21
s_mov_b32 s46, 0x21c000
MM a[84:87],v[144:147],v[104:107],a[84:87]
s_mov_b32 s47, 0x00020000
s_mov_b32 s42, s74
MM a[88:91],v[144:147],v[112:115],a[88:91]
s_mov_b32 s46, s74
s_add_u32 m0, s70, 131072
MM a[88:91],v[148:151],v[116:119],a[88:91]
buffer_load_dwordx4 v33, s[36:39], s64 offen offset:0 sc1 lds
MM a[92:95],v[148:151],v[124:127],a[92:95]
MM a[92:95],v[144:147],v[120:123],a[92:95]
s_waitcnt lgkmcnt(2)
MM a[96:99],v[64:67],v[152:155],a[96:99]
ds_read_b128 v[168:171], v16 offset:10240
MM a[96:99],v[68:71],v[156:159],a[96:99]
buffer_load_dwordx4 v34, s[36:39], s64 offen offset:1024 sc1 lds
s_add_u32 s64, s64, 524288
MM a[100:103],v[76:79],v[156:159],a[100:103]
ds_read_b128 v[172:175], v17 offset:10240
MM a[100:103],v[72:75],v[152:155],a[100:103]
s_add_u32 m0, s70, 139264
MM a[104:107],v[80:83],v[152:155],a[104:107]
MM a[104:107],v[84:87],v[156:159],a[104:107]
buffer_load_dwordx4 v33, s[36:39], s65 offen offset:0 sc1 lds
MM a[108:111],v[92:95],v[156:159],a[108:111]
MM a[108:111],v[88:91],v[152:155],a[108:111]
MM a[112:115],v[152:155],v[96:99],a[112:115]
MM a[112:115],v[156:159],v[100:103],a[112:115]
buffer_load_dwordx4 v34, s[36:39], s65 offen offset:1024 sc1 lds
s_add_u32 s65, s65, 524288
MM a[116:119],v[156:159],v[108:111],a[116:119]
s_add_u32 m0, s70, 147456
MM a[116:119],v[152:155],v[104:107],a[116:119]
MM a[120:123],v[152:155],v[112:115],a[120:123]
MM a[120:123],v[156:159],v[116:119],a[120:123]
buffer_load_dwordx4 v35, s[40:43], s66 offen offset:0 sc1 lds
MM a[124:127],v[156:159],v[124:127],a[124:127]
MM a[124:127],v[152:155],v[120:123],a[124:127]
s_waitcnt lgkmcnt(2)
MM a[192:195],v[64:67],v[160:163],a[192:195]
ds_read_b128 v[176:179], v16 offset:12288
MM a[192:195],v[68:71],v[164:167],a[192:195]
buffer_load_dwordx4 v36, s[40:43], s66 offen offset:1024 sc1 lds
s_add_u32 s66, s66, 221184
MM a[196:199],v[76:79],v[164:167],a[196:199]
ds_read_b128 v[180:183], v17 offset:12288
MM a[196:199],v[72:75],v[160:163],a[196:199]
s_add_u32 m0, s70, 155648
MM a[200:203],v[80:83],v[160:163],a[200:203]
MM a[200:203],v[84:87],v[164:167],a[200:203]
buffer_load_dwordx4 v35, s[44:47], s67 offen offset:0 sc1 lds
MM a[204:207],v[92:95],v[164:167],a[204:207]
MM a[204:207],v[88:91],v[160:163],a[204:207]
MM a[208:211],v[160:163],v[96:99],a[208:211]
MM a[208:211],v[164:167],v[100:103],a[208:211]
buffer_load_dwordx4 v36, s[44:47], s67 offen offset:1024 sc1 lds
s_add_u32 s67, s67, 221184
MM a[212:215],v[164:167],v[108:111],a[212:215]
s_lshl_b32 s56, s31, 20
s_lshl_b32 s57, s3, 17
MM a[212:215],v[160:163],v[104:107],a[212:215]
s_add_u32 s58, s56, s57
s_lshr_b32 s57, s30, 1
MM a[216:219],v[160:163],v[112:115],a[216:219]
s_lshl_b32 s57, s57, 16
s_add_u32 s58, s58, s57
MM a[216:219],v[164:167],v[116:119],a[216:219]
s_add_u32 s58, s58, 0x1000000
s_and_b32 s57, s30, 1
MM a[220:223],v[164:167],v[124:127],a[220:223]
s_lshl_b32 s16, s57, 11
s_add_u32 s16, s16, s58
MM a[220:223],v[160:163],v[120:123],a[220:223]
s_lshl_b32 s17, s57, 12
s_add_u32 s17, s17, s58
s_waitcnt lgkmcnt(2)
MM a[224:227],v[64:67],v[168:171],a[224:227]
ds_read_b128 v[184:187], v16 offset:14336
MM a[224:227],v[68:71],v[172:175],a[224:227]
s_add_u32 s17, s17, 16384
s_lshl_b32 s57, s30, 14
MM a[228:231],v[76:79],v[172:175],a[228:231]
ds_read_b128 v[188:191], v17 offset:14336
MM a[228:231],v[72:75],v[168:171],a[228:231]
v_add_u32 v26, s57, v1
s_lshl_b32 s59, s30, 12
MM a[232:235],v[80:83],v[168:171],a[232:235]
s_add_u32 s56, s56, s59
s_add_u32 s56, s56, 0x1000000
MM a[232:235],v[84:87],v[172:175],a[232:235]
s_lshl_b32 s60, s30, 13
s_add_u32 s60, s60, 98304
MM a[236:239],v[92:95],v[172:175],a[236:239]
s_add_u32 s61, s60, 16384
s_add_u32 s62, s56, 32768
MM a[236:239],v[88:91],v[168:171],a[236:239]
s_add_u32 s57, s56, 65536
s_add_u32 s58, s57, 32768
MM a[240:243],v[168:171],v[96:99],a[240:243]
v_add_u32 v2, 16384, v1
v_and_b32 v62, 7, v0
MM a[240:243],v[172:175],v[100:103],a[240:243]
v_lshlrev_b32 v62, 9, v62
s_and_b32 s79, s2, 31
MM a[244:247],v[172:175],v[108:111],a[244:247]
s_lshl_b32 s79, s79, 4
s_add_u32 s79, s79, 0x7000000
MM a[244:247],v[168:171],v[104:107],a[244:247]
MM a[248:251],v[168:171],v[112:115],a[248:251]
MM a[248:251],v[172:175],v[116:119],a[248:251]
MM a[252:255],v[172:175],v[124:127],a[252:255]
MM a[252:255],v[168:171],v[120:123],a[252:255]
s_waitcnt vmcnt(9) lgkmcnt(0)
s_barrier
MM a[128:131],v[64:67],v[176:179],a[128:131]
ds_read_b128 v[160:163], v16 offset:40960
MM a[128:131],v[68:71],v[180:183],a[128:131]
s_add_u32 m0, s70, 65536
MM a[160:163],v[68:71],v[188:191],a[160:163]
ds_read_b128 v[164:167], v17 offset:40960
MM a[160:163],v[64:67],v[184:187],a[160:163]
buffer_load_dwordx4 v33, s[36:39], s64 offen offset:0 sc1 lds
MM a[132:135],v[72:75],v[176:179],a[132:135]
ds_read_b64_tr_b16 v[64:65], v18 offset:32768
ds_read_b128 v[168:171], v16 offset:43008
MM a[132:135],v[76:79],v[180:183],a[132:135]
ds_read_b64_tr_b16 v[66:67], v18 offset:33792
MM a[164:167],v[76:79],v[188:191],a[164:167]
ds_read_b64_tr_b16 v[68:69], v18 offset:40960
ds_read_b128 v[172:175], v17 offset:43008
MM a[164:167],v[72:75],v[184:187],a[164:167]
ds_read_b64_tr_b16 v[70:71], v18 offset:41984
buffer_load_dwordx4 v34, s[36:39], s64 offen offset:1024 sc1 lds
MM a[136:139],v[80:83],v[176:179],a[136:139]
ds_read_b64_tr_b16 v[72:73], v19 offset:32768
s_add_u32 s64, s64, 524288
MM a[136:139],v[84:87],v[180:183],a[136:139]
ds_read_b64_tr_b16 v[74:75], v19 offset:33792
s_add_u32 m0, s70, 73728
MM a[168:171],v[84:87],v[188:191],a[168:171]
ds_read_b64_tr_b16 v[76:77], v19 offset:40960
MM a[168:171],v[80:83],v[184:187],a[168:171]
ds_read_b64_tr_b16 v[78:79], v19 offset:41984
buffer_load_dwordx4 v33, s[36:39], s65 offen offset:0 sc1 lds
MM a[140:143],v[88:91],v[176:179],a[140:143]
ds_read_b64_tr_b16 v[80:81], v20 offset:32768
MM a[140:143],v[92:95],v[180:183],a[140:143]
ds_read_b64_tr_b16 v[82:83], v20 offset:33792
MM a[172:175],v[92:95],v[188:191],a[172:175]
ds_read_b64_tr_b16 v[84:85], v20 offset:40960
MM a[172:175],v[88:91],v[184:187],a[172:175]
ds_read_b64_tr_b16 v[86:87], v20 offset:41984
buffer_load_dwordx4 v34, s[36:39], s65 offen offset:1024 sc1 lds
MM a[144:147],v[176:179],v[96:99],a[144:147]
ds_read_b64_tr_b16 v[88:89], v21 offset:32768
ds_read_b128 v[128:131], v16 offset:32768
MM a[144:147],v[180:183],v[100:103],a[144:147]
ds_read_b64_tr_b16 v[90:91], v21 offset:33792
s_add_u32 s65, s65, 524288
MM a[176:179],v[188:191],v[100:103],a[176:179]
ds_read_b64_tr_b16 v[92:93], v21 offset:40960
ds_read_b128 v[132:135], v17 offset:32768
MM a[176:179],v[184:187],v[96:99],a[176:179]
ds_read_b64_tr_b16 v[94:95], v21 offset:41984
s_add_u32 m0, s70, 81920
MM a[148:151],v[176:179],v[104:107],a[148:151]
ds_read_b64_tr_b16 v[96:97], v18 offset:49152
ds_read_b128 v[136:139], v16 offset:34816
MM a[148:151],v[180:183],v[108:111],a[148:151]
ds_read_b64_tr_b16 v[98:99], v18 offset:50176
buffer_load_dwordx4 v35, s[40:43], s66 offen offset:0 sc1 lds
MM a[180:183],v[188:191],v[108:111],a[180:183]
ds_read_b64_tr_b16 v[100:101], v18 offset:57344
ds_read_b128 v[140:143], v17 offset:34816
MM a[180:183],v[184:187],v[104:107],a[180:183]
ds_read_b64_tr_b16 v[102:103], v18 offset:58368
MM a[152:155],v[176:179],v[112:115],a[152:155]
ds_read_b64_tr_b16 v[104:105], v19 offset:49152
MM a[152:155],v[180:183],v[116:119],a[152:155]
ds_read_b64_tr_b16 v[106:107], v19 offset:50176
buffer_load_dwordx4 v36, s[40:43], s66 offen offset:1024 sc1 lds
MM a[184:187],v[188:191],v[116:119],a[184:187]
ds_read_b64_tr_b16 v[108:109], v19 offset:57344
s_add_u32 s66, s66, 221184
MM a[184:187],v[184:187],v[112:115],a[184:187]
ds_read_b64_tr_b16 v[110:111], v19 offset:58368
s_add_u32 m0, s70, 90112
MM a[156:159],v[176:179],v[120:123],a[156:159]
ds_read_b64_tr_b16 v[112:113], v20 offset:49152
MM a[156:159],v[180:183],v[124:127],a[156:159]
ds_read_b64_tr_b16 v[114:115], v20 offset:50176
buffer_load_dwordx4 v35, s[44:47], s67 offen offset:0 sc1 lds
MM a[188:191],v[188:191],v[124:127],a[188:191]
ds_read_b64_tr_b16 v[116:117], v20 offset:57344
MM a[188:191],v[184:187],v[120:123],a[188:191]
ds_read_b64_tr_b16 v[118:119], v20 offset:58368
ds_read_b64_tr_b16 v[120:121], v21 offset:49152
ds_read_b64_tr_b16 v[122:123], v21 offset:50176
ds_read_b64_tr_b16 v[124:125], v21 offset:57344
ds_read_b64_tr_b16 v[126:127], v21 offset:58368
s_waitcnt lgkmcnt(15)
MM a[192:195],v[64:67],v[160:163],a[192:195]
ds_read_b128 v[176:179], v16 offset:45056
buffer_load_dwordx4 v36, s[44:47], s67 offen offset:1024 sc1 lds
s_add_u32 s67, s67, 221184
MM a[192:195],v[68:71],v[164:167],a[192:195]
ds_read_b128 v[180:183], v17 offset:45056
MM a[196:199],v[76:79],v[164:167],a[196:199]
ds_read_b128 v[184:187], v16 offset:47104
MM a[196:199],v[72:75],v[160:163],a[196:199]
ds_read_b128 v[188:191], v17 offset:47104
s_waitcnt lgkmcnt(15)
MM a[200:203],v[80:83],v[160:163],a[200:203]
ds_read_b128 v[144:147], v16 offset:36864
MM a[200:203],v[84:87],v[164:167],a[200:203]
ds_read_b128 v[148:151], v17 offset:36864
MM a[204:207],v[92:95],v[164:167],a[204:207]
ds_read_b128 v[152:155], v16 offset:38912
MM a[204:207],v[88:91],v[160:163],a[204:207]
ds_read_b128 v[156:159], v17 offset:38912
s_waitcnt lgkmcnt(15)
MM a[208:211],v[160:163],v[96:99],a[208:211]
MM a[208:211],v[164:167],v[100:103],a[208:211]
MM a[212:215],v[164:167],v[108:111],a[212:215]
MM a[212:215],v[160:163],v[104:107],a[212:215]
s_waitcnt lgkmcnt(8)
MM a[216:219],v[160:163],v[112:115],a[216:219]
MM a[216:219],v[164:167],v[116:119],a[216:219]
MM a[220:223],v[164:167],v[124:127],a[220:223]
MM a[220:223],v[160:163],v[120:123],a[220:223]
s_waitcnt vmcnt(8) lgkmcnt(0)
s_barrier
MM a[224:227],v[64:67],v[168:171],a[224:227]
s_add_u32 m0, s70, 98304
MM a[224:227],v[68:71],v[172:175],a[224:227]
buffer_load_dwordx4 v33, s[36:39], s64 offen offset:0 sc1 lds
MM a[228:231],v[76:79],v[172:175],a[228:231]
buffer_load_dwordx4 v34, s[36:39], s64 offen offset:1024 sc1 lds
s_add_u32 s64, s64, 524288
MM a[228:231],v[72:75],v[168:171],a[228:231]
s_add_u32 m0, s70, 106496
MM a[232:235],v[80:83],v[168:171],a[232:235]
buffer_load_dwordx4 v33, s[36:39], s65 offen offset:0 sc1 lds
MM a[232:235],v[84:87],v[172:175],a[232:235]
buffer_load_dwordx4 v34, s[36:39], s65 offen offset:1024 sc1 lds
s_add_u32 s65, s65, 524288
MM a[236:239],v[92:95],v[172:175],a[236:239]
s_add_u32 m0, s70, 114688
MM a[236:239],v[88:91],v[168:171],a[236:239]
buffer_load_dwordx4 v35, s[40:43], s66 offen offset:0 sc1 lds
MM a[240:243],v[168:171],v[96:99],a[240:243]
buffer_load_dwordx4 v36, s[40:43], s66 offen offset:1024 sc1 lds
s_add_u32 s66, s66, 221184
MM a[240:243],v[172:175],v[100:103],a[240:243]
s_add_u32 m0, s70, 122880
MM a[244:247],v[172:175],v[108:111],a[244:247]
buffer_load_dwordx4 v35, s[44:47], s67 offen offset:0 sc1 lds
MM a[244:247],v[168:171],v[104:107],a[244:247]
buffer_load_dwordx4 v36, s[44:47], s67 offen offset:1024 sc1 lds
s_add_u32 s67, s67, 221184
MM a[248:251],v[168:171],v[112:115],a[248:251]
MM a[248:251],v[172:175],v[116:119],a[248:251]
MM a[252:255],v[172:175],v[124:127],a[252:255]
MM a[252:255],v[168:171],v[120:123],a[252:255]
MM a[128:131],v[64:67],v[176:179],a[128:131]
MM a[128:131],v[68:71],v[180:183],a[128:131]
MM a[132:135],v[76:79],v[180:183],a[132:135]
MM a[132:135],v[72:75],v[176:179],a[132:135]
MM a[136:139],v[80:83],v[176:179],a[136:139]
MM a[136:139],v[84:87],v[180:183],a[136:139]
MM a[140:143],v[92:95],v[180:183],a[140:143]
AR v192,a192
AR v193,a193
AR v194,a194
MM a[140:143],v[88:91],v[176:179],a[140:143]
AR v195,a195
AR v196,a196
AR v197,a197
MM a[144:147],v[176:179],v[96:99],a[144:147]
AR v198,a198
AR v199,a199
CV v200,v192,v193
MM a[144:147],v[180:183],v[100:103],a[144:147]
CV v201,v194,v195
CV v202,v196,v197
CV v203,v198,v199
MM a[148:151],v[180:183],v[108:111],a[148:151]
ds_write_b128 v26, v[200:203] offset:0
AR v204,a200
AR v205,a201
MM a[148:151],v[176:179],v[104:107],a[148:151]
AR v206,a202
AR v207,a203
AR v208,a204
MM a[152:155],v[176:179],v[112:115],a[152:155]
AR v209,a205
AR v210,a206
AR v211,a207
MM a[152:155],v[180:183],v[116:119],a[152:155]
CV v212,v204,v205
CV v213,v206,v207
CV v214,v208,v209
MM a[156:159],v[180:183],v[124:127],a[156:159]
CV v215,v210,v211
ds_write_b128 v26, v[212:215] offset:1024
AR v216,a224
MM a[156:159],v[176:179],v[120:123],a[156:159]
AR v217,a225
AR v218,a226
AR v219,a227
MM a[160:163],v[64:67],v[184:187],a[160:163]
AR v220,a228
AR v221,a229
AR v222,a230
MM a[160:163],v[68:71],v[188:191],a[160:163]
AR v223,a231
CV v224,v216,v217
CV v225,v218,v219
MM a[164:167],v[76:79],v[188:191],a[164:167]
CV v226,v220,v221
CV v227,v222,v223
ds_write_b128 v26, v[224:227] offset:2048
MM a[164:167],v[72:75],v[184:187],a[164:167]
AR v228,a232
AR v229,a233
AR v230,a234
MM a[168:171],v[80:83],v[184:187],a[168:171]
AR v231,a235
AR v232,a236
AR v233,a237
MM a[168:171],v[84:87],v[188:191],a[168:171]
AR v234,a238
AR v235,a239
CV v236,v228,v229
MM a[172:175],v[92:95],v[188:191],a[172:175]
CV v237,v230,v231
CV v238,v232,v233
CV v239,v234,v235
MM a[172:175],v[88:91],v[184:187],a[172:175]
ds_write_b128 v26, v[236:239] offset:3072
AR v192,a208
AR v193,a209
MM a[176:179],v[184:187],v[96:99],a[176:179]
AR v194,a210
AR v195,a211
AR v196,a240
MM a[176:179],v[188:191],v[100:103],a[176:179]
AR v197,a241
AR v198,a242
AR v199,a243
MM a[180:183],v[188:191],v[108:111],a[180:183]
CV v200,v192,v193
CV v201,v194,v195
CV v202,v196,v197
MM a[180:183],v[184:187],v[104:107],a[180:183]
CV v203,v198,v199
ds_write_b128 v26, v[200:203] offset:4096
AR v204,a212
MM a[184:187],v[184:187],v[112:115],a[184:187]
AR v205,a213
AR v206,a214
AR v207,a215
MM a[184:187],v[188:191],v[116:119],a[184:187]
AR v208,a244
AR v209,a245
AR v210,a246
MM a[188:191],v[188:191],v[124:127],a[188:191]
AR v211,a247
CV v212,v204,v205
CV v213,v206,v207
MM a[188:191],v[184:187],v[120:123],a[188:191]
CV v214,v208,v209
CV v215,v210,v211
ds_write_b128 v26, v[212:215] offset:5120
MM a[0:3],v[64:67],v[128:131],a[0:3]
AR v216,a216
AR v217,a217
AR v218,a218
MM a[0:3],v[68:71],v[132:135],a[0:3]
AR v219,a219
AR v220,a248
AR v221,a249
MM a[4:7],v[76:79],v[132:135],a[4:7]
AR v222,a250
AR v223,a251
CV v224,v216,v217
MM a[4:7],v[72:75],v[128:131],a[4:7]
CV v225,v218,v219
CV v226,v220,v221
CV v227,v222,v223
MM a[8:11],v[80:83],v[128:131],a[8:11]
ds_write_b128 v26, v[224:227] offset:6144
AR v228,a220
AR v229,a221
MM a[8:11],v[84:87],v[132:135],a[8:11]
AR v230,a222
AR v231,a223
AR v232,a252
MM a[12:15],v[92:95],v[132:135],a[12:15]
AR v233,a253
AR v234,a254
AR v235,a255
MM a[12:15],v[88:91],v[128:131],a[12:15]
CV v236,v228,v229
CV v237,v230,v231
CV v238,v232,v233
MM a[16:19],v[128:131],v[96:99],a[16:19]
CV v239,v234,v235
ds_write_b128 v26, v[236:239] offset:7168
AR v192,a128
MM a[16:19],v[132:135],v[100:103],a[16:19]
AR v193,a129
AR v194,a130
AR v195,a131
MM a[20:23],v[132:135],v[108:111],a[20:23]
AR v196,a132
AR v197,a133
AR v198,a134
MM a[20:23],v[128:131],v[104:107],a[20:23]
AR v199,a135
CV v200,v192,v193
CV v201,v194,v195
MM a[24:27],v[128:131],v[112:115],a[24:27]
CV v202,v196,v197
CV v203,v198,v199
ds_write_b128 v26, v[200:203] offset:8192
MM a[24:27],v[132:135],v[116:119],a[24:27]
buffer_load_dwordx4 a[192:195], v32, s[32:35], s68 offen offset:0 sc1
buffer_load_dwordx4 a[196:199], v37, s[32:35], s68 offen offset:0 sc1
buffer_load_dwordx4 a[200:203], v32, s[32:35], s69 offen offset:0 sc1
MM a[28:31],v[132:135],v[124:127],a[28:31]
buffer_load_dwordx4 a[204:207], v37, s[32:35], s69 offen offset:0 sc1
AR v204,a136
AR v205,a137
MM a[28:31],v[128:131],v[120:123],a[28:31]
AR v206,a138
AR v207,a139
AR v208,a140
MM a[32:35],v[64:67],v[136:139],a[32:35]
AR v209,a141
AR v210,a142
AR v211,a143
MM a[32:35],v[68:71],v[140:143],a[32:35]
CV v212,v204,v205
CV v213,v206,v207
CV v214,v208,v209
MM a[36:39],v[76:79],v[140:143],a[36:39]
CV v215,v210,v211
ds_write_b128 v26, v[212:215] offset:9216
buffer_load_dwordx4 a[208:211], v32, s[32:35], s68 offen offset:1024 sc1
MM a[36:39],v[72:75],v[136:139],a[36:39]
buffer_load_dwordx4 a[212:215], v37, s[32:35], s68 offen offset:1024 sc1
buffer_load_dwordx4 a[216:219], v32, s[32:35], s69 offen offset:1024 sc1
buffer_load_dwordx4 a[220:223], v37, s[32:35], s69 offen offset:1024 sc1
MM a[40:43],v[80:83],v[136:139],a[40:43]
AR v216,a160
AR v217,a161
AR v218,a162
MM a[40:43],v[84:87],v[140:143],a[40:43]
AR v219,a163
AR v220,a164
AR v221,a165
MM a[44:47],v[92:95],v[140:143],a[44:47]
AR v222,a166
AR v223,a167
CV v224,v216,v217
MM a[44:47],v[88:91],v[136:139],a[44:47]
CV v225,v218,v219
CV v226,v220,v221
CV v227,v222,v223
MM a[48:51],v[136:139],v[96:99],a[48:51]
ds_write_b128 v26, v[224:227] offset:10240
buffer_load_dwordx4 a[224:227], v32, s[32:35], s68 offen offset:2048 sc1
buffer_load_dwordx4 a[228:231], v37, s[32:35], s68 offen offset:2048 sc1
MM a[48:51],v[140:143],v[100:103],a[48:51]
buffer_load_dwordx4 a[232:235], v32, s[32:35], s69 offen offset:2048 sc1
buffer_load_dwordx4 a[236:239], v37, s[32:35], s69 offen offset:2048 sc1
AR v228,a168
MM a[52:55],v[140:143],v[108:111],a[52:55]
AR v229,a169
AR v230,a170
AR v231,a171
MM a[52:55],v[136:139],v[104:107],a[52:55]
AR v232,a172
AR v233,a173
AR v234,a174
MM a[56:59],v[136:139],v[112:115],a[56:59]
AR v235,a175
CV v236,v228,v229
CV v237,v230,v231
MM a[56:59],v[140:143],v[116:119],a[56:59]
CV v238,v232,v233
CV v239,v234,v235
ds_write_b128 v26, v[236:239] offset:11264
MM a[60:63],v[140:143],v[124:127],a[60:63]
buffer_load_dwordx4 a[240:243], v32, s[32:35], s68 offen offset:3072 sc1
buffer_load_dwordx4 a[244:247], v37, s[32:35], s68 offen offset:3072 sc1
buffer_load_dwordx4 a[248:251], v32, s[32:35], s69 offen offset:3072 sc1
MM a[60:63],v[136:139],v[120:123],a[60:63]
buffer_load_dwordx4 a[252:255], v37, s[32:35], s69 offen offset:3072 sc1
s_add_u32 s68, s68, 4096
s_add_u32 s69, s69, 4096
MM a[64:67],v[64:67],v[144:147],a[64:67]
AR v192,a144
AR v193,a145
AR v194,a146
MM a[64:67],v[68:71],v[148:151],a[64:67]
AR v195,a147
AR v196,a176
AR v197,a177
MM a[68:71],v[76:79],v[148:151],a[68:71]
AR v198,a178
AR v199,a179
CV v200,v192,v193
MM a[68:71],v[72:75],v[144:147],a[68:71]
CV v201,v194,v195
CV v202,v196,v197
CV v203,v198,v199
MM a[72:75],v[80:83],v[144:147],a[72:75]
ds_write_b128 v26, v[200:203] offset:12288
AR v204,a148
AR v205,a149
MM a[72:75],v[84:87],v[148:151],a[72:75]
AR v206,a150
AR v207,a151
AR v208,a180
MM a[76:79],v[92:95],v[148:151],a[76:79]
AR v209,a181
AR v210,a182
AR v211,a183
MM a[76:79],v[88:91],v[144:147],a[76:79]
CV v212,v204,v205
CV v213,v206,v207
CV v214,v208,v209
MM a[80:83],v[144:147],v[96:99],a[80:83]
CV v215,v210,v211
ds_write_b128 v26, v[212:215] offset:13312
AR v216,a152
MM a[80:83],v[148:151],v[100:103],a[80:83]
AR v217,a153
AR v218,a154
AR v219,a155
MM a[84:87],v[148:151],v[108:111],a[84:87]
AR v220,a184
AR v221,a185
AR v222,a186
MM a[84:87],v[144:147],v[104:107],a[84:87]
AR v223,a187
CV v224,v216,v217
CV v225,v218,v219
MM a[88:91],v[144:147],v[112:115],a[88:91]
CV v226,v220,v221
CV v227,v222,v223
ds_write_b128 v26, v[224:227] offset:14336
MM a[88:91],v[148:151],v[116:119],a[88:91]
AR v228,a156
AR v229,a157
AR v230,a158
MM a[92:95],v[148:151],v[124:127],a[92:95]
AR v231,a159
AR v232,a188
AR v233,a189
MM a[92:95],v[144:147],v[120:123],a[92:95]
AR v234,a190
AR v235,a191
CV v236,v228,v229
MM a[96:99],v[64:67],v[152:155],a[96:99]
CV v237,v230,v231
CV v238,v232,v233
CV v239,v234,v235
MM a[96:99],v[68:71],v[156:159],a[96:99]
ds_write_b128 v26, v[236:239] offset:15360
ds_read_b64_tr_b16 a[128:129], v44 offset:0
ds_read_b64_tr_b16 a[130:131], v44 offset:2048
MM a[100:103],v[76:79],v[156:159],a[100:103]
ds_read_b64_tr_b16 a[132:133], v44 offset:4096
ds_read_b64_tr_b16 a[134:135], v44 offset:6144
ds_read_b64_tr_b16 a[136:137], v45 offset:0
MM a[100:103],v[72:75],v[152:155],a[100:103]
ds_read_b64_tr_b16 a[138:139], v45 offset:2048
ds_read_b64_tr_b16 a[140:141], v45 offset:4096
ds_read_b64_tr_b16 a[142:143], v45 offset:6144
MM a[104:107],v[80:83],v[152:155],a[104:107]
ds_read_b64_tr_b16 a[144:145], v46 offset:0
ds_read_b64_tr_b16 a[146:147], v46 offset:2048
ds_read_b64_tr_b16 a[148:149], v46 offset:4096
MM a[104:107],v[84:87],v[156:159],a[104:107]
ds_read_b64_tr_b16 a[150:151], v46 offset:6144
ds_read_b64_tr_b16 a[152:153], v47 offset:0
ds_read_b64_tr_b16 a[154:155], v47 offset:2048
MM a[108:111],v[92:95],v[156:159],a[108:111]
ds_read_b64_tr_b16 a[156:157], v47 offset:4096
ds_read_b64_tr_b16 a[158:159], v47 offset:6144
MM a[108:111],v[88:91],v[152:155],a[108:111]
MM a[112:115],v[152:155],v[96:99],a[112:115]
MM a[112:115],v[156:159],v[100:103],a[112:115]
MM a[116:119],v[156:159],v[108:111],a[116:119]
MM a[116:119],v[152:155],v[104:107],a[116:119]
MM a[120:123],v[152:155],v[112:115],a[120:123]
MM a[120:123],v[156:159],v[116:119],a[120:123]
MM a[124:127],v[156:159],v[124:127],a[124:127]
MM a[124:127],v[152:155],v[120:123],a[124:127]
s_waitcnt vmcnt(8) lgkmcnt(8)
MM v[128:131],a[128:131],a[192:195],0
ds_read_b64_tr_b16 a[160:161], v44 offset:8192
AR v4,a0
AR v5,a1
MM v[128:131],a[132:135],a[208:211],v[128:131]
ds_read_b64_tr_b16 a[162:163], v44 offset:10240
AR v6,a2
AR v7,a3
MM v[132:135],a[132:135],a[212:215],0
AR v8,a4
AR v9,a5
MM v[132:135],a[128:131],a[196:199],v[132:135]
ds_read_b64_tr_b16 a[164:165], v44 offset:12288
AR v10,a6
AR v11,a7
MM v[136:139],a[128:131],a[200:203],0
ds_read_b64_tr_b16 a[166:167], v44 offset:14336
CV v64,v4,v5
CV v65,v6,v7
MM v[136:139],a[132:135],a[216:219],v[136:139]
CV v66,v8,v9
CV v67,v10,v11
MM v[140:143],a[132:135],a[220:223],0
ds_read_b64_tr_b16 a[168:169], v45 offset:8192
AR v12,a8
AR v13,a9
MM v[140:143],a[128:131],a[204:207],v[140:143]
ds_read_b64_tr_b16 a[170:171], v45 offset:10240
AR v14,a10
AR v15,a11
MM v[144:147],a[136:139],a[192:195],0
AR v16,a12
AR v17,a13
MM v[144:147],a[140:143],a[208:211],v[144:147]
ds_read_b64_tr_b16 a[172:173], v45 offset:12288
AR v18,a14
AR v19,a15
MM v[148:151],a[140:143],a[212:215],0
ds_read_b64_tr_b16 a[174:175], v45 offset:14336
CV v68,v12,v13
CV v69,v14,v15
MM v[148:151],a[136:139],a[196:199],v[148:151]
CV v70,v16,v17
CV v71,v18,v19
MM v[152:155],a[136:139],a[200:203],0
AR v4,a32
AR v5,a33
MM v[152:155],a[140:143],a[216:219],v[152:155]
AR v6,a34
AR v7,a35
MM v[156:159],a[140:143],a[220:223],0
AR v8,a36
AR v9,a37
MM v[156:159],a[136:139],a[204:207],v[156:159]
AR v10,a38
AR v11,a39
s_waitcnt lgkmcnt(8)
MM v[160:163],a[144:147],a[192:195],0
ds_read_b64_tr_b16 a[176:177], v46 offset:8192
CV v72,v4,v5
CV v73,v6,v7
MM v[160:163],a[148:151],a[208:211],v[160:163]
ds_read_b64_tr_b16 a[178:179], v46 offset:10240
CV v74,v8,v9
CV v75,v10,v11
MM v[164:167],a[148:151],a[212:215],0
AR v12,a40
AR v13,a41
MM v[164:167],a[144:147],a[196:199],v[164:167]
ds_read_b64_tr_b16 a[180:181], v46 offset:12288
AR v14,a42
AR v15,a43
MM v[168:171],a[144:147],a[200:203],0
ds_read_b64_tr_b16 a[182:183], v46 offset:14336
AR v16,a44
AR v17,a45
MM v[168:171],a[148:151],a[216:219],v[168:171]
AR v18,a46
AR v19,a47
MM v[172:175],a[148:151],a[220:223],0
ds_read_b64_tr_b16 a[184:185], v47 offset:8192
CV v76,v12,v13
CV v77,v14,v15
MM v[172:175],a[144:147],a[204:207],v[172:175]
ds_read_b64_tr_b16 a[186:187], v47 offset:10240
CV v78,v16,v17
CV v79,v18,v19
MM v[176:179],a[152:155],a[192:195],0
AR v4,a16
AR v5,a17
MM v[176:179],a[156:159],a[208:211],v[176:179]
ds_read_b64_tr_b16 a[188:189], v47 offset:12288
AR v6,a18
AR v7,a19
MM v[180:183],a[156:159],a[212:215],0
ds_read_b64_tr_b16 a[190:191], v47 offset:14336
AR v8,a48
AR v9,a49
MM v[180:183],a[152:155],a[196:199],v[180:183]
AR v10,a50
AR v11,a51
MM v[184:187],a[152:155],a[200:203],0
CV v80,v4,v5
CV v81,v6,v7
MM v[184:187],a[156:159],a[216:219],v[184:187]
CV v82,v8,v9
CV v83,v10,v11
MM v[188:191],a[156:159],a[220:223],0
AR v12,a20
AR v13,a21
MM v[188:191],a[152:155],a[204:207],v[188:191]
AR v14,a22
AR v15,a23
s_waitcnt lgkmcnt(8)
MM v[192:195],a[160:163],a[192:195],0
ds_read_b64_tr_b16 a[128:129], v44 offset:16384
AR v16,a52
AR v17,a53
MM v[192:195],a[164:167],a[208:211],v[192:195]
ds_read_b64_tr_b16 a[130:131], v44 offset:18432
AR v18,a54
AR v19,a55
MM v[196:199],a[164:167],a[212:215],0
CV v84,v12,v13
CV v85,v14,v15
MM v[196:199],a[160:163],a[196:199],v[196:199]
ds_read_b64_tr_b16 a[132:133], v44 offset:20480
CV v86,v16,v17
CV v87,v18,v19
MM v[200:203],a[160:163],a[200:203],0
ds_read_b64_tr_b16 a[134:135], v44 offset:22528
AR v4,a24
AR v5,a25
MM v[200:203],a[164:167],a[216:219],v[200:203]
AR v6,a26
AR v7,a27
MM v[204:207],a[164:167],a[220:223],0
ds_read_b64_tr_b16 a[136:137], v45 offset:16384
AR v8,a56
AR v9,a57
MM v[204:207],a[160:163],a[204:207],v[204:207]
ds_read_b64_tr_b16 a[138:139], v45 offset:18432
AR v10,a58
AR v11,a59
MM v[208:211],a[168:171],a[192:195],0
CV v88,v4,v5
CV v89,v6,v7
MM v[208:211],a[172:175],a[208:211],v[208:211]
ds_read_b64_tr_b16 a[140:141], v45 offset:20480
CV v90,v8,v9
CV v91,v10,v11
MM v[212:215],a[172:175],a[212:215],0
ds_read_b64_tr_b16 a[142:143], v45 offset:22528
AR v12,a28
AR v13,a29
MM v[212:215],a[168:171],a[196:199],v[212:215]
AR v14,a30
AR v15,a31
MM v[216:219],a[168:171],a[200:203],0
AR v16,a60
AR v17,a61
MM v[216:219],a[172:175],a[216:219],v[216:219]
AR v18,a62
AR v19,a63
MM v[220:223],a[172:175],a[220:223],0
CV v92,v12,v13
CV v93,v14,v15
MM v[220:223],a[168:171],a[204:207],v[220:223]
CV v94,v16,v17
CV v95,v18,v19
s_waitcnt lgkmcnt(8)
MM v[224:227],a[176:179],a[192:195],0
ds_read_b64_tr_b16 a[144:145], v46 offset:16384
AR v4,a64
AR v5,a65
MM v[224:227],a[180:183],a[208:211],v[224:227]
ds_read_b64_tr_b16 a[146:147], v46 offset:18432
AR v6,a66
AR v7,a67
MM v[228:231],a[180:183],a[212:215],0
AR v8,a68
AR v9,a69
MM v[228:231],a[176:179],a[196:199],v[228:231]
ds_read_b64_tr_b16 a[148:149], v46 offset:20480
AR v10,a70
AR v11,a71
MM v[232:235],a[176:179],a[200:203],0
ds_read_b64_tr_b16 a[150:151], v46 offset:22528
CV v96,v4,v5
CV v97,v6,v7
MM v[232:235],a[180:183],a[216:219],v[232:235]
CV v98,v8,v9
CV v99,v10,v11
MM v[236:239],a[180:183],a[220:223],0
ds_read_b64_tr_b16 a[152:153], v47 offset:16384
AR v12,a72
AR v13,a73
MM v[236:239],a[176:179],a[204:207],v[236:239]
ds_read_b64_tr_b16 a[154:155], v47 offset:18432
AR v14,a74
AR v15,a75
MM v[240:243],a[184:187],a[192:195],0
AR v16,a76
AR v17,a77
MM v[240:243],a[188:191],a[208:211],v[240:243]
ds_read_b64_tr_b16 a[156:157], v47 offset:20480
AR v18,a78
AR v19,a79
MM v[244:247],a[188:191],a[212:215],0
ds_read_b64_tr_b16 a[158:159], v47 offset:22528
CV v100,v12,v13
CV v101,v14,v15
MM v[244:247],a[184:187],a[196:199],v[244:247]
CV v102,v16,v17
CV v103,v18,v19
MM v[248:251],a[184:187],a[200:203],0
AR v4,a96
AR v5,a97
MM v[248:251],a[188:191],a[216:219],v[248:251]
AR v6,a98
AR v7,a99
MM v[252:255],a[188:191],a[220:223],0
AR v8,a100
AR v9,a101
MM v[252:255],a[184:187],a[204:207],v[252:255]
AR v10,a102
AR v11,a103
s_waitcnt vmcnt(63) lgkmcnt(8)
MM a[0:3],a[128:131],a[192:195],0
ds_read_b64_tr_b16 a[160:161], v44 offset:24576
CV v104,v4,v5
CV v105,v6,v7
MM a[0:3],a[132:135],a[208:211],a[0:3]
ds_read_b64_tr_b16 a[162:163], v44 offset:26624
CV v106,v8,v9
CV v107,v10,v11
MM a[4:7],a[132:135],a[212:215],0
s_add_u32 s63, s16, 0
AR v12,a104
AR v13,a105
MM a[4:7],a[128:131],a[196:199],a[4:7]
ds_read_b64_tr_b16 a[164:165], v44 offset:28672
AR v14,a106
AR v15,a107
MM a[8:11],a[128:131],a[200:203],0
ds_read_b64_tr_b16 a[166:167], v44 offset:30720
AR v16,a108
AR v17,a109
MM a[8:11],a[132:135],a[216:219],a[8:11]
buffer_store_dwordx4 v[64:67], v1, s[32:35], s63 offen offset:0 sc0 sc1
AR v18,a110
AR v19,a111
MM a[12:15],a[132:135],a[220:223],0
ds_read_b64_tr_b16 a[168:169], v45 offset:24576
CV v108,v12,v13
CV v109,v14,v15
MM a[12:15],a[128:131],a[204:207],a[12:15]
ds_read_b64_tr_b16 a[170:171], v45 offset:26624
CV v110,v16,v17
CV v111,v18,v19
MM a[16:19],a[136:139],a[192:195],0
s_add_u32 s63, s16, 0
AR v4,a80
AR v5,a81
MM a[16:19],a[140:143],a[208:211],a[16:19]
ds_read_b64_tr_b16 a[172:173], v45 offset:28672
AR v6,a82
AR v7,a83
MM a[20:23],a[140:143],a[212:215],0
ds_read_b64_tr_b16 a[174:175], v45 offset:30720
AR v8,a112
AR v9,a113
MM a[20:23],a[136:139],a[196:199],a[20:23]
buffer_store_dwordx4 v[68:71], v1, s[32:35], s63 offen offset:1024 sc0 sc1
AR v10,a114
AR v11,a115
MM a[24:27],a[136:139],a[200:203],0
s_add_u32 s63, s16, 4096
CV v112,v4,v5
CV v113,v6,v7
MM a[24:27],a[140:143],a[216:219],a[24:27]
CV v114,v8,v9
CV v115,v10,v11
MM a[28:31],a[140:143],a[220:223],0
AR v12,a84
AR v13,a85
MM a[28:31],a[136:139],a[204:207],a[28:31]
buffer_store_dwordx4 v[72:75], v1, s[32:35], s63 offen offset:0 sc0 sc1
AR v14,a86
AR v15,a87
s_waitcnt lgkmcnt(8)
MM a[32:35],a[144:147],a[192:195],0
ds_read_b64_tr_b16 a[176:177], v46 offset:24576
AR v16,a116
AR v17,a117
MM a[32:35],a[148:151],a[208:211],a[32:35]
ds_read_b64_tr_b16 a[178:179], v46 offset:26624
AR v18,a118
AR v19,a119
MM a[36:39],a[148:151],a[212:215],0
CV v116,v12,v13
CV v117,v14,v15
MM a[36:39],a[144:147],a[196:199],a[36:39]
ds_read_b64_tr_b16 a[180:181], v46 offset:28672
CV v118,v16,v17
CV v119,v18,v19
MM a[40:43],a[144:147],a[200:203],0
ds_read_b64_tr_b16 a[182:183], v46 offset:30720
AR v4,a88
AR v5,a89
MM a[40:43],a[148:151],a[216:219],a[40:43]
AR v6,a90
AR v7,a91
MM a[44:47],a[148:151],a[220:223],0
ds_read_b64_tr_b16 a[184:185], v47 offset:24576
AR v8,a120
AR v9,a121
MM a[44:47],a[144:147],a[204:207],a[44:47]
ds_read_b64_tr_b16 a[186:187], v47 offset:26624
AR v10,a122
AR v11,a123
MM a[48:51],a[152:155],a[192:195],0
CV v120,v4,v5
CV v121,v6,v7
MM a[48:51],a[156:159],a[208:211],a[48:51]
ds_read_b64_tr_b16 a[188:189], v47 offset:28672
CV v122,v8,v9
CV v123,v10,v11
MM a[52:55],a[156:159],a[212:215],0
ds_read_b64_tr_b16 a[190:191], v47 offset:30720
AR v12,a92
AR v13,a93
MM a[52:55],a[152:155],a[196:199],a[52:55]
AR v14,a94
AR v15,a95
MM a[56:59],a[152:155],a[200:203],0
AR v16,a124
AR v17,a125
MM a[56:59],a[156:159],a[216:219],a[56:59]
AR v18,a126
AR v19,a127
MM a[60:63],a[156:159],a[220:223],0
CV v124,v12,v13
CV v125,v14,v15
MM a[60:63],a[152:155],a[204:207],a[60:63]
CV v126,v16,v17
CV v127,v18,v19
s_waitcnt lgkmcnt(8)
MM a[64:67],a[160:163],a[192:195],0
s_waitcnt vmcnt(27) lgkmcnt(0)
s_barrier
ds_read_b64_tr_b16 a[128:129], v40 offset:0
MM a[64:67],a[164:167],a[208:211],a[64:67]
ds_read_b64_tr_b16 a[130:131], v40 offset:2048
MM a[68:71],a[164:167],a[212:215],0
s_add_u32 m0, s70, 131072
MM a[68:71],a[160:163],a[196:199],a[68:71]
ds_read_b64_tr_b16 a[132:133], v40 offset:4096
MM a[72:75],a[160:163],a[200:203],0
ds_read_b64_tr_b16 a[134:135], v40 offset:6144
MM a[72:75],a[164:167],a[216:219],a[72:75]
buffer_load_dwordx4 v33, s[36:39], s64 offen offset:0 sc1 lds
MM a[76:79],a[164:167],a[220:223],0
ds_read_b64_tr_b16 a[136:137], v41 offset:0
MM a[76:79],a[160:163],a[204:207],a[76:79]
ds_read_b64_tr_b16 a[138:139], v41 offset:2048
MM a[80:83],a[168:171],a[192:195],0
MM a[80:83],a[172:175],a[208:211],a[80:83]
ds_read_b64_tr_b16 a[140:141], v41 offset:4096
MM a[84:87],a[172:175],a[212:215],0
ds_read_b64_tr_b16 a[142:143], v41 offset:6144
MM a[84:87],a[168:171],a[196:199],a[84:87]
buffer_load_dwordx4 v34, s[36:39], s64 offen offset:1024 sc1 lds
s_add_u32 s64, s64, 524288
MM a[88:91],a[168:171],a[200:203],0
s_add_u32 m0, s70, 139264
MM a[88:91],a[172:175],a[216:219],a[88:91]
MM a[92:95],a[172:175],a[220:223],0
MM a[92:95],a[168:171],a[204:207],a[92:95]
buffer_load_dwordx4 v33, s[36:39], s65 offen offset:0 sc1 lds
s_waitcnt lgkmcnt(8)
MM a[96:99],a[176:179],a[192:195],0
ds_read_b64_tr_b16 a[144:145], v42 offset:0
MM a[96:99],a[180:183],a[208:211],a[96:99]
ds_read_b64_tr_b16 a[146:147], v42 offset:2048
MM a[100:103],a[180:183],a[212:215],0
MM a[100:103],a[176:179],a[196:199],a[100:103]
ds_read_b64_tr_b16 a[148:149], v42 offset:4096
MM a[104:107],a[176:179],a[200:203],0
ds_read_b64_tr_b16 a[150:151], v42 offset:6144
MM a[104:107],a[180:183],a[216:219],a[104:107]
buffer_load_dwordx4 v34, s[36:39], s65 offen offset:1024 sc1 lds
s_add_u32 s65, s65, 524288
MM a[108:111],a[180:183],a[220:223],0
ds_read_b64_tr_b16 a[152:153], v43 offset:0
MM a[108:111],a[176:179],a[204:207],a[108:111]
ds_read_b64_tr_b16 a[154:155], v43 offset:2048
MM a[112:115],a[184:187],a[192:195],0
s_add_u32 m0, s70, 147456
MM a[112:115],a[188:191],a[208:211],a[112:115]
ds_read_b64_tr_b16 a[156:157], v43 offset:4096
MM a[116:119],a[188:191],a[212:215],0
ds_read_b64_tr_b16 a[158:159], v43 offset:6144
MM a[116:119],a[184:187],a[196:199],a[116:119]
buffer_load_dwordx4 v35, s[40:43], s66 offen offset:0 sc1 lds
MM a[120:123],a[184:187],a[200:203],0
MM a[120:123],a[188:191],a[216:219],a[120:123]
MM a[124:127],a[188:191],a[220:223],0
MM a[124:127],a[184:187],a[204:207],a[124:127]
buffer_load_dwordx4 v36, s[40:43], s66 offen offset:1024 sc1 lds
s_add_u32 s66, s66, 221184
s_waitcnt vmcnt(9) lgkmcnt(8)
MM v[128:131],a[128:131],a[224:227],v[128:131]
ds_read_b64_tr_b16 a[160:161], v40 offset:8192
MM v[128:131],a[132:135],a[240:243],v[128:131]
ds_read_b64_tr_b16 a[162:163], v40 offset:10240
MM v[132:135],a[132:135],a[244:247],v[132:135]
MM v[132:135],a[128:131],a[228:231],v[132:135]
ds_read_b64_tr_b16 a[164:165], v40 offset:12288
MM v[136:139],a[128:131],a[232:235],v[136:139]
ds_read_b64_tr_b16 a[166:167], v40 offset:14336
MM v[136:139],a[132:135],a[248:251],v[136:139]
buffer_load_dwordx4 a[192:195], v32, s[32:35], s68 offen offset:0 sc1
MM v[140:143],a[132:135],a[252:255],v[140:143]
ds_read_b64_tr_b16 a[168:169], v41 offset:8192
MM v[140:143],a[128:131],a[236:239],v[140:143]
ds_read_b64_tr_b16 a[170:171], v41 offset:10240
MM v[144:147],a[136:139],a[224:227],v[144:147]
MM v[144:147],a[140:143],a[240:243],v[144:147]
ds_read_b64_tr_b16 a[172:173], v41 offset:12288
MM v[148:151],a[140:143],a[244:247],v[148:151]
ds_read_b64_tr_b16 a[174:175], v41 offset:14336
MM v[148:151],a[136:139],a[228:231],v[148:151]
buffer_load_dwordx4 a[196:199], v37, s[32:35], s68 offen offset:0 sc1
MM v[152:155],a[136:139],a[232:235],v[152:155]
MM v[152:155],a[140:143],a[248:251],v[152:155]
MM v[156:159],a[140:143],a[252:255],v[156:159]
MM v[156:159],a[136:139],a[236:239],v[156:159]
buffer_load_dwordx4 a[200:203], v32, s[32:35], s69 offen offset:0 sc1
s_waitcnt lgkmcnt(8)
MM v[160:163],a[144:147],a[224:227],v[160:163]
ds_read_b64_tr_b16 a[176:177], v42 offset:8192
MM v[160:163],a[148:151],a[240:243],v[160:163]
ds_read_b64_tr_b16 a[178:179], v42 offset:10240
MM v[164:167],a[148:151],a[244:247],v[164:167]
MM v[164:167],a[144:147],a[228:231],v[164:167]
ds_read_b64_tr_b16 a[180:181], v42 offset:12288
MM v[168:171],a[144:147],a[232:235],v[168:171]
ds_read_b64_tr_b16 a[182:183], v42 offset:14336
MM v[168:171],a[148:151],a[248:251],v[168:171]
buffer_load_dwordx4 a[204:207], v37, s[32:35], s69 offen offset:0 sc1
MM v[172:175],a[148:151],a[252:255],v[172:175]
ds_read_b64_tr_b16 a[184:185], v43 offset:8192
MM v[172:175],a[144:147],a[236:239],v[172:175]
ds_read_b64_tr_b16 a[186:187], v43 offset:10240
MM v[176:179],a[152:155],a[224:227],v[176:179]
MM v[176:179],a[156:159],a[240:243],v[176:179]
ds_read_b64_tr_b16 a[188:189], v43 offset:12288
MM v[180:183],a[156:159],a[244:247],v[180:183]
ds_read_b64_tr_b16 a[190:191], v43 offset:14336
MM v[180:183],a[152:155],a[228:231],v[180:183]
buffer_load_dwordx4 a[208:211], v32, s[32:35], s68 offen offset:1024 sc1
MM v[184:187],a[152:155],a[232:235],v[184:187]
MM v[184:187],a[156:159],a[248:251],v[184:187]
MM v[188:191],a[156:159],a[252:255],v[188:191]
MM v[188:191],a[152:155],a[236:239],v[188:191]
buffer_load_dwordx4 a[212:215], v37, s[32:35], s68 offen offset:1024 sc1
s_waitcnt lgkmcnt(8)
MM v[192:195],a[160:163],a[224:227],v[192:195]
ds_read_b64_tr_b16 a[128:129], v40 offset:16384
MM v[192:195],a[164:167],a[240:243],v[192:195]
ds_read_b64_tr_b16 a[130:131], v40 offset:18432
MM v[196:199],a[164:167],a[244:247],v[196:199]
MM v[196:199],a[160:163],a[228:231],v[196:199]
ds_read_b64_tr_b16 a[132:133], v40 offset:20480
MM v[200:203],a[160:163],a[232:235],v[200:203]
ds_read_b64_tr_b16 a[134:135], v40 offset:22528
MM v[200:203],a[164:167],a[248:251],v[200:203]
buffer_load_dwordx4 a[216:219], v32, s[32:35], s69 offen offset:1024 sc1
MM v[204:207],a[164:167],a[252:255],v[204:207]
ds_read_b64_tr_b16 a[136:137], v41 offset:16384
MM v[204:207],a[160:163],a[236:239],v[204:207]
ds_read_b64_tr_b16 a[138:139], v41 offset:18432
MM v[208:211],a[168:171],a[224:227],v[208:211]
MM v[208:211],a[172:175],a[240:243],v[208:211]
ds_read_b64_tr_b16 a[140:141], v41 offset:20480
MM v[212:215],a[172:175],a[244:247],v[212:215]
ds_read_b64_tr_b16 a[142:143], v41 offset:22528
MM v[212:215],a[168:171],a[228:231],v[212:215]
buffer_load_dwordx4 a[220:223], v37, s[32:35], s69 offen offset:1024 sc1
s_add_u32 m0, s70, 155648
MM v[216:219],a[168:171],a[232:235],v[216:219]
MM v[216:219],a[172:175],a[248:251],v[216:219]
MM v[220:223],a[172:175],a[252:255],v[220:223]
MM v[220:223],a[168:171],a[236:239],v[220:223]
buffer_load_dwordx4 v35, s[44:47], s67 offen offset:0 sc1 lds
s_waitcnt lgkmcnt(8)
MM v[224:227],a[176:179],a[224:227],v[224:227]
ds_read_b64_tr_b16 a[144:145], v42 offset:16384
MM v[224:227],a[180:183],a[240:243],v[224:227]
ds_read_b64_tr_b16 a[146:147], v42 offset:18432
MM v[228:231],a[180:183],a[244:247],v[228:231]
MM v[228:231],a[176:179],a[228:231],v[228:231]
ds_read_b64_tr_b16 a[148:149], v42 offset:20480
MM v[232:235],a[176:179],a[232:235],v[232:235]
ds_read_b64_tr_b16 a[150:151], v42 offset:22528
MM v[232:235],a[180:183],a[248:251],v[232:235]
buffer_load_dwordx4 v36, s[44:47], s67 offen offset:1024 sc1 lds
s_add_u32 s67, s67, 221184
MM v[236:239],a[180:183],a[252:255],v[236:239]
ds_read_b64_tr_b16 a[152:153], v43 offset:16384
MM v[236:239],a[176:179],a[236:239],v[236:239]
ds_read_b64_tr_b16 a[154:155], v43 offset:18432
MM v[240:243],a[184:187],a[224:227],v[240:243]
ds_read_b128 v[64:67], v26 offset:0
ds_read_b128 v[68:71], v26 offset:1024
MM v[240:243],a[188:191],a[240:243],v[240:243]
ds_read_b64_tr_b16 a[156:157], v43 offset:20480
MM v[244:247],a[188:191],a[244:247],v[244:247]
ds_read_b64_tr_b16 a[158:159], v43 offset:22528
MM v[244:247],a[184:187],a[228:231],v[244:247]
ds_read_b128 v[72:75], v26 offset:2048
s_add_u32 s63, s16, 4096
MM v[248:251],a[184:187],a[232:235],v[248:251]
buffer_store_dwordx4 v[76:79], v1, s[32:35], s63 offen offset:1024 sc0 sc1
s_add_u32 s63, s17, 0
MM v[248:251],a[188:191],a[248:251],v[248:251]
MM v[252:255],a[188:191],a[252:255],v[252:255]
MM v[252:255],a[184:187],a[236:239],v[252:255]
s_waitcnt vmcnt(63) lgkmcnt(8)
MM a[0:3],a[128:131],a[224:227],a[0:3]
ds_read_b64_tr_b16 a[160:161], v40 offset:24576
MM a[0:3],a[132:135],a[240:243],a[0:3]
ds_read_b64_tr_b16 a[162:163], v40 offset:26624
MM a[4:7],a[132:135],a[244:247],a[4:7]
buffer_store_dwordx4 v[80:83], v1, s[32:35], s63 offen offset:0 sc0 sc1
ds_read_b128 v[76:79], v26 offset:3072
MM a[4:7],a[128:131],a[228:231],a[4:7]
ds_read_b64_tr_b16 a[164:165], v40 offset:28672
MM a[8:11],a[128:131],a[232:235],a[8:11]
ds_read_b64_tr_b16 a[166:167], v40 offset:30720
MM a[8:11],a[132:135],a[248:251],a[8:11]
ds_read_b128 v[80:83], v26 offset:4096
s_add_u32 s63, s17, 0
MM a[12:15],a[132:135],a[252:255],a[12:15]
ds_read_b64_tr_b16 a[168:169], v41 offset:24576
MM a[12:15],a[128:131],a[236:239],a[12:15]
ds_read_b64_tr_b16 a[170:171], v41 offset:26624
MM a[16:19],a[136:139],a[224:227],a[16:19]
buffer_store_dwordx4 v[84:87], v1, s[32:35], s63 offen offset:1024 sc0 sc1
s_add_u32 s63, s17, 0
MM a[16:19],a[140:143],a[240:243],a[16:19]
ds_read_b64_tr_b16 a[172:173], v41 offset:28672
MM a[20:23],a[140:143],a[244:247],a[20:23]
ds_read_b64_tr_b16 a[174:175], v41 offset:30720
MM a[20:23],a[136:139],a[228:231],a[20:23]
MM a[24:27],a[136:139],a[232:235],a[24:27]
buffer_store_dwordx4 v[88:91], v1, s[32:35], s63 offen offset:2048 sc0 sc1
s_add_u32 s63, s17, 0
MM a[24:27],a[140:143],a[248:251],a[24:27]
MM a[28:31],a[140:143],a[252:255],a[28:31]
MM a[28:31],a[136:139],a[236:239],a[28:31]
s_waitcnt lgkmcnt(8)
MM a[32:35],a[144:147],a[224:227],a[32:35]
ds_read_b64_tr_b16 a[176:177], v42 offset:24576
MM a[32:35],a[148:151],a[240:243],a[32:35]
ds_read_b64_tr_b16 a[178:179], v42 offset:26624
MM a[36:39],a[148:151],a[244:247],a[36:39]
buffer_store_dwordx4 v[92:95], v1, s[32:35], s63 offen offset:3072 sc0 sc1
MM a[36:39],a[144:147],a[228:231],a[36:39]
ds_read_b64_tr_b16 a[180:181], v42 offset:28672
MM a[40:43],a[144:147],a[232:235],a[40:43]
ds_read_b64_tr_b16 a[182:183], v42 offset:30720
MM a[40:43],a[148:151],a[248:251],a[40:43]
MM a[44:47],a[148:151],a[252:255],a[44:47]
ds_read_b64_tr_b16 a[184:185], v43 offset:24576
MM a[44:47],a[144:147],a[236:239],a[44:47]
ds_read_b64_tr_b16 a[186:187], v43 offset:26624
MM a[48:51],a[152:155],a[224:227],a[48:51]
MM a[48:51],a[156:159],a[240:243],a[48:51]
ds_read_b64_tr_b16 a[188:189], v43 offset:28672
MM a[52:55],a[156:159],a[244:247],a[52:55]
ds_read_b64_tr_b16 a[190:191], v43 offset:30720
MM a[52:55],a[152:155],a[228:231],a[52:55]
MM a[56:59],a[152:155],a[232:235],a[56:59]
MM a[56:59],a[156:159],a[248:251],a[56:59]
MM a[60:63],a[156:159],a[252:255],a[60:63]
MM a[60:63],a[152:155],a[236:239],a[60:63]
s_waitcnt lgkmcnt(8)
MM a[64:67],a[160:163],a[224:227],a[64:67]
s_waitcnt vmcnt(40) lgkmcnt(0)
s_barrier
ds_read_b64_tr_b16 a[128:129], v40 offset:32768
MM a[64:67],a[164:167],a[240:243],a[64:67]
ds_read_b64_tr_b16 a[130:131], v40 offset:34816
MM a[68:71],a[164:167],a[244:247],a[68:71]
s_add_u32 m0, s70, 65536
MM a[68:71],a[160:163],a[228:231],a[68:71]
ds_read_b64_tr_b16 a[132:133], v40 offset:36864
MM a[72:75],a[160:163],a[232:235],a[72:75]
ds_read_b64_tr_b16 a[134:135], v40 offset:38912
MM a[72:75],a[164:167],a[248:251],a[72:75]
buffer_load_dwordx4 v33, s[36:39], s64 offen offset:0 sc1 lds
MM a[76:79],a[164:167],a[252:255],a[76:79]
ds_read_b64_tr_b16 a[136:137], v41 offset:32768
MM a[76:79],a[160:163],a[236:239],a[76:79]
ds_read_b64_tr_b16 a[138:139], v41 offset:34816
MM a[80:83],a[168:171],a[224:227],a[80:83]
MM a[80:83],a[172:175],a[240:243],a[80:83]
ds_read_b64_tr_b16 a[140:141], v41 offset:36864
MM a[84:87],a[172:175],a[244:247],a[84:87]
ds_read_b64_tr_b16 a[142:143], v41 offset:38912
MM a[84:87],a[168:171],a[228:231],a[84:87]
buffer_load_dwordx4 v34, s[36:39], s64 offen offset:1024 sc1 lds
s_add_u32 s64, s64, 524288
MM a[88:91],a[168:171],a[232:235],a[88:91]
s_add_u32 m0, s70, 73728
MM a[88:91],a[172:175],a[248:251],a[88:91]
MM a[92:95],a[172:175],a[252:255],a[92:95]
MM a[92:95],a[168:171],a[236:239],a[92:95]
buffer_load_dwordx4 v33, s[36:39], s65 offen offset:0 sc1 lds
s_waitcnt lgkmcnt(8)
MM a[96:99],a[176:179],a[224:227],a[96:99]
ds_read_b64_tr_b16 a[144:145], v42 offset:32768
MM a[96:99],a[180:183],a[240:243],a[96:99]
ds_read_b64_tr_b16 a[146:147], v42 offset:34816
MM a[100:103],a[180:183],a[244:247],a[100:103]
MM a[100:103],a[176:179],a[228:231],a[100:103]
ds_read_b64_tr_b16 a[148:149], v42 offset:36864
MM a[104:107],a[176:179],a[232:235],a[104:107]
ds_read_b64_tr_b16 a[150:151], v42 offset:38912
MM a[104:107],a[180:183],a[248:251],a[104:107]
buffer_load_dwordx4 v34, s[36:39], s65 offen offset:1024 sc1 lds
s_add_u32 s65, s65, 524288
MM a[108:111],a[180:183],a[252:255],a[108:111]
ds_read_b64_tr_b16 a[152:153], v43 offset:32768
MM a[108:111],a[176:179],a[236:239],a[108:111]
ds_read_b64_tr_b16 a[154:155], v43 offset:34816
MM a[112:115],a[184:187],a[224:227],a[112:115]
s_add_u32 m0, s70, 81920
MM a[112:115],a[188:191],a[240:243],a[112:115]
ds_read_b64_tr_b16 a[156:157], v43 offset:36864
MM a[116:119],a[188:191],a[244:247],a[116:119]
ds_read_b64_tr_b16 a[158:159], v43 offset:38912
MM a[116:119],a[184:187],a[228:231],a[116:119]
buffer_load_dwordx4 v35, s[40:43], s66 offen offset:0 sc1 lds
MM a[120:123],a[184:187],a[232:235],a[120:123]
MM a[120:123],a[188:191],a[248:251],a[120:123]
MM a[124:127],a[188:191],a[252:255],a[124:127]
MM a[124:127],a[184:187],a[236:239],a[124:127]
buffer_load_dwordx4 v36, s[40:43], s66 offen offset:1024 sc1 lds
s_add_u32 s66, s66, 221184
s_waitcnt vmcnt(13) lgkmcnt(8)
MM v[128:131],a[128:131],a[192:195],v[128:131]
ds_read_b64_tr_b16 a[160:161], v40 offset:40960
MM v[128:131],a[132:135],a[208:211],v[128:131]
ds_read_b64_tr_b16 a[162:163], v40 offset:43008
MM v[132:135],a[132:135],a[212:215],v[132:135]
MM v[132:135],a[128:131],a[196:199],v[132:135]
ds_read_b64_tr_b16 a[164:165], v40 offset:45056
MM v[136:139],a[128:131],a[200:203],v[136:139]
ds_read_b64_tr_b16 a[166:167], v40 offset:47104
MM v[136:139],a[132:135],a[216:219],v[136:139]
buffer_load_dwordx4 a[224:227], v32, s[32:35], s68 offen offset:2048 sc1
MM v[140:143],a[132:135],a[220:223],v[140:143]
ds_read_b64_tr_b16 a[168:169], v41 offset:40960
MM v[140:143],a[128:131],a[204:207],v[140:143]
ds_read_b64_tr_b16 a[170:171], v41 offset:43008
MM v[144:147],a[136:139],a[192:195],v[144:147]
MM v[144:147],a[140:143],a[208:211],v[144:147]
ds_read_b64_tr_b16 a[172:173], v41 offset:45056
MM v[148:151],a[140:143],a[212:215],v[148:151]
ds_read_b64_tr_b16 a[174:175], v41 offset:47104
MM v[148:151],a[136:139],a[196:199],v[148:151]
buffer_load_dwordx4 a[228:231], v37, s[32:35], s68 offen offset:2048 sc1
MM v[152:155],a[136:139],a[200:203],v[152:155]
MM v[152:155],a[140:143],a[216:219],v[152:155]
MM v[156:159],a[140:143],a[220:223],v[156:159]
MM v[156:159],a[136:139],a[204:207],v[156:159]
buffer_load_dwordx4 a[232:235], v32, s[32:35], s69 offen offset:2048 sc1
s_waitcnt lgkmcnt(8)
MM v[160:163],a[144:147],a[192:195],v[160:163]
ds_read_b64_tr_b16 a[176:177], v42 offset:40960
MM v[160:163],a[148:151],a[208:211],v[160:163]
ds_read_b64_tr_b16 a[178:179], v42 offset:43008
MM v[164:167],a[148:151],a[212:215],v[164:167]
MM v[164:167],a[144:147],a[196:199],v[164:167]
ds_read_b64_tr_b16 a[180:181], v42 offset:45056
MM v[168:171],a[144:147],a[200:203],v[168:171]
ds_read_b64_tr_b16 a[182:183], v42 offset:47104
MM v[168:171],a[148:151],a[216:219],v[168:171]
buffer_load_dwordx4 a[236:239], v37, s[32:35], s69 offen offset:2048 sc1
MM v[172:175],a[148:151],a[220:223],v[172:175]
ds_read_b64_tr_b16 a[184:185], v43 offset:40960
MM v[172:175],a[144:147],a[204:207],v[172:175]
ds_read_b64_tr_b16 a[186:187], v43 offset:43008
MM v[176:179],a[152:155],a[192:195],v[176:179]
MM v[176:179],a[156:159],a[208:211],v[176:179]
ds_read_b64_tr_b16 a[188:189], v43 offset:45056
MM v[180:183],a[156:159],a[212:215],v[180:183]
ds_read_b64_tr_b16 a[190:191], v43 offset:47104
MM v[180:183],a[152:155],a[196:199],v[180:183]
buffer_load_dwordx4 a[240:243], v32, s[32:35], s68 offen offset:3072 sc1
MM v[184:187],a[152:155],a[200:203],v[184:187]
MM v[184:187],a[156:159],a[216:219],v[184:187]
MM v[188:191],a[156:159],a[220:223],v[188:191]
MM v[188:191],a[152:155],a[204:207],v[188:191]
buffer_load_dwordx4 a[244:247], v37, s[32:35], s68 offen offset:3072 sc1
s_waitcnt lgkmcnt(8)
MM v[192:195],a[160:163],a[192:195],v[192:195]
ds_read_b64_tr_b16 a[128:129], v40 offset:49152
MM v[192:195],a[164:167],a[208:211],v[192:195]
ds_read_b64_tr_b16 a[130:131], v40 offset:51200
MM v[196:199],a[164:167],a[212:215],v[196:199]
MM v[196:199],a[160:163],a[196:199],v[196:199]
ds_read_b64_tr_b16 a[132:133], v40 offset:53248
MM v[200:203],a[160:163],a[200:203],v[200:203]
ds_read_b64_tr_b16 a[134:135], v40 offset:55296
MM v[200:203],a[164:167],a[216:219],v[200:203]
buffer_load_dwordx4 a[248:251], v32, s[32:35], s69 offen offset:3072 sc1
MM v[204:207],a[164:167],a[220:223],v[204:207]
ds_read_b64_tr_b16 a[136:137], v41 offset:49152
MM v[204:207],a[160:163],a[204:207],v[204:207]
ds_read_b64_tr_b16 a[138:139], v41 offset:51200
MM v[208:211],a[168:171],a[192:195],v[208:211]
MM v[208:211],a[172:175],a[208:211],v[208:211]
ds_read_b64_tr_b16 a[140:141], v41 offset:53248
MM v[212:215],a[172:175],a[212:215],v[212:215]
ds_read_b64_tr_b16 a[142:143], v41 offset:55296
MM v[212:215],a[168:171],a[196:199],v[212:215]
buffer_load_dwordx4 a[252:255], v37, s[32:35], s69 offen offset:3072 sc1
s_add_u32 s68, s68, 4096
MM v[216:219],a[168:171],a[200:203],v[216:219]
s_add_u32 s69, s69, 4096
s_add_u32 m0, s70, 90112
MM v[216:219],a[172:175],a[216:219],v[216:219]
MM v[220:223],a[172:175],a[220:223],v[220:223]
MM v[220:223],a[168:171],a[204:207],v[220:223]
buffer_load_dwordx4 v35, s[44:47], s67 offen offset:0 sc1 lds
s_waitcnt lgkmcnt(8)
MM v[224:227],a[176:179],a[192:195],v[224:227]
ds_read_b64_tr_b16 a[144:145], v42 offset:49152
MM v[224:227],a[180:183],a[208:211],v[224:227]
ds_read_b64_tr_b16 a[146:147], v42 offset:51200
MM v[228:231],a[180:183],a[212:215],v[228:231]
MM v[228:231],a[176:179],a[196:199],v[228:231]
ds_read_b64_tr_b16 a[148:149], v42 offset:53248
MM v[232:235],a[176:179],a[200:203],v[232:235]
ds_read_b64_tr_b16 a[150:151], v42 offset:55296
MM v[232:235],a[180:183],a[216:219],v[232:235]
buffer_load_dwordx4 v36, s[44:47], s67 offen offset:1024 sc1 lds
s_add_u32 s67, s67, 221184
MM v[236:239],a[180:183],a[220:223],v[236:239]
ds_read_b64_tr_b16 a[152:153], v43 offset:49152
MM v[236:239],a[176:179],a[204:207],v[236:239]
ds_read_b64_tr_b16 a[154:155], v43 offset:51200
MM v[240:243],a[184:187],a[192:195],v[240:243]
ds_read_b128 v[84:87], v26 offset:5120
ds_read_b128 v[88:91], v26 offset:6144
MM v[240:243],a[188:191],a[208:211],v[240:243]
ds_read_b64_tr_b16 a[156:157], v43 offset:53248
MM v[244:247],a[188:191],a[212:215],v[244:247]
ds_read_b64_tr_b16 a[158:159], v43 offset:55296
MM v[244:247],a[184:187],a[196:199],v[244:247]
ds_read_b128 v[92:95], v26 offset:7168
s_add_u32 s63, s16, 8192
MM v[248:251],a[184:187],a[200:203],v[248:251]
buffer_store_dwordx4 v[96:99], v1, s[32:35], s63 offen offset:0 sc0 sc1
s_add_u32 s63, s16, 8192
MM v[248:251],a[188:191],a[216:219],v[248:251]
MM v[252:255],a[188:191],a[220:223],v[252:255]
MM v[252:255],a[184:187],a[204:207],v[252:255]
s_waitcnt vmcnt(63) lgkmcnt(8)
MM a[0:3],a[128:131],a[192:195],a[0:3]
ds_read_b64_tr_b16 a[160:161], v40 offset:57344
MM a[0:3],a[132:135],a[208:211],a[0:3]
ds_read_b64_tr_b16 a[162:163], v40 offset:59392
MM a[4:7],a[132:135],a[212:215],a[4:7]
buffer_store_dwordx4 v[100:103], v1, s[32:35], s63 offen offset:1024 sc0 sc1
ds_read_b128 v[96:99], v26 offset:8192
MM a[4:7],a[128:131],a[196:199],a[4:7]
ds_read_b64_tr_b16 a[164:165], v40 offset:61440
MM a[8:11],a[128:131],a[200:203],a[8:11]
ds_read_b64_tr_b16 a[166:167], v40 offset:63488
MM a[8:11],a[132:135],a[216:219],a[8:11]
ds_read_b128 v[100:103], v26 offset:9216
s_add_u32 s63, s16, 12288
MM a[12:15],a[132:135],a[220:223],a[12:15]
ds_read_b64_tr_b16 a[168:169], v41 offset:57344
MM a[12:15],a[128:131],a[204:207],a[12:15]
ds_read_b64_tr_b16 a[170:171], v41 offset:59392
MM a[16:19],a[136:139],a[192:195],a[16:19]
buffer_store_dwordx4 v[104:107], v1, s[32:35], s63 offen offset:0 sc0 sc1
s_add_u32 s63, s16, 12288
MM a[16:19],a[140:143],a[208:211],a[16:19]
ds_read_b64_tr_b16 a[172:173], v41 offset:61440
MM a[20:23],a[140:143],a[212:215],a[20:23]
ds_read_b64_tr_b16 a[174:175], v41 offset:63488
MM a[20:23],a[136:139],a[196:199],a[20:23]
MM a[24:27],a[136:139],a[200:203],a[24:27]
buffer_store_dwordx4 v[108:111], v1, s[32:35], s63 offen offset:1024 sc0 sc1
s_add_u32 s63, s17, 8192
MM a[24:27],a[140:143],a[216:219],a[24:27]
MM a[28:31],a[140:143],a[220:223],a[28:31]
MM a[28:31],a[136:139],a[204:207],a[28:31]
s_waitcnt lgkmcnt(8)
MM a[32:35],a[144:147],a[192:195],a[32:35]
ds_read_b64_tr_b16 a[176:177], v42 offset:57344
MM a[32:35],a[148:151],a[208:211],a[32:35]
ds_read_b64_tr_b16 a[178:179], v42 offset:59392
MM a[36:39],a[148:151],a[212:215],a[36:39]
buffer_store_dwordx4 v[112:115], v1, s[32:35], s63 offen offset:0 sc0 sc1
MM a[36:39],a[144:147],a[196:199],a[36:39]
ds_read_b64_tr_b16 a[180:181], v42 offset:61440
MM a[40:43],a[144:147],a[200:203],a[40:43]
ds_read_b64_tr_b16 a[182:183], v42 offset:63488
MM a[40:43],a[148:151],a[216:219],a[40:43]
MM a[44:47],a[148:151],a[220:223],a[44:47]
ds_read_b64_tr_b16 a[184:185], v43 offset:57344
MM a[44:47],a[144:147],a[204:207],a[44:47]
ds_read_b64_tr_b16 a[186:187], v43 offset:59392
MM a[48:51],a[152:155],a[192:195],a[48:51]
MM a[48:51],a[156:159],a[208:211],a[48:51]
ds_read_b64_tr_b16 a[188:189], v43 offset:61440
MM a[52:55],a[156:159],a[212:215],a[52:55]
ds_read_b64_tr_b16 a[190:191], v43 offset:63488
MM a[52:55],a[152:155],a[196:199],a[52:55]
MM a[56:59],a[152:155],a[200:203],a[56:59]
MM a[56:59],a[156:159],a[216:219],a[56:59]
MM a[60:63],a[156:159],a[220:223],a[60:63]
MM a[60:63],a[152:155],a[204:207],a[60:63]
s_waitcnt lgkmcnt(8)
MM a[64:67],a[160:163],a[192:195],a[64:67]
s_waitcnt vmcnt(26) lgkmcnt(0)
s_barrier
ds_read_b64_tr_b16 a[128:129], v44 offset:0
MM a[64:67],a[164:167],a[208:211],a[64:67]
ds_read_b64_tr_b16 a[130:131], v44 offset:2048
MM a[68:71],a[164:167],a[212:215],a[68:71]
s_add_u32 m0, s70, 98304
MM a[68:71],a[160:163],a[196:199],a[68:71]
ds_read_b64_tr_b16 a[132:133], v44 offset:4096
MM a[72:75],a[160:163],a[200:203],a[72:75]
ds_read_b64_tr_b16 a[134:135], v44 offset:6144
MM a[72:75],a[164:167],a[216:219],a[72:75]
buffer_load_dwordx4 v33, s[36:39], s64 offen offset:0 sc1 lds
MM a[76:79],a[164:167],a[220:223],a[76:79]
ds_read_b64_tr_b16 a[136:137], v45 offset:0
MM a[76:79],a[160:163],a[204:207],a[76:79]
ds_read_b64_tr_b16 a[138:139], v45 offset:2048
MM a[80:83],a[168:171],a[192:195],a[80:83]
MM a[80:83],a[172:175],a[208:211],a[80:83]
ds_read_b64_tr_b16 a[140:141], v45 offset:4096
MM a[84:87],a[172:175],a[212:215],a[84:87]
ds_read_b64_tr_b16 a[142:143], v45 offset:6144
MM a[84:87],a[168:171],a[196:199],a[84:87]
buffer_load_dwordx4 v34, s[36:39], s64 offen offset:1024 sc1 lds
s_add_u32 s64, s64, 524288
MM a[88:91],a[168:171],a[200:203],a[88:91]
s_add_u32 m0, s70, 106496
MM a[88:91],a[172:175],a[216:219],a[88:91]
MM a[92:95],a[172:175],a[220:223],a[92:95]
MM a[92:95],a[168:171],a[204:207],a[92:95]
buffer_load_dwordx4 v33, s[36:39], s65 offen offset:0 sc1 lds
s_waitcnt lgkmcnt(8)
MM a[96:99],a[176:179],a[192:195],a[96:99]
ds_read_b64_tr_b16 a[144:145], v46 offset:0
MM a[96:99],a[180:183],a[208:211],a[96:99]
ds_read_b64_tr_b16 a[146:147], v46 offset:2048
MM a[100:103],a[180:183],a[212:215],a[100:103]
MM a[100:103],a[176:179],a[196:199],a[100:103]
ds_read_b64_tr_b16 a[148:149], v46 offset:4096
MM a[104:107],a[176:179],a[200:203],a[104:107]
ds_read_b64_tr_b16 a[150:151], v46 offset:6144
MM a[104:107],a[180:183],a[216:219],a[104:107]
buffer_load_dwordx4 v34, s[36:39], s65 offen offset:1024 sc1 lds
s_add_u32 s65, s65, 524288
MM a[108:111],a[180:183],a[220:223],a[108:111]
ds_read_b64_tr_b16 a[152:153], v47 offset:0
MM a[108:111],a[176:179],a[204:207],a[108:111]
ds_read_b64_tr_b16 a[154:155], v47 offset:2048
MM a[112:115],a[184:187],a[192:195],a[112:115]
s_add_u32 m0, s70, 114688
MM a[112:115],a[188:191],a[208:211],a[112:115]
ds_read_b64_tr_b16 a[156:157], v47 offset:4096
MM a[116:119],a[188:191],a[212:215],a[116:119]
ds_read_b64_tr_b16 a[158:159], v47 offset:6144
MM a[116:119],a[184:187],a[196:199],a[116:119]
buffer_load_dwordx4 v35, s[40:43], s66 offen offset:0 sc1 lds
MM a[120:123],a[184:187],a[200:203],a[120:123]
MM a[120:123],a[188:191],a[216:219],a[120:123]
MM a[124:127],a[188:191],a[220:223],a[124:127]
MM a[124:127],a[184:187],a[204:207],a[124:127]
buffer_load_dwordx4 v36, s[40:43], s66 offen offset:1024 sc1 lds
s_add_u32 s66, s66, 221184
s_waitcnt vmcnt(13) lgkmcnt(8)
MM v[128:131],a[128:131],a[224:227],v[128:131]
ds_read_b64_tr_b16 a[160:161], v44 offset:8192
MM v[128:131],a[132:135],a[240:243],v[128:131]
ds_read_b64_tr_b16 a[162:163], v44 offset:10240
MM v[132:135],a[132:135],a[244:247],v[132:135]
MM v[132:135],a[128:131],a[228:231],v[132:135]
ds_read_b64_tr_b16 a[164:165], v44 offset:12288
MM v[136:139],a[128:131],a[232:235],v[136:139]
ds_read_b64_tr_b16 a[166:167], v44 offset:14336
MM v[136:139],a[132:135],a[248:251],v[136:139]
buffer_load_dwordx4 a[192:195], v32, s[32:35], s68 offen offset:0 sc1
MM v[140:143],a[132:135],a[252:255],v[140:143]
ds_read_b64_tr_b16 a[168:169], v45 offset:8192
MM v[140:143],a[128:131],a[236:239],v[140:143]
ds_read_b64_tr_b16 a[170:171], v45 offset:10240
MM v[144:147],a[136:139],a[224:227],v[144:147]
MM v[144:147],a[140:143],a[240:243],v[144:147]
ds_read_b64_tr_b16 a[172:173], v45 offset:12288
MM v[148:151],a[140:143],a[244:247],v[148:151]
ds_read_b64_tr_b16 a[174:175], v45 offset:14336
MM v[148:151],a[136:139],a[228:231],v[148:151]
buffer_load_dwordx4 a[196:199], v37, s[32:35], s68 offen offset:0 sc1
MM v[152:155],a[136:139],a[232:235],v[152:155]
MM v[152:155],a[140:143],a[248:251],v[152:155]
MM v[156:159],a[140:143],a[252:255],v[156:159]
MM v[156:159],a[136:139],a[236:239],v[156:159]
buffer_load_dwordx4 a[200:203], v32, s[32:35], s69 offen offset:0 sc1
s_waitcnt lgkmcnt(8)
MM v[160:163],a[144:147],a[224:227],v[160:163]
ds_read_b64_tr_b16 a[176:177], v46 offset:8192
MM v[160:163],a[148:151],a[240:243],v[160:163]
ds_read_b64_tr_b16 a[178:179], v46 offset:10240
MM v[164:167],a[148:151],a[244:247],v[164:167]
MM v[164:167],a[144:147],a[228:231],v[164:167]
ds_read_b64_tr_b16 a[180:181], v46 offset:12288
MM v[168:171],a[144:147],a[232:235],v[168:171]
ds_read_b64_tr_b16 a[182:183], v46 offset:14336
MM v[168:171],a[148:151],a[248:251],v[168:171]
buffer_load_dwordx4 a[204:207], v37, s[32:35], s69 offen offset:0 sc1
MM v[172:175],a[148:151],a[252:255],v[172:175]
ds_read_b64_tr_b16 a[184:185], v47 offset:8192
MM v[172:175],a[144:147],a[236:239],v[172:175]
ds_read_b64_tr_b16 a[186:187], v47 offset:10240
MM v[176:179],a[152:155],a[224:227],v[176:179]
MM v[176:179],a[156:159],a[240:243],v[176:179]
ds_read_b64_tr_b16 a[188:189], v47 offset:12288
MM v[180:183],a[156:159],a[244:247],v[180:183]
ds_read_b64_tr_b16 a[190:191], v47 offset:14336
MM v[180:183],a[152:155],a[228:231],v[180:183]
buffer_load_dwordx4 a[208:211], v32, s[32:35], s68 offen offset:1024 sc1
MM v[184:187],a[152:155],a[232:235],v[184:187]
MM v[184:187],a[156:159],a[248:251],v[184:187]
MM v[188:191],a[156:159],a[252:255],v[188:191]
MM v[188:191],a[152:155],a[236:239],v[188:191]
buffer_load_dwordx4 a[212:215], v37, s[32:35], s68 offen offset:1024 sc1
s_waitcnt lgkmcnt(8)
MM v[192:195],a[160:163],a[224:227],v[192:195]
ds_read_b64_tr_b16 a[128:129], v44 offset:16384
MM v[192:195],a[164:167],a[240:243],v[192:195]
ds_read_b64_tr_b16 a[130:131], v44 offset:18432
MM v[196:199],a[164:167],a[244:247],v[196:199]
MM v[196:199],a[160:163],a[228:231],v[196:199]
ds_read_b64_tr_b16 a[132:133], v44 offset:20480
MM v[200:203],a[160:163],a[232:235],v[200:203]
ds_read_b64_tr_b16 a[134:135], v44 offset:22528
MM v[200:203],a[164:167],a[248:251],v[200:203]
buffer_load_dwordx4 a[216:219], v32, s[32:35], s69 offen offset:1024 sc1
MM v[204:207],a[164:167],a[252:255],v[204:207]
ds_read_b64_tr_b16 a[136:137], v45 offset:16384
MM v[204:207],a[160:163],a[236:239],v[204:207]
ds_read_b64_tr_b16 a[138:139], v45 offset:18432
MM v[208:211],a[168:171],a[224:227],v[208:211]
MM v[208:211],a[172:175],a[240:243],v[208:211]
ds_read_b64_tr_b16 a[140:141], v45 offset:20480
MM v[212:215],a[172:175],a[244:247],v[212:215]
ds_read_b64_tr_b16 a[142:143], v45 offset:22528
MM v[212:215],a[168:171],a[228:231],v[212:215]
buffer_load_dwordx4 a[220:223], v37, s[32:35], s69 offen offset:1024 sc1
s_add_u32 m0, s70, 122880
MM v[216:219],a[168:171],a[232:235],v[216:219]
MM v[216:219],a[172:175],a[248:251],v[216:219]
MM v[220:223],a[172:175],a[252:255],v[220:223]
MM v[220:223],a[168:171],a[236:239],v[220:223]
buffer_load_dwordx4 v35, s[44:47], s67 offen offset:0 sc1 lds
s_waitcnt lgkmcnt(8)
MM v[224:227],a[176:179],a[224:227],v[224:227]
ds_read_b64_tr_b16 a[144:145], v46 offset:16384
MM v[224:227],a[180:183],a[240:243],v[224:227]
ds_read_b64_tr_b16 a[146:147], v46 offset:18432
MM v[228:231],a[180:183],a[244:247],v[228:231]
MM v[228:231],a[176:179],a[228:231],v[228:231]
ds_read_b64_tr_b16 a[148:149], v46 offset:20480
MM v[232:235],a[176:179],a[232:235],v[232:235]
ds_read_b64_tr_b16 a[150:151], v46 offset:22528
MM v[232:235],a[180:183],a[248:251],v[232:235]
buffer_load_dwordx4 v36, s[44:47], s67 offen offset:1024 sc1 lds
s_add_u32 s67, s67, 221184
MM v[236:239],a[180:183],a[252:255],v[236:239]
ds_read_b64_tr_b16 a[152:153], v47 offset:16384
MM v[236:239],a[176:179],a[236:239],v[236:239]
ds_read_b64_tr_b16 a[154:155], v47 offset:18432
MM v[240:243],a[184:187],a[224:227],v[240:243]
ds_read_b128 v[104:107], v26 offset:10240
ds_read_b128 v[108:111], v26 offset:11264
MM v[240:243],a[188:191],a[240:243],v[240:243]
ds_read_b64_tr_b16 a[156:157], v47 offset:20480
MM v[244:247],a[188:191],a[244:247],v[244:247]
ds_read_b64_tr_b16 a[158:159], v47 offset:22528
MM v[244:247],a[184:187],a[228:231],v[244:247]
ds_read_b128 v[112:115], v26 offset:12288
s_add_u32 s63, s17, 8192
MM v[248:251],a[184:187],a[232:235],v[248:251]
buffer_store_dwordx4 v[116:119], v1, s[32:35], s63 offen offset:1024 sc0 sc1
s_add_u32 s63, s17, 8192
MM v[248:251],a[188:191],a[248:251],v[248:251]
MM v[252:255],a[188:191],a[252:255],v[252:255]
MM v[252:255],a[184:187],a[236:239],v[252:255]
s_waitcnt vmcnt(63) lgkmcnt(8)
MM a[0:3],a[128:131],a[224:227],a[0:3]
ds_read_b64_tr_b16 a[160:161], v44 offset:24576
MM a[0:3],a[132:135],a[240:243],a[0:3]
ds_read_b64_tr_b16 a[162:163], v44 offset:26624
MM a[4:7],a[132:135],a[244:247],a[4:7]
buffer_store_dwordx4 v[120:123], v1, s[32:35], s63 offen offset:2048 sc0 sc1
ds_read_b128 v[116:119], v26 offset:13312
MM a[4:7],a[128:131],a[228:231],a[4:7]
ds_read_b64_tr_b16 a[164:165], v44 offset:28672
MM a[8:11],a[128:131],a[232:235],a[8:11]
ds_read_b64_tr_b16 a[166:167], v44 offset:30720
MM a[8:11],a[132:135],a[248:251],a[8:11]
ds_read_b128 v[120:123], v26 offset:14336
s_add_u32 s63, s17, 8192
MM a[12:15],a[132:135],a[252:255],a[12:15]
ds_read_b64_tr_b16 a[168:169], v45 offset:24576
MM a[12:15],a[128:131],a[236:239],a[12:15]
ds_read_b64_tr_b16 a[170:171], v45 offset:26624
MM a[16:19],a[136:139],a[224:227],a[16:19]
buffer_store_dwordx4 v[124:127], v1, s[32:35], s63 offen offset:3072 sc0 sc1
s_add_u32 s63, s16, 32768
MM a[16:19],a[140:143],a[240:243],a[16:19]
ds_read_b64_tr_b16 a[172:173], v45 offset:28672
MM a[20:23],a[140:143],a[244:247],a[20:23]
ds_read_b64_tr_b16 a[174:175], v45 offset:30720
MM a[20:23],a[136:139],a[228:231],a[20:23]
MM a[24:27],a[136:139],a[232:235],a[24:27]
buffer_store_dwordx4 v[64:67], v1, s[32:35], s63 offen offset:0 sc0 sc1
s_add_u32 s63, s16, 32768
MM a[24:27],a[140:143],a[248:251],a[24:27]
MM a[28:31],a[140:143],a[252:255],a[28:31]
MM a[28:31],a[136:139],a[236:239],a[28:31]
s_waitcnt lgkmcnt(8)
MM a[32:35],a[144:147],a[224:227],a[32:35]
ds_read_b64_tr_b16 a[176:177], v46 offset:24576
MM a[32:35],a[148:151],a[240:243],a[32:35]
ds_read_b64_tr_b16 a[178:179], v46 offset:26624
MM a[36:39],a[148:151],a[244:247],a[36:39]
buffer_store_dwordx4 v[68:71], v1, s[32:35], s63 offen offset:1024 sc0 sc1
MM a[36:39],a[144:147],a[228:231],a[36:39]
ds_read_b64_tr_b16 a[180:181], v46 offset:28672
MM a[40:43],a[144:147],a[232:235],a[40:43]
ds_read_b64_tr_b16 a[182:183], v46 offset:30720
MM a[40:43],a[148:151],a[248:251],a[40:43]
MM a[44:47],a[148:151],a[252:255],a[44:47]
ds_read_b64_tr_b16 a[184:185], v47 offset:24576
MM a[44:47],a[144:147],a[236:239],a[44:47]
ds_read_b64_tr_b16 a[186:187], v47 offset:26624
MM a[48:51],a[152:155],a[224:227],a[48:51]
MM a[48:51],a[156:159],a[240:243],a[48:51]
ds_read_b64_tr_b16 a[188:189], v47 offset:28672
MM a[52:55],a[156:159],a[244:247],a[52:55]
ds_read_b64_tr_b16 a[190:191], v47 offset:30720
MM a[52:55],a[152:155],a[228:231],a[52:55]
MM a[56:59],a[152:155],a[232:235],a[56:59]
MM a[56:59],a[156:159],a[248:251],a[56:59]
MM a[60:63],a[156:159],a[252:255],a[60:63]
MM a[60:63],a[152:155],a[236:239],a[60:63]
s_waitcnt lgkmcnt(8)
MM a[64:67],a[160:163],a[224:227],a[64:67]
s_waitcnt vmcnt(26) lgkmcnt(0)
s_barrier
ds_read_b64_tr_b16 a[128:129], v40 offset:0
MM a[64:67],a[164:167],a[240:243],a[64:67]
ds_read_b64_tr_b16 a[130:131], v40 offset:2048
MM a[68:71],a[164:167],a[244:247],a[68:71]
s_add_u32 m0, s70, 131072
MM a[68:71],a[160:163],a[228:231],a[68:71]
ds_read_b64_tr_b16 a[132:133], v40 offset:4096
MM a[72:75],a[160:163],a[232:235],a[72:75]
ds_read_b64_tr_b16 a[134:135], v40 offset:6144
MM a[72:75],a[164:167],a[248:251],a[72:75]
buffer_load_dwordx4 v33, s[36:39], s64 offen offset:0 sc1 lds
MM a[76:79],a[164:167],a[252:255],a[76:79]
ds_read_b64_tr_b16 a[136:137], v41 offset:0
MM a[76:79],a[160:163],a[236:239],a[76:79]
ds_read_b64_tr_b16 a[138:139], v41 offset:2048
MM a[80:83],a[168:171],a[224:227],a[80:83]
MM a[80:83],a[172:175],a[240:243],a[80:83]
ds_read_b64_tr_b16 a[140:141], v41 offset:4096
MM a[84:87],a[172:175],a[244:247],a[84:87]
ds_read_b64_tr_b16 a[142:143], v41 offset:6144
MM a[84:87],a[168:171],a[228:231],a[84:87]
buffer_load_dwordx4 v34, s[36:39], s64 offen offset:1024 sc1 lds
s_add_u32 s64, s64, 524288
MM a[88:91],a[168:171],a[232:235],a[88:91]
s_add_u32 m0, s70, 139264
MM a[88:91],a[172:175],a[248:251],a[88:91]
MM a[92:95],a[172:175],a[252:255],a[92:95]
MM a[92:95],a[168:171],a[236:239],a[92:95]
buffer_load_dwordx4 v33, s[36:39], s65 offen offset:0 sc1 lds
s_waitcnt lgkmcnt(8)
MM a[96:99],a[176:179],a[224:227],a[96:99]
ds_read_b64_tr_b16 a[144:145], v42 offset:0
MM a[96:99],a[180:183],a[240:243],a[96:99]
ds_read_b64_tr_b16 a[146:147], v42 offset:2048
MM a[100:103],a[180:183],a[244:247],a[100:103]
MM a[100:103],a[176:179],a[228:231],a[100:103]
ds_read_b64_tr_b16 a[148:149], v42 offset:4096
MM a[104:107],a[176:179],a[232:235],a[104:107]
ds_read_b64_tr_b16 a[150:151], v42 offset:6144
MM a[104:107],a[180:183],a[248:251],a[104:107]
buffer_load_dwordx4 v34, s[36:39], s65 offen offset:1024 sc1 lds
s_add_u32 s65, s65, 524288
MM a[108:111],a[180:183],a[252:255],a[108:111]
ds_read_b64_tr_b16 a[152:153], v43 offset:0
MM a[108:111],a[176:179],a[236:239],a[108:111]
ds_read_b64_tr_b16 a[154:155], v43 offset:2048
MM a[112:115],a[184:187],a[224:227],a[112:115]
s_add_u32 m0, s70, 147456
MM a[112:115],a[188:191],a[240:243],a[112:115]
ds_read_b64_tr_b16 a[156:157], v43 offset:4096
MM a[116:119],a[188:191],a[244:247],a[116:119]
ds_read_b64_tr_b16 a[158:159], v43 offset:6144
MM a[116:119],a[184:187],a[228:231],a[116:119]
buffer_load_dwordx4 v35, s[40:43], s66 offen offset:0 sc1 lds
MM a[120:123],a[184:187],a[232:235],a[120:123]
MM a[120:123],a[188:191],a[248:251],a[120:123]
MM a[124:127],a[188:191],a[252:255],a[124:127]
MM a[124:127],a[184:187],a[236:239],a[124:127]
buffer_load_dwordx4 v36, s[40:43], s66 offen offset:1024 sc1 lds
s_add_u32 s66, s66, 221184
s_waitcnt vmcnt(13) lgkmcnt(8)
MM v[128:131],a[128:131],a[192:195],v[128:131]
ds_read_b64_tr_b16 a[160:161], v40 offset:8192
MM v[128:131],a[132:135],a[208:211],v[128:131]
ds_read_b64_tr_b16 a[162:163], v40 offset:10240
MM v[132:135],a[132:135],a[212:215],v[132:135]
MM v[132:135],a[128:131],a[196:199],v[132:135]
ds_read_b64_tr_b16 a[164:165], v40 offset:12288
MM v[136:139],a[128:131],a[200:203],v[136:139]
ds_read_b64_tr_b16 a[166:167], v40 offset:14336
MM v[136:139],a[132:135],a[216:219],v[136:139]
buffer_load_dwordx4 a[224:227], v32, s[32:35], s68 offen offset:2048 sc1
MM v[140:143],a[132:135],a[220:223],v[140:143]
ds_read_b64_tr_b16 a[168:169], v41 offset:8192
MM v[140:143],a[128:131],a[204:207],v[140:143]
ds_read_b64_tr_b16 a[170:171], v41 offset:10240
MM v[144:147],a[136:139],a[192:195],v[144:147]
MM v[144:147],a[140:143],a[208:211],v[144:147]
ds_read_b64_tr_b16 a[172:173], v41 offset:12288
MM v[148:151],a[140:143],a[212:215],v[148:151]
ds_read_b64_tr_b16 a[174:175], v41 offset:14336
MM v[148:151],a[136:139],a[196:199],v[148:151]
buffer_load_dwordx4 a[228:231], v37, s[32:35], s68 offen offset:2048 sc1
MM v[152:155],a[136:139],a[200:203],v[152:155]
MM v[152:155],a[140:143],a[216:219],v[152:155]
MM v[156:159],a[140:143],a[220:223],v[156:159]
MM v[156:159],a[136:139],a[204:207],v[156:159]
buffer_load_dwordx4 a[232:235], v32, s[32:35], s69 offen offset:2048 sc1
s_waitcnt lgkmcnt(8)
MM v[160:163],a[144:147],a[192:195],v[160:163]
ds_read_b64_tr_b16 a[176:177], v42 offset:8192
MM v[160:163],a[148:151],a[208:211],v[160:163]
ds_read_b64_tr_b16 a[178:179], v42 offset:10240
MM v[164:167],a[148:151],a[212:215],v[164:167]
MM v[164:167],a[144:147],a[196:199],v[164:167]
ds_read_b64_tr_b16 a[180:181], v42 offset:12288
MM v[168:171],a[144:147],a[200:203],v[168:171]
ds_read_b64_tr_b16 a[182:183], v42 offset:14336
MM v[168:171],a[148:151],a[216:219],v[168:171]
buffer_load_dwordx4 a[236:239], v37, s[32:35], s69 offen offset:2048 sc1
MM v[172:175],a[148:151],a[220:223],v[172:175]
ds_read_b64_tr_b16 a[184:185], v43 offset:8192
MM v[172:175],a[144:147],a[204:207],v[172:175]
ds_read_b64_tr_b16 a[186:187], v43 offset:10240
MM v[176:179],a[152:155],a[192:195],v[176:179]
MM v[176:179],a[156:159],a[208:211],v[176:179]
ds_read_b64_tr_b16 a[188:189], v43 offset:12288
MM v[180:183],a[156:159],a[212:215],v[180:183]
ds_read_b64_tr_b16 a[190:191], v43 offset:14336
MM v[180:183],a[152:155],a[196:199],v[180:183]
buffer_load_dwordx4 a[240:243], v32, s[32:35], s68 offen offset:3072 sc1
MM v[184:187],a[152:155],a[200:203],v[184:187]
MM v[184:187],a[156:159],a[216:219],v[184:187]
MM v[188:191],a[156:159],a[220:223],v[188:191]
MM v[188:191],a[152:155],a[204:207],v[188:191]
buffer_load_dwordx4 a[244:247], v37, s[32:35], s68 offen offset:3072 sc1
s_waitcnt lgkmcnt(8)
MM v[192:195],a[160:163],a[192:195],v[192:195]
ds_read_b64_tr_b16 a[128:129], v40 offset:16384
MM v[192:195],a[164:167],a[208:211],v[192:195]
ds_read_b64_tr_b16 a[130:131], v40 offset:18432
MM v[196:199],a[164:167],a[212:215],v[196:199]
MM v[196:199],a[160:163],a[196:199],v[196:199]
ds_read_b64_tr_b16 a[132:133], v40 offset:20480
MM v[200:203],a[160:163],a[200:203],v[200:203]
ds_read_b64_tr_b16 a[134:135], v40 offset:22528
MM v[200:203],a[164:167],a[216:219],v[200:203]
buffer_load_dwordx4 a[248:251], v32, s[32:35], s69 offen offset:3072 sc1
MM v[204:207],a[164:167],a[220:223],v[204:207]
ds_read_b64_tr_b16 a[136:137], v41 offset:16384
MM v[204:207],a[160:163],a[204:207],v[204:207]
ds_read_b64_tr_b16 a[138:139], v41 offset:18432
MM v[208:211],a[168:171],a[192:195],v[208:211]
MM v[208:211],a[172:175],a[208:211],v[208:211]
ds_read_b64_tr_b16 a[140:141], v41 offset:20480
MM v[212:215],a[172:175],a[212:215],v[212:215]
ds_read_b64_tr_b16 a[142:143], v41 offset:22528
MM v[212:215],a[168:171],a[196:199],v[212:215]
buffer_load_dwordx4 a[252:255], v37, s[32:35], s69 offen offset:3072 sc1
s_add_u32 s68, s68, 4096
MM v[216:219],a[168:171],a[200:203],v[216:219]
s_add_u32 s69, s69, 4096
s_add_u32 m0, s70, 155648
MM v[216:219],a[172:175],a[216:219],v[216:219]
MM v[220:223],a[172:175],a[220:223],v[220:223]
MM v[220:223],a[168:171],a[204:207],v[220:223]
buffer_load_dwordx4 v35, s[44:47], s67 offen offset:0 sc1 lds
s_waitcnt lgkmcnt(8)
MM v[224:227],a[176:179],a[192:195],v[224:227]
ds_read_b64_tr_b16 a[144:145], v42 offset:16384
MM v[224:227],a[180:183],a[208:211],v[224:227]
ds_read_b64_tr_b16 a[146:147], v42 offset:18432
MM v[228:231],a[180:183],a[212:215],v[228:231]
MM v[228:231],a[176:179],a[196:199],v[228:231]
ds_read_b64_tr_b16 a[148:149], v42 offset:20480
MM v[232:235],a[176:179],a[200:203],v[232:235]
ds_read_b64_tr_b16 a[150:151], v42 offset:22528
MM v[232:235],a[180:183],a[216:219],v[232:235]
buffer_load_dwordx4 v36, s[44:47], s67 offen offset:1024 sc1 lds
s_add_u32 s67, s67, 221184
MM v[236:239],a[180:183],a[220:223],v[236:239]
ds_read_b64_tr_b16 a[152:153], v43 offset:16384
MM v[236:239],a[176:179],a[204:207],v[236:239]
ds_read_b64_tr_b16 a[154:155], v43 offset:18432
MM v[240:243],a[184:187],a[192:195],v[240:243]
ds_read_b128 v[124:127], v26 offset:15360
s_add_u32 s63, s16, 36864
MM v[240:243],a[188:191],a[208:211],v[240:243]
ds_read_b64_tr_b16 a[156:157], v43 offset:20480
MM v[244:247],a[188:191],a[212:215],v[244:247]
ds_read_b64_tr_b16 a[158:159], v43 offset:22528
MM v[244:247],a[184:187],a[196:199],v[244:247]
buffer_store_dwordx4 v[72:75], v1, s[32:35], s63 offen offset:0 sc0 sc1
s_add_u32 s63, s16, 36864
MM v[248:251],a[184:187],a[200:203],v[248:251]
MM v[248:251],a[188:191],a[216:219],v[248:251]
MM v[252:255],a[188:191],a[220:223],v[252:255]
MM v[252:255],a[184:187],a[204:207],v[252:255]
buffer_store_dwordx4 v[76:79], v1, s[32:35], s63 offen offset:1024 sc0 sc1
s_waitcnt vmcnt(63) lgkmcnt(8)
MM a[0:3],a[128:131],a[192:195],a[0:3]
ds_read_b64_tr_b16 a[160:161], v40 offset:24576
MM a[0:3],a[132:135],a[208:211],a[0:3]
ds_read_b64_tr_b16 a[162:163], v40 offset:26624
MM a[4:7],a[132:135],a[212:215],a[4:7]
s_add_u32 s63, s17, 32768
MM a[4:7],a[128:131],a[196:199],a[4:7]
ds_read_b64_tr_b16 a[164:165], v40 offset:28672
MM a[8:11],a[128:131],a[200:203],a[8:11]
ds_read_b64_tr_b16 a[166:167], v40 offset:30720
MM a[8:11],a[132:135],a[216:219],a[8:11]
buffer_store_dwordx4 v[80:83], v1, s[32:35], s63 offen offset:0 sc0 sc1
s_add_u32 s63, s17, 32768
MM a[12:15],a[132:135],a[220:223],a[12:15]
ds_read_b64_tr_b16 a[168:169], v41 offset:24576
MM a[12:15],a[128:131],a[204:207],a[12:15]
ds_read_b64_tr_b16 a[170:171], v41 offset:26624
MM a[16:19],a[136:139],a[192:195],a[16:19]
MM a[16:19],a[140:143],a[208:211],a[16:19]
ds_read_b64_tr_b16 a[172:173], v41 offset:28672
MM a[20:23],a[140:143],a[212:215],a[20:23]
ds_read_b64_tr_b16 a[174:175], v41 offset:30720
MM a[20:23],a[136:139],a[196:199],a[20:23]
buffer_store_dwordx4 v[84:87], v1, s[32:35], s63 offen offset:1024 sc0 sc1
s_add_u32 s63, s17, 32768
MM a[24:27],a[136:139],a[200:203],a[24:27]
MM a[24:27],a[140:143],a[216:219],a[24:27]
MM a[28:31],a[140:143],a[220:223],a[28:31]
MM a[28:31],a[136:139],a[204:207],a[28:31]
buffer_store_dwordx4 v[88:91], v1, s[32:35], s63 offen offset:2048 sc0 sc1
s_waitcnt lgkmcnt(8)
MM a[32:35],a[144:147],a[192:195],a[32:35]
ds_read_b64_tr_b16 a[176:177], v42 offset:24576
MM a[32:35],a[148:151],a[208:211],a[32:35]
ds_read_b64_tr_b16 a[178:179], v42 offset:26624
MM a[36:39],a[148:151],a[212:215],a[36:39]
MM a[36:39],a[144:147],a[196:199],a[36:39]
ds_read_b64_tr_b16 a[180:181], v42 offset:28672
MM a[40:43],a[144:147],a[200:203],a[40:43]
ds_read_b64_tr_b16 a[182:183], v42 offset:30720
MM a[40:43],a[148:151],a[216:219],a[40:43]
MM a[44:47],a[148:151],a[220:223],a[44:47]
ds_read_b64_tr_b16 a[184:185], v43 offset:24576
MM a[44:47],a[144:147],a[204:207],a[44:47]
ds_read_b64_tr_b16 a[186:187], v43 offset:26624
MM a[48:51],a[152:155],a[192:195],a[48:51]
MM a[48:51],a[156:159],a[208:211],a[48:51]
ds_read_b64_tr_b16 a[188:189], v43 offset:28672
MM a[52:55],a[156:159],a[212:215],a[52:55]
ds_read_b64_tr_b16 a[190:191], v43 offset:30720
MM a[52:55],a[152:155],a[196:199],a[52:55]
MM a[56:59],a[152:155],a[200:203],a[56:59]
MM a[56:59],a[156:159],a[216:219],a[56:59]
MM a[60:63],a[156:159],a[220:223],a[60:63]
MM a[60:63],a[152:155],a[204:207],a[60:63]
s_waitcnt lgkmcnt(8)
MM a[64:67],a[160:163],a[192:195],a[64:67]
s_waitcnt vmcnt(26) lgkmcnt(0)
s_barrier
ds_read_b64_tr_b16 a[128:129], v40 offset:32768
MM a[64:67],a[164:167],a[208:211],a[64:67]
ds_read_b64_tr_b16 a[130:131], v40 offset:34816
MM a[68:71],a[164:167],a[212:215],a[68:71]
s_add_u32 m0, s70, 65536
MM a[68:71],a[160:163],a[196:199],a[68:71]
ds_read_b64_tr_b16 a[132:133], v40 offset:36864
MM a[72:75],a[160:163],a[200:203],a[72:75]
ds_read_b64_tr_b16 a[134:135], v40 offset:38912
MM a[72:75],a[164:167],a[216:219],a[72:75]
buffer_load_dwordx4 v33, s[36:39], s64 offen offset:0 sc1 lds
MM a[76:79],a[164:167],a[220:223],a[76:79]
ds_read_b64_tr_b16 a[136:137], v41 offset:32768
MM a[76:79],a[160:163],a[204:207],a[76:79]
ds_read_b64_tr_b16 a[138:139], v41 offset:34816
MM a[80:83],a[168:171],a[192:195],a[80:83]
MM a[80:83],a[172:175],a[208:211],a[80:83]
ds_read_b64_tr_b16 a[140:141], v41 offset:36864
MM a[84:87],a[172:175],a[212:215],a[84:87]
ds_read_b64_tr_b16 a[142:143], v41 offset:38912
MM a[84:87],a[168:171],a[196:199],a[84:87]
buffer_load_dwordx4 v34, s[36:39], s64 offen offset:1024 sc1 lds
s_add_u32 s64, s64, 524288
MM a[88:91],a[168:171],a[200:203],a[88:91]
s_add_u32 m0, s70, 73728
MM a[88:91],a[172:175],a[216:219],a[88:91]
MM a[92:95],a[172:175],a[220:223],a[92:95]
MM a[92:95],a[168:171],a[204:207],a[92:95]
buffer_load_dwordx4 v33, s[36:39], s65 offen offset:0 sc1 lds
s_waitcnt lgkmcnt(8)
MM a[96:99],a[176:179],a[192:195],a[96:99]
ds_read_b64_tr_b16 a[144:145], v42 offset:32768
MM a[96:99],a[180:183],a[208:211],a[96:99]
ds_read_b64_tr_b16 a[146:147], v42 offset:34816
MM a[100:103],a[180:183],a[212:215],a[100:103]
MM a[100:103],a[176:179],a[196:199],a[100:103]
ds_read_b64_tr_b16 a[148:149], v42 offset:36864
MM a[104:107],a[176:179],a[200:203],a[104:107]
ds_read_b64_tr_b16 a[150:151], v42 offset:38912
MM a[104:107],a[180:183],a[216:219],a[104:107]
buffer_load_dwordx4 v34, s[36:39], s65 offen offset:1024 sc1 lds
s_add_u32 s65, s65, 524288
MM a[108:111],a[180:183],a[220:223],a[108:111]
ds_read_b64_tr_b16 a[152:153], v43 offset:32768
MM a[108:111],a[176:179],a[204:207],a[108:111]
ds_read_b64_tr_b16 a[154:155], v43 offset:34816
MM a[112:115],a[184:187],a[192:195],a[112:115]
s_add_u32 m0, s70, 81920
MM a[112:115],a[188:191],a[208:211],a[112:115]
ds_read_b64_tr_b16 a[156:157], v43 offset:36864
MM a[116:119],a[188:191],a[212:215],a[116:119]
ds_read_b64_tr_b16 a[158:159], v43 offset:38912
MM a[116:119],a[184:187],a[196:199],a[116:119]
buffer_load_dwordx4 v35, s[40:43], s66 offen offset:0 sc1 lds
MM a[120:123],a[184:187],a[200:203],a[120:123]
MM a[120:123],a[188:191],a[216:219],a[120:123]
MM a[124:127],a[188:191],a[220:223],a[124:127]
MM a[124:127],a[184:187],a[204:207],a[124:127]
buffer_load_dwordx4 v36, s[40:43], s66 offen offset:1024 sc1 lds
s_add_u32 s66, s66, 221184
s_waitcnt vmcnt(13) lgkmcnt(8)
MM v[128:131],a[128:131],a[224:227],v[128:131]
ds_read_b64_tr_b16 a[160:161], v40 offset:40960
MM v[128:131],a[132:135],a[240:243],v[128:131]
ds_read_b64_tr_b16 a[162:163], v40 offset:43008
MM v[132:135],a[132:135],a[244:247],v[132:135]
MM v[132:135],a[128:131],a[228:231],v[132:135]
ds_read_b64_tr_b16 a[164:165], v40 offset:45056
MM v[136:139],a[128:131],a[232:235],v[136:139]
ds_read_b64_tr_b16 a[166:167], v40 offset:47104
MM v[136:139],a[132:135],a[248:251],v[136:139]
buffer_load_dwordx4 a[192:195], v32, s[32:35], s68 offen offset:0 sc1
MM v[140:143],a[132:135],a[252:255],v[140:143]
ds_read_b64_tr_b16 a[168:169], v41 offset:40960
MM v[140:143],a[128:131],a[236:239],v[140:143]
ds_read_b64_tr_b16 a[170:171], v41 offset:43008
MM v[144:147],a[136:139],a[224:227],v[144:147]
MM v[144:147],a[140:143],a[240:243],v[144:147]
ds_read_b64_tr_b16 a[172:173], v41 offset:45056
MM v[148:151],a[140:143],a[244:247],v[148:151]
ds_read_b64_tr_b16 a[174:175], v41 offset:47104
MM v[148:151],a[136:139],a[228:231],v[148:151]
buffer_load_dwordx4 a[196:199], v37, s[32:35], s68 offen offset:0 sc1
MM v[152:155],a[136:139],a[232:235],v[152:155]
MM v[152:155],a[140:143],a[248:251],v[152:155]
MM v[156:159],a[140:143],a[252:255],v[156:159]
MM v[156:159],a[136:139],a[236:239],v[156:159]
buffer_load_dwordx4 a[200:203], v32, s[32:35], s69 offen offset:0 sc1
s_waitcnt lgkmcnt(8)
MM v[160:163],a[144:147],a[224:227],v[160:163]
ds_read_b64_tr_b16 a[176:177], v42 offset:40960
MM v[160:163],a[148:151],a[240:243],v[160:163]
ds_read_b64_tr_b16 a[178:179], v42 offset:43008
MM v[164:167],a[148:151],a[244:247],v[164:167]
MM v[164:167],a[144:147],a[228:231],v[164:167]
ds_read_b64_tr_b16 a[180:181], v42 offset:45056
MM v[168:171],a[144:147],a[232:235],v[168:171]
ds_read_b64_tr_b16 a[182:183], v42 offset:47104
MM v[168:171],a[148:151],a[248:251],v[168:171]
buffer_load_dwordx4 a[204:207], v37, s[32:35], s69 offen offset:0 sc1
MM v[172:175],a[148:151],a[252:255],v[172:175]
ds_read_b64_tr_b16 a[184:185], v43 offset:40960
MM v[172:175],a[144:147],a[236:239],v[172:175]
ds_read_b64_tr_b16 a[186:187], v43 offset:43008
MM v[176:179],a[152:155],a[224:227],v[176:179]
MM v[176:179],a[156:159],a[240:243],v[176:179]
ds_read_b64_tr_b16 a[188:189], v43 offset:45056
MM v[180:183],a[156:159],a[244:247],v[180:183]
ds_read_b64_tr_b16 a[190:191], v43 offset:47104
MM v[180:183],a[152:155],a[228:231],v[180:183]
buffer_load_dwordx4 a[208:211], v32, s[32:35], s68 offen offset:1024 sc1
MM v[184:187],a[152:155],a[232:235],v[184:187]
MM v[184:187],a[156:159],a[248:251],v[184:187]
MM v[188:191],a[156:159],a[252:255],v[188:191]
MM v[188:191],a[152:155],a[236:239],v[188:191]
buffer_load_dwordx4 a[212:215], v37, s[32:35], s68 offen offset:1024 sc1
s_waitcnt lgkmcnt(8)
MM v[192:195],a[160:163],a[224:227],v[192:195]
ds_read_b64_tr_b16 a[128:129], v40 offset:49152
MM v[192:195],a[164:167],a[240:243],v[192:195]
ds_read_b64_tr_b16 a[130:131], v40 offset:51200
MM v[196:199],a[164:167],a[244:247],v[196:199]
MM v[196:199],a[160:163],a[228:231],v[196:199]
ds_read_b64_tr_b16 a[132:133], v40 offset:53248
MM v[200:203],a[160:163],a[232:235],v[200:203]
ds_read_b64_tr_b16 a[134:135], v40 offset:55296
MM v[200:203],a[164:167],a[248:251],v[200:203]
buffer_load_dwordx4 a[216:219], v32, s[32:35], s69 offen offset:1024 sc1
MM v[204:207],a[164:167],a[252:255],v[204:207]
ds_read_b64_tr_b16 a[136:137], v41 offset:49152
MM v[204:207],a[160:163],a[236:239],v[204:207]
ds_read_b64_tr_b16 a[138:139], v41 offset:51200
MM v[208:211],a[168:171],a[224:227],v[208:211]
MM v[208:211],a[172:175],a[240:243],v[208:211]
ds_read_b64_tr_b16 a[140:141], v41 offset:53248
MM v[212:215],a[172:175],a[244:247],v[212:215]
ds_read_b64_tr_b16 a[142:143], v41 offset:55296
MM v[212:215],a[168:171],a[228:231],v[212:215]
buffer_load_dwordx4 a[220:223], v37, s[32:35], s69 offen offset:1024 sc1
s_add_u32 m0, s70, 90112
MM v[216:219],a[168:171],a[232:235],v[216:219]
MM v[216:219],a[172:175],a[248:251],v[216:219]
MM v[220:223],a[172:175],a[252:255],v[220:223]
MM v[220:223],a[168:171],a[236:239],v[220:223]
buffer_load_dwordx4 v35, s[44:47], s67 offen offset:0 sc1 lds
s_waitcnt lgkmcnt(8)
MM v[224:227],a[176:179],a[224:227],v[224:227]
ds_read_b64_tr_b16 a[144:145], v42 offset:49152
MM v[224:227],a[180:183],a[240:243],v[224:227]
ds_read_b64_tr_b16 a[146:147], v42 offset:51200
MM v[228:231],a[180:183],a[244:247],v[228:231]
MM v[228:231],a[176:179],a[228:231],v[228:231]
ds_read_b64_tr_b16 a[148:149], v42 offset:53248
MM v[232:235],a[176:179],a[232:235],v[232:235]
ds_read_b64_tr_b16 a[150:151], v42 offset:55296
MM v[232:235],a[180:183],a[248:251],v[232:235]
buffer_load_dwordx4 v36, s[44:47], s67 offen offset:1024 sc1 lds
s_add_u32 s67, s67, 221184
MM v[236:239],a[180:183],a[252:255],v[236:239]
ds_read_b64_tr_b16 a[152:153], v43 offset:49152
MM v[236:239],a[176:179],a[236:239],v[236:239]
ds_read_b64_tr_b16 a[154:155], v43 offset:51200
MM v[240:243],a[184:187],a[224:227],v[240:243]
s_add_u32 s63, s17, 32768
MM v[240:243],a[188:191],a[240:243],v[240:243]
ds_read_b64_tr_b16 a[156:157], v43 offset:53248
MM v[244:247],a[188:191],a[244:247],v[244:247]
ds_read_b64_tr_b16 a[158:159], v43 offset:55296
MM v[244:247],a[184:187],a[228:231],v[244:247]
buffer_store_dwordx4 v[92:95], v1, s[32:35], s63 offen offset:3072 sc0 sc1
s_add_u32 s63, s16, 40960
MM v[248:251],a[184:187],a[232:235],v[248:251]
MM v[248:251],a[188:191],a[248:251],v[248:251]
MM v[252:255],a[188:191],a[252:255],v[252:255]
MM v[252:255],a[184:187],a[236:239],v[252:255]
buffer_store_dwordx4 v[96:99], v1, s[32:35], s63 offen offset:0 sc0 sc1
s_waitcnt vmcnt(63) lgkmcnt(8)
MM a[0:3],a[128:131],a[224:227],a[0:3]
ds_read_b64_tr_b16 a[160:161], v40 offset:57344
MM a[0:3],a[132:135],a[240:243],a[0:3]
ds_read_b64_tr_b16 a[162:163], v40 offset:59392
MM a[4:7],a[132:135],a[244:247],a[4:7]
s_add_u32 s63, s16, 40960
MM a[4:7],a[128:131],a[228:231],a[4:7]
ds_read_b64_tr_b16 a[164:165], v40 offset:61440
MM a[8:11],a[128:131],a[232:235],a[8:11]
ds_read_b64_tr_b16 a[166:167], v40 offset:63488
MM a[8:11],a[132:135],a[248:251],a[8:11]
buffer_store_dwordx4 v[100:103], v1, s[32:35], s63 offen offset:1024 sc0 sc1
s_add_u32 s63, s16, 45056
MM a[12:15],a[132:135],a[252:255],a[12:15]
ds_read_b64_tr_b16 a[168:169], v41 offset:57344
MM a[12:15],a[128:131],a[236:239],a[12:15]
ds_read_b64_tr_b16 a[170:171], v41 offset:59392
MM a[16:19],a[136:139],a[224:227],a[16:19]
MM a[16:19],a[140:143],a[240:243],a[16:19]
ds_read_b64_tr_b16 a[172:173], v41 offset:61440
MM a[20:23],a[140:143],a[244:247],a[20:23]
ds_read_b64_tr_b16 a[174:175], v41 offset:63488
MM a[20:23],a[136:139],a[228:231],a[20:23]
buffer_store_dwordx4 v[104:107], v1, s[32:35], s63 offen offset:0 sc0 sc1
s_add_u32 s63, s16, 45056
MM a[24:27],a[136:139],a[232:235],a[24:27]
MM a[24:27],a[140:143],a[248:251],a[24:27]
MM a[28:31],a[140:143],a[252:255],a[28:31]
MM a[28:31],a[136:139],a[236:239],a[28:31]
buffer_store_dwordx4 v[108:111], v1, s[32:35], s63 offen offset:1024 sc0 sc1
s_waitcnt lgkmcnt(8)
MM a[32:35],a[144:147],a[224:227],a[32:35]
ds_read_b64_tr_b16 a[176:177], v42 offset:57344
MM a[32:35],a[148:151],a[240:243],a[32:35]
ds_read_b64_tr_b16 a[178:179], v42 offset:59392
MM a[36:39],a[148:151],a[244:247],a[36:39]
MM a[36:39],a[144:147],a[228:231],a[36:39]
ds_read_b64_tr_b16 a[180:181], v42 offset:61440
MM a[40:43],a[144:147],a[232:235],a[40:43]
ds_read_b64_tr_b16 a[182:183], v42 offset:63488
MM a[40:43],a[148:151],a[248:251],a[40:43]
MM a[44:47],a[148:151],a[252:255],a[44:47]
ds_read_b64_tr_b16 a[184:185], v43 offset:57344
MM a[44:47],a[144:147],a[236:239],a[44:47]
ds_read_b64_tr_b16 a[186:187], v43 offset:59392
MM a[48:51],a[152:155],a[224:227],a[48:51]
MM a[48:51],a[156:159],a[240:243],a[48:51]
ds_read_b64_tr_b16 a[188:189], v43 offset:61440
MM a[52:55],a[156:159],a[244:247],a[52:55]
ds_read_b64_tr_b16 a[190:191], v43 offset:63488
MM a[52:55],a[152:155],a[228:231],a[52:55]
MM a[56:59],a[152:155],a[232:235],a[56:59]
MM a[56:59],a[156:159],a[248:251],a[56:59]
MM a[60:63],a[156:159],a[252:255],a[60:63]
MM a[60:63],a[152:155],a[236:239],a[60:63]
s_waitcnt lgkmcnt(8)
MM a[64:67],a[160:163],a[224:227],a[64:67]
s_waitcnt vmcnt(26) lgkmcnt(0)
s_barrier
ds_read_b64_tr_b16 a[128:129], v44 offset:0
MM a[64:67],a[164:167],a[240:243],a[64:67]
ds_read_b64_tr_b16 a[130:131], v44 offset:2048
MM a[68:71],a[164:167],a[244:247],a[68:71]
s_add_u32 m0, s70, 98304
MM a[68:71],a[160:163],a[228:231],a[68:71]
ds_read_b64_tr_b16 a[132:133], v44 offset:4096
MM a[72:75],a[160:163],a[232:235],a[72:75]
ds_read_b64_tr_b16 a[134:135], v44 offset:6144
MM a[72:75],a[164:167],a[248:251],a[72:75]
buffer_load_dwordx4 v33, s[36:39], s64 offen offset:0 sc1 lds
MM a[76:79],a[164:167],a[252:255],a[76:79]
ds_read_b64_tr_b16 a[136:137], v45 offset:0
MM a[76:79],a[160:163],a[236:239],a[76:79]
ds_read_b64_tr_b16 a[138:139], v45 offset:2048
MM a[80:83],a[168:171],a[224:227],a[80:83]
MM a[80:83],a[172:175],a[240:243],a[80:83]
ds_read_b64_tr_b16 a[140:141], v45 offset:4096
MM a[84:87],a[172:175],a[244:247],a[84:87]
ds_read_b64_tr_b16 a[142:143], v45 offset:6144
MM a[84:87],a[168:171],a[228:231],a[84:87]
buffer_load_dwordx4 v34, s[36:39], s64 offen offset:1024 sc1 lds
s_add_u32 s64, s64, 524288
MM a[88:91],a[168:171],a[232:235],a[88:91]
s_add_u32 m0, s70, 106496
MM a[88:91],a[172:175],a[248:251],a[88:91]
MM a[92:95],a[172:175],a[252:255],a[92:95]
MM a[92:95],a[168:171],a[236:239],a[92:95]
buffer_load_dwordx4 v33, s[36:39], s65 offen offset:0 sc1 lds
s_waitcnt lgkmcnt(8)
MM a[96:99],a[176:179],a[224:227],a[96:99]
ds_read_b64_tr_b16 a[144:145], v46 offset:0
MM a[96:99],a[180:183],a[240:243],a[96:99]
ds_read_b64_tr_b16 a[146:147], v46 offset:2048
MM a[100:103],a[180:183],a[244:247],a[100:103]
MM a[100:103],a[176:179],a[228:231],a[100:103]
ds_read_b64_tr_b16 a[148:149], v46 offset:4096
MM a[104:107],a[176:179],a[232:235],a[104:107]
ds_read_b64_tr_b16 a[150:151], v46 offset:6144
MM a[104:107],a[180:183],a[248:251],a[104:107]
buffer_load_dwordx4 v34, s[36:39], s65 offen offset:1024 sc1 lds
s_add_u32 s65, s65, 524288
MM a[108:111],a[180:183],a[252:255],a[108:111]
ds_read_b64_tr_b16 a[152:153], v47 offset:0
MM a[108:111],a[176:179],a[236:239],a[108:111]
ds_read_b64_tr_b16 a[154:155], v47 offset:2048
MM a[112:115],a[184:187],a[224:227],a[112:115]
s_add_u32 m0, s70, 114688
MM a[112:115],a[188:191],a[240:243],a[112:115]
ds_read_b64_tr_b16 a[156:157], v47 offset:4096
MM a[116:119],a[188:191],a[244:247],a[116:119]
ds_read_b64_tr_b16 a[158:159], v47 offset:6144
MM a[116:119],a[184:187],a[228:231],a[116:119]
buffer_load_dwordx4 v35, s[40:43], s66 offen offset:0 sc1 lds
MM a[120:123],a[184:187],a[232:235],a[120:123]
MM a[120:123],a[188:191],a[248:251],a[120:123]
MM a[124:127],a[188:191],a[252:255],a[124:127]
MM a[124:127],a[184:187],a[236:239],a[124:127]
buffer_load_dwordx4 v36, s[40:43], s66 offen offset:1024 sc1 lds
s_add_u32 s66, s66, 221184
s_waitcnt vmcnt(13) lgkmcnt(8)
MM v[128:131],a[128:131],a[192:195],v[128:131]
ds_read_b64_tr_b16 a[160:161], v44 offset:8192
MM v[128:131],a[132:135],a[208:211],v[128:131]
ds_read_b64_tr_b16 a[162:163], v44 offset:10240
MM v[132:135],a[132:135],a[212:215],v[132:135]
MM v[132:135],a[128:131],a[196:199],v[132:135]
ds_read_b64_tr_b16 a[164:165], v44 offset:12288
MM v[136:139],a[128:131],a[200:203],v[136:139]
ds_read_b64_tr_b16 a[166:167], v44 offset:14336
MM v[136:139],a[132:135],a[216:219],v[136:139]
buffer_load_dwordx4 a[224:227], v32, s[32:35], s68 offen offset:2048 sc1
MM v[140:143],a[132:135],a[220:223],v[140:143]
ds_read_b64_tr_b16 a[168:169], v45 offset:8192
MM v[140:143],a[128:131],a[204:207],v[140:143]
ds_read_b64_tr_b16 a[170:171], v45 offset:10240
MM v[144:147],a[136:139],a[192:195],v[144:147]
MM v[144:147],a[140:143],a[208:211],v[144:147]
ds_read_b64_tr_b16 a[172:173], v45 offset:12288
MM v[148:151],a[140:143],a[212:215],v[148:151]
ds_read_b64_tr_b16 a[174:175], v45 offset:14336
MM v[148:151],a[136:139],a[196:199],v[148:151]
buffer_load_dwordx4 a[228:231], v37, s[32:35], s68 offen offset:2048 sc1
MM v[152:155],a[136:139],a[200:203],v[152:155]
MM v[152:155],a[140:143],a[216:219],v[152:155]
MM v[156:159],a[140:143],a[220:223],v[156:159]
MM v[156:159],a[136:139],a[204:207],v[156:159]
buffer_load_dwordx4 a[232:235], v32, s[32:35], s69 offen offset:2048 sc1
s_waitcnt lgkmcnt(8)
MM v[160:163],a[144:147],a[192:195],v[160:163]
ds_read_b64_tr_b16 a[176:177], v46 offset:8192
MM v[160:163],a[148:151],a[208:211],v[160:163]
ds_read_b64_tr_b16 a[178:179], v46 offset:10240
MM v[164:167],a[148:151],a[212:215],v[164:167]
MM v[164:167],a[144:147],a[196:199],v[164:167]
ds_read_b64_tr_b16 a[180:181], v46 offset:12288
MM v[168:171],a[144:147],a[200:203],v[168:171]
ds_read_b64_tr_b16 a[182:183], v46 offset:14336
MM v[168:171],a[148:151],a[216:219],v[168:171]
buffer_load_dwordx4 a[236:239], v37, s[32:35], s69 offen offset:2048 sc1
MM v[172:175],a[148:151],a[220:223],v[172:175]
ds_read_b64_tr_b16 a[184:185], v47 offset:8192
MM v[172:175],a[144:147],a[204:207],v[172:175]
ds_read_b64_tr_b16 a[186:187], v47 offset:10240
MM v[176:179],a[152:155],a[192:195],v[176:179]
MM v[176:179],a[156:159],a[208:211],v[176:179]
ds_read_b64_tr_b16 a[188:189], v47 offset:12288
MM v[180:183],a[156:159],a[212:215],v[180:183]
ds_read_b64_tr_b16 a[190:191], v47 offset:14336
MM v[180:183],a[152:155],a[196:199],v[180:183]
buffer_load_dwordx4 a[240:243], v32, s[32:35], s68 offen offset:3072 sc1
MM v[184:187],a[152:155],a[200:203],v[184:187]
MM v[184:187],a[156:159],a[216:219],v[184:187]
MM v[188:191],a[156:159],a[220:223],v[188:191]
MM v[188:191],a[152:155],a[204:207],v[188:191]
buffer_load_dwordx4 a[244:247], v37, s[32:35], s68 offen offset:3072 sc1
s_waitcnt lgkmcnt(8)
MM v[192:195],a[160:163],a[192:195],v[192:195]
ds_read_b64_tr_b16 a[128:129], v44 offset:16384
MM v[192:195],a[164:167],a[208:211],v[192:195]
ds_read_b64_tr_b16 a[130:131], v44 offset:18432
MM v[196:199],a[164:167],a[212:215],v[196:199]
MM v[196:199],a[160:163],a[196:199],v[196:199]
ds_read_b64_tr_b16 a[132:133], v44 offset:20480
MM v[200:203],a[160:163],a[200:203],v[200:203]
ds_read_b64_tr_b16 a[134:135], v44 offset:22528
MM v[200:203],a[164:167],a[216:219],v[200:203]
buffer_load_dwordx4 a[248:251], v32, s[32:35], s69 offen offset:3072 sc1
MM v[204:207],a[164:167],a[220:223],v[204:207]
ds_read_b64_tr_b16 a[136:137], v45 offset:16384
MM v[204:207],a[160:163],a[204:207],v[204:207]
ds_read_b64_tr_b16 a[138:139], v45 offset:18432
MM v[208:211],a[168:171],a[192:195],v[208:211]
MM v[208:211],a[172:175],a[208:211],v[208:211]
ds_read_b64_tr_b16 a[140:141], v45 offset:20480
MM v[212:215],a[172:175],a[212:215],v[212:215]
ds_read_b64_tr_b16 a[142:143], v45 offset:22528
MM v[212:215],a[168:171],a[196:199],v[212:215]
buffer_load_dwordx4 a[252:255], v37, s[32:35], s69 offen offset:3072 sc1
s_add_u32 s68, s68, 4096
MM v[216:219],a[168:171],a[200:203],v[216:219]
s_add_u32 s69, s69, 4096
s_add_u32 m0, s70, 122880
MM v[216:219],a[172:175],a[216:219],v[216:219]
MM v[220:223],a[172:175],a[220:223],v[220:223]
MM v[220:223],a[168:171],a[204:207],v[220:223]
buffer_load_dwordx4 v35, s[44:47], s67 offen offset:0 sc1 lds
s_waitcnt lgkmcnt(8)
MM v[224:227],a[176:179],a[192:195],v[224:227]
ds_read_b64_tr_b16 a[144:145], v46 offset:16384
MM v[224:227],a[180:183],a[208:211],v[224:227]
ds_read_b64_tr_b16 a[146:147], v46 offset:18432
MM v[228:231],a[180:183],a[212:215],v[228:231]
MM v[228:231],a[176:179],a[196:199],v[228:231]
ds_read_b64_tr_b16 a[148:149], v46 offset:20480
MM v[232:235],a[176:179],a[200:203],v[232:235]
ds_read_b64_tr_b16 a[150:151], v46 offset:22528
MM v[232:235],a[180:183],a[216:219],v[232:235]
buffer_load_dwordx4 v36, s[44:47], s67 offen offset:1024 sc1 lds
s_add_u32 s67, s67, 221184
MM v[236:239],a[180:183],a[220:223],v[236:239]
ds_read_b64_tr_b16 a[152:153], v47 offset:16384
MM v[236:239],a[176:179],a[204:207],v[236:239]
ds_read_b64_tr_b16 a[154:155], v47 offset:18432
MM v[240:243],a[184:187],a[192:195],v[240:243]
s_add_u32 s63, s17, 40960
MM v[240:243],a[188:191],a[208:211],v[240:243]
ds_read_b64_tr_b16 a[156:157], v47 offset:20480
MM v[244:247],a[188:191],a[212:215],v[244:247]
ds_read_b64_tr_b16 a[158:159], v47 offset:22528
MM v[244:247],a[184:187],a[196:199],v[244:247]
buffer_store_dwordx4 v[112:115], v1, s[32:35], s63 offen offset:0 sc0 sc1
s_add_u32 s63, s17, 40960
MM v[248:251],a[184:187],a[200:203],v[248:251]
MM v[248:251],a[188:191],a[216:219],v[248:251]
MM v[252:255],a[188:191],a[220:223],v[252:255]
MM v[252:255],a[184:187],a[204:207],v[252:255]
buffer_store_dwordx4 v[116:119], v1, s[32:35], s63 offen offset:1024 sc0 sc1
s_waitcnt vmcnt(63) lgkmcnt(8)
MM a[0:3],a[128:131],a[192:195],a[0:3]
ds_read_b64_tr_b16 a[160:161], v44 offset:24576
MM a[0:3],a[132:135],a[208:211],a[0:3]
ds_read_b64_tr_b16 a[162:163], v44 offset:26624
MM a[4:7],a[132:135],a[212:215],a[4:7]
MM a[4:7],a[128:131],a[196:199],a[4:7]
ds_read_b64_tr_b16 a[164:165], v44 offset:28672
MM a[8:11],a[128:131],a[200:203],a[8:11]
ds_read_b64_tr_b16 a[166:167], v44 offset:30720
MM a[8:11],a[132:135],a[216:219],a[8:11]
global_load_dword v27, v55, s[100:101]
s_add_u32 s63, s17, 40960
MM a[12:15],a[132:135],a[220:223],a[12:15]
ds_read_b64_tr_b16 a[168:169], v45 offset:24576
MM a[12:15],a[128:131],a[204:207],a[12:15]
ds_read_b64_tr_b16 a[170:171], v45 offset:26624
MM a[16:19],a[136:139],a[192:195],a[16:19]
MM a[16:19],a[140:143],a[208:211],a[16:19]
ds_read_b64_tr_b16 a[172:173], v45 offset:28672
MM a[20:23],a[140:143],a[212:215],a[20:23]
ds_read_b64_tr_b16 a[174:175], v45 offset:30720
MM a[20:23],a[136:139],a[196:199],a[20:23]
buffer_store_dwordx4 v[120:123], v1, s[32:35], s63 offen offset:2048 sc0 sc1
s_add_u32 s63, s17, 40960
MM a[24:27],a[136:139],a[200:203],a[24:27]
MM a[24:27],a[140:143],a[216:219],a[24:27]
MM a[28:31],a[140:143],a[220:223],a[28:31]
MM a[28:31],a[136:139],a[204:207],a[28:31]
buffer_store_dwordx4 v[124:127], v1, s[32:35], s63 offen offset:3072 sc0 sc1
s_waitcnt lgkmcnt(8)
MM a[32:35],a[144:147],a[192:195],a[32:35]
ds_read_b64_tr_b16 a[176:177], v46 offset:24576
MM a[32:35],a[148:151],a[208:211],a[32:35]
ds_read_b64_tr_b16 a[178:179], v46 offset:26624
MM a[36:39],a[148:151],a[212:215],a[36:39]
MM a[36:39],a[144:147],a[196:199],a[36:39]
ds_read_b64_tr_b16 a[180:181], v46 offset:28672
MM a[40:43],a[144:147],a[200:203],a[40:43]
ds_read_b64_tr_b16 a[182:183], v46 offset:30720
MM a[40:43],a[148:151],a[216:219],a[40:43]
MM a[44:47],a[148:151],a[220:223],a[44:47]
ds_read_b64_tr_b16 a[184:185], v47 offset:24576
MM a[44:47],a[144:147],a[204:207],a[44:47]
ds_read_b64_tr_b16 a[186:187], v47 offset:26624
MM a[48:51],a[152:155],a[192:195],a[48:51]
MM a[48:51],a[156:159],a[208:211],a[48:51]
ds_read_b64_tr_b16 a[188:189], v47 offset:28672
MM a[52:55],a[156:159],a[212:215],a[52:55]
ds_read_b64_tr_b16 a[190:191], v47 offset:30720
MM a[52:55],a[152:155],a[196:199],a[52:55]
MM a[56:59],a[152:155],a[200:203],a[56:59]
MM a[56:59],a[156:159],a[216:219],a[56:59]
MM a[60:63],a[156:159],a[220:223],a[60:63]
MM a[60:63],a[152:155],a[204:207],a[60:63]
s_waitcnt lgkmcnt(8)
MM a[64:67],a[160:163],a[192:195],a[64:67]
s_waitcnt vmcnt(26) lgkmcnt(0)
s_barrier
ds_read_b64_tr_b16 a[128:129], v40 offset:0
MM a[64:67],a[164:167],a[208:211],a[64:67]
ds_read_b64_tr_b16 a[130:131], v40 offset:2048
MM a[68:71],a[164:167],a[212:215],a[68:71]
s_add_u32 m0, s70, 131072
MM a[68:71],a[160:163],a[196:199],a[68:71]
ds_read_b64_tr_b16 a[132:133], v40 offset:4096
MM a[72:75],a[160:163],a[200:203],a[72:75]
ds_read_b64_tr_b16 a[134:135], v40 offset:6144
MM a[72:75],a[164:167],a[216:219],a[72:75]
buffer_load_dwordx4 v33, s[36:39], s64 offen offset:0 sc1 lds
MM a[76:79],a[164:167],a[220:223],a[76:79]
ds_read_b64_tr_b16 a[136:137], v41 offset:0
MM a[76:79],a[160:163],a[204:207],a[76:79]
ds_read_b64_tr_b16 a[138:139], v41 offset:2048
MM a[80:83],a[168:171],a[192:195],a[80:83]
MM a[80:83],a[172:175],a[208:211],a[80:83]
ds_read_b64_tr_b16 a[140:141], v41 offset:4096
MM a[84:87],a[172:175],a[212:215],a[84:87]
ds_read_b64_tr_b16 a[142:143], v41 offset:6144
MM a[84:87],a[168:171],a[196:199],a[84:87]
buffer_load_dwordx4 v34, s[36:39], s64 offen offset:1024 sc1 lds
s_add_u32 s64, s64, 524288
MM a[88:91],a[168:171],a[200:203],a[88:91]
s_add_u32 m0, s70, 139264
MM a[88:91],a[172:175],a[216:219],a[88:91]
MM a[92:95],a[172:175],a[220:223],a[92:95]
MM a[92:95],a[168:171],a[204:207],a[92:95]
buffer_load_dwordx4 v33, s[36:39], s65 offen offset:0 sc1 lds
s_waitcnt lgkmcnt(8)
MM a[96:99],a[176:179],a[192:195],a[96:99]
ds_read_b64_tr_b16 a[144:145], v42 offset:0
MM a[96:99],a[180:183],a[208:211],a[96:99]
ds_read_b64_tr_b16 a[146:147], v42 offset:2048
MM a[100:103],a[180:183],a[212:215],a[100:103]
MM a[100:103],a[176:179],a[196:199],a[100:103]
ds_read_b64_tr_b16 a[148:149], v42 offset:4096
MM a[104:107],a[176:179],a[200:203],a[104:107]
ds_read_b64_tr_b16 a[150:151], v42 offset:6144
MM a[104:107],a[180:183],a[216:219],a[104:107]
buffer_load_dwordx4 v34, s[36:39], s65 offen offset:1024 sc1 lds
s_add_u32 s65, s65, 524288
MM a[108:111],a[180:183],a[220:223],a[108:111]
ds_read_b64_tr_b16 a[152:153], v43 offset:0
MM a[108:111],a[176:179],a[204:207],a[108:111]
ds_read_b64_tr_b16 a[154:155], v43 offset:2048
MM a[112:115],a[184:187],a[192:195],a[112:115]
s_add_u32 m0, s70, 147456
MM a[112:115],a[188:191],a[208:211],a[112:115]
ds_read_b64_tr_b16 a[156:157], v43 offset:4096
MM a[116:119],a[188:191],a[212:215],a[116:119]
ds_read_b64_tr_b16 a[158:159], v43 offset:6144
MM a[116:119],a[184:187],a[196:199],a[116:119]
buffer_load_dwordx4 v35, s[40:43], s66 offen offset:0 sc1 lds
MM a[120:123],a[184:187],a[200:203],a[120:123]
MM a[120:123],a[188:191],a[216:219],a[120:123]
MM a[124:127],a[188:191],a[220:223],a[124:127]
MM a[124:127],a[184:187],a[204:207],a[124:127]
buffer_load_dwordx4 v36, s[40:43], s66 offen offset:1024 sc1 lds
s_add_u32 s66, s66, 221184
s_waitcnt vmcnt(13) lgkmcnt(8)
MM v[128:131],a[128:131],a[224:227],v[128:131]
ds_read_b64_tr_b16 a[160:161], v40 offset:8192
MM v[128:131],a[132:135],a[240:243],v[128:131]
ds_read_b64_tr_b16 a[162:163], v40 offset:10240
MM v[132:135],a[132:135],a[244:247],v[132:135]
MM v[132:135],a[128:131],a[228:231],v[132:135]
ds_read_b64_tr_b16 a[164:165], v40 offset:12288
MM v[136:139],a[128:131],a[232:235],v[136:139]
ds_read_b64_tr_b16 a[166:167], v40 offset:14336
MM v[136:139],a[132:135],a[248:251],v[136:139]
buffer_load_dwordx4 a[192:195], v32, s[32:35], s68 offen offset:0 sc1
MM v[140:143],a[132:135],a[252:255],v[140:143]
ds_read_b64_tr_b16 a[168:169], v41 offset:8192
MM v[140:143],a[128:131],a[236:239],v[140:143]
ds_read_b64_tr_b16 a[170:171], v41 offset:10240
MM v[144:147],a[136:139],a[224:227],v[144:147]
MM v[144:147],a[140:143],a[240:243],v[144:147]
ds_read_b64_tr_b16 a[172:173], v41 offset:12288
MM v[148:151],a[140:143],a[244:247],v[148:151]
ds_read_b64_tr_b16 a[174:175], v41 offset:14336
MM v[148:151],a[136:139],a[228:231],v[148:151]
buffer_load_dwordx4 a[196:199], v37, s[32:35], s68 offen offset:0 sc1
MM v[152:155],a[136:139],a[232:235],v[152:155]
MM v[152:155],a[140:143],a[248:251],v[152:155]
MM v[156:159],a[140:143],a[252:255],v[156:159]
MM v[156:159],a[136:139],a[236:239],v[156:159]
buffer_load_dwordx4 a[200:203], v32, s[32:35], s69 offen offset:0 sc1
s_waitcnt lgkmcnt(8)
MM v[160:163],a[144:147],a[224:227],v[160:163]
ds_read_b64_tr_b16 a[176:177], v42 offset:8192
MM v[160:163],a[148:151],a[240:243],v[160:163]
ds_read_b64_tr_b16 a[178:179], v42 offset:10240
MM v[164:167],a[148:151],a[244:247],v[164:167]
MM v[164:167],a[144:147],a[228:231],v[164:167]
ds_read_b64_tr_b16 a[180:181], v42 offset:12288
MM v[168:171],a[144:147],a[232:235],v[168:171]
ds_read_b64_tr_b16 a[182:183], v42 offset:14336
MM v[168:171],a[148:151],a[248:251],v[168:171]
buffer_load_dwordx4 a[204:207], v37, s[32:35], s69 offen offset:0 sc1
MM v[172:175],a[148:151],a[252:255],v[172:175]
ds_read_b64_tr_b16 a[184:185], v43 offset:8192
MM v[172:175],a[144:147],a[236:239],v[172:175]
ds_read_b64_tr_b16 a[186:187], v43 offset:10240
MM v[176:179],a[152:155],a[224:227],v[176:179]
MM v[176:179],a[156:159],a[240:243],v[176:179]
ds_read_b64_tr_b16 a[188:189], v43 offset:12288
MM v[180:183],a[156:159],a[244:247],v[180:183]
ds_read_b64_tr_b16 a[190:191], v43 offset:14336
MM v[180:183],a[152:155],a[228:231],v[180:183]
buffer_load_dwordx4 a[208:211], v32, s[32:35], s68 offen offset:1024 sc1
MM v[184:187],a[152:155],a[232:235],v[184:187]
MM v[184:187],a[156:159],a[248:251],v[184:187]
MM v[188:191],a[156:159],a[252:255],v[188:191]
MM v[188:191],a[152:155],a[236:239],v[188:191]
buffer_load_dwordx4 a[212:215], v37, s[32:35], s68 offen offset:1024 sc1
s_waitcnt lgkmcnt(8)
MM v[192:195],a[160:163],a[224:227],v[192:195]
ds_read_b64_tr_b16 a[128:129], v40 offset:16384
MM v[192:195],a[164:167],a[240:243],v[192:195]
ds_read_b64_tr_b16 a[130:131], v40 offset:18432
MM v[196:199],a[164:167],a[244:247],v[196:199]
MM v[196:199],a[160:163],a[228:231],v[196:199]
ds_read_b64_tr_b16 a[132:133], v40 offset:20480
MM v[200:203],a[160:163],a[232:235],v[200:203]
ds_read_b64_tr_b16 a[134:135], v40 offset:22528
MM v[200:203],a[164:167],a[248:251],v[200:203]
buffer_load_dwordx4 a[216:219], v32, s[32:35], s69 offen offset:1024 sc1
MM v[204:207],a[164:167],a[252:255],v[204:207]
ds_read_b64_tr_b16 a[136:137], v41 offset:16384
MM v[204:207],a[160:163],a[236:239],v[204:207]
ds_read_b64_tr_b16 a[138:139], v41 offset:18432
MM v[208:211],a[168:171],a[224:227],v[208:211]
MM v[208:211],a[172:175],a[240:243],v[208:211]
ds_read_b64_tr_b16 a[140:141], v41 offset:20480
MM v[212:215],a[172:175],a[244:247],v[212:215]
ds_read_b64_tr_b16 a[142:143], v41 offset:22528
MM v[212:215],a[168:171],a[228:231],v[212:215]
buffer_load_dwordx4 a[220:223], v37, s[32:35], s69 offen offset:1024 sc1
s_add_u32 m0, s70, 155648
MM v[216:219],a[168:171],a[232:235],v[216:219]
MM v[216:219],a[172:175],a[248:251],v[216:219]
MM v[220:223],a[172:175],a[252:255],v[220:223]
MM v[220:223],a[168:171],a[236:239],v[220:223]
buffer_load_dwordx4 v35, s[44:47], s67 offen offset:0 sc1 lds
s_waitcnt lgkmcnt(8)
MM v[224:227],a[176:179],a[224:227],v[224:227]
ds_read_b64_tr_b16 a[144:145], v42 offset:16384
MM v[224:227],a[180:183],a[240:243],v[224:227]
ds_read_b64_tr_b16 a[146:147], v42 offset:18432
MM v[228:231],a[180:183],a[244:247],v[228:231]
MM v[228:231],a[176:179],a[228:231],v[228:231]
ds_read_b64_tr_b16 a[148:149], v42 offset:20480
MM v[232:235],a[176:179],a[232:235],v[232:235]
ds_read_b64_tr_b16 a[150:151], v42 offset:22528
MM v[232:235],a[180:183],a[248:251],v[232:235]
buffer_load_dwordx4 v36, s[44:47], s67 offen offset:1024 sc1 lds
s_add_u32 s67, s67, 221184
MM v[236:239],a[180:183],a[252:255],v[236:239]
ds_read_b64_tr_b16 a[152:153], v43 offset:16384
MM v[236:239],a[176:179],a[236:239],v[236:239]
ds_read_b64_tr_b16 a[154:155], v43 offset:18432
MM v[240:243],a[184:187],a[224:227],v[240:243]
MM v[240:243],a[188:191],a[240:243],v[240:243]
ds_read_b64_tr_b16 a[156:157], v43 offset:20480
MM v[244:247],a[188:191],a[244:247],v[244:247]
ds_read_b64_tr_b16 a[158:159], v43 offset:22528
MM v[244:247],a[184:187],a[228:231],v[244:247]
MM v[248:251],a[184:187],a[232:235],v[248:251]
MM v[248:251],a[188:191],a[248:251],v[248:251]
MM v[252:255],a[188:191],a[252:255],v[252:255]
MM v[252:255],a[184:187],a[236:239],v[252:255]
s_waitcnt vmcnt(16) lgkmcnt(8)
MM a[0:3],a[128:131],a[224:227],a[0:3]
ds_read_b64_tr_b16 a[160:161], v40 offset:24576
MM a[0:3],a[132:135],a[240:243],a[0:3]
ds_read_b64_tr_b16 a[162:163], v40 offset:26624
MM a[4:7],a[132:135],a[244:247],a[4:7]
buffer_store_dword v61, v60, s[32:35], s75 offen sc0 sc1
MM a[4:7],a[128:131],a[228:231],a[4:7]
ds_read_b64_tr_b16 a[164:165], v40 offset:28672
MM a[8:11],a[128:131],a[232:235],a[8:11]
ds_read_b64_tr_b16 a[166:167], v40 offset:30720
MM a[8:11],a[132:135],a[248:251],a[8:11]
MM a[12:15],a[132:135],a[252:255],a[12:15]
ds_read_b64_tr_b16 a[168:169], v41 offset:24576
MM a[12:15],a[128:131],a[236:239],a[12:15]
ds_read_b64_tr_b16 a[170:171], v41 offset:26624
MM a[16:19],a[136:139],a[224:227],a[16:19]
MM a[16:19],a[140:143],a[240:243],a[16:19]
ds_read_b64_tr_b16 a[172:173], v41 offset:28672
MM a[20:23],a[140:143],a[244:247],a[20:23]
ds_read_b64_tr_b16 a[174:175], v41 offset:30720
MM a[20:23],a[136:139],a[228:231],a[20:23]
MM a[24:27],a[136:139],a[232:235],a[24:27]
MM a[24:27],a[140:143],a[248:251],a[24:27]
MM a[28:31],a[140:143],a[252:255],a[28:31]
MM a[28:31],a[136:139],a[236:239],a[28:31]
s_waitcnt lgkmcnt(8)
MM a[32:35],a[144:147],a[224:227],a[32:35]
ds_read_b64_tr_b16 a[176:177], v42 offset:24576
MM a[32:35],a[148:151],a[240:243],a[32:35]
ds_read_b64_tr_b16 a[178:179], v42 offset:26624
MM a[36:39],a[148:151],a[244:247],a[36:39]
MM a[36:39],a[144:147],a[228:231],a[36:39]
ds_read_b64_tr_b16 a[180:181], v42 offset:28672
MM a[40:43],a[144:147],a[232:235],a[40:43]
ds_read_b64_tr_b16 a[182:183], v42 offset:30720
MM a[40:43],a[148:151],a[248:251],a[40:43]
MM a[44:47],a[148:151],a[252:255],a[44:47]
ds_read_b64_tr_b16 a[184:185], v43 offset:24576
MM a[44:47],a[144:147],a[236:239],a[44:47]
ds_read_b64_tr_b16 a[186:187], v43 offset:26624
MM a[48:51],a[152:155],a[224:227],a[48:51]
MM a[48:51],a[156:159],a[240:243],a[48:51]
ds_read_b64_tr_b16 a[188:189], v43 offset:28672
MM a[52:55],a[156:159],a[244:247],a[52:55]
ds_read_b64_tr_b16 a[190:191], v43 offset:30720
MM a[52:55],a[152:155],a[228:231],a[52:55]
MM a[56:59],a[152:155],a[232:235],a[56:59]
MM a[56:59],a[156:159],a[248:251],a[56:59]
MM a[60:63],a[156:159],a[252:255],a[60:63]
MM a[60:63],a[152:155],a[236:239],a[60:63]
s_waitcnt lgkmcnt(8)
MM a[64:67],a[160:163],a[224:227],a[64:67]
s_waitcnt vmcnt(22) lgkmcnt(0)
s_barrier
ds_read_b64_tr_b16 a[128:129], v40 offset:32768
MM a[64:67],a[164:167],a[240:243],a[64:67]
ds_read_b64_tr_b16 a[130:131], v40 offset:34816
MM a[68:71],a[164:167],a[244:247],a[68:71]
MM a[68:71],a[160:163],a[228:231],a[68:71]
ds_read_b64_tr_b16 a[132:133], v40 offset:36864
MM a[72:75],a[160:163],a[232:235],a[72:75]
ds_read_b64_tr_b16 a[134:135], v40 offset:38912
MM a[72:75],a[164:167],a[248:251],a[72:75]
MM a[76:79],a[164:167],a[252:255],a[76:79]
ds_read_b64_tr_b16 a[136:137], v41 offset:32768
MM a[76:79],a[160:163],a[236:239],a[76:79]
ds_read_b64_tr_b16 a[138:139], v41 offset:34816
MM a[80:83],a[168:171],a[224:227],a[80:83]
MM a[80:83],a[172:175],a[240:243],a[80:83]
ds_read_b64_tr_b16 a[140:141], v41 offset:36864
MM a[84:87],a[172:175],a[244:247],a[84:87]
ds_read_b64_tr_b16 a[142:143], v41 offset:38912
MM a[84:87],a[168:171],a[228:231],a[84:87]
MM a[88:91],a[168:171],a[232:235],a[88:91]
MM a[88:91],a[172:175],a[248:251],a[88:91]
MM a[92:95],a[172:175],a[252:255],a[92:95]
MM a[92:95],a[168:171],a[236:239],a[92:95]
s_waitcnt lgkmcnt(8)
MM a[96:99],a[176:179],a[224:227],a[96:99]
ds_read_b64_tr_b16 a[144:145], v42 offset:32768
MM a[96:99],a[180:183],a[240:243],a[96:99]
ds_read_b64_tr_b16 a[146:147], v42 offset:34816
MM a[100:103],a[180:183],a[244:247],a[100:103]
MM a[100:103],a[176:179],a[228:231],a[100:103]
ds_read_b64_tr_b16 a[148:149], v42 offset:36864
MM a[104:107],a[176:179],a[232:235],a[104:107]
ds_read_b64_tr_b16 a[150:151], v42 offset:38912
MM a[104:107],a[180:183],a[248:251],a[104:107]
MM a[108:111],a[180:183],a[252:255],a[108:111]
ds_read_b64_tr_b16 a[152:153], v43 offset:32768
MM a[108:111],a[176:179],a[236:239],a[108:111]
ds_read_b64_tr_b16 a[154:155], v43 offset:34816
MM a[112:115],a[184:187],a[224:227],a[112:115]
MM a[112:115],a[188:191],a[240:243],a[112:115]
ds_read_b64_tr_b16 a[156:157], v43 offset:36864
MM a[116:119],a[188:191],a[244:247],a[116:119]
ds_read_b64_tr_b16 a[158:159], v43 offset:38912
MM a[116:119],a[184:187],a[228:231],a[116:119]
MM a[120:123],a[184:187],a[232:235],a[120:123]
MM a[120:123],a[188:191],a[248:251],a[120:123]
MM a[124:127],a[188:191],a[252:255],a[124:127]
MM a[124:127],a[184:187],a[236:239],a[124:127]
s_waitcnt vmcnt(3) lgkmcnt(8)
MM v[128:131],a[128:131],a[192:195],v[128:131]
ds_read_b64_tr_b16 a[160:161], v40 offset:40960
MM v[128:131],a[132:135],a[208:211],v[128:131]
ds_read_b64_tr_b16 a[162:163], v40 offset:43008
MM v[132:135],a[132:135],a[212:215],v[132:135]
buffer_load_dwordx4 a[224:227], v32, s[32:35], s68 offen offset:2048 sc1
MM v[132:135],a[128:131],a[196:199],v[132:135]
ds_read_b64_tr_b16 a[164:165], v40 offset:45056
MM v[136:139],a[128:131],a[200:203],v[136:139]
ds_read_b64_tr_b16 a[166:167], v40 offset:47104
MM v[136:139],a[132:135],a[216:219],v[136:139]
buffer_load_dwordx4 a[228:231], v37, s[32:35], s68 offen offset:2048 sc1
MM v[140:143],a[132:135],a[220:223],v[140:143]
ds_read_b64_tr_b16 a[168:169], v41 offset:40960
MM v[140:143],a[128:131],a[204:207],v[140:143]
ds_read_b64_tr_b16 a[170:171], v41 offset:43008
MM v[144:147],a[136:139],a[192:195],v[144:147]
buffer_load_dwordx4 a[232:235], v32, s[32:35], s69 offen offset:2048 sc1
MM v[144:147],a[140:143],a[208:211],v[144:147]
ds_read_b64_tr_b16 a[172:173], v41 offset:45056
MM v[148:151],a[140:143],a[212:215],v[148:151]
ds_read_b64_tr_b16 a[174:175], v41 offset:47104
MM v[148:151],a[136:139],a[196:199],v[148:151]
buffer_load_dwordx4 a[236:239], v37, s[32:35], s69 offen offset:2048 sc1
MM v[152:155],a[136:139],a[200:203],v[152:155]
MM v[152:155],a[140:143],a[216:219],v[152:155]
buffer_load_dwordx4 a[240:243], v32, s[32:35], s68 offen offset:3072 sc1
MM v[156:159],a[140:143],a[220:223],v[156:159]
MM v[156:159],a[136:139],a[204:207],v[156:159]
buffer_load_dwordx4 a[244:247], v37, s[32:35], s68 offen offset:3072 sc1
s_waitcnt lgkmcnt(8)
MM v[160:163],a[144:147],a[192:195],v[160:163]
ds_read_b64_tr_b16 a[176:177], v42 offset:40960
MM v[160:163],a[148:151],a[208:211],v[160:163]
ds_read_b64_tr_b16 a[178:179], v42 offset:43008
MM v[164:167],a[148:151],a[212:215],v[164:167]
buffer_load_dwordx4 a[248:251], v32, s[32:35], s69 offen offset:3072 sc1
MM v[164:167],a[144:147],a[196:199],v[164:167]
ds_read_b64_tr_b16 a[180:181], v42 offset:45056
MM v[168:171],a[144:147],a[200:203],v[168:171]
ds_read_b64_tr_b16 a[182:183], v42 offset:47104
MM v[168:171],a[148:151],a[216:219],v[168:171]
buffer_load_dwordx4 a[252:255], v37, s[32:35], s69 offen offset:3072 sc1
s_add_u32 s68, s68, 4096
MM v[172:175],a[148:151],a[220:223],v[172:175]
ds_read_b64_tr_b16 a[184:185], v43 offset:40960
MM v[172:175],a[144:147],a[204:207],v[172:175]
ds_read_b64_tr_b16 a[186:187], v43 offset:43008
MM v[176:179],a[152:155],a[192:195],v[176:179]
s_add_u32 s69, s69, 4096
MM v[176:179],a[156:159],a[208:211],v[176:179]
ds_read_b64_tr_b16 a[188:189], v43 offset:45056
MM v[180:183],a[156:159],a[212:215],v[180:183]
ds_read_b64_tr_b16 a[190:191], v43 offset:47104
MM v[180:183],a[152:155],a[196:199],v[180:183]
MM v[184:187],a[152:155],a[200:203],v[184:187]
MM v[184:187],a[156:159],a[216:219],v[184:187]
MM v[188:191],a[156:159],a[220:223],v[188:191]
MM v[188:191],a[152:155],a[204:207],v[188:191]
s_waitcnt lgkmcnt(8)
MM v[192:195],a[160:163],a[192:195],v[192:195]
s_waitcnt vmcnt(9) lgkmcnt(0)
s_barrier
ds_read_b64_tr_b16 a[128:129], v44 offset:0
MM v[192:195],a[164:167],a[208:211],v[192:195]
ds_read_b64_tr_b16 a[130:131], v44 offset:2048
MM v[196:199],a[164:167],a[212:215],v[196:199]
MM v[196:199],a[160:163],a[196:199],v[196:199]
ds_read_b64_tr_b16 a[132:133], v44 offset:4096
MM v[200:203],a[160:163],a[200:203],v[200:203]
ds_read_b64_tr_b16 a[134:135], v44 offset:6144
MM v[200:203],a[164:167],a[216:219],v[200:203]
MM v[204:207],a[164:167],a[220:223],v[204:207]
ds_read_b64_tr_b16 a[136:137], v45 offset:0
MM v[204:207],a[160:163],a[204:207],v[204:207]
ds_read_b64_tr_b16 a[138:139], v45 offset:2048
MM v[208:211],a[168:171],a[192:195],v[208:211]
MM v[208:211],a[172:175],a[208:211],v[208:211]
ds_read_b64_tr_b16 a[140:141], v45 offset:4096
MM v[212:215],a[172:175],a[212:215],v[212:215]
ds_read_b64_tr_b16 a[142:143], v45 offset:6144
MM v[212:215],a[168:171],a[196:199],v[212:215]
MM v[216:219],a[168:171],a[200:203],v[216:219]
MM v[216:219],a[172:175],a[216:219],v[216:219]
MM v[220:223],a[172:175],a[220:223],v[220:223]
MM v[220:223],a[168:171],a[204:207],v[220:223]
s_waitcnt lgkmcnt(8)
MM v[224:227],a[176:179],a[192:195],v[224:227]
ds_read_b64_tr_b16 a[144:145], v46 offset:0
MM v[224:227],a[180:183],a[208:211],v[224:227]
ds_read_b64_tr_b16 a[146:147], v46 offset:2048
MM v[228:231],a[180:183],a[212:215],v[228:231]
MM v[228:231],a[176:179],a[196:199],v[228:231]
ds_read_b64_tr_b16 a[148:149], v46 offset:4096
MM v[232:235],a[176:179],a[200:203],v[232:235]
ds_read_b64_tr_b16 a[150:151], v46 offset:6144
MM v[232:235],a[180:183],a[216:219],v[232:235]
MM v[236:239],a[180:183],a[220:223],v[236:239]
ds_read_b64_tr_b16 a[152:153], v47 offset:0
MM v[236:239],a[176:179],a[204:207],v[236:239]
ds_read_b64_tr_b16 a[154:155], v47 offset:2048
MM v[240:243],a[184:187],a[192:195],v[240:243]
MM v[240:243],a[188:191],a[208:211],v[240:243]
ds_read_b64_tr_b16 a[156:157], v47 offset:4096
MM v[244:247],a[188:191],a[212:215],v[244:247]
ds_read_b64_tr_b16 a[158:159], v47 offset:6144
MM v[244:247],a[184:187],a[196:199],v[244:247]
MM v[248:251],a[184:187],a[200:203],v[248:251]
MM v[248:251],a[188:191],a[216:219],v[248:251]
MM v[252:255],a[188:191],a[220:223],v[252:255]
MM v[252:255],a[184:187],a[204:207],v[252:255]
s_waitcnt vmcnt(0) lgkmcnt(8)
MM v[128:131],a[128:131],a[224:227],v[128:131]
ds_read_b64_tr_b16 a[160:161], v44 offset:8192
MM v[128:131],a[132:135],a[240:243],v[128:131]
ds_read_b64_tr_b16 a[162:163], v44 offset:10240
MM v[132:135],a[132:135],a[244:247],v[132:135]
buffer_load_dwordx4 v[20:23], v52, s[32:35], s79 offen sc0 sc1
MM v[132:135],a[128:131],a[228:231],v[132:135]
ds_read_b64_tr_b16 a[164:165], v44 offset:12288
MM v[136:139],a[128:131],a[232:235],v[136:139]
ds_read_b64_tr_b16 a[166:167], v44 offset:14336
MM v[136:139],a[132:135],a[248:251],v[136:139]
MM v[140:143],a[132:135],a[252:255],v[140:143]
ds_read_b64_tr_b16 a[168:169], v45 offset:8192
MM v[140:143],a[128:131],a[236:239],v[140:143]
ds_read_b64_tr_b16 a[170:171], v45 offset:10240
MM v[144:147],a[136:139],a[224:227],v[144:147]
MM v[144:147],a[140:143],a[240:243],v[144:147]
ds_read_b64_tr_b16 a[172:173], v45 offset:12288
MM v[148:151],a[140:143],a[244:247],v[148:151]
ds_read_b64_tr_b16 a[174:175], v45 offset:14336
MM v[148:151],a[136:139],a[228:231],v[148:151]
MM v[152:155],a[136:139],a[232:235],v[152:155]
MM v[152:155],a[140:143],a[248:251],v[152:155]
MM v[156:159],a[140:143],a[252:255],v[156:159]
MM v[156:159],a[136:139],a[236:239],v[156:159]
s_waitcnt lgkmcnt(8)
MM v[160:163],a[144:147],a[224:227],v[160:163]
ds_read_b64_tr_b16 a[176:177], v46 offset:8192
MM v[160:163],a[148:151],a[240:243],v[160:163]
ds_read_b64_tr_b16 a[178:179], v46 offset:10240
MM v[164:167],a[148:151],a[244:247],v[164:167]
MM v[164:167],a[144:147],a[228:231],v[164:167]
ds_read_b64_tr_b16 a[180:181], v46 offset:12288
MM v[168:171],a[144:147],a[232:235],v[168:171]
ds_read_b64_tr_b16 a[182:183], v46 offset:14336
MM v[168:171],a[148:151],a[248:251],v[168:171]
MM v[172:175],a[148:151],a[252:255],v[172:175]
ds_read_b64_tr_b16 a[184:185], v47 offset:8192
MM v[172:175],a[144:147],a[236:239],v[172:175]
ds_read_b64_tr_b16 a[186:187], v47 offset:10240
MM v[176:179],a[152:155],a[224:227],v[176:179]
MM v[176:179],a[156:159],a[240:243],v[176:179]
ds_read_b64_tr_b16 a[188:189], v47 offset:12288
MM v[180:183],a[156:159],a[244:247],v[180:183]
ds_read_b64_tr_b16 a[190:191], v47 offset:14336
MM v[180:183],a[152:155],a[228:231],v[180:183]
MM v[184:187],a[152:155],a[232:235],v[184:187]
MM v[184:187],a[156:159],a[248:251],v[184:187]
MM v[188:191],a[156:159],a[252:255],v[188:191]
MM v[188:191],a[152:155],a[236:239],v[188:191]
s_waitcnt lgkmcnt(8)
MM v[192:195],a[160:163],a[224:227],v[192:195]
ds_read_b64_tr_b16 v[64:65], v40 offset:49152
MM v[192:195],a[164:167],a[240:243],v[192:195]
ds_read_b64_tr_b16 v[66:67], v40 offset:51200
MM v[196:199],a[164:167],a[244:247],v[196:199]
MM v[196:199],a[160:163],a[228:231],v[196:199]
ds_read_b64_tr_b16 v[68:69], v40 offset:53248
MM v[200:203],a[160:163],a[232:235],v[200:203]
ds_read_b64_tr_b16 v[70:71], v40 offset:55296
MM v[200:203],a[164:167],a[248:251],v[200:203]
MM v[204:207],a[164:167],a[252:255],v[204:207]
ds_read_b64_tr_b16 v[72:73], v41 offset:49152
MM v[204:207],a[160:163],a[236:239],v[204:207]
ds_read_b64_tr_b16 v[74:75], v41 offset:51200
MM v[208:211],a[168:171],a[224:227],v[208:211]
MM v[208:211],a[172:175],a[240:243],v[208:211]
ds_read_b64_tr_b16 v[76:77], v41 offset:53248
MM v[212:215],a[172:175],a[244:247],v[212:215]
ds_read_b64_tr_b16 v[78:79], v41 offset:55296
MM v[212:215],a[168:171],a[228:231],v[212:215]
MM v[216:219],a[168:171],a[232:235],v[216:219]
MM v[216:219],a[172:175],a[248:251],v[216:219]
MM v[220:223],a[172:175],a[252:255],v[220:223]
MM v[220:223],a[168:171],a[236:239],v[220:223]
s_waitcnt lgkmcnt(8)
MM v[224:227],a[176:179],a[224:227],v[224:227]
ds_read_b64_tr_b16 v[80:81], v42 offset:49152
MM v[224:227],a[180:183],a[240:243],v[224:227]
ds_read_b64_tr_b16 v[82:83], v42 offset:51200
MM v[228:231],a[180:183],a[244:247],v[228:231]
MM v[228:231],a[176:179],a[228:231],v[228:231]
ds_read_b64_tr_b16 v[84:85], v42 offset:53248
MM v[232:235],a[176:179],a[232:235],v[232:235]
ds_read_b64_tr_b16 v[86:87], v42 offset:55296
MM v[232:235],a[180:183],a[248:251],v[232:235]
MM v[236:239],a[180:183],a[252:255],v[236:239]
ds_read_b64_tr_b16 v[88:89], v43 offset:49152
MM v[236:239],a[176:179],a[236:239],v[236:239]
ds_read_b64_tr_b16 v[90:91], v43 offset:51200
MM v[240:243],a[184:187],a[224:227],v[240:243]
MM v[240:243],a[188:191],a[240:243],v[240:243]
ds_read_b64_tr_b16 v[92:93], v43 offset:53248
MM v[244:247],a[188:191],a[244:247],v[244:247]
ds_read_b64_tr_b16 v[94:95], v43 offset:55296
MM v[244:247],a[184:187],a[228:231],v[244:247]
MM v[248:251],a[184:187],a[232:235],v[248:251]
MM v[248:251],a[188:191],a[248:251],v[248:251]
MM v[252:255],a[188:191],a[252:255],v[252:255]
MM v[252:255],a[184:187],a[236:239],v[252:255]
s_waitcnt vmcnt(0) lgkmcnt(8)
v_xor_b32 v20, v20, v61
v_xor_b32 v21, v21, v61
v_xor_b32 v22, v22, v61
v_xor_b32 v23, v23, v61
v_or3_b32 v20, v20, v21, v22
v_or_b32 v20, v20, v23
v_cmp_ne_u32 vcc, 0, v20
s_nop 1
s_cbranch_vccnz L_sl_3
L_ok_4:
MM a[0:3],v[64:67],a[192:195],a[0:3]
ds_read_b64_tr_b16 v[96:97], v40 offset:57344
s_mov_b32 s64, 0x3e0293ee
v_mul_f32 v128, s64, v128
v_mul_f32 v129, s64, v129
MM a[0:3],v[68:71],a[208:211],a[0:3]
ds_read_b64_tr_b16 v[98:99], v40 offset:59392
v_mul_f32 v130, s64, v130
v_mul_f32 v131, s64, v131
v_mul_f32 v144, s64, v144
MM a[4:7],v[68:71],a[212:215],a[4:7]
s_add_u32 m0, s59, 0
v_mul_f32 v145, s64, v145
v_mul_f32 v146, s64, v146
v_mul_f32 v147, s64, v147
MM a[4:7],v[64:67],a[196:199],a[4:7]
ds_read_b64_tr_b16 v[100:101], v40 offset:61440
CV v128,v128,v129
CV v129,v130,v131
CV v144,v144,v145
MM a[8:11],v[64:67],a[200:203],a[8:11]
ds_read_b64_tr_b16 v[102:103], v40 offset:63488
CV v145,v146,v147
AW a128,v128
AW a129,v129
MM a[8:11],v[68:71],a[216:219],a[8:11]
buffer_load_dwordx4 v1, s[32:35], s56 offen offset:0 sc1 lds
AW a130,v144
AW a131,v145
v_mul_f32 v160, s64, v160
MM a[12:15],v[68:71],a[220:223],a[12:15]
ds_read_b64_tr_b16 v[104:105], v41 offset:57344
v_mul_f32 v161, s64, v161
v_mul_f32 v162, s64, v162
v_mul_f32 v163, s64, v163
MM a[12:15],v[64:67],a[204:207],a[12:15]
ds_read_b64_tr_b16 v[106:107], v41 offset:59392
v_mul_f32 v176, s64, v176
v_mul_f32 v177, s64, v177
v_mul_f32 v178, s64, v178
MM a[16:19],v[72:75],a[192:195],a[16:19]
v_mul_f32 v179, s64, v179
CV v160,v160,v161
CV v161,v162,v163
MM a[16:19],v[76:79],a[208:211],a[16:19]
ds_read_b64_tr_b16 v[108:109], v41 offset:61440
CV v176,v176,v177
CV v177,v178,v179
AW a132,v160
MM a[20:23],v[76:79],a[212:215],a[20:23]
ds_read_b64_tr_b16 v[110:111], v41 offset:63488
AW a133,v161
AW a134,v176
AW a135,v177
MM a[20:23],v[72:75],a[196:199],a[20:23]
buffer_load_dwordx4 v1, s[32:35], s56 offen offset:1024 sc1 lds
v_mul_f32 v192, s64, v192
v_mul_f32 v193, s64, v193
v_mul_f32 v194, s64, v194
MM a[24:27],v[72:75],a[200:203],a[24:27]
v_mul_f32 v195, s64, v195
v_mul_f32 v208, s64, v208
v_mul_f32 v209, s64, v209
MM a[24:27],v[76:79],a[216:219],a[24:27]
v_mul_f32 v210, s64, v210
v_mul_f32 v211, s64, v211
CV v192,v192,v193
MM a[28:31],v[76:79],a[220:223],a[28:31]
CV v193,v194,v195
CV v208,v208,v209
CV v209,v210,v211
MM a[28:31],v[72:75],a[204:207],a[28:31]
buffer_load_dwordx4 v1, s[32:35], s56 offen offset:2048 sc1 lds
AW a136,v192
AW a137,v193
AW a138,v208
s_waitcnt lgkmcnt(8)
MM a[32:35],v[80:83],a[192:195],a[32:35]
ds_read_b64_tr_b16 v[112:113], v42 offset:57344
AW a139,v209
v_mul_f32 v224, s64, v224
v_mul_f32 v225, s64, v225
MM a[32:35],v[84:87],a[208:211],a[32:35]
ds_read_b64_tr_b16 v[114:115], v42 offset:59392
v_mul_f32 v226, s64, v226
v_mul_f32 v227, s64, v227
v_mul_f32 v240, s64, v240
MM a[36:39],v[84:87],a[212:215],a[36:39]
v_mul_f32 v241, s64, v241
v_mul_f32 v242, s64, v242
v_mul_f32 v243, s64, v243
MM a[36:39],v[80:83],a[196:199],a[36:39]
ds_read_b64_tr_b16 v[116:117], v42 offset:61440
CV v224,v224,v225
CV v225,v226,v227
CV v240,v240,v241
MM a[40:43],v[80:83],a[200:203],a[40:43]
ds_read_b64_tr_b16 v[118:119], v42 offset:63488
CV v241,v242,v243
AW a140,v224
AW a141,v225
MM a[40:43],v[84:87],a[216:219],a[40:43]
buffer_load_dwordx4 v1, s[32:35], s56 offen offset:3072 sc1 lds
AW a142,v240
AW a143,v241
v_mul_f32 v132, s64, v132
MM a[44:47],v[84:87],a[220:223],a[44:47]
ds_read_b64_tr_b16 v[120:121], v43 offset:57344
v_mul_f32 v133, s64, v133
v_mul_f32 v134, s64, v134
v_mul_f32 v135, s64, v135
MM a[44:47],v[80:83],a[204:207],a[44:47]
ds_read_b64_tr_b16 v[122:123], v43 offset:59392
v_mul_f32 v148, s64, v148
v_mul_f32 v149, s64, v149
v_mul_f32 v150, s64, v150
MM a[48:51],v[88:91],a[192:195],a[48:51]
s_add_u32 m0, s59, 16384
v_mul_f32 v151, s64, v151
CV v132,v132,v133
CV v133,v134,v135
MM a[48:51],v[92:95],a[208:211],a[48:51]
ds_read_b64_tr_b16 v[124:125], v43 offset:61440
CV v148,v148,v149
CV v149,v150,v151
AW a144,v132
MM a[52:55],v[92:95],a[212:215],a[52:55]
ds_read_b64_tr_b16 v[126:127], v43 offset:63488
AW a145,v133
AW a146,v148
AW a147,v149
MM a[52:55],v[88:91],a[196:199],a[52:55]
buffer_load_dwordx4 v1, s[32:35], s62 offen offset:0 sc1 lds
v_mul_f32 v164, s64, v164
v_mul_f32 v165, s64, v165
v_mul_f32 v166, s64, v166
MM a[56:59],v[88:91],a[200:203],a[56:59]
v_mul_f32 v167, s64, v167
v_mul_f32 v180, s64, v180
v_mul_f32 v181, s64, v181
MM a[56:59],v[92:95],a[216:219],a[56:59]
v_mul_f32 v182, s64, v182
v_mul_f32 v183, s64, v183
CV v164,v164,v165
MM a[60:63],v[92:95],a[220:223],a[60:63]
CV v165,v166,v167
CV v180,v180,v181
CV v181,v182,v183
MM a[60:63],v[88:91],a[204:207],a[60:63]
buffer_load_dwordx4 v1, s[32:35], s62 offen offset:1024 sc1 lds
AW a148,v164
AW a149,v165
AW a150,v180
s_waitcnt lgkmcnt(8)
MM a[64:67],v[96:99],a[192:195],a[64:67]
ds_read_b64_tr_b16 v[64:65], v44 offset:16384
AW a151,v181
v_mul_f32 v196, s64, v196
v_mul_f32 v197, s64, v197
MM a[64:67],v[100:103],a[208:211],a[64:67]
ds_read_b64_tr_b16 v[66:67], v44 offset:18432
v_mul_f32 v198, s64, v198
v_mul_f32 v199, s64, v199
v_mul_f32 v212, s64, v212
MM a[68:71],v[100:103],a[212:215],a[68:71]
v_mul_f32 v213, s64, v213
v_mul_f32 v214, s64, v214
v_mul_f32 v215, s64, v215
MM a[68:71],v[96:99],a[196:199],a[68:71]
ds_read_b64_tr_b16 v[68:69], v44 offset:20480
CV v196,v196,v197
CV v197,v198,v199
CV v212,v212,v213
MM a[72:75],v[96:99],a[200:203],a[72:75]
ds_read_b64_tr_b16 v[70:71], v44 offset:22528
CV v213,v214,v215
AW a152,v196
AW a153,v197
MM a[72:75],v[100:103],a[216:219],a[72:75]
buffer_load_dwordx4 v1, s[32:35], s62 offen offset:2048 sc1 lds
AW a154,v212
AW a155,v213
v_mul_f32 v228, s64, v228
MM a[76:79],v[100:103],a[220:223],a[76:79]
ds_read_b64_tr_b16 v[72:73], v45 offset:16384
v_mul_f32 v229, s64, v229
v_mul_f32 v230, s64, v230
v_mul_f32 v231, s64, v231
MM a[76:79],v[96:99],a[204:207],a[76:79]
ds_read_b64_tr_b16 v[74:75], v45 offset:18432
v_mul_f32 v244, s64, v244
v_mul_f32 v245, s64, v245
v_mul_f32 v246, s64, v246
MM a[80:83],v[104:107],a[192:195],a[80:83]
v_mul_f32 v247, s64, v247
CV v228,v228,v229
CV v229,v230,v231
MM a[80:83],v[108:111],a[208:211],a[80:83]
ds_read_b64_tr_b16 v[76:77], v45 offset:20480
CV v244,v244,v245
CV v245,v246,v247
AW a156,v228
MM a[84:87],v[108:111],a[212:215],a[84:87]
ds_read_b64_tr_b16 v[78:79], v45 offset:22528
AW a157,v229
AW a158,v244
AW a159,v245
MM a[84:87],v[104:107],a[196:199],a[84:87]
buffer_load_dwordx4 v1, s[32:35], s62 offen offset:3072 sc1 lds
v_mul_f32 v136, s64, v136
v_mul_f32 v137, s64, v137
v_mul_f32 v138, s64, v138
MM a[88:91],v[104:107],a[200:203],a[88:91]
s_add_u32 m0, s59, 32768
v_mul_f32 v139, s64, v139
v_mul_f32 v152, s64, v152
v_mul_f32 v153, s64, v153
MM a[88:91],v[108:111],a[216:219],a[88:91]
v_mul_f32 v154, s64, v154
v_mul_f32 v155, s64, v155
CV v136,v136,v137
MM a[92:95],v[108:111],a[220:223],a[92:95]
CV v137,v138,v139
CV v152,v152,v153
CV v153,v154,v155
MM a[92:95],v[104:107],a[204:207],a[92:95]
buffer_load_dwordx4 v1, s[32:35], s57 offen offset:0 sc1 lds
AW a160,v136
AW a161,v137
AW a162,v152
s_waitcnt lgkmcnt(8)
MM a[96:99],v[112:115],a[192:195],a[96:99]
ds_read_b64_tr_b16 v[80:81], v46 offset:16384
AW a163,v153
v_mul_f32 v168, s64, v168
v_mul_f32 v169, s64, v169
MM a[96:99],v[116:119],a[208:211],a[96:99]
ds_read_b64_tr_b16 v[82:83], v46 offset:18432
v_mul_f32 v170, s64, v170
v_mul_f32 v171, s64, v171
v_mul_f32 v184, s64, v184
MM a[100:103],v[116:119],a[212:215],a[100:103]
v_mul_f32 v185, s64, v185
v_mul_f32 v186, s64, v186
v_mul_f32 v187, s64, v187
MM a[100:103],v[112:115],a[196:199],a[100:103]
ds_read_b64_tr_b16 v[84:85], v46 offset:20480
CV v168,v168,v169
CV v169,v170,v171
CV v184,v184,v185
MM a[104:107],v[112:115],a[200:203],a[104:107]
ds_read_b64_tr_b16 v[86:87], v46 offset:22528
CV v185,v186,v187
AW a164,v168
AW a165,v169
MM a[104:107],v[116:119],a[216:219],a[104:107]
buffer_load_dwordx4 v1, s[32:35], s57 offen offset:1024 sc1 lds
AW a166,v184
AW a167,v185
v_mul_f32 v200, s64, v200
MM a[108:111],v[116:119],a[220:223],a[108:111]
ds_read_b64_tr_b16 v[88:89], v47 offset:16384
v_mul_f32 v201, s64, v201
v_mul_f32 v202, s64, v202
v_mul_f32 v203, s64, v203
MM a[108:111],v[112:115],a[204:207],a[108:111]
ds_read_b64_tr_b16 v[90:91], v47 offset:18432
v_mul_f32 v216, s64, v216
v_mul_f32 v217, s64, v217
v_mul_f32 v218, s64, v218
MM a[112:115],v[120:123],a[192:195],a[112:115]
v_mul_f32 v219, s64, v219
CV v200,v200,v201
CV v201,v202,v203
MM a[112:115],v[124:127],a[208:211],a[112:115]
ds_read_b64_tr_b16 v[92:93], v47 offset:20480
CV v216,v216,v217
CV v217,v218,v219
AW a168,v200
MM a[116:119],v[124:127],a[212:215],a[116:119]
ds_read_b64_tr_b16 v[94:95], v47 offset:22528
AW a169,v201
AW a170,v216
AW a171,v217
MM a[116:119],v[120:123],a[196:199],a[116:119]
buffer_load_dwordx4 v1, s[32:35], s57 offen offset:2048 sc1 lds
v_mul_f32 v232, s64, v232
v_mul_f32 v233, s64, v233
v_mul_f32 v234, s64, v234
MM a[120:123],v[120:123],a[200:203],a[120:123]
v_mul_f32 v235, s64, v235
v_mul_f32 v248, s64, v248
v_mul_f32 v249, s64, v249
MM a[120:123],v[124:127],a[216:219],a[120:123]
v_mul_f32 v250, s64, v250
v_mul_f32 v251, s64, v251
CV v232,v232,v233
MM a[124:127],v[124:127],a[220:223],a[124:127]
CV v233,v234,v235
CV v248,v248,v249
CV v249,v250,v251
MM a[124:127],v[120:123],a[204:207],a[124:127]
buffer_load_dwordx4 v1, s[32:35], s57 offen offset:3072 sc1 lds
AW a172,v232
AW a173,v233
AW a174,v248
s_waitcnt vmcnt(63) lgkmcnt(8)
MM a[0:3],v[64:67],a[224:227],a[0:3]
ds_read_b64_tr_b16 v[96:97], v44 offset:24576
AW a175,v249
v_mul_f32 v140, s64, v140
v_mul_f32 v141, s64, v141
MM a[0:3],v[68:71],a[240:243],a[0:3]
ds_read_b64_tr_b16 v[98:99], v44 offset:26624
v_mul_f32 v142, s64, v142
v_mul_f32 v143, s64, v143
v_mul_f32 v156, s64, v156
MM a[4:7],v[68:71],a[244:247],a[4:7]
s_add_u32 m0, s59, 65536
v_mul_f32 v157, s64, v157
v_mul_f32 v158, s64, v158
v_mul_f32 v159, s64, v159
MM a[4:7],v[64:67],a[228:231],a[4:7]
ds_read_b64_tr_b16 v[100:101], v44 offset:28672
CV v140,v140,v141
CV v141,v142,v143
CV v156,v156,v157
MM a[8:11],v[64:67],a[232:235],a[8:11]
ds_read_b64_tr_b16 v[102:103], v44 offset:30720
CV v157,v158,v159
AW a176,v140
AW a177,v141
MM a[8:11],v[68:71],a[248:251],a[8:11]
buffer_load_dwordx4 v2, s[32:35], s56 offen offset:0 sc1 lds
AW a178,v156
AW a179,v157
v_mul_f32 v172, s64, v172
MM a[12:15],v[68:71],a[252:255],a[12:15]
ds_read_b64_tr_b16 v[104:105], v45 offset:24576
v_mul_f32 v173, s64, v173
v_mul_f32 v174, s64, v174
v_mul_f32 v175, s64, v175
MM a[12:15],v[64:67],a[236:239],a[12:15]
ds_read_b64_tr_b16 v[106:107], v45 offset:26624
v_mul_f32 v188, s64, v188
v_mul_f32 v189, s64, v189
v_mul_f32 v190, s64, v190
MM a[16:19],v[72:75],a[224:227],a[16:19]
v_mul_f32 v191, s64, v191
CV v172,v172,v173
CV v173,v174,v175
MM a[16:19],v[76:79],a[240:243],a[16:19]
ds_read_b64_tr_b16 v[108:109], v45 offset:28672
CV v188,v188,v189
CV v189,v190,v191
AW a180,v172
MM a[20:23],v[76:79],a[244:247],a[20:23]
ds_read_b64_tr_b16 v[110:111], v45 offset:30720
AW a181,v173
AW a182,v188
AW a183,v189
MM a[20:23],v[72:75],a[228:231],a[20:23]
buffer_load_dwordx4 v2, s[32:35], s56 offen offset:1024 sc1 lds
v_mul_f32 v204, s64, v204
v_mul_f32 v205, s64, v205
v_mul_f32 v206, s64, v206
MM a[24:27],v[72:75],a[232:235],a[24:27]
v_mul_f32 v207, s64, v207
v_mul_f32 v220, s64, v220
v_mul_f32 v221, s64, v221
MM a[24:27],v[76:79],a[248:251],a[24:27]
v_mul_f32 v222, s64, v222
v_mul_f32 v223, s64, v223
CV v204,v204,v205
MM a[28:31],v[76:79],a[252:255],a[28:31]
CV v205,v206,v207
CV v220,v220,v221
CV v221,v222,v223
MM a[28:31],v[72:75],a[236:239],a[28:31]
buffer_load_dwordx4 v2, s[32:35], s56 offen offset:2048 sc1 lds
AW a184,v204
AW a185,v205
AW a186,v220
s_waitcnt lgkmcnt(8)
MM a[32:35],v[80:83],a[224:227],a[32:35]
ds_read_b64_tr_b16 v[112:113], v46 offset:24576
AW a187,v221
v_mul_f32 v236, s64, v236
v_mul_f32 v237, s64, v237
MM a[32:35],v[84:87],a[240:243],a[32:35]
ds_read_b64_tr_b16 v[114:115], v46 offset:26624
v_mul_f32 v238, s64, v238
v_mul_f32 v239, s64, v239
v_mul_f32 v252, s64, v252
MM a[36:39],v[84:87],a[244:247],a[36:39]
v_mul_f32 v253, s64, v253
v_mul_f32 v254, s64, v254
v_mul_f32 v255, s64, v255
MM a[36:39],v[80:83],a[228:231],a[36:39]
ds_read_b64_tr_b16 v[116:117], v46 offset:28672
CV v236,v236,v237
CV v237,v238,v239
CV v252,v252,v253
MM a[40:43],v[80:83],a[232:235],a[40:43]
ds_read_b64_tr_b16 v[118:119], v46 offset:30720
CV v253,v254,v255
AW a188,v236
AW a189,v237
MM a[40:43],v[84:87],a[248:251],a[40:43]
buffer_load_dwordx4 v2, s[32:35], s56 offen offset:3072 sc1 lds
AW a190,v252
AW a191,v253
v_and_b32 v5, 15, v0
MM a[44:47],v[84:87],a[252:255],a[44:47]
ds_read_b64_tr_b16 v[120:121], v47 offset:24576
v_lshrrev_b32 v6, 4, v0
v_lshlrev_b32 v6, 2, v6
v_sub_u32 v5, v5, v6
MM a[44:47],v[80:83],a[236:239],a[44:47]
ds_read_b64_tr_b16 v[122:123], v47 offset:26624
v_cmp_gt_i32 vcc, 0, v5
s_nop 1
v_cndmask_b32 v12, 0, 1.0, vcc
v_cmp_gt_i32 vcc, 1, v5
s_nop 1
v_cndmask_b32 v13, 0, 1.0, vcc
v_cmp_gt_i32 vcc, 2, v5
s_nop 1
v_cndmask_b32 v14, 0, 1.0, vcc
MM a[48:51],v[88:91],a[224:227],a[48:51]
s_add_u32 m0, s59, 49152
v_cmp_gt_i32 vcc, 3, v5
s_nop 1
v_cndmask_b32 v15, 0, 1.0, vcc
v_mov_b32 v56, 0x3f803f80
v_mov_b32 v57, 0x3f803f80
MM a[48:51],v[92:95],a[240:243],a[48:51]
ds_read_b64_tr_b16 v[124:125], v47 offset:28672
v_mov_b32 v58, 0x3f803f80
v_mov_b32 v59, 0x3f803f80
v_mov_b32 v16, 0
MM a[52:55],v[92:95],a[244:247],a[52:55]
ds_read_b64_tr_b16 v[126:127], v47 offset:30720
v_mov_b32 v17, 0
v_mov_b32 v18, 0
v_mov_b32 v19, 0
MM a[52:55],v[88:91],a[228:231],a[52:55]
buffer_load_dwordx4 v1, s[32:35], s58 offen offset:0 sc1 lds
v_mov_b32 v20, 0
v_mov_b32 v21, 0
v_mov_b32 v22, 0
MM a[56:59],v[88:91],a[232:235],a[56:59]
v_mov_b32 v23, 0
v_mov_b32 v24, 0
v_mov_b32 v25, 0
MM a[56:59],v[92:95],a[248:251],a[56:59]
v_mov_b32 v26, 0
v_mov_b32 v27, 0
v_mov_b32 v28, 0
MM a[60:63],v[92:95],a[252:255],a[60:63]
v_mov_b32 v29, 0
v_mov_b32 v30, 0
v_mov_b32 v31, 0
MM a[60:63],v[88:91],a[236:239],a[60:63]
buffer_load_dwordx4 v1, s[32:35], s58 offen offset:1024 sc1 lds
v_mov_b32 v8, 0
v_mov_b32 v9, 0
v_mov_b32 v10, 0
s_waitcnt lgkmcnt(8)
MM a[64:67],v[96:99],a[224:227],a[64:67]
v_mov_b32 v11, 0
v_mov_b32 v3, v1
v_add_u32 v4, 65536, v1
MM a[64:67],v[100:103],a[240:243],a[64:67]
s_mul_i32 s8, s72, 55296
s_mul_i32 s9, s73, 55296
s_lshl_b32 s10, s71, 14
MM a[68:71],v[100:103],a[244:247],a[68:71]
s_add_u32 s10, s10, 0x6000000
s_cmp_eq_u32 s74, 0
s_cselect_b32 s10, 0x20000000, s10
s_add_u32 s8, s8, s10
MM a[68:71],v[96:99],a[228:231],a[68:71]
buffer_load_dwordx4 v1, s[32:35], s58 offen offset:2048 sc1 lds
s_add_u32 s9, s9, s10
s_add_u32 s10, s8, 8192
s_add_u32 s11, s9, 8192
MM a[72:75],v[96:99],a[232:235],a[72:75]
s_sub_u32 s12, 7, s30
s_lshl_b32 s12, s12, 10
v_add_u32 v32, s12, v1
MM a[72:75],v[100:103],a[248:251],a[72:75]
s_lshl_b32 s12, s30, 10
v_add_u32 v37, s12, v1
s_mov_b32 s64, 0x53800000
MM a[76:79],v[100:103],a[252:255],a[76:79]
s_mov_b32 s65, 0xf149f2ca
s_sub_u32 s66, 3, s30
s_cmp_eq_u32 s3, 0
s_cselect_b32 s69, s65, 0
MM a[76:79],v[96:99],a[236:239],a[76:79]
buffer_load_dwordx4 v1, s[32:35], s58 offen offset:3072 sc1 lds
s_add_u32 m0, s59, 81920
MM a[80:83],v[104:107],a[224:227],a[80:83]
MM a[80:83],v[108:111],a[240:243],a[80:83]
MM a[84:87],v[108:111],a[244:247],a[84:87]
MM a[84:87],v[104:107],a[228:231],a[84:87]
buffer_load_dwordx4 v2, s[32:35], s62 offen offset:0 sc1 lds
MM a[88:91],v[104:107],a[232:235],a[88:91]
MM a[88:91],v[108:111],a[248:251],a[88:91]
MM a[92:95],v[108:111],a[252:255],a[92:95]
MM a[92:95],v[104:107],a[236:239],a[92:95]
buffer_load_dwordx4 v2, s[32:35], s62 offen offset:1024 sc1 lds
s_waitcnt lgkmcnt(0)
MM a[96:99],v[112:115],a[224:227],a[96:99]
MM a[96:99],v[116:119],a[240:243],a[96:99]
MM a[100:103],v[116:119],a[244:247],a[100:103]
MM a[100:103],v[112:115],a[228:231],a[100:103]
buffer_load_dwordx4 v2, s[32:35], s62 offen offset:2048 sc1 lds
MM a[104:107],v[112:115],a[232:235],a[104:107]
MM a[104:107],v[116:119],a[248:251],a[104:107]
MM a[108:111],v[116:119],a[252:255],a[108:111]
MM a[108:111],v[112:115],a[236:239],a[108:111]
buffer_load_dwordx4 v2, s[32:35], s62 offen offset:3072 sc1 lds
MM a[112:115],v[120:123],a[224:227],a[112:115]
MM a[112:115],v[124:127],a[240:243],a[112:115]
MM a[116:119],v[124:127],a[244:247],a[116:119]
MM a[116:119],v[120:123],a[228:231],a[116:119]
MM a[120:123],v[120:123],a[232:235],a[120:123]
MM a[120:123],v[124:127],a[248:251],a[120:123]
MM a[124:127],v[124:127],a[252:255],a[124:127]
MM a[124:127],v[120:123],a[236:239],a[124:127]
s_waitcnt vmcnt(8)
s_barrier
ds_read_b128 a[192:195], v3 offset:0
ds_read_b128 a[196:199], v3 offset:1024
ds_read_b128 a[200:203], v3 offset:2048
ds_read_b128 a[204:207], v3 offset:3072
ds_read_b128 a[208:211], v3 offset:4096
ds_read_b128 a[212:215], v3 offset:5120
ds_read_b128 a[216:219], v3 offset:6144
ds_read_b128 a[220:223], v3 offset:7168
ds_read_b128 a[224:227], v3 offset:8192
ds_read_b128 a[228:231], v3 offset:9216
AR v192,a0
AR v193,a1
AR v194,a2
AR v195,a3
AR v196,a64
AR v197,a65
AR v198,a66
AR v199,a67
v_mul_f32 v192, v192, v196
v_mul_f32 v193, v193, v197
v_mul_f32 v194, v194, v198
v_mul_f32 v195, v195, v199
CV v208,v192,v193
CV v209,v194,v195
AR v200,a16
AR v201,a17
s_cmp_eq_u32 s30, 0
s_cselect_b32 s67, s69, 0
v_fma_f32 v68, v12, s67, v20
v_fma_f32 v69, v13, s67, v20
v_fma_f32 v70, v14, s67, v20
v_fma_f32 v71, v15, s67, v20
s_nop 1
s_waitcnt lgkmcnt(6)
MM v[128:131],a[192:195],a[160:163],v[24:27]
ds_read_b128 a[232:235], v3 offset:10240
s_cmp_eq_u32 s30, 1
s_cselect_b32 s67, s69, 0
s_cmp_lt_u32 s30, 1
s_cselect_b32 s68, s69, 0
v_add_f32 v6, s68, v20
v_fma_f32 v76, v12, s67, v6
v_fma_f32 v77, v13, s67, v6
v_fma_f32 v78, v14, s67, v6
v_fma_f32 v79, v15, s67, v6
MM v[128:131],a[196:199],a[164:167],v[128:131]
AR v202,a18
AR v203,a19
MM v[128:131],a[200:203],a[168:171],v[128:131]
AR v204,a80
AR v205,a81
MM v[128:131],a[204:207],a[172:175],v[128:131]
AR v206,a82
AR v207,a83
MM v[132:135],a[204:207],a[188:191],v[28:31]
ds_read_b128 a[236:239], v3 offset:11264
v_mul_f32 v200, v200, v204
MM v[132:135],a[200:203],a[184:187],v[132:135]
v_mul_f32 v201, v201, v205
v_mul_f32 v202, v202, v206
MM v[132:135],a[196:199],a[180:183],v[132:135]
v_mul_f32 v203, v203, v207
CV v210,v200,v201
MM v[132:135],a[192:195],a[176:179],v[132:135]
CV v211,v202,v203
buffer_store_dwordx4 v[208:211], v32, s[32:35], s8 offen sc0 sc1
MM v[64:67],a[192:195],a[128:131],v[16:19]
ds_read_b128 a[240:243], v3 offset:12288
AR v212,a4
MM v[64:67],a[196:199],a[132:135],v[64:67]
AR v213,a5
AR v214,a6
MM v[64:67],a[200:203],a[136:139],v[64:67]
AR v215,a7
AR v216,a68
MM v[64:67],a[204:207],a[140:143],v[64:67]
AR v217,a69
AR v218,a70
MM v[68:71],a[204:207],a[156:159],v[68:71]
ds_read_b128 a[244:247], v3 offset:13312
s_waitcnt lgkmcnt(6)
MM v[68:71],a[200:203],a[152:155],v[68:71]
s_cmp_eq_u32 s30, 2
s_cselect_b32 s67, s69, 0
s_cmp_lt_u32 s30, 2
s_cselect_b32 s68, s69, 0
v_add_f32 v6, s68, v20
v_fma_f32 v84, v12, s67, v6
v_fma_f32 v85, v13, s67, v6
v_fma_f32 v86, v14, s67, v6
v_fma_f32 v87, v15, s67, v6
AR v219,a71
MM v[68:71],a[196:199],a[148:151],v[68:71]
v_mul_f32 v212, v212, v216
v_mul_f32 v213, v213, v217
MM v[68:71],a[192:195],a[144:147],v[68:71]
v_mul_f32 v214, v214, v218
v_mul_f32 v215, v215, v219
MM v[136:139],a[208:211],a[160:163],v[24:27]
ds_read_b128 a[248:251], v3 offset:14336
CV v228,v212,v213
MM v[136:139],a[212:215],a[164:167],v[136:139]
CV v229,v214,v215
AR v220,a20
MM v[136:139],a[216:219],a[168:171],v[136:139]
AR v221,a21
AR v222,a22
MM v[136:139],a[220:223],a[172:175],v[136:139]
AR v223,a23
AR v224,a84
MM v[140:143],a[220:223],a[188:191],v[28:31]
ds_read_b128 a[252:255], v3 offset:15360
AR v225,a85
MM v[140:143],a[216:219],a[184:187],v[140:143]
AR v226,a86
AR v227,a87
MM v[140:143],a[212:215],a[180:183],v[140:143]
v_mul_f32 v220, v220, v224
v_mul_f32 v221, v221, v225
MM v[140:143],a[208:211],a[176:179],v[140:143]
v_mul_f32 v222, v222, v226
v_mul_f32 v223, v223, v227
MM v[72:75],a[208:211],a[128:131],v[16:19]
ds_read_b128 a[192:195], v3 offset:16384
CV v230,v220,v221
MM v[72:75],a[212:215],a[132:135],v[72:75]
CV v231,v222,v223
buffer_store_dwordx4 v[228:231], v37, s[32:35], s8 offen sc0 sc1
MM v[72:75],a[216:219],a[136:139],v[72:75]
AR v232,a8
AR v233,a9
MM v[72:75],a[220:223],a[140:143],v[72:75]
AR v234,a10
AR v235,a11
MM v[76:79],a[220:223],a[156:159],v[76:79]
ds_read_b128 a[196:199], v3 offset:17408
s_waitcnt lgkmcnt(6)
MM v[76:79],a[216:219],a[152:155],v[76:79]
s_cmp_eq_u32 s30, 3
s_cselect_b32 s67, s69, 0
s_cmp_lt_u32 s30, 3
s_cselect_b32 s68, s69, 0
v_add_f32 v6, s68, v20
v_fma_f32 v92, v12, s67, v6
v_fma_f32 v93, v13, s67, v6
v_fma_f32 v94, v14, s67, v6
v_fma_f32 v95, v15, s67, v6
AR v236,a72
MM v[76:79],a[212:215],a[148:151],v[76:79]
AR v237,a73
AR v238,a74
MM v[76:79],a[208:211],a[144:147],v[76:79]
AR v239,a75
v_mul_f32 v232, v232, v236
MM v[144:147],a[224:227],a[160:163],v[24:27]
ds_read_b128 a[200:203], v3 offset:18432
v_mul_f32 v233, v233, v237
MM v[144:147],a[228:231],a[164:167],v[144:147]
v_mul_f32 v234, v234, v238
v_mul_f32 v235, v235, v239
MM v[144:147],a[232:235],a[168:171],v[144:147]
CV v248,v232,v233
CV v249,v234,v235
MM v[144:147],a[236:239],a[172:175],v[144:147]
AR v240,a24
AR v241,a25
MM v[148:151],a[236:239],a[188:191],v[28:31]
ds_read_b128 a[204:207], v3 offset:19456
AR v242,a26
MM v[148:151],a[232:235],a[184:187],v[148:151]
AR v243,a27
AR v244,a88
MM v[148:151],a[228:231],a[180:183],v[148:151]
AR v245,a89
AR v246,a90
MM v[148:151],a[224:227],a[176:179],v[148:151]
AR v247,a91
v_mul_f32 v240, v240, v244
MM v[80:83],a[224:227],a[128:131],v[16:19]
ds_read_b128 a[208:211], v3 offset:20480
v_mul_f32 v241, v241, v245
MM v[80:83],a[228:231],a[132:135],v[80:83]
v_mul_f32 v242, v242, v246
v_mul_f32 v243, v243, v247
MM v[80:83],a[232:235],a[136:139],v[80:83]
CV v250,v240,v241
CV v251,v242,v243
MM v[80:83],a[236:239],a[140:143],v[80:83]
buffer_store_dwordx4 v[248:251], v32, s[32:35], s9 offen sc0 sc1
AR v192,a12
MM v[84:87],a[236:239],a[156:159],v[84:87]
ds_read_b128 a[212:215], v3 offset:21504
s_waitcnt lgkmcnt(6)
MM v[84:87],a[232:235],a[152:155],v[84:87]
AR v193,a13
AR v194,a14
MM v[84:87],a[228:231],a[148:151],v[84:87]
AR v195,a15
AR v196,a76
MM v[84:87],a[224:227],a[144:147],v[84:87]
AR v197,a77
AR v198,a78
MM v[152:155],a[240:243],a[160:163],v[24:27]
ds_read_b128 a[216:219], v3 offset:22528
AR v199,a79
MM v[152:155],a[244:247],a[164:167],v[152:155]
v_mul_f32 v192, v192, v196
v_mul_f32 v193, v193, v197
MM v[152:155],a[248:251],a[168:171],v[152:155]
v_mul_f32 v194, v194, v198
v_mul_f32 v195, v195, v199
MM v[152:155],a[252:255],a[172:175],v[152:155]
CV v208,v192,v193
CV v209,v194,v195
MM v[156:159],a[252:255],a[188:191],v[28:31]
ds_read_b128 a[220:223], v3 offset:23552
AR v200,a28
MM v[156:159],a[248:251],a[184:187],v[156:159]
AR v201,a29
AR v202,a30
MM v[156:159],a[244:247],a[180:183],v[156:159]
AR v203,a31
AR v204,a92
MM v[156:159],a[240:243],a[176:179],v[156:159]
AR v205,a93
AR v206,a94
MM v[88:91],a[240:243],a[128:131],v[16:19]
ds_read_b128 a[224:227], v3 offset:24576
AR v207,a95
MM v[88:91],a[244:247],a[132:135],v[88:91]
v_mul_f32 v200, v200, v204
v_mul_f32 v201, v201, v205
MM v[88:91],a[248:251],a[136:139],v[88:91]
v_mul_f32 v202, v202, v206
v_mul_f32 v203, v203, v207
MM v[88:91],a[252:255],a[140:143],v[88:91]
CV v210,v200,v201
CV v211,v202,v203
MM v[92:95],a[252:255],a[156:159],v[92:95]
ds_read_b128 a[228:231], v3 offset:25600
s_waitcnt lgkmcnt(6)
MM v[92:95],a[248:251],a[152:155],v[92:95]
buffer_store_dwordx4 v[208:211], v37, s[32:35], s9 offen sc0 sc1
AR v212,a32
MM v[92:95],a[244:247],a[148:151],v[92:95]
AR v213,a33
AR v214,a34
MM v[92:95],a[240:243],a[144:147],v[92:95]
AR v215,a35
AR v216,a96
AR v217,a97
AR v218,a98
AR v219,a99
v_mul_f32 v212, v212, v216
v_mul_f32 v213, v213, v217
v_mul_f32 v214, v214, v218
v_mul_f32 v215, v215, v219
CV v228,v212,v213
CV v229,v214,v215
AR v220,a48
AR v221,a49
AR v222,a50
AR v223,a51
AR v224,a112
AR v225,a113
AR v226,a114
AR v227,a115
v_mul_f32 v220, v220, v224
v_mul_f32 v221, v221, v225
v_mul_f32 v222, v222, v226
v_mul_f32 v223, v223, v227
CV v230,v220,v221
CV v231,v222,v223
buffer_store_dwordx4 v[228:231], v32, s[32:35], s10 offen sc0 sc1
AR v232,a36
AR v233,a37
AR v234,a38
AR v235,a39
AR v236,a100
AR v237,a101
AR v238,a102
AR v239,a103
v_mul_f32 v232, v232, v236
v_mul_f32 v233, v233, v237
v_mul_f32 v234, v234, v238
v_mul_f32 v235, v235, v239
CV v248,v232,v233
CV v249,v234,v235
AR v240,a52
AR v241,a53
AR v242,a54
AR v243,a55
AR v244,a116
AR v245,a117
AR v246,a118
AR v247,a119
v_mul_f32 v240, v240, v244
v_mul_f32 v241, v241, v245
v_mul_f32 v242, v242, v246
v_mul_f32 v243, v243, v247
CV v250,v240,v241
CV v251,v242,v243
buffer_store_dwordx4 v[248:251], v37, s[32:35], s10 offen sc0 sc1
AR v192,a40
AR v193,a41
AR v194,a42
AR v195,a43
AR v196,a104
AR v197,a105
AR v198,a106
AR v199,a107
v_mul_f32 v192, v192, v196
v_mul_f32 v193, v193, v197
v_mul_f32 v194, v194, v198
v_mul_f32 v195, v195, v199
CV v208,v192,v193
CV v209,v194,v195
AR v200,a56
AR v201,a57
AR v202,a58
AR v203,a59
AR v204,a120
AR v205,a121
AR v206,a122
AR v207,a123
v_mul_f32 v200, v200, v204
v_mul_f32 v201, v201, v205
v_mul_f32 v202, v202, v206
v_mul_f32 v203, v203, v207
CV v210,v200,v201
CV v211,v202,v203
buffer_store_dwordx4 v[208:211], v32, s[32:35], s11 offen sc0 sc1
AR v212,a44
AR v213,a45
AR v214,a46
AR v215,a47
AR v216,a108
AR v217,a109
AR v218,a110
AR v219,a111
v_mul_f32 v212, v212, v216
v_mul_f32 v213, v213, v217
v_mul_f32 v214, v214, v218
v_mul_f32 v215, v215, v219
CV v228,v212,v213
CV v229,v214,v215
AR v220,a60
AR v221,a61
AR v222,a62
AR v223,a63
AR v224,a124
AR v225,a125
AR v226,a126
AR v227,a127
v_mul_f32 v220, v220, v224
v_mul_f32 v221, v221, v225
v_mul_f32 v222, v222, v226
v_mul_f32 v223, v223, v227
CV v230,v220,v221
CV v231,v222,v223
buffer_store_dwordx4 v[228:231], v37, s[32:35], s11 offen sc0 sc1
v_mfma_f32_32x32x16_bf16 a[0:15], v[16:19], v[16:19], 0
v_mfma_f32_32x32x16_bf16 a[16:31], v[16:19], v[16:19], 0
v_mfma_f32_32x32x16_bf16 a[32:47], v[16:19], v[16:19], 0
v_mfma_f32_32x32x16_bf16 a[48:63], v[16:19], v[16:19], 0
v_mfma_f32_32x32x16_bf16 a[64:79], v[16:19], v[16:19], 0
v_mfma_f32_32x32x16_bf16 a[80:95], v[16:19], v[16:19], 0
v_mfma_f32_32x32x16_bf16 a[96:111], v[16:19], v[16:19], 0
v_mfma_f32_32x32x16_bf16 a[112:127], v[16:19], v[16:19], 0
buffer_load_dwordx4 v[208:211], v62, s[32:35], s79 offen sc0 sc1
s_nop 3
v_max3_f32 v5, v64, v65, v66
v_max3_f32 v6, v67, v72, v73
v_max3_f32 v5, v5, v74, v75
v_max3_f32 v6, v6, v80, v81
v_max3_f32 v5, v5, v82, v83
v_max3_f32 v6, v6, v88, v89
v_max3_f32 v5, v5, v90, v91
v_max_f32 v5, v5, v6
v_mov_b32 v6, v5
s_nop 1
v_permlane16_swap_b32 v5, v6
s_nop 1
v_max_f32 v5, v5, v6
v_mov_b32 v6, v5
s_nop 1
v_permlane32_swap_b32 v5, v6
s_nop 1
v_max_f32 v5, v5, v6
v_sub_f32 v16, 0, v5
v_sub_f32 v17, 0, v5
v_sub_f32 v18, 0, v5
v_sub_f32 v19, 0, v5
v_max3_f32 v5, v68, v69, v70
v_max3_f32 v6, v71, v76, v77
v_max3_f32 v5, v5, v78, v79
v_max3_f32 v6, v6, v84, v85
v_max3_f32 v5, v5, v86, v87
v_max3_f32 v6, v6, v92, v93
v_max3_f32 v5, v5, v94, v95
v_max_f32 v5, v5, v6
v_mov_b32 v6, v5
s_nop 1
v_permlane16_swap_b32 v5, v6
s_nop 1
v_max_f32 v5, v5, v6
v_mov_b32 v6, v5
s_nop 1
v_permlane32_swap_b32 v5, v6
s_nop 1
v_max_f32 v5, v5, v6
v_sub_f32 v20, 0, v5
v_sub_f32 v21, 0, v5
v_sub_f32 v22, 0, v5
v_sub_f32 v23, 0, v5
v_max3_f32 v5, v128, v129, v130
v_max3_f32 v6, v131, v136, v137
v_max3_f32 v5, v5, v138, v139
v_max3_f32 v6, v6, v144, v145
v_max3_f32 v5, v5, v146, v147
v_max3_f32 v6, v6, v152, v153
v_max3_f32 v5, v5, v154, v155
v_max_f32 v5, v5, v6
v_mov_b32 v6, v5
s_nop 1
v_permlane16_swap_b32 v5, v6
s_nop 1
v_max_f32 v5, v5, v6
v_mov_b32 v6, v5
s_nop 1
v_permlane32_swap_b32 v5, v6
s_nop 1
v_max_f32 v5, v5, v6
v_sub_f32 v24, 0, v5
v_sub_f32 v25, 0, v5
v_sub_f32 v26, 0, v5
v_sub_f32 v27, 0, v5
v_max3_f32 v5, v132, v133, v134
v_max3_f32 v6, v135, v140, v141
v_max3_f32 v5, v5, v142, v143
v_max3_f32 v6, v6, v148, v149
v_max3_f32 v5, v5, v150, v151
v_max3_f32 v6, v6, v156, v157
v_max3_f32 v5, v5, v158, v159
v_max_f32 v5, v5, v6
v_mov_b32 v6, v5
s_nop 1
v_permlane16_swap_b32 v5, v6
s_nop 1
v_max_f32 v5, v5, v6
v_mov_b32 v6, v5
s_nop 1
v_permlane32_swap_b32 v5, v6
s_nop 1
v_max_f32 v5, v5, v6
v_sub_f32 v28, 0, v5
v_sub_f32 v29, 0, v5
v_sub_f32 v30, 0, v5
v_sub_f32 v31, 0, v5
s_cmp_eq_u32 s66, 0
s_cselect_b32 s67, s69, 0
v_fma_f32 v96, v12, s67, v16
v_fma_f32 v97, v13, s67, v16
v_fma_f32 v98, v14, s67, v16
v_fma_f32 v99, v15, s67, v16
s_nop 1
MM v[160:163],a[192:195],a[160:163],v[24:27]
ds_read_b128 a[232:235], v3 offset:26624
v_add_f32 v128, v128, v24
MM v[160:163],a[196:199],a[164:167],v[160:163]
v_exp_f32 v48, v128
MM v[160:163],a[200:203],a[168:171],v[160:163]
v_add_f32 v129, v129, v24
v_add_f32 v130, v130, v24
MM v[160:163],a[204:207],a[172:175],v[160:163]
v_exp_f32 v49, v129
MM v[164:167],a[204:207],a[188:191],v[28:31]
ds_read_b128 a[236:239], v3 offset:27648
s_cmp_eq_u32 s66, 1
s_cselect_b32 s67, s69, 0
s_cmp_lt_u32 s66, 1
s_cselect_b32 s68, s69, 0
v_add_f32 v6, s68, v16
v_fma_f32 v104, v12, s67, v6
v_fma_f32 v105, v13, s67, v6
v_fma_f32 v106, v14, s67, v6
v_fma_f32 v107, v15, s67, v6
MM v[164:167],a[200:203],a[184:187],v[164:167]
v_exp_f32 v50, v130
MM v[164:167],a[196:199],a[180:183],v[164:167]
v_add_f32 v131, v131, v24
v_add_f32 v136, v136, v24
MM v[164:167],a[192:195],a[176:179],v[164:167]
v_exp_f32 v51, v131
MM v[96:99],a[192:195],a[128:131],v[96:99]
ds_read_b128 a[240:243], v3 offset:28672
v_add_f32 v137, v137, v24
MM v[96:99],a[196:199],a[132:135],v[96:99]
v_exp_f32 v52, v136
MM v[96:99],a[200:203],a[136:139],v[96:99]
v_exp_f32 v53, v137
MM v[96:99],a[204:207],a[140:143],v[96:99]
CV v224,v48,v49
v_add_f32 v138, v138, v24
MM v[100:103],a[204:207],a[156:159],v[20:23]
ds_read_b128 a[244:247], v3 offset:29696
s_waitcnt lgkmcnt(6)
MM v[100:103],a[200:203],a[152:155],v[100:103]
v_exp_f32 v54, v138
MM v[100:103],a[196:199],a[148:151],v[100:103]
CV v225,v50,v51
v_add_f32 v139, v139, v24
MM v[100:103],a[192:195],a[144:147],v[100:103]
v_exp_f32 v55, v139
MM v[168:171],a[208:211],a[160:163],v[24:27]
ds_read_b128 a[248:251], v3 offset:30720
v_add_f32 v132, v132, v28
MM v[168:171],a[212:215],a[164:167],v[168:171]
v_exp_f32 v48, v132
MM v[168:171],a[216:219],a[168:171],v[168:171]
CV v226,v52,v53
v_add_f32 v133, v133, v28
MM v[168:171],a[220:223],a[172:175],v[168:171]
v_exp_f32 v49, v133
MM v[172:175],a[220:223],a[188:191],v[28:31]
ds_read_b128 a[252:255], v3 offset:31744
s_cmp_eq_u32 s66, 2
s_cselect_b32 s67, s69, 0
s_cmp_lt_u32 s66, 2
s_cselect_b32 s68, s69, 0
v_add_f32 v6, s68, v16
v_fma_f32 v112, v12, s67, v6
v_fma_f32 v113, v13, s67, v6
v_fma_f32 v114, v14, s67, v6
v_fma_f32 v115, v15, s67, v6
MM v[172:175],a[216:219],a[184:187],v[172:175]
v_xor_b32 v3, 32768, v3
v_add_f32 v134, v134, v28
MM v[172:175],a[212:215],a[180:183],v[172:175]
v_exp_f32 v50, v134
MM v[172:175],a[208:211],a[176:179],v[172:175]
CV v227,v54,v55
v_add_f32 v135, v135, v28
MM v[104:107],a[208:211],a[128:131],v[104:107]
ds_read_b128 a[192:195], v3 offset:0
v_add_f32 v140, v140, v28
MM v[104:107],a[212:215],a[132:135],v[104:107]
v_exp_f32 v51, v135
MM v[104:107],a[216:219],a[136:139],v[104:107]
v_exp_f32 v52, v140
MM v[104:107],a[220:223],a[140:143],v[104:107]
CV v232,v48,v49
v_add_f32 v141, v141, v28
MM v[40:43],v[56:59],v[224:227],0
v_exp_f32 v53, v141
MM v[108:111],a[220:223],a[156:159],v[20:23]
ds_read_b128 a[196:199], v3 offset:1024
s_waitcnt lgkmcnt(6)
MM v[108:111],a[216:219],a[152:155],v[108:111]
v_add_f32 v142, v142, v28
v_add_f32 v143, v143, v28
MM v[108:111],a[212:215],a[148:151],v[108:111]
v_exp_f32 v54, v142
MM v[108:111],a[208:211],a[144:147],v[108:111]
v_exp_f32 v55, v143
MM v[176:179],a[224:227],a[160:163],v[24:27]
ds_read_b128 a[200:203], v3 offset:2048
CV v233,v50,v51
MM v[176:179],a[228:231],a[164:167],v[176:179]
v_add_f32 v144, v144, v24
v_add_f32 v145, v145, v24
MM v[176:179],a[232:235],a[168:171],v[176:179]
v_exp_f32 v48, v144
MM v[176:179],a[236:239],a[172:175],v[176:179]
v_exp_f32 v49, v145
MM v[180:183],a[236:239],a[188:191],v[28:31]
ds_read_b128 a[204:207], v3 offset:3072
s_cmp_eq_u32 s66, 3
s_cselect_b32 s67, s69, 0
s_cmp_lt_u32 s66, 3
s_cselect_b32 s68, s69, 0
v_add_f32 v6, s68, v16
v_fma_f32 v120, v12, s67, v6
v_fma_f32 v121, v13, s67, v6
v_fma_f32 v122, v14, s67, v6
v_fma_f32 v123, v15, s67, v6
MM v[180:183],a[232:235],a[184:187],v[180:183]
CV v234,v52,v53
v_add_f32 v146, v146, v24
MM v[180:183],a[228:231],a[180:183],v[180:183]
v_exp_f32 v50, v146
MM v[180:183],a[224:227],a[176:179],v[180:183]
CV v235,v54,v55
v_add_f32 v147, v147, v24
MM v[112:115],a[224:227],a[128:131],v[112:115]
ds_read_b128 a[208:211], v3 offset:4096
v_add_f32 v152, v152, v24
MM v[112:115],a[228:231],a[132:135],v[112:115]
v_exp_f32 v51, v147
MM v[112:115],a[232:235],a[136:139],v[112:115]
v_exp_f32 v52, v152
MM v[112:115],a[236:239],a[140:143],v[112:115]
CV v228,v48,v49
v_add_f32 v153, v153, v24
MM v[44:47],v[56:59],v[232:235],0
v_exp_f32 v53, v153
MM v[116:119],a[236:239],a[156:159],v[20:23]
ds_read_b128 a[212:215], v3 offset:5120
s_waitcnt lgkmcnt(6)
MM v[116:119],a[232:235],a[152:155],v[116:119]
v_add_f32 v154, v154, v24
v_add_f32 v155, v155, v24
MM v[116:119],a[228:231],a[148:151],v[116:119]
v_exp_f32 v54, v154
MM v[116:119],a[224:227],a[144:147],v[116:119]
v_exp_f32 v55, v155
MM v[184:187],a[240:243],a[160:163],v[24:27]
ds_read_b128 a[216:219], v3 offset:6144
CV v229,v50,v51
MM v[184:187],a[244:247],a[164:167],v[184:187]
v_add_f32 v148, v148, v28
v_add_f32 v149, v149, v28
MM v[184:187],a[248:251],a[168:171],v[184:187]
v_exp_f32 v48, v148
MM v[184:187],a[252:255],a[172:175],v[184:187]
v_exp_f32 v49, v149
MM v[188:191],a[252:255],a[188:191],v[28:31]
ds_read_b128 a[220:223], v3 offset:7168
CV v230,v52,v53
MM v[188:191],a[248:251],a[184:187],v[188:191]
v_add_f32 v150, v150, v28
v_add_f32 v151, v151, v28
MM v[188:191],a[244:247],a[180:183],v[188:191]
v_exp_f32 v50, v150
MM v[188:191],a[240:243],a[176:179],v[188:191]
v_exp_f32 v51, v151
MM v[120:123],a[240:243],a[128:131],v[120:123]
ds_read_b128 a[224:227], v3 offset:8192
CV v231,v54,v55
MM v[120:123],a[244:247],a[132:135],v[120:123]
v_add_f32 v156, v156, v28
v_add_f32 v157, v157, v28
MM v[120:123],a[248:251],a[136:139],v[120:123]
v_exp_f32 v52, v156
MM v[120:123],a[252:255],a[140:143],v[120:123]
v_exp_f32 v53, v157
MM v[40:43],v[56:59],v[228:231],v[40:43]
CV v236,v48,v49
v_add_f32 v158, v158, v28
MM v[124:127],a[252:255],a[156:159],v[20:23]
ds_read_b128 a[228:231], v3 offset:9216
s_waitcnt lgkmcnt(6)
MM v[124:127],a[248:251],a[152:155],v[124:127]
v_exp_f32 v54, v158
MM v[124:127],a[244:247],a[148:151],v[124:127]
CV v237,v50,v51
v_add_f32 v159, v159, v28
MM v[124:127],a[240:243],a[144:147],v[124:127]
v_exp_f32 v55, v159
v_add_f32 v64, v64, v16
v_exp_f32 v48, v64
CV v238,v52,v53
v_add_f32 v65, v65, v16
v_exp_f32 v49, v65
v_add_f32 v66, v66, v16
v_exp_f32 v50, v66
CV v239,v54,v55
v_add_f32 v67, v67, v16
s_nop 1
MM v[44:47],v[56:59],v[236:239],v[44:47]
v_exp_f32 v51, v67
v_add_f32 v72, v72, v16
v_add_f32 v73, v73, v16
v_exp_f32 v52, v72
v_exp_f32 v53, v73
CV v192,v48,v49
v_add_f32 v74, v74, v16
v_exp_f32 v54, v74
CV v193,v50,v51
v_add_f32 v75, v75, v16
v_exp_f32 v55, v75
v_add_f32 v68, v68, v20
v_exp_f32 v48, v68
CV v194,v52,v53
v_add_f32 v69, v69, v20
v_exp_f32 v49, v69
v_add_f32 v70, v70, v20
v_exp_f32 v50, v70
CV v195,v54,v55
v_add_f32 v71, v71, v20
s_nop 1
MM v[32:35],v[56:59],v[192:195],0
v_exp_f32 v51, v71
v_add_f32 v76, v76, v20
v_add_f32 v77, v77, v20
v_exp_f32 v52, v76
v_exp_f32 v53, v77
CV v200,v48,v49
v_add_f32 v78, v78, v20
v_exp_f32 v54, v78
CV v201,v50,v51
v_add_f32 v79, v79, v20
v_exp_f32 v55, v79
v_add_f32 v80, v80, v16
v_exp_f32 v48, v80
CV v202,v52,v53
v_add_f32 v81, v81, v16
v_exp_f32 v49, v81
v_add_f32 v82, v82, v16
v_exp_f32 v50, v82
CV v203,v54,v55
v_add_f32 v83, v83, v16
s_nop 1
MM v[36:39],v[56:59],v[200:203],0
v_exp_f32 v51, v83
v_add_f32 v88, v88, v16
v_add_f32 v89, v89, v16
v_exp_f32 v52, v88
v_exp_f32 v53, v89
CV v196,v48,v49
v_add_f32 v90, v90, v16
v_exp_f32 v54, v90
CV v197,v50,v51
v_add_f32 v91, v91, v16
v_exp_f32 v55, v91
v_add_f32 v84, v84, v20
v_exp_f32 v48, v84
CV v198,v52,v53
v_add_f32 v85, v85, v20
v_exp_f32 v49, v85
v_add_f32 v86, v86, v20
v_exp_f32 v50, v86
CV v199,v54,v55
v_add_f32 v87, v87, v20
s_nop 1
MM v[32:35],v[56:59],v[196:199],v[32:35]
v_exp_f32 v51, v87
v_add_f32 v92, v92, v20
v_add_f32 v93, v93, v20
v_exp_f32 v52, v92
v_exp_f32 v53, v93
CV v204,v48,v49
v_add_f32 v94, v94, v20
v_exp_f32 v54, v94
CV v205,v50,v51
v_add_f32 v95, v95, v20
v_exp_f32 v55, v95
CV v206,v52,v53
v_exp_f32 v48, v160
CV v207,v54,v55
v_exp_f32 v49, v161
s_nop 1
MM v[36:39],v[56:59],v[204:207],v[36:39]
v_exp_f32 v50, v162
v_exp_f32 v51, v163
v_exp_f32 v52, v168
v_exp_f32 v53, v169
s_waitcnt vmcnt(0)
buffer_store_dword v61, v60, s[32:35], s76 offen sc0 sc1
v_xor_b32 v208, v208, v61
v_xor_b32 v209, v209, v61
v_xor_b32 v210, v210, v61
v_xor_b32 v211, v211, v61
v_or3_b32 v208, v208, v209, v210
v_or_b32 v208, v208, v211
v_cmp_ne_u32 vcc, 0, v208
s_nop 1
s_cbranch_vccnz L_sl_5
L_ok_6:
s_cmp_eq_u32 s3, 0
s_cbranch_scc1 L_tail2A
s_sub_u32 s63, s3, 2
s_cbranch_scc1 L_skipA
.p2align 6
L_loopA:
MM v[128:131],a[192:195],a[160:163],v[24:27]
ds_read_b128 a[232:235], v3 offset:10240
v_add_f32 v10, v10, v40
MM v[128:131],a[196:199],a[164:167],v[128:131]
v_exp_f32 v54, v170
MM v[128:131],a[200:203],a[168:171],v[128:131]
v_exp_f32 v55, v171
MM v[128:131],a[204:207],a[172:175],v[128:131]
v_add_f32 v11, v11, v44
v_add_f32 v8, v8, v32
v_add_f32 v9, v9, v36
MM v[132:135],a[204:207],a[188:191],v[28:31]
ds_read_b128 a[236:239], v3 offset:11264
CV v240,v48,v49
MM v[132:135],a[200:203],a[184:187],v[132:135]
v_exp_f32 v48, v164
MM v[132:135],a[196:199],a[180:183],v[132:135]
v_exp_f32 v49, v165
MM v[132:135],a[192:195],a[176:179],v[132:135]
s_sub_u32 m0, s60, s59
CV v241,v50,v51
MM v[64:67],a[192:195],a[128:131],v[16:19]
ds_read_b128 a[240:243], v3 offset:12288
CV v242,v52,v53
MM v[64:67],a[196:199],a[132:135],v[64:67]
v_exp_f32 v50, v166
MM v[64:67],a[200:203],a[136:139],v[64:67]
v_exp_f32 v51, v167
MM v[64:67],a[204:207],a[140:143],v[64:67]
v_exp_f32 v52, v172
MM v[68:71],a[204:207],a[156:159],v[20:23]
ds_read_b128 a[244:247], v3 offset:13312
CV v243,v54,v55
MM v[68:71],a[200:203],a[152:155],v[68:71]
v_exp_f32 v53, v173
MM v[68:71],a[196:199],a[148:151],v[68:71]
v_exp_f32 v54, v174
MM v[68:71],a[192:195],a[144:147],v[68:71]
v_exp_f32 v55, v175
MM v[40:43],v[56:59],v[240:243],0
buffer_load_dwordx4 v2, s[32:35], s57 offen offset:0 sc1 lds
s_waitcnt lgkmcnt(6)
MM v[136:139],a[208:211],a[160:163],v[24:27]
ds_read_b128 a[248:251], v3 offset:14336
CV v248,v48,v49
MM v[136:139],a[212:215],a[164:167],v[136:139]
v_exp_f32 v48, v176
MM v[136:139],a[216:219],a[168:171],v[136:139]
v_exp_f32 v49, v177
MM v[136:139],a[220:223],a[172:175],v[136:139]
CV v249,v50,v51
CV v250,v52,v53
MM v[140:143],a[220:223],a[188:191],v[28:31]
ds_read_b128 a[252:255], v3 offset:15360
buffer_load_dwordx4 v2, s[32:35], s57 offen offset:1024 sc1 lds
MM v[140:143],a[216:219],a[184:187],v[140:143]
v_exp_f32 v50, v178
MM v[140:143],a[212:215],a[180:183],v[140:143]
v_exp_f32 v51, v179
MM v[140:143],a[208:211],a[176:179],v[140:143]
v_exp_f32 v52, v184
MM v[72:75],a[208:211],a[128:131],v[16:19]
ds_read_b128 a[192:195], v4 offset:0
CV v251,v54,v55
MM v[72:75],a[212:215],a[132:135],v[72:75]
v_exp_f32 v53, v185
MM v[72:75],a[216:219],a[136:139],v[72:75]
v_exp_f32 v54, v186
MM v[72:75],a[220:223],a[140:143],v[72:75]
v_exp_f32 v55, v187
MM v[44:47],v[56:59],v[248:251],0
buffer_load_dwordx4 v2, s[32:35], s57 offen offset:2048 sc1 lds
CV v244,v48,v49
MM v[76:79],a[220:223],a[156:159],v[20:23]
ds_read_b128 a[196:199], v4 offset:8192
buffer_load_dwordx4 v2, s[32:35], s57 offen offset:3072 sc1 lds
MM v[76:79],a[216:219],a[152:155],v[76:79]
v_exp_f32 v48, v180
MM v[76:79],a[212:215],a[148:151],v[76:79]
v_exp_f32 v49, v181
MM v[76:79],a[208:211],a[144:147],v[76:79]
s_waitcnt lgkmcnt(6)
CV v245,v50,v51
MM v[144:147],a[224:227],a[160:163],v[24:27]
ds_read_b128 a[200:203], v4 offset:1024
CV v246,v52,v53
MM v[144:147],a[228:231],a[164:167],v[144:147]
v_exp_f32 v50, v182
MM v[144:147],a[232:235],a[168:171],v[144:147]
v_exp_f32 v51, v183
MM v[144:147],a[236:239],a[172:175],v[144:147]
v_exp_f32 v52, v188
MM v[148:151],a[236:239],a[188:191],v[28:31]
ds_read_b128 a[204:207], v4 offset:9216
CV v247,v54,v55
MM v[148:151],a[232:235],a[184:187],v[148:151]
v_exp_f32 v53, v189
MM v[148:151],a[228:231],a[180:183],v[148:151]
v_exp_f32 v54, v190
MM v[148:151],a[224:227],a[176:179],v[148:151]
v_exp_f32 v55, v191
MM v[40:43],v[56:59],v[244:247],v[40:43]
s_add_u32 m0, s59, 0
s_add_u32 s57, s58, 32768
MM v[80:83],a[224:227],a[128:131],v[16:19]
ds_read_b128 a[208:211], v4 offset:2048
CV v252,v48,v49
MM v[80:83],a[228:231],a[132:135],v[80:83]
v_exp_f32 v48, v96
MM v[80:83],a[232:235],a[136:139],v[80:83]
v_exp_f32 v49, v97
MM v[80:83],a[236:239],a[140:143],v[80:83]
CV v253,v50,v51
CV v254,v52,v53
MM v[84:87],a[236:239],a[156:159],v[20:23]
ds_read_b128 a[212:215], v4 offset:10240
buffer_load_dwordx4 v1, s[32:35], s57 offen offset:0 sc1 lds
MM v[84:87],a[232:235],a[152:155],v[84:87]
v_exp_f32 v50, v98
MM v[84:87],a[228:231],a[148:151],v[84:87]
v_exp_f32 v51, v99
MM v[84:87],a[224:227],a[144:147],v[84:87]
s_waitcnt lgkmcnt(6)
v_exp_f32 v52, v104
MM v[152:155],a[240:243],a[160:163],v[24:27]
ds_read_b128 a[216:219], v4 offset:3072
CV v255,v54,v55
MM v[152:155],a[244:247],a[164:167],v[152:155]
v_exp_f32 v53, v105
MM v[152:155],a[248:251],a[168:171],v[152:155]
buffer_load_dwordx4 v1, s[32:35], s57 offen offset:1024 sc1 lds
CV v208,v48,v49
MM v[152:155],a[252:255],a[172:175],v[152:155]
v_exp_f32 v54, v106
MM v[44:47],v[56:59],v[252:255],v[44:47]
CV v209,v50,v51
CV v210,v52,v53
MM v[156:159],a[252:255],a[188:191],v[28:31]
ds_read_b128 a[220:223], v4 offset:11264
MM v[156:159],a[248:251],a[184:187],v[156:159]
v_exp_f32 v55, v107
MM v[156:159],a[244:247],a[180:183],v[156:159]
v_exp_f32 v48, v100
MM v[156:159],a[240:243],a[176:179],v[156:159]
CV v211,v54,v55
MM v[88:91],a[240:243],a[128:131],v[16:19]
ds_read_b128 a[224:227], v4 offset:4096
buffer_load_dwordx4 v1, s[32:35], s57 offen offset:2048 sc1 lds
MM v[88:91],a[244:247],a[132:135],v[88:91]
v_exp_f32 v49, v101
MM v[88:91],a[248:251],a[136:139],v[88:91]
v_exp_f32 v50, v102
MM v[88:91],a[252:255],a[140:143],v[88:91]
v_exp_f32 v51, v103
MM v[32:35],v[56:59],v[208:211],0
CV v216,v48,v49
CV v217,v50,v51
MM v[92:95],a[252:255],a[156:159],v[20:23]
ds_read_b128 a[228:231], v4 offset:12288
s_waitcnt lgkmcnt(6)
MM v[92:95],a[248:251],a[152:155],v[92:95]
v_exp_f32 v52, v108
MM v[92:95],a[244:247],a[148:151],v[92:95]
v_exp_f32 v53, v109
MM v[92:95],a[240:243],a[144:147],v[92:95]
CV v218,v52,v53
MM a[64:67],a[192:195],v[224:227],a[64:67]
ds_read_b128 a[232:235], v4 offset:5120
buffer_load_dwordx4 v1, s[32:35], s57 offen offset:3072 sc1 lds
MM a[64:67],a[196:199],v[228:231],a[64:67]
v_exp_f32 v54, v110
MM a[68:71],a[196:199],v[236:239],a[68:71]
v_exp_f32 v55, v111
MM a[68:71],a[192:195],v[232:235],a[68:71]
CV v219,v54,v55
MM a[0:3],a[192:195],v[192:195],a[0:3]
ds_read_b128 a[236:239], v4 offset:13312
MM a[0:3],a[196:199],v[196:199],a[0:3]
v_exp_f32 v48, v112
MM a[4:7],a[196:199],v[204:207],a[4:7]
v_exp_f32 v49, v113
MM a[4:7],a[192:195],v[200:203],a[4:7]
v_exp_f32 v50, v114
MM v[36:39],v[56:59],v[216:219],0
CV v212,v48,v49
MM a[72:75],a[200:203],v[224:227],a[72:75]
ds_read_b128 a[240:243], v4 offset:6144
MM a[72:75],a[204:207],v[228:231],a[72:75]
v_exp_f32 v51, v115
MM a[76:79],a[204:207],v[236:239],a[76:79]
v_exp_f32 v52, v120
MM a[76:79],a[200:203],v[232:235],a[76:79]
CV v213,v50,v51
MM a[8:11],a[200:203],v[192:195],a[8:11]
ds_read_b128 a[244:247], v4 offset:14336
s_waitcnt lgkmcnt(6)
MM a[8:11],a[204:207],v[196:199],a[8:11]
v_exp_f32 v53, v121
MM a[12:15],a[204:207],v[204:207],a[12:15]
v_exp_f32 v54, v122
MM a[12:15],a[200:203],v[200:203],a[12:15]
s_waitcnt vmcnt(8)
CV v214,v52,v53
MM a[80:83],a[208:211],v[224:227],a[80:83]
ds_read_b128 a[248:251], v4 offset:7168
MM a[80:83],a[212:215],v[228:231],a[80:83]
v_exp_f32 v55, v123
MM a[84:87],a[212:215],v[236:239],a[84:87]
v_exp_f32 v48, v116
MM a[84:87],a[208:211],v[232:235],a[84:87]
CV v215,v54,v55
MM a[16:19],a[208:211],v[192:195],a[16:19]
ds_read_b128 a[252:255], v4 offset:15360
s_barrier
MM a[16:19],a[212:215],v[196:199],a[16:19]
v_exp_f32 v49, v117
MM a[20:23],a[212:215],v[204:207],a[20:23]
v_exp_f32 v50, v118
MM a[20:23],a[208:211],v[200:203],a[20:23]
v_exp_f32 v51, v119
MM v[32:35],v[56:59],v[212:215],v[32:35]
CV v220,v48,v49
CV v221,v50,v51
MM a[88:91],a[216:219],v[224:227],a[88:91]
ds_read_b128 a[192:195], v3 offset:16384
MM a[88:91],a[220:223],v[228:231],a[88:91]
v_exp_f32 v52, v124
MM a[92:95],a[220:223],v[236:239],a[92:95]
v_exp_f32 v53, v125
MM a[92:95],a[216:219],v[232:235],a[92:95]
CV v222,v52,v53
MM a[24:27],a[216:219],v[192:195],a[24:27]
ds_read_b128 a[196:199], v3 offset:17408
s_waitcnt lgkmcnt(6)
MM a[24:27],a[220:223],v[196:199],a[24:27]
v_exp_f32 v54, v126
MM a[28:31],a[220:223],v[204:207],a[28:31]
v_exp_f32 v55, v127
MM a[28:31],a[216:219],v[200:203],a[28:31]
CV v223,v54,v55
MM a[96:99],a[224:227],v[224:227],a[96:99]
ds_read_b128 a[200:203], v3 offset:18432
MM a[96:99],a[228:231],v[228:231],a[96:99]
v_exp_f32 v48, v128
MM a[100:103],a[228:231],v[236:239],a[100:103]
v_exp_f32 v49, v129
MM a[100:103],a[224:227],v[232:235],a[100:103]
v_exp_f32 v50, v130
MM v[36:39],v[56:59],v[220:223],v[36:39]
v_exp_f32 v51, v131
MM a[32:35],a[224:227],v[192:195],a[32:35]
ds_read_b128 a[204:207], v3 offset:19456
MM a[32:35],a[228:231],v[196:199],a[32:35]
v_exp_f32 v52, v136
MM a[36:39],a[228:231],v[204:207],a[36:39]
v_exp_f32 v53, v137
MM a[36:39],a[224:227],v[200:203],a[36:39]
MM a[104:107],a[232:235],v[224:227],a[104:107]
ds_read_b128 a[208:211], v3 offset:20480
v_max3_f32 v5, v40, v44, v32
MM a[104:107],a[236:239],v[228:231],a[104:107]
v_max_f32 v5, v5, v36
v_cmp_lt_f32 vcc, s64, v5
MM a[108:111],a[236:239],v[236:239],a[108:111]
MM a[108:111],a[232:235],v[232:235],a[108:111]
MM a[40:43],a[232:235],v[192:195],a[40:43]
ds_read_b128 a[212:215], v3 offset:21504
s_waitcnt lgkmcnt(6)
MM a[40:43],a[236:239],v[196:199],a[40:43]
MM a[44:47],a[236:239],v[204:207],a[44:47]
MM a[44:47],a[232:235],v[200:203],a[44:47]
MM a[112:115],a[240:243],v[224:227],a[112:115]
ds_read_b128 a[216:219], v3 offset:22528
MM a[112:115],a[244:247],v[228:231],a[112:115]
MM a[116:119],a[244:247],v[236:239],a[116:119]
MM a[116:119],a[240:243],v[232:235],a[116:119]
MM a[48:51],a[240:243],v[192:195],a[48:51]
ds_read_b128 a[220:223], v3 offset:23552
MM a[48:51],a[244:247],v[196:199],a[48:51]
MM a[52:55],a[244:247],v[204:207],a[52:55]
MM a[52:55],a[240:243],v[200:203],a[52:55]
MM a[120:123],a[248:251],v[224:227],a[120:123]
ds_read_b128 a[224:227], v3 offset:24576
MM a[120:123],a[252:255],v[228:231],a[120:123]
MM a[124:127],a[252:255],v[236:239],a[124:127]
MM a[124:127],a[248:251],v[232:235],a[124:127]
MM a[56:59],a[248:251],v[192:195],a[56:59]
ds_read_b128 a[228:231], v3 offset:25600
s_waitcnt lgkmcnt(6)
MM a[56:59],a[252:255],v[196:199],a[56:59]
MM a[60:63],a[252:255],v[204:207],a[60:63]
MM a[60:63],a[248:251],v[200:203],a[60:63]
s_cbranch_vccnz L_rs_7
L_rb_8:
MM v[160:163],a[192:195],a[160:163],v[24:27]
ds_read_b128 a[232:235], v3 offset:26624
v_add_f32 v10, v10, v40
MM v[160:163],a[196:199],a[164:167],v[160:163]
v_exp_f32 v54, v138
MM v[160:163],a[200:203],a[168:171],v[160:163]
v_exp_f32 v55, v139
MM v[160:163],a[204:207],a[172:175],v[160:163]
v_add_f32 v11, v11, v44
v_add_f32 v8, v8, v32
v_add_f32 v9, v9, v36
MM v[164:167],a[204:207],a[188:191],v[28:31]
ds_read_b128 a[236:239], v3 offset:27648
CV v224,v48,v49
MM v[164:167],a[200:203],a[184:187],v[164:167]
v_exp_f32 v48, v132
MM v[164:167],a[196:199],a[180:183],v[164:167]
v_exp_f32 v49, v133
MM v[164:167],a[192:195],a[176:179],v[164:167]
s_sub_u32 m0, s61, s59
CV v225,v50,v51
MM v[96:99],a[192:195],a[128:131],v[16:19]
ds_read_b128 a[240:243], v3 offset:28672
CV v226,v52,v53
MM v[96:99],a[196:199],a[132:135],v[96:99]
v_exp_f32 v50, v134
MM v[96:99],a[200:203],a[136:139],v[96:99]
v_exp_f32 v51, v135
MM v[96:99],a[204:207],a[140:143],v[96:99]
v_exp_f32 v52, v140
MM v[100:103],a[204:207],a[156:159],v[20:23]
ds_read_b128 a[244:247], v3 offset:29696
CV v227,v54,v55
MM v[100:103],a[200:203],a[152:155],v[100:103]
v_exp_f32 v53, v141
MM v[100:103],a[196:199],a[148:151],v[100:103]
v_exp_f32 v54, v142
MM v[100:103],a[192:195],a[144:147],v[100:103]
v_exp_f32 v55, v143
MM v[40:43],v[56:59],v[224:227],0
buffer_load_dwordx4 v2, s[32:35], s58 offen offset:0 sc1 lds
s_waitcnt lgkmcnt(6)
MM v[168:171],a[208:211],a[160:163],v[24:27]
ds_read_b128 a[248:251], v3 offset:30720
CV v232,v48,v49
MM v[168:171],a[212:215],a[164:167],v[168:171]
v_exp_f32 v48, v144
MM v[168:171],a[216:219],a[168:171],v[168:171]
v_exp_f32 v49, v145
MM v[168:171],a[220:223],a[172:175],v[168:171]
CV v233,v50,v51
CV v234,v52,v53
MM v[172:175],a[220:223],a[188:191],v[28:31]
ds_read_b128 a[252:255], v3 offset:31744
buffer_load_dwordx4 v2, s[32:35], s58 offen offset:1024 sc1 lds
MM v[172:175],a[216:219],a[184:187],v[172:175]
v_exp_f32 v50, v146
MM v[172:175],a[212:215],a[180:183],v[172:175]
v_exp_f32 v51, v147
MM v[172:175],a[208:211],a[176:179],v[172:175]
v_exp_f32 v52, v152
MM v[104:107],a[208:211],a[128:131],v[16:19]
ds_read_b128 a[192:195], v4 offset:16384
CV v235,v54,v55
MM v[104:107],a[212:215],a[132:135],v[104:107]
v_exp_f32 v53, v153
MM v[104:107],a[216:219],a[136:139],v[104:107]
v_exp_f32 v54, v154
MM v[104:107],a[220:223],a[140:143],v[104:107]
v_exp_f32 v55, v155
MM v[44:47],v[56:59],v[232:235],0
buffer_load_dwordx4 v2, s[32:35], s58 offen offset:2048 sc1 lds
CV v228,v48,v49
MM v[108:111],a[220:223],a[156:159],v[20:23]
ds_read_b128 a[196:199], v4 offset:24576
buffer_load_dwordx4 v2, s[32:35], s58 offen offset:3072 sc1 lds
MM v[108:111],a[216:219],a[152:155],v[108:111]
v_exp_f32 v48, v148
MM v[108:111],a[212:215],a[148:151],v[108:111]
v_exp_f32 v49, v149
MM v[108:111],a[208:211],a[144:147],v[108:111]
s_waitcnt lgkmcnt(6)
CV v229,v50,v51
MM v[176:179],a[224:227],a[160:163],v[24:27]
ds_read_b128 a[200:203], v4 offset:17408
CV v230,v52,v53
MM v[176:179],a[228:231],a[164:167],v[176:179]
v_exp_f32 v50, v150
MM v[176:179],a[232:235],a[168:171],v[176:179]
v_exp_f32 v51, v151
MM v[176:179],a[236:239],a[172:175],v[176:179]
v_exp_f32 v52, v156
MM v[180:183],a[236:239],a[188:191],v[28:31]
ds_read_b128 a[204:207], v4 offset:25600
CV v231,v54,v55
MM v[180:183],a[232:235],a[184:187],v[180:183]
v_exp_f32 v53, v157
MM v[180:183],a[228:231],a[180:183],v[180:183]
v_exp_f32 v54, v158
MM v[180:183],a[224:227],a[176:179],v[180:183]
v_exp_f32 v55, v159
MM v[40:43],v[56:59],v[228:231],v[40:43]
s_add_u32 m0, s59, 16384
s_add_u32 s58, s57, 32768
MM v[112:115],a[224:227],a[128:131],v[16:19]
ds_read_b128 a[208:211], v4 offset:18432
CV v236,v48,v49
MM v[112:115],a[228:231],a[132:135],v[112:115]
v_exp_f32 v48, v64
MM v[112:115],a[232:235],a[136:139],v[112:115]
v_exp_f32 v49, v65
MM v[112:115],a[236:239],a[140:143],v[112:115]
CV v237,v50,v51
CV v238,v52,v53
MM v[116:119],a[236:239],a[156:159],v[20:23]
ds_read_b128 a[212:215], v4 offset:26624
buffer_load_dwordx4 v1, s[32:35], s58 offen offset:0 sc1 lds
MM v[116:119],a[232:235],a[152:155],v[116:119]
v_exp_f32 v50, v66
MM v[116:119],a[228:231],a[148:151],v[116:119]
v_exp_f32 v51, v67
MM v[116:119],a[224:227],a[144:147],v[116:119]
s_waitcnt lgkmcnt(6)
v_exp_f32 v52, v72
MM v[184:187],a[240:243],a[160:163],v[24:27]
ds_read_b128 a[216:219], v4 offset:19456
CV v239,v54,v55
MM v[184:187],a[244:247],a[164:167],v[184:187]
v_exp_f32 v53, v73
MM v[184:187],a[248:251],a[168:171],v[184:187]
buffer_load_dwordx4 v1, s[32:35], s58 offen offset:1024 sc1 lds
CV v192,v48,v49
MM v[184:187],a[252:255],a[172:175],v[184:187]
v_exp_f32 v54, v74
MM v[44:47],v[56:59],v[236:239],v[44:47]
v_xor_b32 v3, 32768, v3
CV v193,v50,v51
MM v[188:191],a[252:255],a[188:191],v[28:31]
ds_read_b128 a[220:223], v4 offset:27648
s_xor_b32 s59, s59, 32768
MM v[188:191],a[248:251],a[184:187],v[188:191]
v_exp_f32 v55, v75
MM v[188:191],a[244:247],a[180:183],v[188:191]
v_exp_f32 v48, v68
MM v[188:191],a[240:243],a[176:179],v[188:191]
CV v194,v52,v53
CV v195,v54,v55
MM v[120:123],a[240:243],a[128:131],v[16:19]
ds_read_b128 a[224:227], v4 offset:20480
buffer_load_dwordx4 v1, s[32:35], s58 offen offset:2048 sc1 lds
MM v[120:123],a[244:247],a[132:135],v[120:123]
v_exp_f32 v49, v69
MM v[120:123],a[248:251],a[136:139],v[120:123]
v_exp_f32 v50, v70
MM v[120:123],a[252:255],a[140:143],v[120:123]
v_exp_f32 v51, v71
MM v[32:35],v[56:59],v[192:195],0
CV v200,v48,v49
CV v201,v50,v51
MM v[124:127],a[252:255],a[156:159],v[20:23]
ds_read_b128 a[228:231], v4 offset:28672
s_waitcnt lgkmcnt(6)
MM v[124:127],a[248:251],a[152:155],v[124:127]
v_exp_f32 v52, v76
MM v[124:127],a[244:247],a[148:151],v[124:127]
v_exp_f32 v53, v77
MM v[124:127],a[240:243],a[144:147],v[124:127]
CV v202,v52,v53
MM a[64:67],a[192:195],v[240:243],a[64:67]
ds_read_b128 a[232:235], v4 offset:21504
buffer_load_dwordx4 v1, s[32:35], s58 offen offset:3072 sc1 lds
MM a[64:67],a[196:199],v[244:247],a[64:67]
v_exp_f32 v54, v78
MM a[68:71],a[196:199],v[252:255],a[68:71]
v_exp_f32 v55, v79
MM a[68:71],a[192:195],v[248:251],a[68:71]
CV v203,v54,v55
MM a[0:3],a[192:195],v[208:211],a[0:3]
ds_read_b128 a[236:239], v4 offset:29696
MM a[0:3],a[196:199],v[212:215],a[0:3]
v_exp_f32 v48, v80
MM a[4:7],a[196:199],v[220:223],a[4:7]
v_exp_f32 v49, v81
MM a[4:7],a[192:195],v[216:219],a[4:7]
v_exp_f32 v50, v82
MM v[36:39],v[56:59],v[200:203],0
CV v196,v48,v49
MM a[72:75],a[200:203],v[240:243],a[72:75]
ds_read_b128 a[240:243], v4 offset:22528
MM a[72:75],a[204:207],v[244:247],a[72:75]
v_exp_f32 v51, v83
MM a[76:79],a[204:207],v[252:255],a[76:79]
v_exp_f32 v52, v88
MM a[76:79],a[200:203],v[248:251],a[76:79]
CV v197,v50,v51
MM a[8:11],a[200:203],v[208:211],a[8:11]
ds_read_b128 a[244:247], v4 offset:30720
s_waitcnt lgkmcnt(6)
MM a[8:11],a[204:207],v[212:215],a[8:11]
v_exp_f32 v53, v89
MM a[12:15],a[204:207],v[220:223],a[12:15]
v_exp_f32 v54, v90
MM a[12:15],a[200:203],v[216:219],a[12:15]
s_waitcnt vmcnt(8)
CV v198,v52,v53
MM a[80:83],a[208:211],v[240:243],a[80:83]
ds_read_b128 a[248:251], v4 offset:23552
MM a[80:83],a[212:215],v[244:247],a[80:83]
v_exp_f32 v55, v91
MM a[84:87],a[212:215],v[252:255],a[84:87]
v_exp_f32 v48, v84
MM a[84:87],a[208:211],v[248:251],a[84:87]
CV v199,v54,v55
MM a[16:19],a[208:211],v[208:211],a[16:19]
ds_read_b128 a[252:255], v4 offset:31744
s_barrier
MM a[16:19],a[212:215],v[212:215],a[16:19]
v_exp_f32 v49, v85
MM a[20:23],a[212:215],v[220:223],a[20:23]
v_exp_f32 v50, v86
MM a[20:23],a[208:211],v[216:219],a[20:23]
v_exp_f32 v51, v87
MM v[32:35],v[56:59],v[196:199],v[32:35]
CV v204,v48,v49
CV v205,v50,v51
MM a[88:91],a[216:219],v[240:243],a[88:91]
ds_read_b128 a[192:195], v3 offset:0
v_xor_b32 v4, 32768, v4
MM a[88:91],a[220:223],v[244:247],a[88:91]
v_exp_f32 v52, v92
MM a[92:95],a[220:223],v[252:255],a[92:95]
v_exp_f32 v53, v93
MM a[92:95],a[216:219],v[248:251],a[92:95]
CV v206,v52,v53
MM a[24:27],a[216:219],v[208:211],a[24:27]
ds_read_b128 a[196:199], v3 offset:1024
s_waitcnt lgkmcnt(6)
MM a[24:27],a[220:223],v[212:215],a[24:27]
v_exp_f32 v54, v94
MM a[28:31],a[220:223],v[220:223],a[28:31]
v_exp_f32 v55, v95
MM a[28:31],a[216:219],v[216:219],a[28:31]
CV v207,v54,v55
MM a[96:99],a[224:227],v[240:243],a[96:99]
ds_read_b128 a[200:203], v3 offset:2048
MM a[96:99],a[228:231],v[244:247],a[96:99]
v_exp_f32 v48, v160
MM a[100:103],a[228:231],v[252:255],a[100:103]
v_exp_f32 v49, v161
MM a[100:103],a[224:227],v[248:251],a[100:103]
v_exp_f32 v50, v162
MM v[36:39],v[56:59],v[204:207],v[36:39]
v_exp_f32 v51, v163
MM a[32:35],a[224:227],v[208:211],a[32:35]
ds_read_b128 a[204:207], v3 offset:3072
MM a[32:35],a[228:231],v[212:215],a[32:35]
v_exp_f32 v52, v168
MM a[36:39],a[228:231],v[220:223],a[36:39]
v_exp_f32 v53, v169
MM a[36:39],a[224:227],v[216:219],a[36:39]
MM a[104:107],a[232:235],v[240:243],a[104:107]
ds_read_b128 a[208:211], v3 offset:4096
v_max3_f32 v5, v40, v44, v32
MM a[104:107],a[236:239],v[244:247],a[104:107]
v_max_f32 v5, v5, v36
v_cmp_lt_f32 vcc, s64, v5
MM a[108:111],a[236:239],v[252:255],a[108:111]
MM a[108:111],a[232:235],v[248:251],a[108:111]
MM a[40:43],a[232:235],v[208:211],a[40:43]
ds_read_b128 a[212:215], v3 offset:5120
s_waitcnt lgkmcnt(6)
MM a[40:43],a[236:239],v[212:215],a[40:43]
MM a[44:47],a[236:239],v[220:223],a[44:47]
MM a[44:47],a[232:235],v[216:219],a[44:47]
MM a[112:115],a[240:243],v[240:243],a[112:115]
ds_read_b128 a[216:219], v3 offset:6144
MM a[112:115],a[244:247],v[244:247],a[112:115]
MM a[116:119],a[244:247],v[252:255],a[116:119]
MM a[116:119],a[240:243],v[248:251],a[116:119]
MM a[48:51],a[240:243],v[208:211],a[48:51]
ds_read_b128 a[220:223], v3 offset:7168
MM a[48:51],a[244:247],v[212:215],a[48:51]
MM a[52:55],a[244:247],v[220:223],a[52:55]
MM a[52:55],a[240:243],v[216:219],a[52:55]
MM a[120:123],a[248:251],v[240:243],a[120:123]
ds_read_b128 a[224:227], v3 offset:8192
MM a[120:123],a[252:255],v[244:247],a[120:123]
MM a[124:127],a[252:255],v[252:255],a[124:127]
MM a[124:127],a[248:251],v[248:251],a[124:127]
MM a[56:59],a[248:251],v[208:211],a[56:59]
ds_read_b128 a[228:231], v3 offset:9216
s_waitcnt lgkmcnt(6)
MM a[56:59],a[252:255],v[212:215],a[56:59]
MM a[60:63],a[252:255],v[220:223],a[60:63]
MM a[60:63],a[248:251],v[216:219],a[60:63]
s_sub_u32 s63, s63, 1
s_cbranch_vccnz L_rs_9
L_rb_10:
s_cbranch_scc0 L_loopA
L_skipA:
s_cmp_eq_u32 s30, 0
s_cselect_b32 s67, s65, 0
v_fma_f32 v68, v12, s67, v20
v_fma_f32 v69, v13, s67, v20
v_fma_f32 v70, v14, s67, v20
v_fma_f32 v71, v15, s67, v20
s_nop 1
MM v[128:131],a[192:195],a[160:163],v[24:27]
ds_read_b128 a[232:235], v3 offset:10240
v_add_f32 v10, v10, v40
MM v[128:131],a[196:199],a[164:167],v[128:131]
v_exp_f32 v54, v170
MM v[128:131],a[200:203],a[168:171],v[128:131]
v_exp_f32 v55, v171
MM v[128:131],a[204:207],a[172:175],v[128:131]
v_add_f32 v11, v11, v44
v_add_f32 v8, v8, v32
v_add_f32 v9, v9, v36
MM v[132:135],a[204:207],a[188:191],v[28:31]
ds_read_b128 a[236:239], v3 offset:11264
CV v240,v48,v49
MM v[132:135],a[200:203],a[184:187],v[132:135]
v_exp_f32 v48, v164
MM v[132:135],a[196:199],a[180:183],v[132:135]
v_exp_f32 v49, v165
MM v[132:135],a[192:195],a[176:179],v[132:135]
s_cmp_eq_u32 s30, 1
s_cselect_b32 s67, s65, 0
s_cmp_lt_u32 s30, 1
s_cselect_b32 s68, s65, 0
v_add_f32 v6, s68, v20
v_fma_f32 v76, v12, s67, v6
v_fma_f32 v77, v13, s67, v6
v_fma_f32 v78, v14, s67, v6
v_fma_f32 v79, v15, s67, v6
s_sub_u32 m0, s60, s59
MM v[64:67],a[192:195],a[128:131],v[16:19]
ds_read_b128 a[240:243], v3 offset:12288
CV v241,v50,v51
MM v[64:67],a[196:199],a[132:135],v[64:67]
v_exp_f32 v50, v166
MM v[64:67],a[200:203],a[136:139],v[64:67]
v_exp_f32 v51, v167
MM v[64:67],a[204:207],a[140:143],v[64:67]
CV v242,v52,v53
CV v243,v54,v55
MM v[68:71],a[204:207],a[156:159],v[68:71]
ds_read_b128 a[244:247], v3 offset:13312
buffer_load_dwordx4 v2, s[32:35], s57 offen offset:0 sc1 lds
MM v[68:71],a[200:203],a[152:155],v[68:71]
v_exp_f32 v52, v172
MM v[68:71],a[196:199],a[148:151],v[68:71]
v_exp_f32 v53, v173
MM v[68:71],a[192:195],a[144:147],v[68:71]
v_exp_f32 v54, v174
MM v[40:43],v[56:59],v[240:243],0
s_waitcnt lgkmcnt(6)
v_exp_f32 v55, v175
MM v[136:139],a[208:211],a[160:163],v[24:27]
ds_read_b128 a[248:251], v3 offset:14336
CV v248,v48,v49
MM v[136:139],a[212:215],a[164:167],v[136:139]
v_exp_f32 v48, v176
MM v[136:139],a[216:219],a[168:171],v[136:139]
v_exp_f32 v49, v177
MM v[136:139],a[220:223],a[172:175],v[136:139]
CV v249,v50,v51
CV v250,v52,v53
MM v[140:143],a[220:223],a[188:191],v[28:31]
ds_read_b128 a[252:255], v3 offset:15360
s_cmp_eq_u32 s30, 2
s_cselect_b32 s67, s65, 0
s_cmp_lt_u32 s30, 2
s_cselect_b32 s68, s65, 0
v_add_f32 v6, s68, v20
v_fma_f32 v84, v12, s67, v6
v_fma_f32 v85, v13, s67, v6
v_fma_f32 v86, v14, s67, v6
v_fma_f32 v87, v15, s67, v6
MM v[140:143],a[216:219],a[184:187],v[140:143]
v_exp_f32 v50, v178
MM v[140:143],a[212:215],a[180:183],v[140:143]
v_exp_f32 v51, v179
MM v[140:143],a[208:211],a[176:179],v[140:143]
buffer_load_dwordx4 v2, s[32:35], s57 offen offset:1024 sc1 lds
v_exp_f32 v52, v184
MM v[72:75],a[208:211],a[128:131],v[16:19]
ds_read_b128 a[192:195], v4 offset:0
CV v251,v54,v55
MM v[72:75],a[212:215],a[132:135],v[72:75]
v_exp_f32 v53, v185
MM v[72:75],a[216:219],a[136:139],v[72:75]
v_exp_f32 v54, v186
MM v[72:75],a[220:223],a[140:143],v[72:75]
v_exp_f32 v55, v187
MM v[44:47],v[56:59],v[248:251],0
buffer_load_dwordx4 v2, s[32:35], s57 offen offset:2048 sc1 lds
CV v244,v48,v49
MM v[76:79],a[220:223],a[156:159],v[76:79]
ds_read_b128 a[196:199], v4 offset:8192
buffer_load_dwordx4 v2, s[32:35], s57 offen offset:3072 sc1 lds
MM v[76:79],a[216:219],a[152:155],v[76:79]
v_exp_f32 v48, v180
MM v[76:79],a[212:215],a[148:151],v[76:79]
v_exp_f32 v49, v181
MM v[76:79],a[208:211],a[144:147],v[76:79]
s_waitcnt lgkmcnt(6)
CV v245,v50,v51
MM v[144:147],a[224:227],a[160:163],v[24:27]
ds_read_b128 a[200:203], v4 offset:1024
CV v246,v52,v53
MM v[144:147],a[228:231],a[164:167],v[144:147]
v_exp_f32 v50, v182
MM v[144:147],a[232:235],a[168:171],v[144:147]
v_exp_f32 v51, v183
MM v[144:147],a[236:239],a[172:175],v[144:147]
v_exp_f32 v52, v188
MM v[148:151],a[236:239],a[188:191],v[28:31]
ds_read_b128 a[204:207], v4 offset:9216
CV v247,v54,v55
MM v[148:151],a[232:235],a[184:187],v[148:151]
v_exp_f32 v53, v189
MM v[148:151],a[228:231],a[180:183],v[148:151]
v_exp_f32 v54, v190
MM v[148:151],a[224:227],a[176:179],v[148:151]
v_exp_f32 v55, v191
MM v[40:43],v[56:59],v[244:247],v[40:43]
s_cmp_eq_u32 s30, 3
s_cselect_b32 s67, s65, 0
s_cmp_lt_u32 s30, 3
s_cselect_b32 s68, s65, 0
v_add_f32 v6, s68, v20
v_fma_f32 v92, v12, s67, v6
v_fma_f32 v93, v13, s67, v6
v_fma_f32 v94, v14, s67, v6
v_fma_f32 v95, v15, s67, v6
s_add_u32 m0, s59, 0
s_add_u32 s57, s58, 32768
MM v[80:83],a[224:227],a[128:131],v[16:19]
ds_read_b128 a[208:211], v4 offset:2048
CV v252,v48,v49
MM v[80:83],a[228:231],a[132:135],v[80:83]
v_exp_f32 v48, v96
MM v[80:83],a[232:235],a[136:139],v[80:83]
v_exp_f32 v49, v97
MM v[80:83],a[236:239],a[140:143],v[80:83]
CV v253,v50,v51
CV v254,v52,v53
MM v[84:87],a[236:239],a[156:159],v[84:87]
ds_read_b128 a[212:215], v4 offset:10240
buffer_load_dwordx4 v1, s[32:35], s57 offen offset:0 sc1 lds
MM v[84:87],a[232:235],a[152:155],v[84:87]
v_exp_f32 v50, v98
MM v[84:87],a[228:231],a[148:151],v[84:87]
v_exp_f32 v51, v99
MM v[84:87],a[224:227],a[144:147],v[84:87]
s_waitcnt lgkmcnt(6)
v_exp_f32 v52, v104
MM v[152:155],a[240:243],a[160:163],v[24:27]
ds_read_b128 a[216:219], v4 offset:3072
CV v255,v54,v55
MM v[152:155],a[244:247],a[164:167],v[152:155]
v_exp_f32 v53, v105
MM v[152:155],a[248:251],a[168:171],v[152:155]
buffer_load_dwordx4 v1, s[32:35], s57 offen offset:1024 sc1 lds
CV v208,v48,v49
MM v[152:155],a[252:255],a[172:175],v[152:155]
v_exp_f32 v54, v106
MM v[44:47],v[56:59],v[252:255],v[44:47]
CV v209,v50,v51
CV v210,v52,v53
MM v[156:159],a[252:255],a[188:191],v[28:31]
ds_read_b128 a[220:223], v4 offset:11264
MM v[156:159],a[248:251],a[184:187],v[156:159]
v_exp_f32 v55, v107
MM v[156:159],a[244:247],a[180:183],v[156:159]
v_exp_f32 v48, v100
MM v[156:159],a[240:243],a[176:179],v[156:159]
CV v211,v54,v55
MM v[88:91],a[240:243],a[128:131],v[16:19]
ds_read_b128 a[224:227], v4 offset:4096
buffer_load_dwordx4 v1, s[32:35], s57 offen offset:2048 sc1 lds
MM v[88:91],a[244:247],a[132:135],v[88:91]
v_exp_f32 v49, v101
MM v[88:91],a[248:251],a[136:139],v[88:91]
v_exp_f32 v50, v102
MM v[88:91],a[252:255],a[140:143],v[88:91]
v_exp_f32 v51, v103
MM v[32:35],v[56:59],v[208:211],0
CV v216,v48,v49
CV v217,v50,v51
MM v[92:95],a[252:255],a[156:159],v[92:95]
ds_read_b128 a[228:231], v4 offset:12288
s_waitcnt lgkmcnt(6)
MM v[92:95],a[248:251],a[152:155],v[92:95]
v_exp_f32 v52, v108
MM v[92:95],a[244:247],a[148:151],v[92:95]
v_exp_f32 v53, v109
MM v[92:95],a[240:243],a[144:147],v[92:95]
CV v218,v52,v53
MM a[64:67],a[192:195],v[224:227],a[64:67]
ds_read_b128 a[232:235], v4 offset:5120
buffer_load_dwordx4 v1, s[32:35], s57 offen offset:3072 sc1 lds
MM a[64:67],a[196:199],v[228:231],a[64:67]
v_exp_f32 v54, v110
MM a[68:71],a[196:199],v[236:239],a[68:71]
v_exp_f32 v55, v111
MM a[68:71],a[192:195],v[232:235],a[68:71]
CV v219,v54,v55
MM a[0:3],a[192:195],v[192:195],a[0:3]
ds_read_b128 a[236:239], v4 offset:13312
MM a[0:3],a[196:199],v[196:199],a[0:3]
v_exp_f32 v48, v112
MM a[4:7],a[196:199],v[204:207],a[4:7]
v_exp_f32 v49, v113
MM a[4:7],a[192:195],v[200:203],a[4:7]
v_exp_f32 v50, v114
MM v[36:39],v[56:59],v[216:219],0
CV v212,v48,v49
MM a[72:75],a[200:203],v[224:227],a[72:75]
ds_read_b128 a[240:243], v4 offset:6144
MM a[72:75],a[204:207],v[228:231],a[72:75]
v_exp_f32 v51, v115
MM a[76:79],a[204:207],v[236:239],a[76:79]
v_exp_f32 v52, v120
MM a[76:79],a[200:203],v[232:235],a[76:79]
CV v213,v50,v51
MM a[8:11],a[200:203],v[192:195],a[8:11]
ds_read_b128 a[244:247], v4 offset:14336
s_waitcnt lgkmcnt(6)
MM a[8:11],a[204:207],v[196:199],a[8:11]
v_exp_f32 v53, v121
MM a[12:15],a[204:207],v[204:207],a[12:15]
v_exp_f32 v54, v122
MM a[12:15],a[200:203],v[200:203],a[12:15]
s_waitcnt vmcnt(8)
CV v214,v52,v53
MM a[80:83],a[208:211],v[224:227],a[80:83]
ds_read_b128 a[248:251], v4 offset:7168
MM a[80:83],a[212:215],v[228:231],a[80:83]
v_exp_f32 v55, v123
MM a[84:87],a[212:215],v[236:239],a[84:87]
v_exp_f32 v48, v116
MM a[84:87],a[208:211],v[232:235],a[84:87]
CV v215,v54,v55
MM a[16:19],a[208:211],v[192:195],a[16:19]
ds_read_b128 a[252:255], v4 offset:15360
s_barrier
MM a[16:19],a[212:215],v[196:199],a[16:19]
v_exp_f32 v49, v117
MM a[20:23],a[212:215],v[204:207],a[20:23]
v_exp_f32 v50, v118
MM a[20:23],a[208:211],v[200:203],a[20:23]
v_exp_f32 v51, v119
MM v[32:35],v[56:59],v[212:215],v[32:35]
CV v220,v48,v49
CV v221,v50,v51
MM a[88:91],a[216:219],v[224:227],a[88:91]
ds_read_b128 a[192:195], v3 offset:16384
MM a[88:91],a[220:223],v[228:231],a[88:91]
v_exp_f32 v52, v124
MM a[92:95],a[220:223],v[236:239],a[92:95]
v_exp_f32 v53, v125
MM a[92:95],a[216:219],v[232:235],a[92:95]
CV v222,v52,v53
MM a[24:27],a[216:219],v[192:195],a[24:27]
ds_read_b128 a[196:199], v3 offset:17408
s_waitcnt lgkmcnt(6)
MM a[24:27],a[220:223],v[196:199],a[24:27]
v_exp_f32 v54, v126
MM a[28:31],a[220:223],v[204:207],a[28:31]
v_exp_f32 v55, v127
MM a[28:31],a[216:219],v[200:203],a[28:31]
CV v223,v54,v55
MM a[96:99],a[224:227],v[224:227],a[96:99]
ds_read_b128 a[200:203], v3 offset:18432
MM a[96:99],a[228:231],v[228:231],a[96:99]
v_exp_f32 v48, v128
MM a[100:103],a[228:231],v[236:239],a[100:103]
v_exp_f32 v49, v129
MM a[100:103],a[224:227],v[232:235],a[100:103]
v_exp_f32 v50, v130
MM v[36:39],v[56:59],v[220:223],v[36:39]
v_exp_f32 v51, v131
MM a[32:35],a[224:227],v[192:195],a[32:35]
ds_read_b128 a[204:207], v3 offset:19456
MM a[32:35],a[228:231],v[196:199],a[32:35]
v_exp_f32 v52, v136
MM a[36:39],a[228:231],v[204:207],a[36:39]
v_exp_f32 v53, v137
MM a[36:39],a[224:227],v[200:203],a[36:39]
MM a[104:107],a[232:235],v[224:227],a[104:107]
ds_read_b128 a[208:211], v3 offset:20480
v_max3_f32 v5, v40, v44, v32
MM a[104:107],a[236:239],v[228:231],a[104:107]
v_max_f32 v5, v5, v36
v_cmp_lt_f32 vcc, s64, v5
MM a[108:111],a[236:239],v[236:239],a[108:111]
MM a[108:111],a[232:235],v[232:235],a[108:111]
MM a[40:43],a[232:235],v[192:195],a[40:43]
ds_read_b128 a[212:215], v3 offset:21504
s_waitcnt lgkmcnt(6)
MM a[40:43],a[236:239],v[196:199],a[40:43]
MM a[44:47],a[236:239],v[204:207],a[44:47]
MM a[44:47],a[232:235],v[200:203],a[44:47]
MM a[112:115],a[240:243],v[224:227],a[112:115]
ds_read_b128 a[216:219], v3 offset:22528
MM a[112:115],a[244:247],v[228:231],a[112:115]
MM a[116:119],a[244:247],v[236:239],a[116:119]
MM a[116:119],a[240:243],v[232:235],a[116:119]
MM a[48:51],a[240:243],v[192:195],a[48:51]
ds_read_b128 a[220:223], v3 offset:23552
MM a[48:51],a[244:247],v[196:199],a[48:51]
MM a[52:55],a[244:247],v[204:207],a[52:55]
MM a[52:55],a[240:243],v[200:203],a[52:55]
MM a[120:123],a[248:251],v[224:227],a[120:123]
ds_read_b128 a[224:227], v3 offset:24576
MM a[120:123],a[252:255],v[228:231],a[120:123]
MM a[124:127],a[252:255],v[236:239],a[124:127]
MM a[124:127],a[248:251],v[232:235],a[124:127]
MM a[56:59],a[248:251],v[192:195],a[56:59]
ds_read_b128 a[228:231], v3 offset:25600
s_waitcnt lgkmcnt(6)
MM a[56:59],a[252:255],v[196:199],a[56:59]
MM a[60:63],a[252:255],v[204:207],a[60:63]
MM a[60:63],a[248:251],v[200:203],a[60:63]
s_cbranch_vccnz L_rs_11
L_rb_12:
s_cmp_eq_u32 s66, 0
s_cselect_b32 s67, s65, 0
v_fma_f32 v96, v12, s67, v16
v_fma_f32 v97, v13, s67, v16
v_fma_f32 v98, v14, s67, v16
v_fma_f32 v99, v15, s67, v16
s_nop 1
MM v[160:163],a[192:195],a[160:163],v[24:27]
ds_read_b128 a[232:235], v3 offset:26624
v_add_f32 v10, v10, v40
MM v[160:163],a[196:199],a[164:167],v[160:163]
v_exp_f32 v54, v138
MM v[160:163],a[200:203],a[168:171],v[160:163]
v_add_f32 v11, v11, v44
v_add_f32 v8, v8, v32
v_add_f32 v9, v9, v36
MM v[160:163],a[204:207],a[172:175],v[160:163]
ds_read_b128 a[236:239], v3 offset:27648
CV v224,v48,v49
MM v[164:167],a[204:207],a[188:191],v[28:31]
v_exp_f32 v55, v139
MM v[164:167],a[200:203],a[184:187],v[164:167]
s_cmp_eq_u32 s66, 1
s_cselect_b32 s67, s65, 0
s_cmp_lt_u32 s66, 1
s_cselect_b32 s68, s65, 0
v_add_f32 v6, s68, v16
v_fma_f32 v104, v12, s67, v6
v_fma_f32 v105, v13, s67, v6
v_fma_f32 v106, v14, s67, v6
v_fma_f32 v107, v15, s67, v6
s_sub_u32 m0, s61, s59
MM v[164:167],a[196:199],a[180:183],v[164:167]
ds_read_b128 a[240:243], v3 offset:28672
CV v225,v50,v51
MM v[164:167],a[192:195],a[176:179],v[164:167]
v_exp_f32 v48, v132
MM v[96:99],a[192:195],a[128:131],v[96:99]
v_exp_f32 v49, v133
MM v[96:99],a[196:199],a[132:135],v[96:99]
ds_read_b128 a[244:247], v3 offset:29696
buffer_load_dwordx4 v2, s[32:35], s58 offen offset:0 sc1 lds
MM v[96:99],a[200:203],a[136:139],v[96:99]
v_exp_f32 v50, v134
MM v[96:99],a[204:207],a[140:143],v[96:99]
s_waitcnt lgkmcnt(6)
v_exp_f32 v51, v135
MM v[168:171],a[208:211],a[160:163],v[24:27]
ds_read_b128 a[248:251], v3 offset:30720
CV v226,v52,v53
MM v[168:171],a[212:215],a[164:167],v[168:171]
v_exp_f32 v52, v140
MM v[168:171],a[216:219],a[168:171],v[168:171]
v_exp_f32 v53, v141
MM v[168:171],a[220:223],a[172:175],v[168:171]
ds_read_b128 a[252:255], v3 offset:31744
CV v227,v54,v55
MM v[172:175],a[220:223],a[188:191],v[28:31]
v_exp_f32 v54, v142
MM v[172:175],a[216:219],a[184:187],v[172:175]
v_exp_f32 v55, v143
MM v[40:43],v[56:59],v[224:227],0
s_cmp_eq_u32 s66, 2
s_cselect_b32 s67, s65, 0
s_cmp_lt_u32 s66, 2
s_cselect_b32 s68, s65, 0
v_add_f32 v6, s68, v16
v_fma_f32 v112, v12, s67, v6
v_fma_f32 v113, v13, s67, v6
v_fma_f32 v114, v14, s67, v6
v_fma_f32 v115, v15, s67, v6
buffer_load_dwordx4 v2, s[32:35], s58 offen offset:1024 sc1 lds
MM v[172:175],a[212:215],a[180:183],v[172:175]
ds_read_b128 a[192:195], v4 offset:16384
CV v232,v48,v49
MM v[172:175],a[208:211],a[176:179],v[172:175]
v_exp_f32 v48, v144
MM v[104:107],a[208:211],a[128:131],v[104:107]
buffer_load_dwordx4 v2, s[32:35], s58 offen offset:2048 sc1 lds
v_exp_f32 v49, v145
MM v[104:107],a[212:215],a[132:135],v[104:107]
ds_read_b128 a[196:199], v4 offset:24576
CV v233,v50,v51
MM v[104:107],a[216:219],a[136:139],v[104:107]
v_exp_f32 v50, v146
MM v[104:107],a[220:223],a[140:143],v[104:107]
buffer_load_dwordx4 v2, s[32:35], s58 offen offset:3072 sc1 lds
s_waitcnt lgkmcnt(6)
MM v[176:179],a[224:227],a[160:163],v[24:27]
ds_read_b128 a[200:203], v4 offset:17408
CV v234,v52,v53
MM v[176:179],a[228:231],a[164:167],v[176:179]
v_exp_f32 v51, v147
MM v[176:179],a[232:235],a[168:171],v[176:179]
v_exp_f32 v52, v152
MM v[176:179],a[236:239],a[172:175],v[176:179]
ds_read_b128 a[204:207], v4 offset:25600
CV v235,v54,v55
MM v[180:183],a[236:239],a[188:191],v[28:31]
v_exp_f32 v53, v153
MM v[180:183],a[232:235],a[184:187],v[180:183]
v_exp_f32 v54, v154
MM v[44:47],v[56:59],v[232:235],0
s_cmp_eq_u32 s66, 3
s_cselect_b32 s67, s65, 0
s_cmp_lt_u32 s66, 3
s_cselect_b32 s68, s65, 0
v_add_f32 v6, s68, v16
v_fma_f32 v120, v12, s67, v6
v_fma_f32 v121, v13, s67, v6
v_fma_f32 v122, v14, s67, v6
v_fma_f32 v123, v15, s67, v6
s_add_u32 m0, s59, 16384
s_add_u32 s58, s57, 32768
MM v[180:183],a[228:231],a[180:183],v[180:183]
ds_read_b128 a[208:211], v4 offset:18432
CV v228,v48,v49
MM v[180:183],a[224:227],a[176:179],v[180:183]
v_exp_f32 v55, v155
MM v[112:115],a[224:227],a[128:131],v[112:115]
v_exp_f32 v48, v148
MM v[112:115],a[228:231],a[132:135],v[112:115]
ds_read_b128 a[212:215], v4 offset:26624
CV v229,v50,v51
MM v[112:115],a[232:235],a[136:139],v[112:115]
v_exp_f32 v49, v149
MM v[112:115],a[236:239],a[140:143],v[112:115]
buffer_load_dwordx4 v1, s[32:35], s58 offen offset:0 sc1 lds
s_waitcnt lgkmcnt(6)
MM v[184:187],a[240:243],a[160:163],v[24:27]
ds_read_b128 a[216:219], v4 offset:19456
CV v230,v52,v53
MM v[184:187],a[244:247],a[164:167],v[184:187]
v_exp_f32 v50, v150
MM v[184:187],a[248:251],a[168:171],v[184:187]
v_exp_f32 v51, v151
MM v[184:187],a[252:255],a[172:175],v[184:187]
ds_read_b128 a[220:223], v4 offset:27648
buffer_load_dwordx4 v1, s[32:35], s58 offen offset:1024 sc1 lds
MM v[188:191],a[252:255],a[188:191],v[28:31]
v_exp_f32 v52, v156
MM v[188:191],a[248:251],a[184:187],v[188:191]
v_exp_f32 v53, v157
MM v[188:191],a[244:247],a[180:183],v[188:191]
ds_read_b128 a[224:227], v4 offset:20480
CV v231,v54,v55
MM v[188:191],a[240:243],a[176:179],v[188:191]
v_exp_f32 v54, v158
MM v[120:123],a[240:243],a[128:131],v[120:123]
v_exp_f32 v55, v159
MM v[40:43],v[56:59],v[228:231],v[40:43]
CV v236,v48,v49
CV v237,v50,v51
MM v[120:123],a[244:247],a[132:135],v[120:123]
ds_read_b128 a[228:231], v4 offset:28672
buffer_load_dwordx4 v1, s[32:35], s58 offen offset:2048 sc1 lds
MM v[120:123],a[248:251],a[136:139],v[120:123]
v_exp_f32 v48, v64
MM v[120:123],a[252:255],a[140:143],v[120:123]
s_waitcnt lgkmcnt(6)
v_exp_f32 v49, v65
MM a[64:67],a[192:195],v[240:243],a[64:67]
ds_read_b128 a[232:235], v4 offset:21504
CV v238,v52,v53
MM a[64:67],a[196:199],v[244:247],a[64:67]
v_exp_f32 v50, v66
MM a[68:71],a[196:199],v[252:255],a[68:71]
v_exp_f32 v51, v67
MM a[68:71],a[192:195],v[248:251],a[68:71]
v_exp_f32 v52, v72
MM a[0:3],a[192:195],v[208:211],a[0:3]
ds_read_b128 a[236:239], v4 offset:29696
CV v239,v54,v55
MM a[0:3],a[196:199],v[212:215],a[0:3]
v_exp_f32 v53, v73
MM a[4:7],a[196:199],v[220:223],a[4:7]
v_exp_f32 v54, v74
MM a[4:7],a[192:195],v[216:219],a[4:7]
v_exp_f32 v55, v75
MM v[44:47],v[56:59],v[236:239],v[44:47]
buffer_load_dwordx4 v1, s[32:35], s58 offen offset:3072 sc1 lds
CV v192,v48,v49
MM a[72:75],a[200:203],v[240:243],a[72:75]
ds_read_b128 a[240:243], v4 offset:22528
CV v193,v50,v51
MM a[72:75],a[204:207],v[244:247],a[72:75]
v_exp_f32 v48, v68
MM a[76:79],a[204:207],v[252:255],a[76:79]
v_exp_f32 v49, v69
MM a[76:79],a[200:203],v[248:251],a[76:79]
v_exp_f32 v50, v70
MM a[8:11],a[200:203],v[208:211],a[8:11]
ds_read_b128 a[244:247], v4 offset:30720
CV v194,v52,v53
MM a[8:11],a[204:207],v[212:215],a[8:11]
v_exp_f32 v51, v71
MM a[12:15],a[204:207],v[220:223],a[12:15]
v_exp_f32 v52, v76
MM a[12:15],a[200:203],v[216:219],a[12:15]
s_waitcnt lgkmcnt(6)
v_exp_f32 v53, v77
MM a[80:83],a[208:211],v[240:243],a[80:83]
ds_read_b128 a[248:251], v4 offset:23552
CV v195,v54,v55
MM a[80:83],a[212:215],v[244:247],a[80:83]
v_exp_f32 v54, v78
MM a[84:87],a[212:215],v[252:255],a[84:87]
v_exp_f32 v55, v79
MM a[84:87],a[208:211],v[248:251],a[84:87]
s_waitcnt vmcnt(8)
CV v200,v48,v49
MM v[32:35],v[56:59],v[192:195],0
v_exp_f32 v48, v80
MM a[16:19],a[208:211],v[208:211],a[16:19]
ds_read_b128 a[252:255], v4 offset:31744
CV v201,v50,v51
MM a[16:19],a[212:215],v[212:215],a[16:19]
v_exp_f32 v49, v81
MM a[20:23],a[212:215],v[220:223],a[20:23]
v_exp_f32 v50, v82
MM a[20:23],a[208:211],v[216:219],a[20:23]
s_barrier
v_xor_b32 v3, 32768, v3
MM a[88:91],a[216:219],v[240:243],a[88:91]
ds_read_b128 a[192:195], v3 offset:0
CV v202,v52,v53
MM a[88:91],a[220:223],v[244:247],a[88:91]
v_exp_f32 v51, v83
MM a[92:95],a[220:223],v[252:255],a[92:95]
v_exp_f32 v52, v88
MM a[92:95],a[216:219],v[248:251],a[92:95]
v_exp_f32 v53, v89
MM a[24:27],a[216:219],v[208:211],a[24:27]
ds_read_b128 a[196:199], v3 offset:1024
CV v203,v54,v55
MM a[24:27],a[220:223],v[212:215],a[24:27]
v_exp_f32 v54, v90
MM a[28:31],a[220:223],v[220:223],a[28:31]
v_exp_f32 v55, v91
MM a[28:31],a[216:219],v[216:219],a[28:31]
s_waitcnt lgkmcnt(6)
CV v196,v48,v49
MM v[36:39],v[56:59],v[200:203],0
v_exp_f32 v48, v84
MM a[96:99],a[224:227],v[240:243],a[96:99]
ds_read_b128 a[200:203], v3 offset:2048
CV v197,v50,v51
MM a[96:99],a[228:231],v[244:247],a[96:99]
v_exp_f32 v49, v85
MM a[100:103],a[228:231],v[252:255],a[100:103]
v_exp_f32 v50, v86
MM a[100:103],a[224:227],v[248:251],a[100:103]
v_exp_f32 v51, v87
MM a[32:35],a[224:227],v[208:211],a[32:35]
ds_read_b128 a[204:207], v3 offset:3072
CV v198,v52,v53
MM a[32:35],a[228:231],v[212:215],a[32:35]
v_exp_f32 v52, v92
MM a[36:39],a[228:231],v[220:223],a[36:39]
v_exp_f32 v53, v93
MM a[36:39],a[224:227],v[216:219],a[36:39]
CV v199,v54,v55
CV v204,v48,v49
MM a[104:107],a[232:235],v[240:243],a[104:107]
ds_read_b128 a[208:211], v3 offset:4096
s_xor_b32 s59, s59, 32768
MM a[104:107],a[236:239],v[244:247],a[104:107]
v_exp_f32 v54, v94
MM a[108:111],a[236:239],v[252:255],a[108:111]
v_exp_f32 v55, v95
MM a[108:111],a[232:235],v[248:251],a[108:111]
CV v205,v50,v51
CV v206,v52,v53
MM v[32:35],v[56:59],v[196:199],v[32:35]
v_xor_b32 v4, 32768, v4
CV v207,v54,v55
MM a[40:43],a[232:235],v[208:211],a[40:43]
ds_read_b128 a[212:215], v3 offset:5120
s_waitcnt lgkmcnt(6)
MM a[40:43],a[236:239],v[212:215],a[40:43]
v_exp_f32 v48, v160
MM a[44:47],a[236:239],v[220:223],a[44:47]
v_exp_f32 v49, v161
MM a[44:47],a[232:235],v[216:219],a[44:47]
v_exp_f32 v50, v162
MM v[36:39],v[56:59],v[204:207],v[36:39]
v_exp_f32 v51, v163
MM a[112:115],a[240:243],v[240:243],a[112:115]
ds_read_b128 a[216:219], v3 offset:6144
MM a[112:115],a[244:247],v[244:247],a[112:115]
v_exp_f32 v52, v168
MM a[116:119],a[244:247],v[252:255],a[116:119]
v_exp_f32 v53, v169
MM a[116:119],a[240:243],v[248:251],a[116:119]
MM a[48:51],a[240:243],v[208:211],a[48:51]
ds_read_b128 a[220:223], v3 offset:7168
v_max3_f32 v5, v40, v44, v32
MM a[48:51],a[244:247],v[212:215],a[48:51]
v_max_f32 v5, v5, v36
v_cmp_lt_f32 vcc, s64, v5
MM a[52:55],a[244:247],v[220:223],a[52:55]
MM a[52:55],a[240:243],v[216:219],a[52:55]
MM a[120:123],a[248:251],v[240:243],a[120:123]
ds_read_b128 a[224:227], v3 offset:8192
MM a[120:123],a[252:255],v[244:247],a[120:123]
MM a[124:127],a[252:255],v[252:255],a[124:127]
MM a[124:127],a[248:251],v[248:251],a[124:127]
MM a[56:59],a[248:251],v[208:211],a[56:59]
ds_read_b128 a[228:231], v3 offset:9216
s_waitcnt lgkmcnt(6)
MM a[56:59],a[252:255],v[212:215],a[56:59]
MM a[60:63],a[252:255],v[220:223],a[60:63]
MM a[60:63],a[248:251],v[216:219],a[60:63]
s_cbranch_vccnz L_rs_13
L_rb_14:
L_tail2A:
s_cmp_eq_u32 s3, 7
s_cbranch_scc1 L_i7
MM v[128:131],a[192:195],a[160:163],v[24:27]
ds_read_b128 a[232:235], v3 offset:10240
v_add_f32 v10, v10, v40
MM v[128:131],a[196:199],a[164:167],v[128:131]
v_add_f32 v11, v11, v44
v_add_f32 v8, v8, v32
v_add_f32 v9, v9, v36
MM v[128:131],a[200:203],a[168:171],v[128:131]
ds_read_b128 a[236:239], v3 offset:11264
s_sub_u32 m0, s60, s59
MM v[128:131],a[204:207],a[172:175],v[128:131]
v_exp_f32 v54, v170
MM v[132:135],a[204:207],a[188:191],v[28:31]
ds_read_b128 a[240:243], v3 offset:12288
CV v240,v48,v49
MM v[132:135],a[200:203],a[184:187],v[132:135]
v_exp_f32 v55, v171
MM v[132:135],a[196:199],a[180:183],v[132:135]
ds_read_b128 a[244:247], v3 offset:13312
buffer_load_dwordx4 v2, s[32:35], s57 offen offset:0 sc1 lds
MM v[132:135],a[192:195],a[176:179],v[132:135]
s_waitcnt lgkmcnt(6)
v_exp_f32 v48, v164
MM v[136:139],a[208:211],a[160:163],v[24:27]
ds_read_b128 a[248:251], v3 offset:14336
CV v241,v50,v51
MM v[136:139],a[212:215],a[164:167],v[136:139]
v_exp_f32 v49, v165
MM v[136:139],a[216:219],a[168:171],v[136:139]
ds_read_b128 a[252:255], v3 offset:15360
buffer_load_dwordx4 v2, s[32:35], s57 offen offset:1024 sc1 lds
MM v[136:139],a[220:223],a[172:175],v[136:139]
v_exp_f32 v50, v166
MM v[140:143],a[220:223],a[188:191],v[28:31]
ds_read_b128 a[192:195], v4 offset:0
CV v242,v52,v53
MM v[140:143],a[216:219],a[184:187],v[140:143]
buffer_load_dwordx4 v2, s[32:35], s57 offen offset:2048 sc1 lds
v_exp_f32 v51, v167
MM v[140:143],a[212:215],a[180:183],v[140:143]
ds_read_b128 a[196:199], v4 offset:8192
buffer_load_dwordx4 v2, s[32:35], s57 offen offset:3072 sc1 lds
MM v[140:143],a[208:211],a[176:179],v[140:143]
s_waitcnt lgkmcnt(6)
v_exp_f32 v52, v172
MM v[144:147],a[224:227],a[160:163],v[24:27]
ds_read_b128 a[200:203], v4 offset:1024
CV v243,v54,v55
MM v[144:147],a[228:231],a[164:167],v[144:147]
v_exp_f32 v53, v173
MM v[40:43],v[56:59],v[240:243],0
v_exp_f32 v54, v174
MM v[144:147],a[232:235],a[168:171],v[144:147]
ds_read_b128 a[204:207], v4 offset:9216
CV v248,v48,v49
MM v[144:147],a[236:239],a[172:175],v[144:147]
s_add_u32 m0, s59, 0
s_add_u32 s57, s58, 32768
MM v[148:151],a[236:239],a[188:191],v[28:31]
ds_read_b128 a[208:211], v4 offset:2048
CV v249,v50,v51
MM v[148:151],a[232:235],a[184:187],v[148:151]
v_exp_f32 v55, v175
MM v[148:151],a[228:231],a[180:183],v[148:151]
ds_read_b128 a[212:215], v4 offset:10240
buffer_load_dwordx4 v1, s[32:35], s57 offen offset:0 sc1 lds
MM v[148:151],a[224:227],a[176:179],v[148:151]
s_waitcnt lgkmcnt(6)
v_exp_f32 v48, v176
MM v[152:155],a[240:243],a[160:163],v[24:27]
ds_read_b128 a[216:219], v4 offset:3072
CV v250,v52,v53
MM v[152:155],a[244:247],a[164:167],v[152:155]
v_exp_f32 v49, v177
MM v[152:155],a[248:251],a[168:171],v[152:155]
ds_read_b128 a[220:223], v4 offset:11264
buffer_load_dwordx4 v1, s[32:35], s57 offen offset:1024 sc1 lds
MM v[152:155],a[252:255],a[172:175],v[152:155]
v_exp_f32 v50, v178
MM v[156:159],a[252:255],a[188:191],v[28:31]
ds_read_b128 a[224:227], v4 offset:4096
CV v251,v54,v55
MM v[156:159],a[248:251],a[184:187],v[156:159]
v_exp_f32 v51, v179
MM v[44:47],v[56:59],v[248:251],0
v_exp_f32 v52, v184
MM v[156:159],a[244:247],a[180:183],v[156:159]
ds_read_b128 a[228:231], v4 offset:12288
buffer_load_dwordx4 v1, s[32:35], s57 offen offset:2048 sc1 lds
MM v[156:159],a[240:243],a[176:179],v[156:159]
s_waitcnt lgkmcnt(6)
v_exp_f32 v53, v185
MM a[64:67],a[192:195],v[224:227],a[64:67]
ds_read_b128 a[232:235], v4 offset:5120
CV v244,v48,v49
MM a[64:67],a[196:199],v[228:231],a[64:67]
v_exp_f32 v54, v186
MM a[68:71],a[196:199],v[236:239],a[68:71]
v_exp_f32 v55, v187
MM a[68:71],a[192:195],v[232:235],a[68:71]
v_exp_f32 v48, v180
MM a[0:3],a[192:195],v[192:195],a[0:3]
ds_read_b128 a[236:239], v4 offset:13312
CV v245,v50,v51
MM a[0:3],a[196:199],v[196:199],a[0:3]
v_exp_f32 v49, v181
MM a[4:7],a[196:199],v[204:207],a[4:7]
v_exp_f32 v50, v182
MM a[4:7],a[192:195],v[200:203],a[4:7]
buffer_load_dwordx4 v1, s[32:35], s57 offen offset:3072 sc1 lds
v_exp_f32 v51, v183
MM a[72:75],a[200:203],v[224:227],a[72:75]
ds_read_b128 a[240:243], v4 offset:6144
CV v246,v52,v53
MM a[72:75],a[204:207],v[228:231],a[72:75]
v_exp_f32 v52, v188
MM a[76:79],a[204:207],v[236:239],a[76:79]
v_exp_f32 v53, v189
MM a[76:79],a[200:203],v[232:235],a[76:79]
CV v247,v54,v55
CV v252,v48,v49
MM a[8:11],a[200:203],v[192:195],a[8:11]
ds_read_b128 a[244:247], v4 offset:14336
s_waitcnt lgkmcnt(6)
MM a[8:11],a[204:207],v[196:199],a[8:11]
v_exp_f32 v54, v190
MM a[12:15],a[204:207],v[204:207],a[12:15]
v_exp_f32 v55, v191
MM a[12:15],a[200:203],v[200:203],a[12:15]
v_exp_f32 v48, v96
MM v[40:43],v[56:59],v[244:247],v[40:43]
v_exp_f32 v49, v97
MM a[80:83],a[208:211],v[224:227],a[80:83]
ds_read_b128 a[248:251], v4 offset:7168
CV v253,v50,v51
MM a[80:83],a[212:215],v[228:231],a[80:83]
v_exp_f32 v50, v98
MM a[84:87],a[212:215],v[236:239],a[84:87]
v_exp_f32 v51, v99
MM a[84:87],a[208:211],v[232:235],a[84:87]
s_waitcnt vmcnt(8)
CV v254,v52,v53
MM a[16:19],a[208:211],v[192:195],a[16:19]
ds_read_b128 a[252:255], v4 offset:15360
s_barrier
MM a[16:19],a[212:215],v[196:199],a[16:19]
v_exp_f32 v52, v104
MM a[20:23],a[212:215],v[204:207],a[20:23]
v_exp_f32 v53, v105
MM a[20:23],a[208:211],v[200:203],a[20:23]
CV v255,v54,v55
CV v208,v48,v49
MM a[88:91],a[216:219],v[224:227],a[88:91]
ds_read_b128 a[192:195], v3 offset:16384
s_lshl_b32 s67, s2, 2
MM a[88:91],a[220:223],v[228:231],a[88:91]
v_exp_f32 v54, v106
MM a[92:95],a[220:223],v[236:239],a[92:95]
v_exp_f32 v55, v107
MM a[92:95],a[216:219],v[232:235],a[92:95]
v_exp_f32 v48, v112
MM v[44:47],v[56:59],v[252:255],v[44:47]
v_exp_f32 v49, v113
MM a[24:27],a[216:219],v[192:195],a[24:27]
ds_read_b128 a[196:199], v3 offset:17408
CV v209,v50,v51
MM a[24:27],a[220:223],v[196:199],a[24:27]
v_exp_f32 v50, v114
MM a[28:31],a[220:223],v[204:207],a[28:31]
v_exp_f32 v51, v115
MM a[28:31],a[216:219],v[200:203],a[28:31]
s_waitcnt lgkmcnt(6)
CV v210,v52,v53
MM a[96:99],a[224:227],v[224:227],a[96:99]
ds_read_b128 a[200:203], v3 offset:18432
CV v211,v54,v55
MM a[96:99],a[228:231],v[228:231],a[96:99]
v_exp_f32 v52, v120
MM a[100:103],a[228:231],v[236:239],a[100:103]
v_exp_f32 v53, v121
MM a[100:103],a[224:227],v[232:235],a[100:103]
v_exp_f32 v54, v122
MM v[32:35],v[56:59],v[208:211],0
v_exp_f32 v55, v123
MM a[32:35],a[224:227],v[192:195],a[32:35]
ds_read_b128 a[204:207], v3 offset:19456
CV v212,v48,v49
MM a[32:35],a[228:231],v[196:199],a[32:35]
CV v213,v50,v51
CV v214,v52,v53
MM a[36:39],a[228:231],v[204:207],a[36:39]
s_add_u32 s67, s67, s30
CV v215,v54,v55
MM a[36:39],a[224:227],v[200:203],a[36:39]
v_exp_f32 v48, v128
MM v[32:35],v[56:59],v[212:215],v[32:35]
v_exp_f32 v49, v129
MM a[104:107],a[232:235],v[224:227],a[104:107]
ds_read_b128 a[208:211], v3 offset:20480
s_mul_i32 s68, s67, 46
MM a[104:107],a[236:239],v[228:231],a[104:107]
v_exp_f32 v50, v130
MM a[108:111],a[236:239],v[236:239],a[108:111]
v_exp_f32 v51, v131
MM a[108:111],a[232:235],v[232:235],a[108:111]
v_exp_f32 v52, v136
MM a[40:43],a[232:235],v[192:195],a[40:43]
ds_read_b128 a[212:215], v3 offset:21504
s_waitcnt lgkmcnt(6)
MM a[40:43],a[236:239],v[196:199],a[40:43]
v_exp_f32 v53, v137
MM a[44:47],a[236:239],v[204:207],a[44:47]
v_max3_f32 v5, v40, v44, v32
v_cmp_lt_f32 vcc, s64, v5
MM a[44:47],a[232:235],v[200:203],a[44:47]
v_min_u32 v72, 45, v0
v_add_u32 v72, s68, v72
MM a[112:115],a[240:243],v[224:227],a[112:115]
ds_read_b128 a[216:219], v3 offset:22528
v_min_u32 v72, 40959, v72
MM a[112:115],a[244:247],v[228:231],a[112:115]
v_lshlrev_b32 v72, 7, v72
global_load_dword v63, v72, s[14:15]
MM a[116:119],a[244:247],v[236:239],a[116:119]
s_mul_i32 s68, s67, 20
v_min_u32 v73, 19, v0
MM a[116:119],a[240:243],v[232:235],a[116:119]
MM a[48:51],a[240:243],v[192:195],a[48:51]
ds_read_b128 a[220:223], v3 offset:23552
v_add_u32 v73, s68, v73
MM a[48:51],a[244:247],v[196:199],a[48:51]
v_min_u32 v73, 17279, v73
MM a[52:55],a[244:247],v[204:207],a[52:55]
MM a[52:55],a[240:243],v[200:203],a[52:55]
MM a[120:123],a[248:251],v[224:227],a[120:123]
ds_read_b128 a[224:227], v3 offset:24576
v_lshlrev_b32 v73, 7, v73
MM a[120:123],a[252:255],v[228:231],a[120:123]
MM a[124:127],a[252:255],v[236:239],a[124:127]
MM a[124:127],a[248:251],v[232:235],a[124:127]
MM a[56:59],a[248:251],v[192:195],a[56:59]
ds_read_b128 a[228:231], v3 offset:25600
s_waitcnt lgkmcnt(6)
MM a[56:59],a[252:255],v[196:199],a[56:59]
global_load_dword v63, v73, s[22:23]
MM a[60:63],a[252:255],v[204:207],a[60:63]
MM a[60:63],a[248:251],v[200:203],a[60:63]
s_cbranch_vccnz L_rs_15
L_rb_16:
MM v[160:163],a[192:195],a[160:163],v[24:27]
ds_read_b128 a[232:235], v3 offset:26624
v_add_f32 v10, v10, v40
MM v[160:163],a[196:199],a[164:167],v[160:163]
v_add_f32 v11, v11, v44
v_add_f32 v8, v8, v32
MM v[160:163],a[200:203],a[168:171],v[160:163]
ds_read_b128 a[236:239], v3 offset:27648
s_sub_u32 m0, s61, s59
MM v[160:163],a[204:207],a[172:175],v[160:163]
v_exp_f32 v54, v138
MM v[164:167],a[204:207],a[188:191],v[28:31]
ds_read_b128 a[240:243], v3 offset:28672
CV v224,v48,v49
MM v[164:167],a[200:203],a[184:187],v[164:167]
v_exp_f32 v55, v139
MM v[164:167],a[196:199],a[180:183],v[164:167]
ds_read_b128 a[244:247], v3 offset:29696
buffer_load_dwordx4 v2, s[32:35], s58 offen offset:0 sc1 lds
MM v[164:167],a[192:195],a[176:179],v[164:167]
s_waitcnt lgkmcnt(6)
v_exp_f32 v48, v132
MM v[168:171],a[208:211],a[160:163],v[24:27]
ds_read_b128 a[248:251], v3 offset:30720
CV v225,v50,v51
MM v[168:171],a[212:215],a[164:167],v[168:171]
v_exp_f32 v49, v133
MM v[168:171],a[216:219],a[168:171],v[168:171]
ds_read_b128 a[252:255], v3 offset:31744
buffer_load_dwordx4 v2, s[32:35], s58 offen offset:1024 sc1 lds
MM v[168:171],a[220:223],a[172:175],v[168:171]
v_exp_f32 v50, v134
MM v[172:175],a[220:223],a[188:191],v[28:31]
ds_read_b128 a[192:195], v4 offset:16384
CV v226,v52,v53
MM v[172:175],a[216:219],a[184:187],v[172:175]
buffer_load_dwordx4 v2, s[32:35], s58 offen offset:2048 sc1 lds
v_exp_f32 v51, v135
MM v[172:175],a[212:215],a[180:183],v[172:175]
ds_read_b128 a[196:199], v4 offset:24576
buffer_load_dwordx4 v2, s[32:35], s58 offen offset:3072 sc1 lds
MM v[172:175],a[208:211],a[176:179],v[172:175]
s_waitcnt lgkmcnt(6)
v_exp_f32 v52, v140
MM v[176:179],a[224:227],a[160:163],v[24:27]
ds_read_b128 a[200:203], v4 offset:17408
CV v227,v54,v55
MM v[176:179],a[228:231],a[164:167],v[176:179]
v_exp_f32 v53, v141
MM v[40:43],v[56:59],v[224:227],0
v_exp_f32 v54, v142
MM v[176:179],a[232:235],a[168:171],v[176:179]
ds_read_b128 a[204:207], v4 offset:25600
CV v232,v48,v49
MM v[176:179],a[236:239],a[172:175],v[176:179]
s_add_u32 m0, s59, 16384
s_add_u32 s58, s57, 32768
MM v[180:183],a[236:239],a[188:191],v[28:31]
ds_read_b128 a[208:211], v4 offset:18432
CV v233,v50,v51
MM v[180:183],a[232:235],a[184:187],v[180:183]
v_exp_f32 v55, v143
MM v[180:183],a[228:231],a[180:183],v[180:183]
ds_read_b128 a[212:215], v4 offset:26624
buffer_load_dwordx4 v1, s[32:35], s58 offen offset:0 sc1 lds
MM v[180:183],a[224:227],a[176:179],v[180:183]
s_waitcnt lgkmcnt(6)
v_exp_f32 v48, v144
MM v[184:187],a[240:243],a[160:163],v[24:27]
ds_read_b128 a[216:219], v4 offset:19456
CV v234,v52,v53
MM v[184:187],a[244:247],a[164:167],v[184:187]
v_exp_f32 v49, v145
MM v[184:187],a[248:251],a[168:171],v[184:187]
ds_read_b128 a[220:223], v4 offset:27648
buffer_load_dwordx4 v1, s[32:35], s58 offen offset:1024 sc1 lds
MM v[184:187],a[252:255],a[172:175],v[184:187]
v_exp_f32 v50, v146
MM v[188:191],a[252:255],a[188:191],v[28:31]
ds_read_b128 a[224:227], v4 offset:20480
CV v235,v54,v55
MM v[188:191],a[248:251],a[184:187],v[188:191]
v_exp_f32 v51, v147
MM v[44:47],v[56:59],v[232:235],0
v_exp_f32 v52, v152
MM v[188:191],a[244:247],a[180:183],v[188:191]
ds_read_b128 a[228:231], v4 offset:28672
buffer_load_dwordx4 v1, s[32:35], s58 offen offset:2048 sc1 lds
MM v[188:191],a[240:243],a[176:179],v[188:191]
s_waitcnt lgkmcnt(6)
v_exp_f32 v53, v153
MM a[64:67],a[192:195],v[240:243],a[64:67]
ds_read_b128 a[232:235], v4 offset:21504
CV v228,v48,v49
MM a[64:67],a[196:199],v[244:247],a[64:67]
v_exp_f32 v54, v154
MM a[68:71],a[196:199],v[252:255],a[68:71]
v_exp_f32 v55, v155
MM a[68:71],a[192:195],v[248:251],a[68:71]
ds_read_b128 a[236:239], v4 offset:29696
buffer_load_dwordx4 v1, s[32:35], s58 offen offset:3072 sc1 lds
MM a[0:3],a[192:195],v[208:211],a[0:3]
v_exp_f32 v48, v148
MM a[0:3],a[196:199],v[212:215],a[0:3]
v_exp_f32 v49, v149
MM a[72:75],a[200:203],v[240:243],a[72:75]
ds_read_b128 a[240:243], v4 offset:22528
CV v229,v50,v51
MM a[72:75],a[204:207],v[244:247],a[72:75]
v_exp_f32 v50, v150
MM a[76:79],a[204:207],v[252:255],a[76:79]
v_exp_f32 v51, v151
MM a[76:79],a[200:203],v[248:251],a[76:79]
ds_read_b128 a[244:247], v4 offset:30720
CV v230,v52,v53
MM a[8:11],a[200:203],v[208:211],a[8:11]
v_exp_f32 v52, v156
MM a[8:11],a[204:207],v[212:215],a[8:11]
s_waitcnt lgkmcnt(6)
v_exp_f32 v53, v157
MM a[80:83],a[208:211],v[240:243],a[80:83]
ds_read_b128 a[248:251], v4 offset:23552
CV v231,v54,v55
MM a[80:83],a[212:215],v[244:247],a[80:83]
v_exp_f32 v54, v158
MM a[84:87],a[212:215],v[252:255],a[84:87]
v_exp_f32 v55, v159
MM v[40:43],v[56:59],v[228:231],v[40:43]
s_waitcnt vmcnt(10)
CV v236,v48,v49
MM a[84:87],a[208:211],v[248:251],a[84:87]
ds_read_b128 a[252:255], v4 offset:31744
v_xor_b32 v3, 32768, v3
MM a[16:19],a[208:211],v[208:211],a[16:19]
s_barrier
CV v237,v50,v51
MM a[16:19],a[212:215],v[212:215],a[16:19]
CV v238,v52,v53
CV v239,v54,v55
MM a[88:91],a[216:219],v[240:243],a[88:91]
ds_read_b128 a[192:195], v3 offset:0
s_xor_b32 s59, s59, 32768
MM a[88:91],a[220:223],v[244:247],a[88:91]
v_exp_f32 v48, v160
MM a[92:95],a[220:223],v[252:255],a[92:95]
v_exp_f32 v49, v161
MM v[44:47],v[56:59],v[236:239],v[44:47]
v_exp_f32 v50, v162
MM a[92:95],a[216:219],v[248:251],a[92:95]
ds_read_b128 a[196:199], v3 offset:1024
s_waitcnt lgkmcnt(6)
MM a[24:27],a[216:219],v[208:211],a[24:27]
v_exp_f32 v51, v163
MM a[24:27],a[220:223],v[212:215],a[24:27]
v_exp_f32 v52, v168
MM a[96:99],a[224:227],v[240:243],a[96:99]
ds_read_b128 a[200:203], v3 offset:2048
v_max_f32 v5, v40, v44
MM a[96:99],a[228:231],v[244:247],a[96:99]
v_exp_f32 v53, v169
MM a[100:103],a[228:231],v[252:255],a[100:103]
v_xor_b32 v4, 32768, v4
v_cmp_lt_f32 vcc, s64, v5
MM a[100:103],a[224:227],v[248:251],a[100:103]
ds_read_b128 a[204:207], v3 offset:3072
s_lshr_b32 s67, s2, 3
MM a[32:35],a[224:227],v[208:211],a[32:35]
s_cmp_lt_u32 s67, 30
s_cselect_b32 s74, 1, 0
s_min_u32 s67, s67, 29
MM a[32:35],a[228:231],v[212:215],a[32:35]
s_mul_i32 s68, s67, 205
s_lshr_b32 s68, s68, 10
MM a[104:107],a[232:235],v[240:243],a[104:107]
ds_read_b128 a[208:211], v3 offset:4096
s_mul_i32 s69, s68, 5
MM a[104:107],a[236:239],v[244:247],a[104:107]
s_sub_u32 s10, s67, s69
s_and_b32 s69, s2, 7
MM a[108:111],a[236:239],v[252:255],a[108:111]
s_lshl_b32 s69, s69, 2
s_lshr_b32 s69, 0x07362514, s69
MM a[108:111],a[232:235],v[248:251],a[108:111]
ds_read_b128 a[212:215], v3 offset:5120
s_waitcnt lgkmcnt(6)
MM a[40:43],a[232:235],v[208:211],a[40:43]
s_and_b32 s69, s69, 7
s_mul_i32 s69, s69, 6
MM a[40:43],a[236:239],v[212:215],a[40:43]
s_add_u32 s69, s69, s68
s_lshr_b32 s8, s69, 4
MM a[112:115],a[240:243],v[240:243],a[112:115]
ds_read_b128 a[216:219], v3 offset:6144
s_and_b32 s9, s69, 15
MM a[112:115],a[244:247],v[244:247],a[112:115]
s_mov_b32 s52, s4
s_mov_b32 s53, s5
MM a[116:119],a[244:247],v[252:255],a[116:119]
s_mov_b32 s54, 0x280000
s_mov_b32 s55, 0x00020000
MM a[116:119],a[240:243],v[248:251],a[116:119]
ds_read_b128 a[220:223], v3 offset:7168
s_mov_b32 s4, s24
MM a[48:51],a[240:243],v[208:211],a[48:51]
s_mov_b32 s5, s25
s_mov_b32 s6, 0x280000
MM a[48:51],a[244:247],v[212:215],a[48:51]
s_mov_b32 s7, 0x00020000
s_add_u32 s70, s8, 2
MM a[120:123],a[248:251],v[240:243],a[120:123]
ds_read_b128 a[224:227], v3 offset:8192
s_cmp_eq_u32 s8, 0
s_cselect_b32 s71, 0, 3
MM a[120:123],a[252:255],v[244:247],a[120:123]
s_sub_u32 s70, s70, s71
s_cmp_eq_u32 s8, 0
s_cselect_b32 s71, 40, 44
MM a[124:127],a[252:255],v[252:255],a[124:127]
s_mul_i32 s71, s71, s74
s_mul_i32 s67, s8, 147456
MM a[124:127],a[248:251],v[248:251],a[124:127]
ds_read_b128 a[228:231], v3 offset:9216
s_waitcnt lgkmcnt(6)
MM a[56:59],a[248:251],v[208:211],a[56:59]
s_add_u32 s67, s67, 0x6000000
s_mul_i32 s68, s9, 442368
MM a[56:59],a[252:255],v[212:215],a[56:59]
s_add_u32 s67, s67, s68
s_add_u32 s36, s28, s67
s_addc_u32 s37, s29, 0
s_mul_i32 s38, s74, 147456
s_mul_i32 s67, s70, 360448
s_add_u32 s67, s67, 0x4000000
s_lshl_b32 s68, s9, 20
s_add_u32 s67, s67, s68
s_add_u32 s40, s28, s67
s_addc_u32 s41, s29, 0
s_lshl_b32 s42, s71, 13
s_mul_i32 s67, s8, 737280
s_add_u32 s44, s22, s67
s_addc_u32 s45, s23, 0
s_mul_i32 s46, s74, 737280
s_mul_i32 s67, s70, 1802240
s_add_u32 s48, s14, s67
s_addc_u32 s49, s15, 0
s_mul_i32 s50, s71, 40960
s_mov_b32 s39, 0x00020000
s_mov_b32 s43, 0x00020000
s_mov_b32 s47, 0x00020000
s_mov_b32 s51, 0x00020000
s_cmp_eq_u32 s8, 2
s_cselect_b32 s18, 1, 0
s_lshl_b32 s11, s9, 2
s_add_u32 s11, s11, s30
s_lshl_b32 s67, s11, 1
s_add_u32 s67, s67, s18
s_mul_i32 s13, s67, 20480
s_lshl_b32 s68, s10, 8
s_add_u32 s13, s13, s68
s_lshl_b32 s11, s30, 11
s_mov_b32 s26, s11
s_lshl_b32 s67, s18, 10
v_add_u32 v16, s67, v1
v_xor_b32 v17, 1024, v16
s_mul_i32 s12, s30, 20480
s_add_u32 s12, s12, s68
s_mov_b32 s27, s12
v_lshrrev_b32 v69, 3, v0
v_mul_u32_u24 v69, 1280, v69
v_bfe_u32 v70, v0, 1, 2
v_bfe_u32 v71, v0, 4, 2
v_xor_b32 v70, v70, v71
v_lshl_add_u32 v69, v70, 5, v69
v_and_b32 v70, 1, v0
v_lshl_add_u32 v18, v70, 4, v69
v_add_u32 v19, 9216, v18
v_lshrrev_b32 v69, 2, v0
v_lshlrev_b32 v69, 7, v69
v_and_b32 v70, 3, v0
v_lshl_add_u32 v69, v70, 3, v69
v_bfe_u32 v70, v0, 3, 2
v_xor_b32 v71, 0, v70
v_lshl_add_u32 v32, v71, 5, v69
v_add_u32 v36, 65536, v32
v_xor_b32 v71, 1, v70
v_lshl_add_u32 v33, v71, 5, v69
v_add_u32 v37, 65536, v33
v_xor_b32 v71, 2, v70
v_lshl_add_u32 v34, v71, 5, v69
v_add_u32 v38, 65536, v34
v_xor_b32 v71, 3, v70
v_lshl_add_u32 v35, v71, 5, v69
v_add_u32 v39, 65536, v35
v_lshrrev_b32 v69, 4, v0
v_mul_u32_u24 v69, 5120, v69
v_and_b32 v70, 15, v0
v_lshl_add_u32 v20, v70, 4, v69
v_and_b32 v200, 0x1f0, v1
s_mul_i32 s67, s30, 4608
v_and_b32 v69, 15, v0
v_mul_u32_u24 v69, 272, v69
v_lshrrev_b32 v70, 4, v0
v_lshl_add_u32 v69, v70, 3, v69
v_add_u32 v21, s67, v69
v_mul_u32_u24 v70, 1088, v70
v_and_b32 v69, 15, v0
v_lshl_add_u32 v69, v69, 4, v70
v_add_u32 v23, s67, v69
s_sub_u32 s67, 15, s9
s_min_u32 s67, s67, s9
s_lshl_b32 s79, s67, 9
s_add_u32 s79, s79, 0x7001000
s_lshl_b32 s76, s9, 9
s_add_u32 s76, s76, 0x7002000
s_mul_i32 s67, s9, 5
s_add_u32 s67, s67, s10
s_lshl_b32 s68, s67, 2
s_add_u32 s68, s68, s30
s_lshl_b32 s75, s68, 10
s_add_u32 s75, s75, 0x7010000
s_lshl_b32 s68, s68, 16
s_add_u32 s68, s68, 0x8000000
s_add_u32 s67, s8, 1
s_lshl_b32 s67, s67, 13
s_add_u32 s16, s68, s67
s_cmp_eq_u32 s8, 0
s_cselect_b32 s17, s68, 0x20000000
s_cmp_eq_u32 s74, 0
s_cselect_b32 s17, 0x20000000, s17
s_cselect_b32 s16, 0x20000000, s16
s_lshl_b32 s67, s18, 13
s_add_u32 s21, s68, s67
s_sub_u32 s67, 3, s18
s_lshl_b32 s67, s67, 13
s_add_u32 s62, s68, s67
s_cmp_eq_u32 s8, 0
s_cselect_b32 s21, 0x20000000, s21
s_cselect_b32 s62, 0x20000000, s62
s_lshl_b32 s56, s8, 7
s_add_u32 s56, s56, s75
s_sub_u32 s67, 3, s8
s_cmp_eq_u32 s8, 0
s_cselect_b32 s67, 0, s67
s_lshl_b32 s67, s67, 7
v_and_b32 v22, 1, v0
v_mul_u32_u24 v22, s67, v22
s_lshl_b32 s19, s30, 11
v_add_u32 v196, 131072, v32
v_add_u32 v197, 131072, v33
v_add_u32 v198, 131072, v34
v_add_u32 v199, 131072, v35
buffer_load_dwordx4 v[192:195], v200, s[32:35], s79 offen sc0 sc1
s_cbranch_vccnz L_rs_17
L_rb_18:
s_lshl_b32 s70, s72, 17
s_lshl_b32 s71, s31, 15
s_add_u32 s70, s70, s71
s_add_u32 s70, s70, 0x4000000
s_lshl_b32 s68, s30, 10
s_sub_u32 s67, s70, s68
s_add_u32 s67, s67, 7168
s_add_u32 s68, s70, s68
v_rcp_f32 v5, v8
v_rcp_f32 v6, v9
AR v64,a0
AR v65,a1
AR v66,a2
AR v67,a3
AR v68,a8
AR v69,a9
AR v70,a10
AR v71,a11
v_mul_f32 v64, v64, v5
v_mul_f32 v65, v65, v5
v_mul_f32 v66, v66, v5
v_mul_f32 v67, v67, v5
v_mul_f32 v68, v68, v5
v_mul_f32 v69, v69, v5
v_mul_f32 v70, v70, v5
v_mul_f32 v71, v71, v5
CV v72,v64,v65
CV v73,v66,v67
CV v74,v68,v69
CV v75,v70,v71
s_add_u32 s71, s67, 0
buffer_store_dwordx4 v[72:75], v1, s[32:35], s71 offen sc0 sc1
AR v80,a4
AR v81,a5
AR v82,a6
AR v83,a7
AR v84,a12
AR v85,a13
AR v86,a14
AR v87,a15
v_mul_f32 v80, v80, v6
v_mul_f32 v81, v81, v6
v_mul_f32 v82, v82, v6
v_mul_f32 v83, v83, v6
v_mul_f32 v84, v84, v6
v_mul_f32 v85, v85, v6
v_mul_f32 v86, v86, v6
v_mul_f32 v87, v87, v6
CV v88,v80,v81
CV v89,v82,v83
CV v90,v84,v85
CV v91,v86,v87
s_add_u32 s71, s68, 0
buffer_store_dwordx4 v[88:91], v1, s[32:35], s71 offen sc0 sc1
AR v96,a16
AR v97,a17
AR v98,a18
AR v99,a19
AR v100,a24
AR v101,a25
AR v102,a26
AR v103,a27
v_mul_f32 v96, v96, v5
v_mul_f32 v97, v97, v5
v_mul_f32 v98, v98, v5
v_mul_f32 v99, v99, v5
v_mul_f32 v100, v100, v5
v_mul_f32 v101, v101, v5
v_mul_f32 v102, v102, v5
v_mul_f32 v103, v103, v5
CV v104,v96,v97
CV v105,v98,v99
CV v106,v100,v101
CV v107,v102,v103
s_add_u32 s71, s67, 8192
buffer_store_dwordx4 v[104:107], v1, s[32:35], s71 offen sc0 sc1
AR v112,a20
AR v113,a21
AR v114,a22
AR v115,a23
AR v116,a28
AR v117,a29
AR v118,a30
AR v119,a31
v_mul_f32 v112, v112, v6
v_mul_f32 v113, v113, v6
v_mul_f32 v114, v114, v6
v_mul_f32 v115, v115, v6
v_mul_f32 v116, v116, v6
v_mul_f32 v117, v117, v6
v_mul_f32 v118, v118, v6
v_mul_f32 v119, v119, v6
CV v120,v112,v113
CV v121,v114,v115
CV v122,v116,v117
CV v123,v118,v119
s_add_u32 s71, s68, 8192
buffer_store_dwordx4 v[120:123], v1, s[32:35], s71 offen sc0 sc1
AR v64,a32
AR v65,a33
AR v66,a34
AR v67,a35
AR v68,a40
AR v69,a41
AR v70,a42
AR v71,a43
v_mul_f32 v64, v64, v5
v_mul_f32 v65, v65, v5
v_mul_f32 v66, v66, v5
v_mul_f32 v67, v67, v5
v_mul_f32 v68, v68, v5
v_mul_f32 v69, v69, v5
v_mul_f32 v70, v70, v5
v_mul_f32 v71, v71, v5
CV v72,v64,v65
CV v73,v66,v67
CV v74,v68,v69
CV v75,v70,v71
s_add_u32 s71, s67, 16384
buffer_store_dwordx4 v[72:75], v1, s[32:35], s71 offen sc0 sc1
AR v80,a36
AR v81,a37
AR v82,a38
AR v83,a39
AR v84,a44
AR v85,a45
AR v86,a46
AR v87,a47
v_mul_f32 v80, v80, v6
v_mul_f32 v81, v81, v6
v_mul_f32 v82, v82, v6
v_mul_f32 v83, v83, v6
v_mul_f32 v84, v84, v6
v_mul_f32 v85, v85, v6
v_mul_f32 v86, v86, v6
v_mul_f32 v87, v87, v6
CV v88,v80,v81
CV v89,v82,v83
CV v90,v84,v85
CV v91,v86,v87
s_add_u32 s71, s68, 16384
buffer_store_dwordx4 v[88:91], v1, s[32:35], s71 offen sc0 sc1
AR v96,a48
AR v97,a49
AR v98,a50
AR v99,a51
AR v100,a56
AR v101,a57
AR v102,a58
AR v103,a59
v_mul_f32 v96, v96, v5
v_mul_f32 v97, v97, v5
v_mul_f32 v98, v98, v5
v_mul_f32 v99, v99, v5
v_mul_f32 v100, v100, v5
v_mul_f32 v101, v101, v5
v_mul_f32 v102, v102, v5
v_mul_f32 v103, v103, v5
CV v104,v96,v97
CV v105,v98,v99
CV v106,v100,v101
CV v107,v102,v103
s_add_u32 s71, s67, 24576
buffer_store_dwordx4 v[104:107], v1, s[32:35], s71 offen sc0 sc1
AR v112,a52
AR v113,a53
AR v114,a54
AR v115,a55
AR v116,a60
AR v117,a61
AR v118,a62
AR v119,a63
v_mul_f32 v112, v112, v6
v_mul_f32 v113, v113, v6
v_mul_f32 v114, v114, v6
v_mul_f32 v115, v115, v6
v_mul_f32 v116, v116, v6
v_mul_f32 v117, v117, v6
v_mul_f32 v118, v118, v6
v_mul_f32 v119, v119, v6
CV v120,v112,v113
CV v121,v114,v115
CV v122,v116,v117
CV v123,v118,v119
s_add_u32 s71, s68, 24576
buffer_store_dwordx4 v[120:123], v1, s[32:35], s71 offen sc0 sc1
s_waitcnt vmcnt(8)
v_xor_b32 v192, v192, v61
v_xor_b32 v193, v193, v61
v_xor_b32 v194, v194, v61
v_xor_b32 v195, v195, v61
v_or3_b32 v192, v192, v193, v194
v_or_b32 v192, v192, v195
v_cmp_ne_u32 vcc, 0, v192
s_nop 1
s_cbranch_vccnz L_sl_19
L_ok_20:
s_lshl_b32 s63, s3, 1
s_sub_u32 s63, 12, s63
.p2align 6
L_loopB:
MM v[128:131],a[192:195],a[160:163],v[24:27]
ds_read_b128 a[232:235], v3 offset:10240
v_add_f32 v10, v10, v40
MM v[128:131],a[196:199],a[164:167],v[128:131]
v_add_f32 v11, v11, v44
v_exp_f32 v54, v170
MM v[128:131],a[200:203],a[168:171],v[128:131]
ds_read_b128 a[236:239], v3 offset:11264
CV v240,v48,v49
MM v[128:131],a[204:207],a[172:175],v[128:131]
s_sub_u32 m0, s60, s59
v_exp_f32 v55, v171
MM v[132:135],a[204:207],a[188:191],v[28:31]
ds_read_b128 a[240:243], v3 offset:12288
CV v241,v50,v51
MM v[132:135],a[200:203],a[184:187],v[132:135]
v_exp_f32 v48, v164
MM v[132:135],a[196:199],a[180:183],v[132:135]
ds_read_b128 a[244:247], v3 offset:13312
buffer_load_dwordx4 v2, s[32:35], s57 offen offset:0 sc1 lds
MM v[132:135],a[192:195],a[176:179],v[132:135]
s_waitcnt lgkmcnt(6)
v_exp_f32 v49, v165
MM v[136:139],a[208:211],a[160:163],v[24:27]
ds_read_b128 a[248:251], v3 offset:14336
CV v242,v52,v53
MM v[136:139],a[212:215],a[164:167],v[136:139]
v_exp_f32 v50, v166
MM v[136:139],a[216:219],a[168:171],v[136:139]
ds_read_b128 a[252:255], v3 offset:15360
buffer_load_dwordx4 v2, s[32:35], s57 offen offset:1024 sc1 lds
MM v[136:139],a[220:223],a[172:175],v[136:139]
v_exp_f32 v51, v167
MM v[140:143],a[220:223],a[188:191],v[28:31]
ds_read_b128 a[192:195], v4 offset:0
buffer_load_dwordx4 v2, s[32:35], s57 offen offset:2048 sc1 lds
MM v[140:143],a[216:219],a[184:187],v[140:143]
v_exp_f32 v52, v172
MM v[140:143],a[212:215],a[180:183],v[140:143]
ds_read_b128 a[196:199], v4 offset:8192
CV v243,v54,v55
MM v[140:143],a[208:211],a[176:179],v[140:143]
v_exp_f32 v53, v173
MM v[40:43],v[56:59],v[240:243],0
buffer_load_dwordx4 v2, s[32:35], s57 offen offset:3072 sc1 lds
s_waitcnt lgkmcnt(6)
MM v[144:147],a[224:227],a[160:163],v[24:27]
ds_read_b128 a[200:203], v4 offset:1024
CV v248,v48,v49
MM v[144:147],a[228:231],a[164:167],v[144:147]
v_exp_f32 v54, v174
MM v[144:147],a[232:235],a[168:171],v[144:147]
ds_read_b128 a[204:207], v4 offset:9216
s_add_u32 m0, s59, 0
MM v[144:147],a[236:239],a[172:175],v[144:147]
s_add_u32 s57, s58, 32768
v_exp_f32 v55, v175
MM v[148:151],a[236:239],a[188:191],v[28:31]
ds_read_b128 a[208:211], v4 offset:2048
CV v249,v50,v51
MM v[148:151],a[232:235],a[184:187],v[148:151]
v_exp_f32 v48, v176
MM v[148:151],a[228:231],a[180:183],v[148:151]
ds_read_b128 a[212:215], v4 offset:10240
buffer_load_dwordx4 v1, s[32:35], s57 offen offset:0 sc1 lds
MM v[148:151],a[224:227],a[176:179],v[148:151]
s_waitcnt lgkmcnt(6)
v_exp_f32 v49, v177
MM v[152:155],a[240:243],a[160:163],v[24:27]
ds_read_b128 a[216:219], v4 offset:3072
CV v250,v52,v53
MM v[152:155],a[244:247],a[164:167],v[152:155]
v_exp_f32 v50, v178
MM v[152:155],a[248:251],a[168:171],v[152:155]
ds_read_b128 a[220:223], v4 offset:11264
buffer_load_dwordx4 v1, s[32:35], s57 offen offset:1024 sc1 lds
MM v[152:155],a[252:255],a[172:175],v[152:155]
v_exp_f32 v51, v179
MM v[156:159],a[252:255],a[188:191],v[28:31]
ds_read_b128 a[224:227], v4 offset:4096
CV v251,v54,v55
MM v[156:159],a[248:251],a[184:187],v[156:159]
v_exp_f32 v52, v184
MM v[44:47],v[56:59],v[248:251],0
v_exp_f32 v53, v185
MM v[156:159],a[244:247],a[180:183],v[156:159]
ds_read_b128 a[228:231], v4 offset:12288
buffer_load_dwordx4 v1, s[32:35], s57 offen offset:2048 sc1 lds
MM v[156:159],a[240:243],a[176:179],v[156:159]
s_waitcnt lgkmcnt(6)
v_exp_f32 v54, v186
MM a[64:67],a[192:195],v[224:227],a[64:67]
ds_read_b128 a[232:235], v4 offset:5120
CV v244,v48,v49
MM a[64:67],a[196:199],v[228:231],a[64:67]
v_exp_f32 v55, v187
MM a[68:71],a[196:199],v[236:239],a[68:71]
ds_read_b128 a[236:239], v4 offset:13312
buffer_load_dwordx4 v1, s[32:35], s57 offen offset:3072 sc1 lds
MM a[68:71],a[192:195],v[232:235],a[68:71]
v_exp_f32 v48, v180
MM a[72:75],a[200:203],v[224:227],a[72:75]
ds_read_b128 a[240:243], v4 offset:6144
CV v245,v50,v51
MM a[72:75],a[204:207],v[228:231],a[72:75]
v_exp_f32 v49, v181
MM a[76:79],a[204:207],v[236:239],a[76:79]
ds_read_b128 a[244:247], v4 offset:14336
s_waitcnt lgkmcnt(6)
MM a[76:79],a[200:203],v[232:235],a[76:79]
v_exp_f32 v50, v182
MM a[80:83],a[208:211],v[224:227],a[80:83]
ds_read_b128 a[248:251], v4 offset:7168
CV v246,v52,v53
MM a[80:83],a[212:215],v[228:231],a[80:83]
s_waitcnt vmcnt(8)
v_exp_f32 v51, v183
MM a[84:87],a[212:215],v[236:239],a[84:87]
ds_read_b128 a[252:255], v4 offset:15360
s_barrier
MM a[84:87],a[208:211],v[232:235],a[84:87]
v_exp_f32 v52, v188
MM a[88:91],a[216:219],v[224:227],a[88:91]
ds_read_b128 a[192:195], v3 offset:16384
CV v247,v54,v55
MM a[88:91],a[220:223],v[228:231],a[88:91]
v_exp_f32 v53, v189
MM v[40:43],v[56:59],v[244:247],v[40:43]
v_exp_f32 v54, v190
MM a[92:95],a[220:223],v[236:239],a[92:95]
ds_read_b128 a[196:199], v3 offset:17408
CV v252,v48,v49
MM a[92:95],a[216:219],v[232:235],a[92:95]
s_waitcnt lgkmcnt(6)
v_exp_f32 v55, v191
MM a[96:99],a[224:227],v[224:227],a[96:99]
ds_read_b128 a[200:203], v3 offset:18432
CV v253,v50,v51
MM a[96:99],a[228:231],v[228:231],a[96:99]
CV v254,v52,v53
CV v255,v54,v55
MM a[100:103],a[228:231],v[236:239],a[100:103]
ds_read_b128 a[204:207], v3 offset:19456
MM a[100:103],a[224:227],v[232:235],a[100:103]
v_exp_f32 v48, v128
MM v[44:47],v[56:59],v[252:255],v[44:47]
v_exp_f32 v49, v129
MM a[104:107],a[232:235],v[224:227],a[104:107]
ds_read_b128 a[208:211], v3 offset:20480
MM a[104:107],a[236:239],v[228:231],a[104:107]
v_exp_f32 v50, v130
MM a[108:111],a[236:239],v[236:239],a[108:111]
ds_read_b128 a[212:215], v3 offset:21504
s_waitcnt lgkmcnt(6)
MM a[108:111],a[232:235],v[232:235],a[108:111]
v_exp_f32 v51, v131
MM a[112:115],a[240:243],v[224:227],a[112:115]
ds_read_b128 a[216:219], v3 offset:22528
v_max_f32 v5, v40, v44
MM a[112:115],a[244:247],v[228:231],a[112:115]
v_exp_f32 v52, v136
MM a[116:119],a[244:247],v[236:239],a[116:119]
ds_read_b128 a[220:223], v3 offset:23552
v_cmp_lt_f32 vcc, s64, v5
MM a[116:119],a[240:243],v[232:235],a[116:119]
v_exp_f32 v53, v137
MM a[120:123],a[248:251],v[224:227],a[120:123]
ds_read_b128 a[224:227], v3 offset:24576
MM a[120:123],a[252:255],v[228:231],a[120:123]
MM a[124:127],a[252:255],v[236:239],a[124:127]
ds_read_b128 a[228:231], v3 offset:25600
s_waitcnt lgkmcnt(6)
MM a[124:127],a[248:251],v[232:235],a[124:127]
s_cbranch_vccnz L_rs_21
L_rb_22:
MM v[160:163],a[192:195],a[160:163],v[24:27]
ds_read_b128 a[232:235], v3 offset:26624
v_add_f32 v10, v10, v40
MM v[160:163],a[196:199],a[164:167],v[160:163]
v_add_f32 v11, v11, v44
v_exp_f32 v54, v138
MM v[160:163],a[200:203],a[168:171],v[160:163]
ds_read_b128 a[236:239], v3 offset:27648
CV v224,v48,v49
MM v[160:163],a[204:207],a[172:175],v[160:163]
s_sub_u32 m0, s61, s59
v_exp_f32 v55, v139
MM v[164:167],a[204:207],a[188:191],v[28:31]
ds_read_b128 a[240:243], v3 offset:28672
CV v225,v50,v51
MM v[164:167],a[200:203],a[184:187],v[164:167]
v_exp_f32 v48, v132
MM v[164:167],a[196:199],a[180:183],v[164:167]
ds_read_b128 a[244:247], v3 offset:29696
buffer_load_dwordx4 v2, s[32:35], s58 offen offset:0 sc1 lds
MM v[164:167],a[192:195],a[176:179],v[164:167]
s_waitcnt lgkmcnt(6)
v_exp_f32 v49, v133
MM v[168:171],a[208:211],a[160:163],v[24:27]
ds_read_b128 a[248:251], v3 offset:30720
CV v226,v52,v53
MM v[168:171],a[212:215],a[164:167],v[168:171]
v_exp_f32 v50, v134
MM v[168:171],a[216:219],a[168:171],v[168:171]
ds_read_b128 a[252:255], v3 offset:31744
buffer_load_dwordx4 v2, s[32:35], s58 offen offset:1024 sc1 lds
MM v[168:171],a[220:223],a[172:175],v[168:171]
v_exp_f32 v51, v135
MM v[172:175],a[220:223],a[188:191],v[28:31]
ds_read_b128 a[192:195], v4 offset:16384
buffer_load_dwordx4 v2, s[32:35], s58 offen offset:2048 sc1 lds
MM v[172:175],a[216:219],a[184:187],v[172:175]
v_exp_f32 v52, v140
MM v[172:175],a[212:215],a[180:183],v[172:175]
ds_read_b128 a[196:199], v4 offset:24576
CV v227,v54,v55
MM v[172:175],a[208:211],a[176:179],v[172:175]
v_exp_f32 v53, v141
MM v[40:43],v[56:59],v[224:227],0
buffer_load_dwordx4 v2, s[32:35], s58 offen offset:3072 sc1 lds
s_waitcnt lgkmcnt(6)
MM v[176:179],a[224:227],a[160:163],v[24:27]
ds_read_b128 a[200:203], v4 offset:17408
CV v232,v48,v49
MM v[176:179],a[228:231],a[164:167],v[176:179]
v_exp_f32 v54, v142
MM v[176:179],a[232:235],a[168:171],v[176:179]
ds_read_b128 a[204:207], v4 offset:25600
s_add_u32 m0, s59, 16384
MM v[176:179],a[236:239],a[172:175],v[176:179]
s_add_u32 s58, s57, 32768
v_exp_f32 v55, v143
MM v[180:183],a[236:239],a[188:191],v[28:31]
ds_read_b128 a[208:211], v4 offset:18432
CV v233,v50,v51
MM v[180:183],a[232:235],a[184:187],v[180:183]
v_exp_f32 v48, v144
MM v[180:183],a[228:231],a[180:183],v[180:183]
ds_read_b128 a[212:215], v4 offset:26624
buffer_load_dwordx4 v1, s[32:35], s58 offen offset:0 sc1 lds
MM v[180:183],a[224:227],a[176:179],v[180:183]
s_waitcnt lgkmcnt(6)
v_exp_f32 v49, v145
MM v[184:187],a[240:243],a[160:163],v[24:27]
ds_read_b128 a[216:219], v4 offset:19456
CV v234,v52,v53
MM v[184:187],a[244:247],a[164:167],v[184:187]
v_exp_f32 v50, v146
MM v[184:187],a[248:251],a[168:171],v[184:187]
ds_read_b128 a[220:223], v4 offset:27648
buffer_load_dwordx4 v1, s[32:35], s58 offen offset:1024 sc1 lds
MM v[184:187],a[252:255],a[172:175],v[184:187]
v_exp_f32 v51, v147
MM v[188:191],a[252:255],a[188:191],v[28:31]
ds_read_b128 a[224:227], v4 offset:20480
CV v235,v54,v55
MM v[188:191],a[248:251],a[184:187],v[188:191]
v_exp_f32 v52, v152
MM v[44:47],v[56:59],v[232:235],0
v_exp_f32 v53, v153
MM v[188:191],a[244:247],a[180:183],v[188:191]
ds_read_b128 a[228:231], v4 offset:28672
buffer_load_dwordx4 v1, s[32:35], s58 offen offset:2048 sc1 lds
MM v[188:191],a[240:243],a[176:179],v[188:191]
s_waitcnt lgkmcnt(6)
v_exp_f32 v54, v154
MM a[64:67],a[192:195],v[240:243],a[64:67]
ds_read_b128 a[232:235], v4 offset:21504
CV v228,v48,v49
MM a[64:67],a[196:199],v[244:247],a[64:67]
v_exp_f32 v55, v155
MM a[68:71],a[196:199],v[252:255],a[68:71]
ds_read_b128 a[236:239], v4 offset:29696
buffer_load_dwordx4 v1, s[32:35], s58 offen offset:3072 sc1 lds
MM a[68:71],a[192:195],v[248:251],a[68:71]
v_exp_f32 v48, v148
MM a[72:75],a[200:203],v[240:243],a[72:75]
ds_read_b128 a[240:243], v4 offset:22528
CV v229,v50,v51
MM a[72:75],a[204:207],v[244:247],a[72:75]
v_exp_f32 v49, v149
MM a[76:79],a[204:207],v[252:255],a[76:79]
ds_read_b128 a[244:247], v4 offset:30720
s_waitcnt lgkmcnt(6)
MM a[76:79],a[200:203],v[248:251],a[76:79]
v_exp_f32 v50, v150
MM a[80:83],a[208:211],v[240:243],a[80:83]
ds_read_b128 a[248:251], v4 offset:23552
CV v230,v52,v53
MM a[80:83],a[212:215],v[244:247],a[80:83]
s_waitcnt vmcnt(8)
v_exp_f32 v51, v151
MM a[84:87],a[212:215],v[252:255],a[84:87]
ds_read_b128 a[252:255], v4 offset:31744
v_xor_b32 v3, 32768, v3
MM a[84:87],a[208:211],v[248:251],a[84:87]
s_barrier
v_exp_f32 v52, v156
MM a[88:91],a[216:219],v[240:243],a[88:91]
ds_read_b128 a[192:195], v3 offset:0
CV v231,v54,v55
MM a[88:91],a[220:223],v[244:247],a[88:91]
v_exp_f32 v53, v157
MM v[40:43],v[56:59],v[228:231],v[40:43]
v_exp_f32 v54, v158
MM a[92:95],a[220:223],v[252:255],a[92:95]
ds_read_b128 a[196:199], v3 offset:1024
CV v236,v48,v49
MM a[92:95],a[216:219],v[248:251],a[92:95]
s_waitcnt lgkmcnt(6)
v_exp_f32 v55, v159
MM a[96:99],a[224:227],v[240:243],a[96:99]
ds_read_b128 a[200:203], v3 offset:2048
CV v237,v50,v51
MM a[96:99],a[228:231],v[244:247],a[96:99]
CV v238,v52,v53
CV v239,v54,v55
MM a[100:103],a[228:231],v[252:255],a[100:103]
ds_read_b128 a[204:207], v3 offset:3072
s_xor_b32 s59, s59, 32768
MM a[100:103],a[224:227],v[248:251],a[100:103]
v_exp_f32 v48, v160
MM v[44:47],v[56:59],v[236:239],v[44:47]
v_exp_f32 v49, v161
MM a[104:107],a[232:235],v[240:243],a[104:107]
ds_read_b128 a[208:211], v3 offset:4096
v_xor_b32 v4, 32768, v4
MM a[104:107],a[236:239],v[244:247],a[104:107]
v_exp_f32 v50, v162
MM a[108:111],a[236:239],v[252:255],a[108:111]
ds_read_b128 a[212:215], v3 offset:5120
s_waitcnt lgkmcnt(6)
MM a[108:111],a[232:235],v[248:251],a[108:111]
v_exp_f32 v51, v163
MM a[112:115],a[240:243],v[240:243],a[112:115]
ds_read_b128 a[216:219], v3 offset:6144
v_max_f32 v5, v40, v44
MM a[112:115],a[244:247],v[244:247],a[112:115]
v_exp_f32 v52, v168
MM a[116:119],a[244:247],v[252:255],a[116:119]
ds_read_b128 a[220:223], v3 offset:7168
v_cmp_lt_f32 vcc, s64, v5
MM a[116:119],a[240:243],v[248:251],a[116:119]
v_exp_f32 v53, v169
MM a[120:123],a[248:251],v[240:243],a[120:123]
ds_read_b128 a[224:227], v3 offset:8192
MM a[120:123],a[252:255],v[244:247],a[120:123]
MM a[124:127],a[252:255],v[252:255],a[124:127]
ds_read_b128 a[228:231], v3 offset:9216
s_waitcnt lgkmcnt(6)
MM a[124:127],a[248:251],v[248:251],a[124:127]
s_sub_u32 s63, s63, 1
s_cbranch_vccnz L_rs_23
L_rb_24:
s_cbranch_scc0 L_loopB
s_cmp_eq_u32 s30, 0
s_cselect_b32 s67, s65, 0
v_fma_f32 v132, v12, s67, v28
v_fma_f32 v133, v13, s67, v28
v_fma_f32 v134, v14, s67, v28
v_fma_f32 v135, v15, s67, v28
s_nop 1
MM v[128:131],a[192:195],a[160:163],v[24:27]
ds_read_b128 a[232:235], v3 offset:10240
v_add_f32 v10, v10, v40
MM v[128:131],a[196:199],a[164:167],v[128:131]
v_add_f32 v11, v11, v44
v_exp_f32 v54, v170
MM v[128:131],a[200:203],a[168:171],v[128:131]
ds_read_b128 a[236:239], v3 offset:11264
CV v240,v48,v49
MM v[128:131],a[204:207],a[172:175],v[128:131]
s_cmp_eq_u32 s30, 1
s_cselect_b32 s67, s65, 0
s_cmp_lt_u32 s30, 1
s_cselect_b32 s68, s65, 0
v_add_f32 v6, s68, v28
v_fma_f32 v140, v12, s67, v6
v_fma_f32 v141, v13, s67, v6
v_fma_f32 v142, v14, s67, v6
v_fma_f32 v143, v15, s67, v6
s_sub_u32 m0, s60, s59
MM v[132:135],a[204:207],a[188:191],v[132:135]
ds_read_b128 a[240:243], v3 offset:12288
CV v241,v50,v51
MM v[132:135],a[200:203],a[184:187],v[132:135]
v_exp_f32 v55, v171
MM v[132:135],a[196:199],a[180:183],v[132:135]
ds_read_b128 a[244:247], v3 offset:13312
buffer_load_dwordx4 v2, s[32:35], s57 offen offset:0 sc1 lds
MM v[132:135],a[192:195],a[176:179],v[132:135]
s_waitcnt lgkmcnt(6)
v_exp_f32 v48, v164
MM v[136:139],a[208:211],a[160:163],v[24:27]
ds_read_b128 a[248:251], v3 offset:14336
CV v242,v52,v53
MM v[136:139],a[212:215],a[164:167],v[136:139]
v_exp_f32 v49, v165
MM v[136:139],a[216:219],a[168:171],v[136:139]
ds_read_b128 a[252:255], v3 offset:15360
s_cmp_eq_u32 s30, 2
s_cselect_b32 s67, s65, 0
s_cmp_lt_u32 s30, 2
s_cselect_b32 s68, s65, 0
v_add_f32 v6, s68, v28
v_fma_f32 v148, v12, s67, v6
v_fma_f32 v149, v13, s67, v6
v_fma_f32 v150, v14, s67, v6
v_fma_f32 v151, v15, s67, v6
MM v[136:139],a[220:223],a[172:175],v[136:139]
buffer_load_dwordx4 v2, s[32:35], s57 offen offset:1024 sc1 lds
v_exp_f32 v50, v166
MM v[140:143],a[220:223],a[188:191],v[140:143]
ds_read_b128 a[192:195], v4 offset:0
buffer_load_dwordx4 v2, s[32:35], s57 offen offset:2048 sc1 lds
MM v[140:143],a[216:219],a[184:187],v[140:143]
v_exp_f32 v51, v167
MM v[140:143],a[212:215],a[180:183],v[140:143]
ds_read_b128 a[196:199], v4 offset:8192
buffer_load_dwordx4 v2, s[32:35], s57 offen offset:3072 sc1 lds
MM v[140:143],a[208:211],a[176:179],v[140:143]
s_waitcnt lgkmcnt(6)
v_exp_f32 v52, v172
MM v[144:147],a[224:227],a[160:163],v[24:27]
ds_read_b128 a[200:203], v4 offset:1024
CV v243,v54,v55
MM v[144:147],a[228:231],a[164:167],v[144:147]
v_exp_f32 v53, v173
MM v[40:43],v[56:59],v[240:243],0
v_exp_f32 v54, v174
MM v[144:147],a[232:235],a[168:171],v[144:147]
ds_read_b128 a[204:207], v4 offset:9216
CV v248,v48,v49
MM v[144:147],a[236:239],a[172:175],v[144:147]
s_cmp_eq_u32 s30, 3
s_cselect_b32 s67, s65, 0
s_cmp_lt_u32 s30, 3
s_cselect_b32 s68, s65, 0
v_add_f32 v6, s68, v28
v_fma_f32 v156, v12, s67, v6
v_fma_f32 v157, v13, s67, v6
v_fma_f32 v158, v14, s67, v6
v_fma_f32 v159, v15, s67, v6
v_exp_f32 v55, v175
MM v[148:151],a[236:239],a[188:191],v[148:151]
ds_read_b128 a[208:211], v4 offset:2048
CV v249,v50,v51
MM v[148:151],a[232:235],a[184:187],v[148:151]
v_exp_f32 v48, v176
MM v[148:151],a[228:231],a[180:183],v[148:151]
ds_read_b128 a[212:215], v4 offset:10240
s_waitcnt lgkmcnt(6)
MM v[148:151],a[224:227],a[176:179],v[148:151]
v_exp_f32 v49, v177
MM v[152:155],a[240:243],a[160:163],v[24:27]
ds_read_b128 a[216:219], v4 offset:3072
CV v250,v52,v53
MM v[152:155],a[244:247],a[164:167],v[152:155]
v_exp_f32 v50, v178
MM v[152:155],a[248:251],a[168:171],v[152:155]
ds_read_b128 a[220:223], v4 offset:11264
CV v251,v54,v55
MM v[152:155],a[252:255],a[172:175],v[152:155]
v_exp_f32 v51, v179
MM v[44:47],v[56:59],v[248:251],0
v_exp_f32 v52, v184
MM v[156:159],a[252:255],a[188:191],v[156:159]
ds_read_b128 a[224:227], v4 offset:4096
CV v244,v48,v49
MM v[156:159],a[248:251],a[184:187],v[156:159]
v_exp_f32 v53, v185
MM v[156:159],a[244:247],a[180:183],v[156:159]
ds_read_b128 a[228:231], v4 offset:12288
s_waitcnt lgkmcnt(6)
MM v[156:159],a[240:243],a[176:179],v[156:159]
v_exp_f32 v54, v186
MM a[64:67],a[192:195],v[224:227],a[64:67]
ds_read_b128 a[232:235], v4 offset:5120
CV v245,v50,v51
MM a[64:67],a[196:199],v[228:231],a[64:67]
v_exp_f32 v55, v187
MM a[68:71],a[196:199],v[236:239],a[68:71]
ds_read_b128 a[236:239], v4 offset:13312
s_add_u32 m0, s19, 131072
MM a[68:71],a[192:195],v[232:235],a[68:71]
v_exp_f32 v48, v180
MM a[72:75],a[200:203],v[224:227],a[72:75]
ds_read_b128 a[240:243], v4 offset:6144
s_nop 0
MM a[72:75],a[204:207],v[228:231],a[72:75]
buffer_load_dwordx4 v18, s[44:47], s12 offen offset:0 sc1 lds
buffer_load_dwordx4 v19, s[44:47], s12 offen offset:1024 sc1 lds
s_add_u32 m0, s19, 139264
s_add_u32 s20, s12, 128
buffer_load_dwordx4 v18, s[44:47], s20 offen offset:0 sc1 lds
buffer_load_dwordx4 v19, s[44:47], s20 offen offset:1024 sc1 lds
s_add_u32 s12, s12, 81920
s_getpc_b64 s[70:71]
L_pc2:
s_add_u32 s70, s70, L_tail2B-L_pc2
s_addc_u32 s71, s71, 0
s_lshr_b32 s67, s2, 3
s_lshl_b32 s67, s67, 2
s_add_u32 s67, s67, s30
s_lshl_b32 s67, s67, 9
v_and_b32 v63, 3, v0
v_lshlrev_b32 v63, 7, v63
v_add_u32 v63, s67, v63
v_min_u32 v63, L_codeend-L_tail2B-4, v63
global_load_dword v63, v63, s[70:71]
MM a[76:79],a[204:207],v[236:239],a[76:79]
ds_read_b128 a[244:247], v4 offset:14336
s_waitcnt lgkmcnt(6)
MM a[76:79],a[200:203],v[232:235],a[76:79]
v_exp_f32 v49, v181
MM a[80:83],a[208:211],v[224:227],a[80:83]
ds_read_b128 a[248:251], v4 offset:7168
s_waitcnt vmcnt(8)
MM a[80:83],a[212:215],v[228:231],a[80:83]
v_exp_f32 v50, v182
MM a[84:87],a[212:215],v[236:239],a[84:87]
ds_read_b128 a[252:255], v4 offset:15360
CV v246,v52,v53
MM a[84:87],a[208:211],v[232:235],a[84:87]
s_barrier
v_exp_f32 v51, v183
MM a[88:91],a[216:219],v[224:227],a[88:91]
ds_read_b128 a[192:195], v3 offset:16384
CV v247,v54,v55
MM a[88:91],a[220:223],v[228:231],a[88:91]
v_exp_f32 v52, v188
MM v[40:43],v[56:59],v[244:247],v[40:43]
v_exp_f32 v53, v189
MM a[92:95],a[220:223],v[236:239],a[92:95]
ds_read_b128 a[196:199], v3 offset:17408
s_waitcnt lgkmcnt(6)
MM a[92:95],a[216:219],v[232:235],a[92:95]
v_exp_f32 v54, v190
MM a[96:99],a[224:227],v[224:227],a[96:99]
ds_read_b128 a[200:203], v3 offset:18432
CV v252,v48,v49
MM a[96:99],a[228:231],v[228:231],a[96:99]
v_exp_f32 v55, v191
MM a[100:103],a[228:231],v[236:239],a[100:103]
ds_read_b128 a[204:207], v3 offset:19456
CV v253,v50,v51
MM a[100:103],a[224:227],v[232:235],a[100:103]
CV v254,v52,v53
CV v255,v54,v55
MM a[104:107],a[232:235],v[224:227],a[104:107]
ds_read_b128 a[208:211], v3 offset:20480
buffer_load_dwordx4 a[0:3], v16, s[36:39], s11 offen sc1
MM a[104:107],a[236:239],v[228:231],a[104:107]
v_exp_f32 v48, v128
MM v[44:47],v[56:59],v[252:255],v[44:47]
v_exp_f32 v49, v129
MM a[108:111],a[236:239],v[236:239],a[108:111]
ds_read_b128 a[212:215], v3 offset:21504
s_waitcnt lgkmcnt(6)
MM a[108:111],a[232:235],v[232:235],a[108:111]
v_exp_f32 v50, v130
MM a[112:115],a[240:243],v[224:227],a[112:115]
ds_read_b128 a[216:219], v3 offset:22528
buffer_load_dwordx4 a[4:7], v17, s[36:39], s11 offen sc1
MM a[112:115],a[244:247],v[228:231],a[112:115]
v_exp_f32 v51, v131
MM a[116:119],a[244:247],v[236:239],a[116:119]
ds_read_b128 a[220:223], v3 offset:23552
v_max_f32 v5, v40, v44
MM a[116:119],a[240:243],v[232:235],a[116:119]
v_exp_f32 v52, v136
MM a[120:123],a[248:251],v[224:227],a[120:123]
ds_read_b128 a[224:227], v3 offset:24576
v_cmp_lt_f32 vcc, s64, v5
MM a[120:123],a[252:255],v[228:231],a[120:123]
v_exp_f32 v53, v137
MM a[124:127],a[252:255],v[236:239],a[124:127]
ds_read_b128 a[228:231], v3 offset:25600
s_waitcnt lgkmcnt(6)
MM a[124:127],a[248:251],v[232:235],a[124:127]
s_add_u32 s11, s11, 8192
buffer_load_dwordx4 a[8:11], v16, s[36:39], s11 offen sc1
buffer_load_dwordx4 a[12:15], v17, s[36:39], s11 offen sc1
s_add_u32 s11, s11, 8192
buffer_load_dwordx4 a[16:19], v16, s[36:39], s11 offen sc1
buffer_load_dwordx4 a[20:23], v17, s[36:39], s11 offen sc1
s_add_u32 s11, s11, 8192
s_cbranch_vccnz L_rs_25
L_rb_26:
s_cmp_eq_u32 s66, 0
s_cselect_b32 s67, s65, 0
v_fma_f32 v160, v12, s67, v24
v_fma_f32 v161, v13, s67, v24
v_fma_f32 v162, v14, s67, v24
v_fma_f32 v163, v15, s67, v24
s_nop 1
MM v[160:163],a[192:195],a[160:163],v[160:163]
ds_read_b128 a[232:235], v3 offset:26624
v_add_f32 v10, v10, v40
v_add_f32 v11, v11, v44
MM v[160:163],a[196:199],a[164:167],v[160:163]
ds_read_b128 a[236:239], v3 offset:27648
s_cmp_eq_u32 s66, 1
s_cselect_b32 s67, s65, 0
s_cmp_lt_u32 s66, 1
s_cselect_b32 s68, s65, 0
v_add_f32 v6, s68, v24
v_fma_f32 v168, v12, s67, v6
v_fma_f32 v169, v13, s67, v6
v_fma_f32 v170, v14, s67, v6
v_fma_f32 v171, v15, s67, v6
s_sub_u32 m0, s61, s59
MM v[160:163],a[200:203],a[168:171],v[160:163]
ds_read_b128 a[240:243], v3 offset:28672
CV v224,v48,v49
MM v[160:163],a[204:207],a[172:175],v[160:163]
ds_read_b128 a[244:247], v3 offset:29696
buffer_load_dwordx4 v2, s[32:35], s58 offen offset:0 sc1 lds
s_waitcnt lgkmcnt(6)
MM v[168:171],a[208:211],a[160:163],v[168:171]
ds_read_b128 a[248:251], v3 offset:30720
s_cmp_eq_u32 s66, 2
s_cselect_b32 s67, s65, 0
s_cmp_lt_u32 s66, 2
s_cselect_b32 s68, s65, 0
v_add_f32 v6, s68, v24
v_fma_f32 v176, v12, s67, v6
v_fma_f32 v177, v13, s67, v6
v_fma_f32 v178, v14, s67, v6
v_fma_f32 v179, v15, s67, v6
MM v[168:171],a[212:215],a[164:167],v[168:171]
ds_read_b128 a[252:255], v3 offset:31744
buffer_load_dwordx4 v2, s[32:35], s58 offen offset:1024 sc1 lds
MM v[168:171],a[216:219],a[168:171],v[168:171]
ds_read_b128 a[192:195], v4 offset:16384
buffer_load_dwordx4 v2, s[32:35], s58 offen offset:2048 sc1 lds
MM v[168:171],a[220:223],a[172:175],v[168:171]
ds_read_b128 a[196:199], v4 offset:24576
buffer_load_dwordx4 v2, s[32:35], s58 offen offset:3072 sc1 lds
s_waitcnt lgkmcnt(6)
MM v[176:179],a[224:227],a[160:163],v[176:179]
ds_read_b128 a[200:203], v4 offset:17408
s_cmp_eq_u32 s66, 3
s_cselect_b32 s67, s65, 0
s_cmp_lt_u32 s66, 3
s_cselect_b32 s68, s65, 0
v_add_f32 v6, s68, v24
v_fma_f32 v184, v12, s67, v6
v_fma_f32 v185, v13, s67, v6
v_fma_f32 v186, v14, s67, v6
v_fma_f32 v187, v15, s67, v6
MM v[176:179],a[228:231],a[164:167],v[176:179]
ds_read_b128 a[204:207], v4 offset:25600
v_xor_b32 v3, 32768, v3
MM v[176:179],a[232:235],a[168:171],v[176:179]
ds_read_b128 a[208:211], v4 offset:18432
s_add_u32 m0, s19, 147456
MM v[176:179],a[236:239],a[172:175],v[176:179]
ds_read_b128 a[212:215], v4 offset:26624
s_waitcnt lgkmcnt(6)
MM v[184:187],a[240:243],a[160:163],v[184:187]
ds_read_b128 a[216:219], v4 offset:19456
s_nop 0
MM v[184:187],a[244:247],a[164:167],v[184:187]
ds_read_b128 a[220:223], v4 offset:27648
s_xor_b32 s59, s59, 32768
MM v[184:187],a[248:251],a[168:171],v[184:187]
ds_read_b128 a[224:227], v4 offset:20480
buffer_load_dwordx4 v18, s[44:47], s12 offen offset:0 sc1 lds
MM v[184:187],a[252:255],a[172:175],v[184:187]
ds_read_b128 a[228:231], v4 offset:28672
s_waitcnt lgkmcnt(6)
MM a[64:67],a[192:195],v[240:243],a[64:67]
ds_read_b128 a[232:235], v4 offset:21504
buffer_load_dwordx4 v19, s[44:47], s12 offen offset:1024 sc1 lds
MM a[64:67],a[196:199],v[244:247],a[64:67]
v_exp_f32 v54, v138
MM a[68:71],a[196:199],v[252:255],a[68:71]
ds_read_b128 a[236:239], v4 offset:29696
CV v225,v50,v51
MM a[68:71],a[192:195],v[248:251],a[68:71]
v_exp_f32 v55, v139
MM a[72:75],a[200:203],v[240:243],a[72:75]
ds_read_b128 a[240:243], v4 offset:22528
s_add_u32 m0, s19, 155648
MM a[72:75],a[204:207],v[244:247],a[72:75]
s_add_u32 s20, s12, 128
buffer_load_dwordx4 v18, s[44:47], s20 offen offset:0 sc1 lds
buffer_load_dwordx4 v19, s[44:47], s20 offen offset:1024 sc1 lds
s_add_u32 s12, s12, 81920
buffer_load_dwordx4 a[24:27], v16, s[36:39], s11 offen sc1
buffer_load_dwordx4 a[28:31], v17, s[36:39], s11 offen sc1
s_add_u32 s11, s11, 8192
MM a[76:79],a[204:207],v[252:255],a[76:79]
ds_read_b128 a[244:247], v4 offset:30720
s_waitcnt lgkmcnt(6)
MM a[76:79],a[200:203],v[248:251],a[76:79]
v_exp_f32 v48, v132
MM a[80:83],a[208:211],v[240:243],a[80:83]
ds_read_b128 a[248:251], v4 offset:23552
s_waitcnt vmcnt(20)
MM a[80:83],a[212:215],v[244:247],a[80:83]
v_exp_f32 v49, v133
MM a[84:87],a[212:215],v[252:255],a[84:87]
ds_read_b128 a[252:255], v4 offset:31744
v_xor_b32 v4, 32768, v4
MM a[84:87],a[208:211],v[248:251],a[84:87]
s_barrier
v_exp_f32 v50, v134
MM a[88:91],a[216:219],v[240:243],a[88:91]
ds_read_b128 a[192:195], v4 offset:0
CV v226,v52,v53
MM a[88:91],a[220:223],v[244:247],a[88:91]
v_exp_f32 v51, v135
MM a[92:95],a[220:223],v[252:255],a[92:95]
ds_read_b128 a[196:199], v4 offset:8192
s_waitcnt lgkmcnt(6)
MM a[92:95],a[216:219],v[248:251],a[92:95]
v_exp_f32 v52, v140
MM a[96:99],a[224:227],v[240:243],a[96:99]
ds_read_b128 a[200:203], v4 offset:1024
CV v227,v54,v55
MM a[96:99],a[228:231],v[244:247],a[96:99]
v_exp_f32 v53, v141
MM v[40:43],v[56:59],v[224:227],0
v_exp_f32 v54, v142
MM a[100:103],a[228:231],v[252:255],a[100:103]
ds_read_b128 a[204:207], v4 offset:9216
CV v232,v48,v49
MM a[100:103],a[224:227],v[248:251],a[100:103]
v_exp_f32 v55, v143
MM a[104:107],a[232:235],v[240:243],a[104:107]
ds_read_b128 a[208:211], v4 offset:2048
CV v233,v50,v51
MM a[104:107],a[236:239],v[244:247],a[104:107]
v_exp_f32 v48, v144
MM a[108:111],a[236:239],v[252:255],a[108:111]
ds_read_b128 a[212:215], v4 offset:10240
s_waitcnt lgkmcnt(6)
MM a[108:111],a[232:235],v[248:251],a[108:111]
v_exp_f32 v49, v145
MM a[112:115],a[240:243],v[240:243],a[112:115]
ds_read_b128 a[216:219], v4 offset:3072
CV v234,v52,v53
MM a[112:115],a[244:247],v[244:247],a[112:115]
v_exp_f32 v50, v146
MM a[116:119],a[244:247],v[252:255],a[116:119]
ds_read_b128 a[220:223], v4 offset:11264
CV v235,v54,v55
MM a[116:119],a[240:243],v[248:251],a[116:119]
v_exp_f32 v51, v147
MM v[44:47],v[56:59],v[232:235],0
v_exp_f32 v52, v152
MM a[120:123],a[248:251],v[240:243],a[120:123]
ds_read_b128 a[224:227], v4 offset:4096
CV v228,v48,v49
MM a[120:123],a[252:255],v[244:247],a[120:123]
v_exp_f32 v53, v153
MM a[124:127],a[252:255],v[252:255],a[124:127]
ds_read_b128 a[228:231], v4 offset:12288
s_waitcnt lgkmcnt(6)
MM a[124:127],a[248:251],v[248:251],a[124:127]
buffer_load_dwordx4 a[32:35], v16, s[36:39], s11 offen sc1
buffer_load_dwordx4 a[36:39], v17, s[36:39], s11 offen sc1
s_add_u32 s11, s11, 8192
buffer_load_dwordx4 a[40:43], v16, s[36:39], s11 offen sc1
buffer_load_dwordx4 a[44:47], v17, s[36:39], s11 offen sc1
s_add_u32 s11, s11, 8192
buffer_load_dwordx4 a[48:51], v16, s[36:39], s11 offen sc1
buffer_load_dwordx4 a[52:55], v17, s[36:39], s11 offen sc1
s_add_u32 s11, s11, 8192
buffer_load_dwordx4 a[56:59], v16, s[36:39], s11 offen sc1
buffer_load_dwordx4 a[60:63], v17, s[36:39], s11 offen sc1
s_add_u32 s11, s11, 8192
v_exp_f32 v54, v154
v_exp_f32 v55, v155
v_exp_f32 v48, v148
v_exp_f32 v49, v149
CV v229,v50,v51
v_exp_f32 v50, v150
CV v230,v52,v53
v_exp_f32 v51, v151
v_exp_f32 v52, v156
v_exp_f32 v53, v157
CV v231,v54,v55
CV v236,v48,v49
s_nop 1
MM v[40:43],v[56:59],v[228:231],v[40:43]
v_exp_f32 v54, v158
v_exp_f32 v55, v159
CV v237,v50,v51
CV v238,v52,v53
v_exp_f32 v48, v160
CV v239,v54,v55
v_exp_f32 v49, v161
s_nop 1
MM v[44:47],v[56:59],v[236:239],v[44:47]
v_exp_f32 v50, v162
v_exp_f32 v51, v163
v_exp_f32 v52, v168
v_exp_f32 v53, v169
s_nop 1
s_nop 1
s_nop 1
s_nop 1
s_nop 1
v_max_f32 v5, v40, v44
v_cmp_lt_f32 vcc, s64, v5
s_cbranch_vccnz L_rs_27
L_rb_28:
s_branch L_tail2B
L_i7:
s_cmp_eq_u32 s30, 0
s_cselect_b32 s67, s65, 0
v_fma_f32 v132, v12, s67, v28
v_fma_f32 v133, v13, s67, v28
v_fma_f32 v134, v14, s67, v28
v_fma_f32 v135, v15, s67, v28
s_nop 1
MM v[128:131],a[192:195],a[160:163],v[24:27]
ds_read_b128 a[232:235], v3 offset:10240
v_add_f32 v10, v10, v40
MM v[128:131],a[196:199],a[164:167],v[128:131]
v_add_f32 v11, v11, v44
v_add_f32 v8, v8, v32
v_add_f32 v9, v9, v36
MM v[128:131],a[200:203],a[168:171],v[128:131]
ds_read_b128 a[236:239], v3 offset:11264
s_cmp_eq_u32 s30, 1
s_cselect_b32 s67, s65, 0
s_cmp_lt_u32 s30, 1
s_cselect_b32 s68, s65, 0
v_add_f32 v6, s68, v28
v_fma_f32 v140, v12, s67, v6
v_fma_f32 v141, v13, s67, v6
v_fma_f32 v142, v14, s67, v6
v_fma_f32 v143, v15, s67, v6
MM v[128:131],a[204:207],a[172:175],v[128:131]
s_sub_u32 m0, s60, s59
v_exp_f32 v54, v170
MM v[132:135],a[204:207],a[188:191],v[132:135]
ds_read_b128 a[240:243], v3 offset:12288
CV v240,v48,v49
MM v[132:135],a[200:203],a[184:187],v[132:135]
v_exp_f32 v55, v171
MM v[132:135],a[196:199],a[180:183],v[132:135]
ds_read_b128 a[244:247], v3 offset:13312
buffer_load_dwordx4 v2, s[32:35], s57 offen offset:0 sc1 lds
MM v[132:135],a[192:195],a[176:179],v[132:135]
s_waitcnt lgkmcnt(6)
v_exp_f32 v48, v164
MM v[136:139],a[208:211],a[160:163],v[24:27]
ds_read_b128 a[248:251], v3 offset:14336
CV v241,v50,v51
MM v[136:139],a[212:215],a[164:167],v[136:139]
v_exp_f32 v49, v165
MM v[136:139],a[216:219],a[168:171],v[136:139]
ds_read_b128 a[252:255], v3 offset:15360
s_cmp_eq_u32 s30, 2
s_cselect_b32 s67, s65, 0
s_cmp_lt_u32 s30, 2
s_cselect_b32 s68, s65, 0
v_add_f32 v6, s68, v28
v_fma_f32 v148, v12, s67, v6
v_fma_f32 v149, v13, s67, v6
v_fma_f32 v150, v14, s67, v6
v_fma_f32 v151, v15, s67, v6
MM v[136:139],a[220:223],a[172:175],v[136:139]
buffer_load_dwordx4 v2, s[32:35], s57 offen offset:1024 sc1 lds
v_exp_f32 v50, v166
MM v[140:143],a[220:223],a[188:191],v[140:143]
ds_read_b128 a[192:195], v4 offset:0
CV v242,v52,v53
MM v[140:143],a[216:219],a[184:187],v[140:143]
buffer_load_dwordx4 v2, s[32:35], s57 offen offset:2048 sc1 lds
v_exp_f32 v51, v167
MM v[140:143],a[212:215],a[180:183],v[140:143]
ds_read_b128 a[196:199], v4 offset:8192
buffer_load_dwordx4 v2, s[32:35], s57 offen offset:3072 sc1 lds
MM v[140:143],a[208:211],a[176:179],v[140:143]
s_waitcnt lgkmcnt(6)
v_exp_f32 v52, v172
MM v[144:147],a[224:227],a[160:163],v[24:27]
ds_read_b128 a[200:203], v4 offset:1024
CV v243,v54,v55
MM v[144:147],a[228:231],a[164:167],v[144:147]
v_exp_f32 v53, v173
MM v[40:43],v[56:59],v[240:243],0
v_exp_f32 v54, v174
MM v[144:147],a[232:235],a[168:171],v[144:147]
ds_read_b128 a[204:207], v4 offset:9216
CV v248,v48,v49
MM v[144:147],a[236:239],a[172:175],v[144:147]
s_cmp_eq_u32 s30, 3
s_cselect_b32 s67, s65, 0
s_cmp_lt_u32 s30, 3
s_cselect_b32 s68, s65, 0
v_add_f32 v6, s68, v28
v_fma_f32 v156, v12, s67, v6
v_fma_f32 v157, v13, s67, v6
v_fma_f32 v158, v14, s67, v6
v_fma_f32 v159, v15, s67, v6
v_exp_f32 v55, v175
MM v[148:151],a[236:239],a[188:191],v[148:151]
ds_read_b128 a[208:211], v4 offset:2048
CV v249,v50,v51
MM v[148:151],a[232:235],a[184:187],v[148:151]
v_exp_f32 v48, v176
MM v[148:151],a[228:231],a[180:183],v[148:151]
ds_read_b128 a[212:215], v4 offset:10240
s_waitcnt lgkmcnt(6)
MM v[148:151],a[224:227],a[176:179],v[148:151]
v_exp_f32 v49, v177
MM v[152:155],a[240:243],a[160:163],v[24:27]
ds_read_b128 a[216:219], v4 offset:3072
CV v250,v52,v53
MM v[152:155],a[244:247],a[164:167],v[152:155]
v_exp_f32 v50, v178
MM v[152:155],a[248:251],a[168:171],v[152:155]
ds_read_b128 a[220:223], v4 offset:11264
CV v251,v54,v55
MM v[152:155],a[252:255],a[172:175],v[152:155]
v_exp_f32 v51, v179
MM v[44:47],v[56:59],v[248:251],0
v_exp_f32 v52, v184
MM v[156:159],a[252:255],a[188:191],v[156:159]
ds_read_b128 a[224:227], v4 offset:4096
CV v244,v48,v49
MM v[156:159],a[248:251],a[184:187],v[156:159]
v_exp_f32 v53, v185
MM v[156:159],a[244:247],a[180:183],v[156:159]
ds_read_b128 a[228:231], v4 offset:12288
s_waitcnt lgkmcnt(6)
MM v[156:159],a[240:243],a[176:179],v[156:159]
v_exp_f32 v54, v186
MM a[64:67],a[192:195],v[224:227],a[64:67]
ds_read_b128 a[232:235], v4 offset:5120
CV v245,v50,v51
MM a[64:67],a[196:199],v[228:231],a[64:67]
v_exp_f32 v55, v187
MM a[68:71],a[196:199],v[236:239],a[68:71]
v_exp_f32 v48, v180
MM a[68:71],a[192:195],v[232:235],a[68:71]
v_exp_f32 v49, v181
MM a[0:3],a[192:195],v[192:195],a[0:3]
ds_read_b128 a[236:239], v4 offset:13312
CV v246,v52,v53
MM a[0:3],a[196:199],v[196:199],a[0:3]
v_exp_f32 v50, v182
MM a[4:7],a[196:199],v[204:207],a[4:7]
v_exp_f32 v51, v183
MM a[4:7],a[192:195],v[200:203],a[4:7]
v_exp_f32 v52, v188
MM a[72:75],a[200:203],v[224:227],a[72:75]
ds_read_b128 a[240:243], v4 offset:6144
CV v247,v54,v55
MM a[72:75],a[204:207],v[228:231],a[72:75]
v_exp_f32 v53, v189
MM a[76:79],a[204:207],v[236:239],a[76:79]
v_exp_f32 v54, v190
MM a[76:79],a[200:203],v[232:235],a[76:79]
v_exp_f32 v55, v191
MM v[40:43],v[56:59],v[244:247],v[40:43]
CV v252,v48,v49
CV v253,v50,v51
MM a[8:11],a[200:203],v[192:195],a[8:11]
ds_read_b128 a[244:247], v4 offset:14336
s_waitcnt lgkmcnt(6)
MM a[8:11],a[204:207],v[196:199],a[8:11]
v_exp_f32 v48, v96
MM a[12:15],a[204:207],v[204:207],a[12:15]
v_exp_f32 v49, v97
MM a[12:15],a[200:203],v[200:203],a[12:15]
v_exp_f32 v50, v98
MM a[80:83],a[208:211],v[224:227],a[80:83]
ds_read_b128 a[248:251], v4 offset:7168
CV v254,v52,v53
MM a[80:83],a[212:215],v[228:231],a[80:83]
v_exp_f32 v51, v99
MM a[84:87],a[212:215],v[236:239],a[84:87]
v_exp_f32 v52, v104
MM a[84:87],a[208:211],v[232:235],a[84:87]
s_waitcnt vmcnt(4)
v_exp_f32 v53, v105
MM a[16:19],a[208:211],v[192:195],a[16:19]
ds_read_b128 a[252:255], v4 offset:15360
CV v255,v54,v55
MM a[16:19],a[212:215],v[196:199],a[16:19]
v_exp_f32 v54, v106
MM a[20:23],a[212:215],v[204:207],a[20:23]
v_exp_f32 v55, v107
MM a[20:23],a[208:211],v[200:203],a[20:23]
s_barrier
CV v208,v48,v49
MM v[44:47],v[56:59],v[252:255],v[44:47]
v_exp_f32 v48, v112
MM a[88:91],a[216:219],v[224:227],a[88:91]
ds_read_b128 a[192:195], v3 offset:16384
CV v209,v50,v51
MM a[88:91],a[220:223],v[228:231],a[88:91]
v_exp_f32 v49, v113
MM a[92:95],a[220:223],v[236:239],a[92:95]
v_exp_f32 v50, v114
MM a[92:95],a[216:219],v[232:235],a[92:95]
v_exp_f32 v51, v115
MM a[24:27],a[216:219],v[192:195],a[24:27]
ds_read_b128 a[196:199], v3 offset:17408
CV v210,v52,v53
MM a[24:27],a[220:223],v[196:199],a[24:27]
v_exp_f32 v52, v120
MM a[28:31],a[220:223],v[204:207],a[28:31]
v_exp_f32 v53, v121
MM a[28:31],a[216:219],v[200:203],a[28:31]
s_waitcnt lgkmcnt(6)
CV v211,v54,v55
MM a[96:99],a[224:227],v[224:227],a[96:99]
ds_read_b128 a[200:203], v3 offset:18432
CV v212,v48,v49
MM a[96:99],a[228:231],v[228:231],a[96:99]
v_exp_f32 v54, v122
MM a[100:103],a[228:231],v[236:239],a[100:103]
v_exp_f32 v55, v123
MM a[100:103],a[224:227],v[232:235],a[100:103]
CV v213,v50,v51
CV v214,v52,v53
MM v[32:35],v[56:59],v[208:211],0
CV v215,v54,v55
MM a[32:35],a[224:227],v[192:195],a[32:35]
ds_read_b128 a[204:207], v3 offset:19456
MM a[32:35],a[228:231],v[196:199],a[32:35]
v_exp_f32 v48, v128
MM a[36:39],a[228:231],v[204:207],a[36:39]
v_exp_f32 v49, v129
MM a[36:39],a[224:227],v[200:203],a[36:39]
v_exp_f32 v50, v130
MM v[32:35],v[56:59],v[212:215],v[32:35]
v_exp_f32 v51, v131
MM a[104:107],a[232:235],v[224:227],a[104:107]
ds_read_b128 a[208:211], v3 offset:20480
MM a[104:107],a[236:239],v[228:231],a[104:107]
v_exp_f32 v52, v136
MM a[108:111],a[236:239],v[236:239],a[108:111]
v_exp_f32 v53, v137
MM a[108:111],a[232:235],v[232:235],a[108:111]
MM a[40:43],a[232:235],v[192:195],a[40:43]
ds_read_b128 a[212:215], v3 offset:21504
s_waitcnt lgkmcnt(6)
MM a[40:43],a[236:239],v[196:199],a[40:43]
v_max3_f32 v5, v40, v44, v32
v_cmp_lt_f32 vcc, s64, v5
MM a[44:47],a[236:239],v[204:207],a[44:47]
MM a[44:47],a[232:235],v[200:203],a[44:47]
MM a[112:115],a[240:243],v[224:227],a[112:115]
ds_read_b128 a[216:219], v3 offset:22528
MM a[112:115],a[244:247],v[228:231],a[112:115]
MM a[116:119],a[244:247],v[236:239],a[116:119]
MM a[116:119],a[240:243],v[232:235],a[116:119]
MM a[48:51],a[240:243],v[192:195],a[48:51]
ds_read_b128 a[220:223], v3 offset:23552
MM a[48:51],a[244:247],v[196:199],a[48:51]
MM a[52:55],a[244:247],v[204:207],a[52:55]
MM a[52:55],a[240:243],v[200:203],a[52:55]
MM a[120:123],a[248:251],v[224:227],a[120:123]
ds_read_b128 a[224:227], v3 offset:24576
MM a[120:123],a[252:255],v[228:231],a[120:123]
MM a[124:127],a[252:255],v[236:239],a[124:127]
MM a[124:127],a[248:251],v[232:235],a[124:127]
MM a[56:59],a[248:251],v[192:195],a[56:59]
ds_read_b128 a[228:231], v3 offset:25600
s_waitcnt lgkmcnt(6)
MM a[56:59],a[252:255],v[196:199],a[56:59]
MM a[60:63],a[252:255],v[204:207],a[60:63]
MM a[60:63],a[248:251],v[200:203],a[60:63]
s_cbranch_vccnz L_rs_29
L_rb_30:
s_cmp_eq_u32 s66, 0
s_cselect_b32 s67, s65, 0
v_fma_f32 v160, v12, s67, v24
v_fma_f32 v161, v13, s67, v24
v_fma_f32 v162, v14, s67, v24
v_fma_f32 v163, v15, s67, v24
s_nop 1
MM v[160:163],a[192:195],a[160:163],v[160:163]
ds_read_b128 a[232:235], v3 offset:26624
v_add_f32 v10, v10, v40
v_add_f32 v11, v11, v44
v_add_f32 v8, v8, v32
MM v[160:163],a[196:199],a[164:167],v[160:163]
ds_read_b128 a[236:239], v3 offset:27648
s_cmp_eq_u32 s66, 1
s_cselect_b32 s67, s65, 0
s_cmp_lt_u32 s66, 1
s_cselect_b32 s68, s65, 0
v_add_f32 v6, s68, v24
v_fma_f32 v168, v12, s67, v6
v_fma_f32 v169, v13, s67, v6
v_fma_f32 v170, v14, s67, v6
v_fma_f32 v171, v15, s67, v6
s_sub_u32 m0, s61, s59
MM v[160:163],a[200:203],a[168:171],v[160:163]
ds_read_b128 a[240:243], v3 offset:28672
CV v224,v48,v49
MM v[160:163],a[204:207],a[172:175],v[160:163]
ds_read_b128 a[244:247], v3 offset:29696
buffer_load_dwordx4 v2, s[32:35], s58 offen offset:0 sc1 lds
s_waitcnt lgkmcnt(6)
MM v[168:171],a[208:211],a[160:163],v[168:171]
ds_read_b128 a[248:251], v3 offset:30720
s_cmp_eq_u32 s66, 2
s_cselect_b32 s67, s65, 0
s_cmp_lt_u32 s66, 2
s_cselect_b32 s68, s65, 0
v_add_f32 v6, s68, v24
v_fma_f32 v176, v12, s67, v6
v_fma_f32 v177, v13, s67, v6
v_fma_f32 v178, v14, s67, v6
v_fma_f32 v179, v15, s67, v6
MM v[168:171],a[212:215],a[164:167],v[168:171]
ds_read_b128 a[252:255], v3 offset:31744
buffer_load_dwordx4 v2, s[32:35], s58 offen offset:1024 sc1 lds
MM v[168:171],a[216:219],a[168:171],v[168:171]
ds_read_b128 a[192:195], v4 offset:16384
buffer_load_dwordx4 v2, s[32:35], s58 offen offset:2048 sc1 lds
MM v[168:171],a[220:223],a[172:175],v[168:171]
ds_read_b128 a[196:199], v4 offset:24576
buffer_load_dwordx4 v2, s[32:35], s58 offen offset:3072 sc1 lds
s_waitcnt lgkmcnt(6)
MM v[176:179],a[224:227],a[160:163],v[176:179]
ds_read_b128 a[200:203], v4 offset:17408
s_cmp_eq_u32 s66, 3
s_cselect_b32 s67, s65, 0
s_cmp_lt_u32 s66, 3
s_cselect_b32 s68, s65, 0
v_add_f32 v6, s68, v24
v_fma_f32 v184, v12, s67, v6
v_fma_f32 v185, v13, s67, v6
v_fma_f32 v186, v14, s67, v6
v_fma_f32 v187, v15, s67, v6
MM v[176:179],a[228:231],a[164:167],v[176:179]
ds_read_b128 a[204:207], v4 offset:25600
v_xor_b32 v3, 32768, v3
MM v[176:179],a[232:235],a[168:171],v[176:179]
ds_read_b128 a[208:211], v4 offset:18432
s_lshr_b32 s67, s2, 3
MM v[176:179],a[236:239],a[172:175],v[176:179]
ds_read_b128 a[212:215], v4 offset:26624
s_waitcnt lgkmcnt(6)
MM v[184:187],a[240:243],a[160:163],v[184:187]
ds_read_b128 a[216:219], v4 offset:19456
s_cmp_lt_u32 s67, 30
s_cselect_b32 s74, 1, 0
MM v[184:187],a[244:247],a[164:167],v[184:187]
ds_read_b128 a[220:223], v4 offset:27648
s_xor_b32 s59, s59, 32768
MM v[184:187],a[248:251],a[168:171],v[184:187]
ds_read_b128 a[224:227], v4 offset:20480
s_min_u32 s67, s67, 29
MM v[184:187],a[252:255],a[172:175],v[184:187]
ds_read_b128 a[228:231], v4 offset:28672
s_waitcnt lgkmcnt(6)
MM a[64:67],a[192:195],v[240:243],a[64:67]
ds_read_b128 a[232:235], v4 offset:21504
s_mul_i32 s68, s67, 205
MM a[64:67],a[196:199],v[244:247],a[64:67]
v_exp_f32 v54, v138
MM a[68:71],a[196:199],v[252:255],a[68:71]
v_exp_f32 v55, v139
MM a[68:71],a[192:195],v[248:251],a[68:71]
ds_read_b128 a[236:239], v4 offset:29696
CV v225,v50,v51
MM a[0:3],a[192:195],v[208:211],a[0:3]
v_exp_f32 v48, v132
MM a[0:3],a[196:199],v[212:215],a[0:3]
v_exp_f32 v49, v133
MM a[72:75],a[200:203],v[240:243],a[72:75]
ds_read_b128 a[240:243], v4 offset:22528
CV v226,v52,v53
MM a[72:75],a[204:207],v[244:247],a[72:75]
v_exp_f32 v50, v134
MM a[76:79],a[204:207],v[252:255],a[76:79]
v_exp_f32 v51, v135
MM a[76:79],a[200:203],v[248:251],a[76:79]
ds_read_b128 a[244:247], v4 offset:30720
s_waitcnt lgkmcnt(6)
MM a[8:11],a[200:203],v[208:211],a[8:11]
v_exp_f32 v52, v140
MM a[8:11],a[204:207],v[212:215],a[8:11]
v_exp_f32 v53, v141
MM a[80:83],a[208:211],v[240:243],a[80:83]
ds_read_b128 a[248:251], v4 offset:23552
CV v227,v54,v55
MM a[80:83],a[212:215],v[244:247],a[80:83]
v_exp_f32 v54, v142
MM a[84:87],a[212:215],v[252:255],a[84:87]
v_exp_f32 v55, v143
MM v[40:43],v[56:59],v[224:227],0
s_waitcnt vmcnt(4)
CV v232,v48,v49
MM a[84:87],a[208:211],v[248:251],a[84:87]
ds_read_b128 a[252:255], v4 offset:31744
v_xor_b32 v4, 32768, v4
MM a[16:19],a[208:211],v[208:211],a[16:19]
v_exp_f32 v48, v144
MM a[16:19],a[212:215],v[212:215],a[16:19]
s_barrier
v_exp_f32 v49, v145
MM a[88:91],a[216:219],v[240:243],a[88:91]
ds_read_b128 a[192:195], v4 offset:0
CV v233,v50,v51
MM a[88:91],a[220:223],v[244:247],a[88:91]
v_exp_f32 v50, v146
MM a[92:95],a[220:223],v[252:255],a[92:95]
v_exp_f32 v51, v147
MM a[92:95],a[216:219],v[248:251],a[92:95]
ds_read_b128 a[196:199], v4 offset:8192
CV v234,v52,v53
MM a[24:27],a[216:219],v[208:211],a[24:27]
v_exp_f32 v52, v152
MM a[24:27],a[220:223],v[212:215],a[24:27]
s_waitcnt lgkmcnt(6)
v_exp_f32 v53, v153
MM a[96:99],a[224:227],v[240:243],a[96:99]
ds_read_b128 a[200:203], v4 offset:1024
CV v235,v54,v55
MM a[96:99],a[228:231],v[244:247],a[96:99]
v_exp_f32 v54, v154
MM a[100:103],a[228:231],v[252:255],a[100:103]
v_exp_f32 v55, v155
MM v[44:47],v[56:59],v[232:235],0
CV v228,v48,v49
CV v229,v50,v51
MM a[100:103],a[224:227],v[248:251],a[100:103]
ds_read_b128 a[204:207], v4 offset:9216
s_lshr_b32 s68, s68, 10
MM a[32:35],a[224:227],v[208:211],a[32:35]
v_exp_f32 v48, v148
MM a[32:35],a[228:231],v[212:215],a[32:35]
v_exp_f32 v49, v149
MM a[104:107],a[232:235],v[240:243],a[104:107]
ds_read_b128 a[208:211], v4 offset:2048
CV v230,v52,v53
MM a[104:107],a[236:239],v[244:247],a[104:107]
v_exp_f32 v50, v150
MM a[108:111],a[236:239],v[252:255],a[108:111]
v_exp_f32 v51, v151
MM a[108:111],a[232:235],v[248:251],a[108:111]
ds_read_b128 a[212:215], v4 offset:10240
s_waitcnt lgkmcnt(6)
MM a[40:43],a[232:235],v[208:211],a[40:43]
v_exp_f32 v52, v156
MM a[40:43],a[236:239],v[212:215],a[40:43]
v_exp_f32 v53, v157
MM a[112:115],a[240:243],v[240:243],a[112:115]
ds_read_b128 a[216:219], v4 offset:3072
CV v231,v54,v55
MM a[112:115],a[244:247],v[244:247],a[112:115]
v_exp_f32 v54, v158
MM a[116:119],a[244:247],v[252:255],a[116:119]
v_exp_f32 v55, v159
MM v[40:43],v[56:59],v[228:231],v[40:43]
CV v236,v48,v49
CV v237,v50,v51
MM a[116:119],a[240:243],v[248:251],a[116:119]
ds_read_b128 a[220:223], v4 offset:11264
CV v238,v52,v53
MM a[48:51],a[240:243],v[208:211],a[48:51]
s_mul_i32 s69, s68, 5
CV v239,v54,v55
MM a[48:51],a[244:247],v[212:215],a[48:51]
v_exp_f32 v48, v160
MM v[44:47],v[56:59],v[236:239],v[44:47]
v_exp_f32 v49, v161
MM a[120:123],a[248:251],v[240:243],a[120:123]
ds_read_b128 a[224:227], v4 offset:4096
s_sub_u32 s10, s67, s69
MM a[120:123],a[252:255],v[244:247],a[120:123]
v_exp_f32 v50, v162
MM a[124:127],a[252:255],v[252:255],a[124:127]
v_exp_f32 v51, v163
MM a[124:127],a[248:251],v[248:251],a[124:127]
ds_read_b128 a[228:231], v4 offset:12288
s_waitcnt lgkmcnt(6)
MM a[56:59],a[248:251],v[208:211],a[56:59]
v_exp_f32 v52, v168
MM a[56:59],a[252:255],v[212:215],a[56:59]
s_and_b32 s69, s2, 7
s_lshl_b32 s69, s69, 2
s_lshr_b32 s69, 0x07362514, s69
s_and_b32 s69, s69, 7
s_mul_i32 s69, s69, 6
s_add_u32 s69, s69, s68
s_lshr_b32 s8, s69, 4
s_and_b32 s9, s69, 15
s_mov_b32 s52, s4
s_mov_b32 s53, s5
s_mov_b32 s54, 0x280000
s_mov_b32 s55, 0x00020000
s_mov_b32 s4, s24
s_mov_b32 s5, s25
s_mov_b32 s6, 0x280000
s_mov_b32 s7, 0x00020000
s_add_u32 s70, s8, 2
s_cmp_eq_u32 s8, 0
s_cselect_b32 s71, 0, 3
s_sub_u32 s70, s70, s71
s_cmp_eq_u32 s8, 0
s_cselect_b32 s71, 40, 44
s_mul_i32 s71, s71, s74
s_mul_i32 s67, s8, 147456
s_add_u32 s67, s67, 0x6000000
s_mul_i32 s68, s9, 442368
s_add_u32 s67, s67, s68
s_add_u32 s36, s28, s67
s_addc_u32 s37, s29, 0
s_mul_i32 s38, s74, 147456
s_mul_i32 s67, s70, 360448
s_add_u32 s67, s67, 0x4000000
s_lshl_b32 s68, s9, 20
s_add_u32 s67, s67, s68
s_add_u32 s40, s28, s67
s_addc_u32 s41, s29, 0
s_lshl_b32 s42, s71, 13
s_mul_i32 s67, s8, 737280
s_add_u32 s44, s22, s67
s_addc_u32 s45, s23, 0
s_mul_i32 s46, s74, 737280
s_mul_i32 s67, s70, 1802240
s_add_u32 s48, s14, s67
s_addc_u32 s49, s15, 0
s_mul_i32 s50, s71, 40960
s_mov_b32 s39, 0x00020000
s_mov_b32 s43, 0x00020000
s_mov_b32 s47, 0x00020000
s_mov_b32 s51, 0x00020000
s_cmp_eq_u32 s8, 2
s_cselect_b32 s18, 1, 0
s_lshl_b32 s11, s9, 2
s_add_u32 s11, s11, s30
s_lshl_b32 s67, s11, 1
s_add_u32 s67, s67, s18
s_mul_i32 s13, s67, 20480
s_lshl_b32 s68, s10, 8
s_add_u32 s13, s13, s68
s_lshl_b32 s11, s30, 11
s_mov_b32 s26, s11
s_lshl_b32 s67, s18, 10
v_add_u32 v16, s67, v1
v_xor_b32 v17, 1024, v16
s_mul_i32 s12, s30, 20480
s_add_u32 s12, s12, s68
s_mov_b32 s27, s12
v_lshrrev_b32 v69, 3, v0
v_mul_u32_u24 v69, 1280, v69
v_bfe_u32 v70, v0, 1, 2
v_bfe_u32 v71, v0, 4, 2
v_xor_b32 v70, v70, v71
v_lshl_add_u32 v69, v70, 5, v69
v_and_b32 v70, 1, v0
v_lshl_add_u32 v18, v70, 4, v69
v_add_u32 v19, 9216, v18
v_lshrrev_b32 v69, 2, v0
v_lshlrev_b32 v69, 7, v69
v_and_b32 v70, 3, v0
v_lshl_add_u32 v69, v70, 3, v69
v_bfe_u32 v70, v0, 3, 2
v_xor_b32 v71, 0, v70
v_lshl_add_u32 v32, v71, 5, v69
v_add_u32 v36, 65536, v32
v_xor_b32 v71, 1, v70
v_lshl_add_u32 v33, v71, 5, v69
v_add_u32 v37, 65536, v33
v_xor_b32 v71, 2, v70
v_lshl_add_u32 v34, v71, 5, v69
v_add_u32 v38, 65536, v34
v_xor_b32 v71, 3, v70
v_lshl_add_u32 v35, v71, 5, v69
v_add_u32 v39, 65536, v35
v_lshrrev_b32 v69, 4, v0
v_mul_u32_u24 v69, 5120, v69
v_and_b32 v70, 15, v0
v_lshl_add_u32 v20, v70, 4, v69
v_and_b32 v200, 0x1f0, v1
s_mul_i32 s67, s30, 4608
v_and_b32 v69, 15, v0
v_mul_u32_u24 v69, 272, v69
v_lshrrev_b32 v70, 4, v0
v_lshl_add_u32 v69, v70, 3, v69
v_add_u32 v21, s67, v69
v_mul_u32_u24 v70, 1088, v70
v_and_b32 v69, 15, v0
v_lshl_add_u32 v69, v69, 4, v70
v_add_u32 v23, s67, v69
s_sub_u32 s67, 15, s9
s_min_u32 s67, s67, s9
s_lshl_b32 s79, s67, 9
s_add_u32 s79, s79, 0x7001000
s_lshl_b32 s76, s9, 9
s_add_u32 s76, s76, 0x7002000
s_mul_i32 s67, s9, 5
s_add_u32 s67, s67, s10
s_lshl_b32 s68, s67, 2
s_add_u32 s68, s68, s30
s_lshl_b32 s75, s68, 10
s_add_u32 s75, s75, 0x7010000
s_lshl_b32 s68, s68, 16
s_add_u32 s68, s68, 0x8000000
s_add_u32 s67, s8, 1
s_lshl_b32 s67, s67, 13
s_add_u32 s16, s68, s67
s_cmp_eq_u32 s8, 0
s_cselect_b32 s17, s68, 0x20000000
s_cmp_eq_u32 s74, 0
s_cselect_b32 s17, 0x20000000, s17
s_cselect_b32 s16, 0x20000000, s16
s_lshl_b32 s67, s18, 13
s_add_u32 s21, s68, s67
s_sub_u32 s67, 3, s18
s_lshl_b32 s67, s67, 13
s_add_u32 s62, s68, s67
s_cmp_eq_u32 s8, 0
s_cselect_b32 s21, 0x20000000, s21
s_cselect_b32 s62, 0x20000000, s62
s_lshl_b32 s56, s8, 7
s_add_u32 s56, s56, s75
s_sub_u32 s67, 3, s8
s_cmp_eq_u32 s8, 0
s_cselect_b32 s67, 0, s67
s_lshl_b32 s67, s67, 7
v_and_b32 v22, 1, v0
v_mul_u32_u24 v22, s67, v22
s_lshl_b32 s19, s30, 11
v_add_u32 v196, 131072, v32
v_add_u32 v197, 131072, v33
v_add_u32 v198, 131072, v34
v_add_u32 v199, 131072, v35
buffer_load_dwordx4 v[192:195], v200, s[32:35], s79 offen sc0 sc1
v_exp_f32 v53, v169
v_max_f32 v5, v40, v44
v_cmp_lt_f32 vcc, s64, v5
s_cbranch_vccnz L_rs_31
L_rb_32:
s_lshl_b32 s70, s72, 17
s_lshl_b32 s71, s31, 15
s_add_u32 s70, s70, s71
s_add_u32 s70, s70, 0x4000000
s_lshl_b32 s68, s30, 10
s_sub_u32 s67, s70, s68
s_add_u32 s67, s67, 7168
s_add_u32 s68, s70, s68
v_rcp_f32 v5, v8
v_rcp_f32 v6, v9
AR v64,a0
AR v65,a1
AR v66,a2
AR v67,a3
AR v68,a8
AR v69,a9
AR v70,a10
AR v71,a11
v_mul_f32 v64, v64, v5
v_mul_f32 v65, v65, v5
v_mul_f32 v66, v66, v5
v_mul_f32 v67, v67, v5
v_mul_f32 v68, v68, v5
v_mul_f32 v69, v69, v5
v_mul_f32 v70, v70, v5
v_mul_f32 v71, v71, v5
CV v72,v64,v65
CV v73,v66,v67
CV v74,v68,v69
CV v75,v70,v71
s_add_u32 s71, s67, 0
buffer_store_dwordx4 v[72:75], v1, s[32:35], s71 offen sc0 sc1
AR v80,a4
AR v81,a5
AR v82,a6
AR v83,a7
AR v84,a12
AR v85,a13
AR v86,a14
AR v87,a15
v_mul_f32 v80, v80, v6
v_mul_f32 v81, v81, v6
v_mul_f32 v82, v82, v6
v_mul_f32 v83, v83, v6
v_mul_f32 v84, v84, v6
v_mul_f32 v85, v85, v6
v_mul_f32 v86, v86, v6
v_mul_f32 v87, v87, v6
CV v88,v80,v81
CV v89,v82,v83
CV v90,v84,v85
CV v91,v86,v87
s_add_u32 s71, s68, 0
buffer_store_dwordx4 v[88:91], v1, s[32:35], s71 offen sc0 sc1
AR v96,a16
AR v97,a17
AR v98,a18
AR v99,a19
AR v100,a24
AR v101,a25
AR v102,a26
AR v103,a27
v_mul_f32 v96, v96, v5
v_mul_f32 v97, v97, v5
v_mul_f32 v98, v98, v5
v_mul_f32 v99, v99, v5
v_mul_f32 v100, v100, v5
v_mul_f32 v101, v101, v5
v_mul_f32 v102, v102, v5
v_mul_f32 v103, v103, v5
CV v104,v96,v97
CV v105,v98,v99
CV v106,v100,v101
CV v107,v102,v103
s_add_u32 s71, s67, 8192
buffer_store_dwordx4 v[104:107], v1, s[32:35], s71 offen sc0 sc1
AR v112,a20
AR v113,a21
AR v114,a22
AR v115,a23
AR v116,a28
AR v117,a29
AR v118,a30
AR v119,a31
v_mul_f32 v112, v112, v6
v_mul_f32 v113, v113, v6
v_mul_f32 v114, v114, v6
v_mul_f32 v115, v115, v6
v_mul_f32 v116, v116, v6
v_mul_f32 v117, v117, v6
v_mul_f32 v118, v118, v6
v_mul_f32 v119, v119, v6
CV v120,v112,v113
CV v121,v114,v115
CV v122,v116,v117
CV v123,v118,v119
s_add_u32 s71, s68, 8192
buffer_store_dwordx4 v[120:123], v1, s[32:35], s71 offen sc0 sc1
AR v64,a32
AR v65,a33
AR v66,a34
AR v67,a35
AR v68,a40
AR v69,a41
AR v70,a42
AR v71,a43
v_mul_f32 v64, v64, v5
v_mul_f32 v65, v65, v5
v_mul_f32 v66, v66, v5
v_mul_f32 v67, v67, v5
v_mul_f32 v68, v68, v5
v_mul_f32 v69, v69, v5
v_mul_f32 v70, v70, v5
v_mul_f32 v71, v71, v5
CV v72,v64,v65
CV v73,v66,v67
CV v74,v68,v69
CV v75,v70,v71
s_add_u32 s71, s67, 16384
buffer_store_dwordx4 v[72:75], v1, s[32:35], s71 offen sc0 sc1
AR v80,a36
AR v81,a37
AR v82,a38
AR v83,a39
AR v84,a44
AR v85,a45
AR v86,a46
AR v87,a47
v_mul_f32 v80, v80, v6
v_mul_f32 v81, v81, v6
v_mul_f32 v82, v82, v6
v_mul_f32 v83, v83, v6
v_mul_f32 v84, v84, v6
v_mul_f32 v85, v85, v6
v_mul_f32 v86, v86, v6
v_mul_f32 v87, v87, v6
CV v88,v80,v81
CV v89,v82,v83
CV v90,v84,v85
CV v91,v86,v87
s_add_u32 s71, s68, 16384
buffer_store_dwordx4 v[88:91], v1, s[32:35], s71 offen sc0 sc1
AR v96,a48
AR v97,a49
AR v98,a50
AR v99,a51
AR v100,a56
AR v101,a57
AR v102,a58
AR v103,a59
v_mul_f32 v96, v96, v5
v_mul_f32 v97, v97, v5
v_mul_f32 v98, v98, v5
v_mul_f32 v99, v99, v5
v_mul_f32 v100, v100, v5
v_mul_f32 v101, v101, v5
v_mul_f32 v102, v102, v5
v_mul_f32 v103, v103, v5
CV v104,v96,v97
CV v105,v98,v99
CV v106,v100,v101
CV v107,v102,v103
s_add_u32 s71, s67, 24576
buffer_store_dwordx4 v[104:107], v1, s[32:35], s71 offen sc0 sc1
AR v112,a52
AR v113,a53
AR v114,a54
AR v115,a55
AR v116,a60
AR v117,a61
AR v118,a62
AR v119,a63
v_mul_f32 v112, v112, v6
v_mul_f32 v113, v113, v6
v_mul_f32 v114, v114, v6
v_mul_f32 v115, v115, v6
v_mul_f32 v116, v116, v6
v_mul_f32 v117, v117, v6
v_mul_f32 v118, v118, v6
v_mul_f32 v119, v119, v6
CV v120,v112,v113
CV v121,v114,v115
CV v122,v116,v117
CV v123,v118,v119
s_add_u32 s71, s68, 24576
buffer_store_dwordx4 v[120:123], v1, s[32:35], s71 offen sc0 sc1
s_waitcnt vmcnt(8)
v_xor_b32 v192, v192, v61
v_xor_b32 v193, v193, v61
v_xor_b32 v194, v194, v61
v_xor_b32 v195, v195, v61
v_or3_b32 v192, v192, v193, v194
v_or_b32 v192, v192, v195
v_cmp_ne_u32 vcc, 0, v192
s_nop 1
s_cbranch_vccnz L_sl_33
L_ok_34:
s_add_u32 m0, s19, 131072
s_nop 0
buffer_load_dwordx4 v18, s[44:47], s12 offen offset:0 sc1 lds
buffer_load_dwordx4 v19, s[44:47], s12 offen offset:1024 sc1 lds
s_add_u32 m0, s19, 139264
s_add_u32 s20, s12, 128
buffer_load_dwordx4 v18, s[44:47], s20 offen offset:0 sc1 lds
buffer_load_dwordx4 v19, s[44:47], s20 offen offset:1024 sc1 lds
s_add_u32 s12, s12, 81920
buffer_load_dwordx4 a[0:3], v16, s[36:39], s11 offen sc1
buffer_load_dwordx4 a[4:7], v17, s[36:39], s11 offen sc1
s_add_u32 s11, s11, 8192
buffer_load_dwordx4 a[8:11], v16, s[36:39], s11 offen sc1
buffer_load_dwordx4 a[12:15], v17, s[36:39], s11 offen sc1
s_add_u32 s11, s11, 8192
buffer_load_dwordx4 a[16:19], v16, s[36:39], s11 offen sc1
buffer_load_dwordx4 a[20:23], v17, s[36:39], s11 offen sc1
s_add_u32 s11, s11, 8192
s_add_u32 m0, s19, 147456
s_nop 0
buffer_load_dwordx4 v18, s[44:47], s12 offen offset:0 sc1 lds
buffer_load_dwordx4 v19, s[44:47], s12 offen offset:1024 sc1 lds
s_add_u32 m0, s19, 155648
s_add_u32 s20, s12, 128
buffer_load_dwordx4 v18, s[44:47], s20 offen offset:0 sc1 lds
buffer_load_dwordx4 v19, s[44:47], s20 offen offset:1024 sc1 lds
s_add_u32 s12, s12, 81920
buffer_load_dwordx4 a[24:27], v16, s[36:39], s11 offen sc1
buffer_load_dwordx4 a[28:31], v17, s[36:39], s11 offen sc1
s_add_u32 s11, s11, 8192
buffer_load_dwordx4 a[32:35], v16, s[36:39], s11 offen sc1
buffer_load_dwordx4 a[36:39], v17, s[36:39], s11 offen sc1
s_add_u32 s11, s11, 8192
buffer_load_dwordx4 a[40:43], v16, s[36:39], s11 offen sc1
buffer_load_dwordx4 a[44:47], v17, s[36:39], s11 offen sc1
s_add_u32 s11, s11, 8192
buffer_load_dwordx4 a[48:51], v16, s[36:39], s11 offen sc1
buffer_load_dwordx4 a[52:55], v17, s[36:39], s11 offen sc1
s_add_u32 s11, s11, 8192
buffer_load_dwordx4 a[56:59], v16, s[36:39], s11 offen sc1
buffer_load_dwordx4 a[60:63], v17, s[36:39], s11 offen sc1
s_add_u32 s11, s11, 8192
L_tail2B:
MM a[64:67],a[192:195],v[224:227],a[64:67]
ds_read_b128 a[232:235], v4 offset:5120
v_add_f32 v10, v10, v40
MM a[64:67],a[196:199],v[228:231],a[64:67]
v_add_f32 v11, v11, v44
v_exp_f32 v54, v170
MM a[68:71],a[196:199],v[236:239],a[68:71]
ds_read_b128 a[236:239], v4 offset:13312
CV v240,v48,v49
MM a[68:71],a[192:195],v[232:235],a[68:71]
v_exp_f32 v55, v171
MM a[72:75],a[200:203],v[224:227],a[72:75]
ds_read_b128 a[240:243], v4 offset:6144
CV v241,v50,v51
MM a[72:75],a[204:207],v[228:231],a[72:75]
v_exp_f32 v48, v176
MM a[76:79],a[204:207],v[236:239],a[76:79]
ds_read_b128 a[244:247], v4 offset:14336
s_waitcnt lgkmcnt(6)
MM a[76:79],a[200:203],v[232:235],a[76:79]
v_exp_f32 v49, v177
MM a[80:83],a[208:211],v[224:227],a[80:83]
ds_read_b128 a[248:251], v4 offset:7168
s_waitcnt vmcnt(0)
MM a[80:83],a[212:215],v[228:231],a[80:83]
v_exp_f32 v50, v178
MM a[84:87],a[212:215],v[236:239],a[84:87]
ds_read_b128 a[252:255], v4 offset:15360
CV v242,v52,v53
MM a[84:87],a[208:211],v[232:235],a[84:87]
s_barrier
v_exp_f32 v51, v179
MM a[88:91],a[216:219],v[224:227],a[88:91]
ds_read_b128 a[192:195], v4 offset:16384
CV v243,v54,v55
MM a[88:91],a[220:223],v[228:231],a[88:91]
v_exp_f32 v52, v184
MM v[40:43],v[56:59],v[240:243],0
v_exp_f32 v53, v185
MM a[92:95],a[220:223],v[236:239],a[92:95]
ds_read_b128 a[196:199], v4 offset:24576
s_waitcnt lgkmcnt(6)
MM a[92:95],a[216:219],v[232:235],a[92:95]
v_exp_f32 v54, v186
MM a[96:99],a[224:227],v[224:227],a[96:99]
ds_read_b128 a[200:203], v4 offset:17408
CV v244,v48,v49
MM a[96:99],a[228:231],v[228:231],a[96:99]
v_exp_f32 v55, v187
MM a[100:103],a[228:231],v[236:239],a[100:103]
ds_read_b128 a[204:207], v4 offset:25600
CV v245,v50,v51
MM a[100:103],a[224:227],v[232:235],a[100:103]
CV v246,v52,v53
CV v247,v54,v55
MM a[104:107],a[232:235],v[224:227],a[104:107]
ds_read_b128 a[208:211], v4 offset:18432
buffer_store_dword v61, v60, s[32:35], s77 offen sc0 sc1
MM a[104:107],a[236:239],v[228:231],a[104:107]
s_add_u32 m0, s19, 0
s_nop 0
MM v[40:43],v[56:59],v[244:247],v[40:43]
buffer_load_dwordx4 v18, s[44:47], s12 offen offset:0 sc1 lds
buffer_load_dwordx4 v19, s[44:47], s12 offen offset:1024 sc1 lds
MM a[108:111],a[236:239],v[236:239],a[108:111]
ds_read_b128 a[212:215], v4 offset:26624
s_waitcnt lgkmcnt(6)
MM a[108:111],a[232:235],v[232:235],a[108:111]
s_add_u32 m0, s19, 8192
s_add_u32 s20, s12, 128
MM a[112:115],a[240:243],v[224:227],a[112:115]
ds_read_b128 a[216:219], v4 offset:19456
v_cmp_lt_f32 vcc, s64, v40
MM a[112:115],a[244:247],v[228:231],a[112:115]
buffer_load_dwordx4 v18, s[44:47], s20 offen offset:0 sc1 lds
buffer_load_dwordx4 v19, s[44:47], s20 offen offset:1024 sc1 lds
MM a[116:119],a[244:247],v[236:239],a[116:119]
ds_read_b128 a[220:223], v4 offset:27648
s_add_u32 s12, s12, 81920
MM a[116:119],a[240:243],v[232:235],a[116:119]
buffer_load_dwordx4 a[128:131], v16, s[36:39], s11 offen sc1
buffer_load_dwordx4 a[132:135], v17, s[36:39], s11 offen sc1
MM a[120:123],a[248:251],v[224:227],a[120:123]
ds_read_b128 a[224:227], v4 offset:20480
s_add_u32 s11, s11, 8192
MM a[120:123],a[252:255],v[228:231],a[120:123]
buffer_load_dwordx4 a[136:139], v16, s[36:39], s11 offen sc1
buffer_load_dwordx4 a[140:143], v17, s[36:39], s11 offen sc1
MM a[124:127],a[252:255],v[236:239],a[124:127]
ds_read_b128 a[228:231], v4 offset:28672
s_waitcnt lgkmcnt(6)
MM a[124:127],a[248:251],v[232:235],a[124:127]
s_add_u32 s11, s11, 8192
s_cbranch_vccnz L_rs_35
L_rb_36:
MM a[64:67],a[192:195],v[240:243],a[64:67]
ds_read_b128 a[232:235], v4 offset:21504
v_add_f32 v10, v10, v40
MM a[64:67],a[196:199],v[244:247],a[64:67]
ds_read_b128 a[236:239], v4 offset:29696
s_add_u32 m0, s19, 16384
MM a[72:75],a[200:203],v[240:243],a[72:75]
ds_read_b128 a[240:243], v4 offset:22528
s_nop 0
MM a[72:75],a[204:207],v[244:247],a[72:75]
ds_read_b128 a[244:247], v4 offset:30720
s_waitcnt lgkmcnt(6)
MM a[80:83],a[208:211],v[240:243],a[80:83]
ds_read_b128 a[248:251], v4 offset:23552
buffer_load_dwordx4 v18, s[44:47], s12 offen offset:0 sc1 lds
MM a[80:83],a[212:215],v[244:247],a[80:83]
ds_read_b128 a[252:255], v4 offset:31744
buffer_load_dwordx4 v19, s[44:47], s12 offen offset:1024 sc1 lds
MM a[88:91],a[216:219],v[240:243],a[88:91]
s_add_u32 m0, s19, 24576
v_xor_b32 v4, 32768, v4
MM a[88:91],a[220:223],v[244:247],a[88:91]
s_waitcnt lgkmcnt(4)
s_add_u32 s20, s12, 128
MM a[96:99],a[224:227],v[240:243],a[96:99]
buffer_load_dwordx4 v18, s[44:47], s20 offen offset:0 sc1 lds
buffer_load_dwordx4 v19, s[44:47], s20 offen offset:1024 sc1 lds
MM a[96:99],a[228:231],v[244:247],a[96:99]
s_add_u32 s12, s12, 81920
buffer_load_dwordx4 a[144:147], v16, s[36:39], s11 offen sc1
MM a[104:107],a[232:235],v[240:243],a[104:107]
buffer_load_dwordx4 a[148:151], v17, s[36:39], s11 offen sc1
MM a[104:107],a[236:239],v[244:247],a[104:107]
s_waitcnt lgkmcnt(0)
s_add_u32 s11, s11, 8192
MM a[112:115],a[240:243],v[240:243],a[112:115]
buffer_load_dwordx4 a[152:155], v16, s[36:39], s11 offen sc1
MM a[112:115],a[244:247],v[244:247],a[112:115]
s_xor_b32 s59, s59, 32768
buffer_load_dwordx4 a[156:159], v17, s[36:39], s11 offen sc1
MM a[120:123],a[248:251],v[240:243],a[120:123]
s_add_u32 s11, s11, 8192
MM a[120:123],a[252:255],v[244:247],a[120:123]
s_lshl_b32 s70, s73, 17
s_lshl_b32 s71, s31, 15
s_add_u32 s70, s70, s71
s_add_u32 s70, s70, 0x4000000
s_lshl_b32 s68, s30, 10
s_sub_u32 s67, s70, s68
s_add_u32 s67, s67, 7168
s_add_u32 s68, s70, s68
v_rcp_f32 v5, v10
v_rcp_f32 v6, v11
AR v128,a64
AR v129,a65
AR v130,a66
AR v131,a67
AR v132,a72
AR v133,a73
AR v134,a74
AR v135,a75
v_mul_f32 v128, v128, v5
v_mul_f32 v129, v129, v5
v_mul_f32 v130, v130, v5
v_mul_f32 v131, v131, v5
v_mul_f32 v132, v132, v5
v_mul_f32 v133, v133, v5
v_mul_f32 v134, v134, v5
v_mul_f32 v135, v135, v5
CV v136,v128,v129
CV v137,v130,v131
CV v138,v132,v133
CV v139,v134,v135
s_add_u32 s71, s67, 0
buffer_store_dwordx4 v[136:139], v1, s[32:35], s71 offen sc0 sc1
AR v144,a68
AR v145,a69
AR v146,a70
AR v147,a71
AR v148,a76
AR v149,a77
AR v150,a78
AR v151,a79
v_mul_f32 v144, v144, v6
v_mul_f32 v145, v145, v6
v_mul_f32 v146, v146, v6
v_mul_f32 v147, v147, v6
v_mul_f32 v148, v148, v6
v_mul_f32 v149, v149, v6
v_mul_f32 v150, v150, v6
v_mul_f32 v151, v151, v6
CV v152,v144,v145
CV v153,v146,v147
CV v154,v148,v149
CV v155,v150,v151
s_add_u32 s71, s68, 0
buffer_store_dwordx4 v[152:155], v1, s[32:35], s71 offen sc0 sc1
AR v160,a80
AR v161,a81
AR v162,a82
AR v163,a83
AR v164,a88
AR v165,a89
AR v166,a90
AR v167,a91
v_mul_f32 v160, v160, v5
v_mul_f32 v161, v161, v5
v_mul_f32 v162, v162, v5
v_mul_f32 v163, v163, v5
v_mul_f32 v164, v164, v5
v_mul_f32 v165, v165, v5
v_mul_f32 v166, v166, v5
v_mul_f32 v167, v167, v5
CV v168,v160,v161
CV v169,v162,v163
CV v170,v164,v165
CV v171,v166,v167
s_add_u32 s71, s67, 8192
buffer_store_dwordx4 v[168:171], v1, s[32:35], s71 offen sc0 sc1
AR v176,a84
AR v177,a85
AR v178,a86
AR v179,a87
AR v180,a92
AR v181,a93
AR v182,a94
AR v183,a95
v_mul_f32 v176, v176, v6
v_mul_f32 v177, v177, v6
v_mul_f32 v178, v178, v6
v_mul_f32 v179, v179, v6
v_mul_f32 v180, v180, v6
v_mul_f32 v181, v181, v6
v_mul_f32 v182, v182, v6
v_mul_f32 v183, v183, v6
CV v184,v176,v177
CV v185,v178,v179
CV v186,v180,v181
CV v187,v182,v183
s_add_u32 s71, s68, 8192
buffer_store_dwordx4 v[184:187], v1, s[32:35], s71 offen sc0 sc1
AR v128,a96
AR v129,a97
AR v130,a98
AR v131,a99
AR v132,a104
AR v133,a105
AR v134,a106
AR v135,a107
v_mul_f32 v128, v128, v5
v_mul_f32 v129, v129, v5
v_mul_f32 v130, v130, v5
v_mul_f32 v131, v131, v5
v_mul_f32 v132, v132, v5
v_mul_f32 v133, v133, v5
v_mul_f32 v134, v134, v5
v_mul_f32 v135, v135, v5
CV v136,v128,v129
CV v137,v130,v131
CV v138,v132,v133
CV v139,v134,v135
s_add_u32 s71, s67, 16384
buffer_store_dwordx4 v[136:139], v1, s[32:35], s71 offen sc0 sc1
AR v144,a100
AR v145,a101
AR v146,a102
AR v147,a103
AR v148,a108
AR v149,a109
AR v150,a110
AR v151,a111
v_mul_f32 v144, v144, v6
v_mul_f32 v145, v145, v6
v_mul_f32 v146, v146, v6
v_mul_f32 v147, v147, v6
v_mul_f32 v148, v148, v6
v_mul_f32 v149, v149, v6
v_mul_f32 v150, v150, v6
v_mul_f32 v151, v151, v6
CV v152,v144,v145
CV v153,v146,v147
CV v154,v148,v149
CV v155,v150,v151
s_add_u32 s71, s68, 16384
buffer_store_dwordx4 v[152:155], v1, s[32:35], s71 offen sc0 sc1
AR v160,a112
AR v161,a113
AR v162,a114
AR v163,a115
AR v164,a120
AR v165,a121
AR v166,a122
AR v167,a123
v_mul_f32 v160, v160, v5
v_mul_f32 v161, v161, v5
v_mul_f32 v162, v162, v5
v_mul_f32 v163, v163, v5
v_mul_f32 v164, v164, v5
v_mul_f32 v165, v165, v5
v_mul_f32 v166, v166, v5
v_mul_f32 v167, v167, v5
CV v168,v160,v161
CV v169,v162,v163
CV v170,v164,v165
CV v171,v166,v167
s_add_u32 s71, s67, 24576
buffer_store_dwordx4 v[168:171], v1, s[32:35], s71 offen sc0 sc1
AR v176,a116
AR v177,a117
AR v178,a118
AR v179,a119
AR v180,a124
AR v181,a125
AR v182,a126
AR v183,a127
v_mul_f32 v176, v176, v6
v_mul_f32 v177, v177, v6
v_mul_f32 v178, v178, v6
v_mul_f32 v179, v179, v6
v_mul_f32 v180, v180, v6
v_mul_f32 v181, v181, v6
v_mul_f32 v182, v182, v6
v_mul_f32 v183, v183, v6
CV v184,v176,v177
CV v185,v178,v179
CV v186,v180,v181
CV v187,v182,v183
s_add_u32 s71, s68, 24576
buffer_store_dwordx4 v[184:187], v1, s[32:35], s71 offen sc0 sc1
s_cmp_eq_u32 s74, 0
s_cbranch_scc1 L_notile
s_barrier
ds_read_b64_tr_b16 a[192:193], v196 offset:0
ds_read_b64_tr_b16 a[194:195], v196 offset:2048
ds_read_b64_tr_b16 a[196:197], v196 offset:4096
ds_read_b64_tr_b16 a[198:199], v196 offset:6144
ds_read_b64_tr_b16 a[200:201], v196 offset:16384
ds_read_b64_tr_b16 a[202:203], v196 offset:18432
ds_read_b64_tr_b16 a[204:205], v196 offset:20480
ds_read_b64_tr_b16 a[206:207], v196 offset:22528
ds_read_b64_tr_b16 a[208:209], v197 offset:0
ds_read_b64_tr_b16 a[210:211], v197 offset:2048
ds_read_b64_tr_b16 a[212:213], v197 offset:4096
ds_read_b64_tr_b16 a[214:215], v197 offset:6144
ds_read_b64_tr_b16 a[216:217], v197 offset:16384
ds_read_b64_tr_b16 a[218:219], v197 offset:18432
ds_read_b64_tr_b16 a[220:221], v197 offset:20480
ds_read_b64_tr_b16 a[222:223], v197 offset:22528
s_mov_b32 s64, 0xbfb8aa3b
s_mov_b32 s65, 0xffff0000
s_waitcnt vmcnt(63) lgkmcnt(8)
MM v[128:131],a[192:195],a[0:3],0
ds_read_b64_tr_b16 a[224:225], v198 offset:0
buffer_load_dwordx4 a[160:163], v16, s[36:39], s11 offen sc1
MM v[128:131],a[196:199],a[8:11],v[128:131]
ds_read_b64_tr_b16 a[226:227], v198 offset:2048
MM v[128:131],a[200:203],a[16:19],v[128:131]
ds_read_b64_tr_b16 a[228:229], v198 offset:4096
buffer_load_dwordx4 a[164:167], v17, s[36:39], s11 offen sc1
MM v[128:131],a[204:207],a[24:27],v[128:131]
ds_read_b64_tr_b16 a[230:231], v198 offset:6144
s_add_u32 s11, s11, 8192
MM v[160:163],a[204:207],a[28:31],0
ds_read_b64_tr_b16 a[232:233], v198 offset:16384
s_add_u32 m0, s19, 32768
MM v[160:163],a[200:203],a[20:23],v[160:163]
ds_read_b64_tr_b16 a[234:235], v198 offset:18432
MM v[160:163],a[196:199],a[12:15],v[160:163]
ds_read_b64_tr_b16 a[236:237], v198 offset:20480
buffer_load_dwordx4 v18, s[44:47], s12 offen offset:0 sc1 lds
MM v[160:163],a[192:195],a[4:7],v[160:163]
ds_read_b64_tr_b16 a[238:239], v198 offset:22528
s_waitcnt lgkmcnt(8)
MM v[132:135],a[208:211],a[0:3],0
ds_read_b64_tr_b16 a[240:241], v199 offset:0
buffer_load_dwordx4 v19, s[44:47], s12 offen offset:1024 sc1 lds
MM v[132:135],a[212:215],a[8:11],v[132:135]
ds_read_b64_tr_b16 a[242:243], v199 offset:2048
s_add_u32 m0, s19, 40960
MM v[132:135],a[216:219],a[16:19],v[132:135]
ds_read_b64_tr_b16 a[244:245], v199 offset:4096
s_add_u32 s20, s12, 128
MM v[132:135],a[220:223],a[24:27],v[132:135]
ds_read_b64_tr_b16 a[246:247], v199 offset:6144
MM v[164:167],a[220:223],a[28:31],0
ds_read_b64_tr_b16 a[248:249], v199 offset:16384
buffer_load_dwordx4 v18, s[44:47], s20 offen offset:0 sc1 lds
MM v[164:167],a[216:219],a[20:23],v[164:167]
ds_read_b64_tr_b16 a[250:251], v199 offset:18432
MM v[164:167],a[212:215],a[12:15],v[164:167]
ds_read_b64_tr_b16 a[252:253], v199 offset:20480
buffer_load_dwordx4 v19, s[44:47], s20 offen offset:1024 sc1 lds
MM v[164:167],a[208:211],a[4:7],v[164:167]
ds_read_b64_tr_b16 a[254:255], v199 offset:22528
s_add_u32 s12, s12, 81920
s_waitcnt vmcnt(6) lgkmcnt(8)
MM v[136:139],a[224:227],a[0:3],0
ds_read_b64_tr_b16 a[192:193], v196 offset:8192
buffer_load_dwordx4 a[168:171], v16, s[36:39], s11 offen sc1
MM v[136:139],a[228:231],a[8:11],v[136:139]
ds_read_b64_tr_b16 a[194:195], v196 offset:10240
MM v[136:139],a[232:235],a[16:19],v[136:139]
ds_read_b64_tr_b16 a[196:197], v196 offset:12288
buffer_load_dwordx4 a[172:175], v17, s[36:39], s11 offen sc1
MM v[136:139],a[236:239],a[24:27],v[136:139]
ds_read_b64_tr_b16 a[198:199], v196 offset:14336
s_add_u32 s11, s11, 8192
MM v[168:171],a[236:239],a[28:31],0
ds_read_b64_tr_b16 a[200:201], v196 offset:24576
buffer_store_dword v61, v60, s[32:35], s78 offen sc0 sc1
MM v[168:171],a[232:235],a[20:23],v[168:171]
ds_read_b64_tr_b16 a[202:203], v196 offset:26624
s_add_u32 m0, s19, 49152
MM v[168:171],a[228:231],a[12:15],v[168:171]
ds_read_b64_tr_b16 a[204:205], v196 offset:28672
buffer_load_dwordx4 v18, s[44:47], s12 offen offset:0 sc1 lds
MM v[168:171],a[224:227],a[4:7],v[168:171]
ds_read_b64_tr_b16 a[206:207], v196 offset:30720
s_waitcnt lgkmcnt(8)
MM v[140:143],a[240:243],a[0:3],0
ds_read_b64_tr_b16 a[208:209], v197 offset:8192
buffer_load_dwordx4 v19, s[44:47], s12 offen offset:1024 sc1 lds
MM v[140:143],a[244:247],a[8:11],v[140:143]
ds_read_b64_tr_b16 a[210:211], v197 offset:10240
s_add_u32 m0, s19, 57344
MM v[140:143],a[248:251],a[16:19],v[140:143]
ds_read_b64_tr_b16 a[212:213], v197 offset:12288
s_add_u32 s20, s12, 128
MM v[140:143],a[252:255],a[24:27],v[140:143]
ds_read_b64_tr_b16 a[214:215], v197 offset:14336
MM v[172:175],a[252:255],a[28:31],0
ds_read_b64_tr_b16 a[216:217], v197 offset:24576
buffer_load_dwordx4 v18, s[44:47], s20 offen offset:0 sc1 lds
MM v[172:175],a[248:251],a[20:23],v[172:175]
ds_read_b64_tr_b16 a[218:219], v197 offset:26624
MM v[172:175],a[244:247],a[12:15],v[172:175]
ds_read_b64_tr_b16 a[220:221], v197 offset:28672
buffer_load_dwordx4 v19, s[44:47], s20 offen offset:1024 sc1 lds
MM v[172:175],a[240:243],a[4:7],v[172:175]
ds_read_b64_tr_b16 a[222:223], v197 offset:30720
s_add_u32 s12, s12, 81920
s_waitcnt vmcnt(63) lgkmcnt(8)
MM v[144:147],a[192:195],a[0:3],0
ds_read_b64_tr_b16 a[224:225], v198 offset:8192
buffer_load_dwordx4 a[176:179], v16, s[36:39], s11 offen sc1
MM v[144:147],a[196:199],a[8:11],v[144:147]
ds_read_b64_tr_b16 a[226:227], v198 offset:10240
MM v[144:147],a[200:203],a[16:19],v[144:147]
ds_read_b64_tr_b16 a[228:229], v198 offset:12288
buffer_load_dwordx4 a[180:183], v17, s[36:39], s11 offen sc1
MM v[144:147],a[204:207],a[24:27],v[144:147]
ds_read_b64_tr_b16 a[230:231], v198 offset:14336
s_add_u32 s11, s11, 8192
MM v[176:179],a[204:207],a[28:31],0
ds_read_b64_tr_b16 a[232:233], v198 offset:24576
s_add_u32 m0, s19, 65536
MM v[176:179],a[200:203],a[20:23],v[176:179]
ds_read_b64_tr_b16 a[234:235], v198 offset:26624
MM v[176:179],a[196:199],a[12:15],v[176:179]
ds_read_b64_tr_b16 a[236:237], v198 offset:28672
buffer_load_dwordx4 v18, s[44:47], s12 offen offset:0 sc1 lds
MM v[176:179],a[192:195],a[4:7],v[176:179]
ds_read_b64_tr_b16 a[238:239], v198 offset:30720
s_waitcnt lgkmcnt(8)
MM v[148:151],a[208:211],a[0:3],0
ds_read_b64_tr_b16 a[240:241], v199 offset:8192
buffer_load_dwordx4 v19, s[44:47], s12 offen offset:1024 sc1 lds
MM v[148:151],a[212:215],a[8:11],v[148:151]
ds_read_b64_tr_b16 a[242:243], v199 offset:10240
s_add_u32 m0, s19, 73728
MM v[148:151],a[216:219],a[16:19],v[148:151]
ds_read_b64_tr_b16 a[244:245], v199 offset:12288
s_add_u32 s20, s12, 128
MM v[148:151],a[220:223],a[24:27],v[148:151]
ds_read_b64_tr_b16 a[246:247], v199 offset:14336
MM v[180:183],a[220:223],a[28:31],0
ds_read_b64_tr_b16 a[248:249], v199 offset:24576
buffer_load_dwordx4 v18, s[44:47], s20 offen offset:0 sc1 lds
MM v[180:183],a[216:219],a[20:23],v[180:183]
ds_read_b64_tr_b16 a[250:251], v199 offset:26624
MM v[180:183],a[212:215],a[12:15],v[180:183]
ds_read_b64_tr_b16 a[252:253], v199 offset:28672
buffer_load_dwordx4 v19, s[44:47], s20 offen offset:1024 sc1 lds
MM v[180:183],a[208:211],a[4:7],v[180:183]
ds_read_b64_tr_b16 a[254:255], v199 offset:30720
s_add_u32 s12, s12, 81920
s_waitcnt vmcnt(63) lgkmcnt(8)
MM v[152:155],a[224:227],a[0:3],0
buffer_load_dwordx4 a[184:187], v16, s[36:39], s11 offen sc1
MM v[152:155],a[228:231],a[8:11],v[152:155]
MM v[152:155],a[232:235],a[16:19],v[152:155]
s_waitcnt vmcnt(32) lgkmcnt(0)
s_barrier
ds_read_b64_tr_b16 a[192:193], v32 offset:0
ds_read_b64_tr_b16 a[194:195], v32 offset:2048
MM v[152:155],a[236:239],a[24:27],v[152:155]
ds_read_b64_tr_b16 a[196:197], v32 offset:4096
ds_read_b64_tr_b16 a[198:199], v32 offset:6144
MM v[184:187],a[236:239],a[28:31],0
ds_read_b64_tr_b16 a[200:201], v32 offset:16384
buffer_load_dwordx4 a[188:191], v17, s[36:39], s11 offen sc1
MM v[184:187],a[232:235],a[20:23],v[184:187]
ds_read_b64_tr_b16 a[202:203], v32 offset:18432
s_add_u32 s11, s11, 8192
MM v[184:187],a[228:231],a[12:15],v[184:187]
ds_read_b64_tr_b16 a[204:205], v32 offset:20480
s_add_u32 m0, s19, 81920
MM v[184:187],a[224:227],a[4:7],v[184:187]
ds_read_b64_tr_b16 a[206:207], v32 offset:22528
s_waitcnt lgkmcnt(8)
MM v[156:159],a[240:243],a[0:3],0
ds_read_b64_tr_b16 a[208:209], v33 offset:0
buffer_load_dwordx4 v18, s[44:47], s12 offen offset:0 sc1 lds
MM v[156:159],a[244:247],a[8:11],v[156:159]
ds_read_b64_tr_b16 a[210:211], v33 offset:2048
MM v[156:159],a[248:251],a[16:19],v[156:159]
ds_read_b64_tr_b16 a[212:213], v33 offset:4096
buffer_load_dwordx4 v19, s[44:47], s12 offen offset:1024 sc1 lds
MM v[156:159],a[252:255],a[24:27],v[156:159]
ds_read_b64_tr_b16 a[214:215], v33 offset:6144
s_add_u32 m0, s19, 90112
MM v[188:191],a[252:255],a[28:31],0
ds_read_b64_tr_b16 a[216:217], v33 offset:16384
s_add_u32 s20, s12, 128
MM v[188:191],a[248:251],a[20:23],v[188:191]
ds_read_b64_tr_b16 a[218:219], v33 offset:18432
MM v[188:191],a[244:247],a[12:15],v[188:191]
ds_read_b64_tr_b16 a[220:221], v33 offset:20480
buffer_load_dwordx4 v18, s[44:47], s20 offen offset:0 sc1 lds
MM v[188:191],a[240:243],a[4:7],v[188:191]
ds_read_b64_tr_b16 a[222:223], v33 offset:22528
s_waitcnt vmcnt(63) lgkmcnt(8)
MM v[128:131],a[192:195],a[32:35],v[128:131]
ds_read_b64_tr_b16 a[224:225], v34 offset:0
buffer_load_dwordx4 a[0:3], v16, s[36:39], s11 offen sc1
MM v[128:131],a[196:199],a[40:43],v[128:131]
ds_read_b64_tr_b16 a[226:227], v34 offset:2048
MM v[128:131],a[200:203],a[48:51],v[128:131]
ds_read_b64_tr_b16 a[228:229], v34 offset:4096
buffer_load_dwordx4 a[4:7], v17, s[36:39], s11 offen sc1
MM v[128:131],a[204:207],a[56:59],v[128:131]
ds_read_b64_tr_b16 a[230:231], v34 offset:6144
s_add_u32 s11, s11, 8192
MM v[160:163],a[204:207],a[60:63],v[160:163]
ds_read_b64_tr_b16 a[232:233], v34 offset:16384
buffer_load_dwordx4 v19, s[44:47], s20 offen offset:1024 sc1 lds
MM v[160:163],a[200:203],a[52:55],v[160:163]
ds_read_b64_tr_b16 a[234:235], v34 offset:18432
s_add_u32 s12, s12, 81920
MM v[160:163],a[196:199],a[44:47],v[160:163]
ds_read_b64_tr_b16 a[236:237], v34 offset:20480
s_add_u32 m0, s19, 98304
MM v[160:163],a[192:195],a[36:39],v[160:163]
ds_read_b64_tr_b16 a[238:239], v34 offset:22528
s_waitcnt lgkmcnt(8)
MM v[132:135],a[208:211],a[32:35],v[132:135]
ds_read_b64_tr_b16 a[240:241], v35 offset:0
buffer_load_dwordx4 v18, s[44:47], s12 offen offset:0 sc1 lds
MM v[132:135],a[212:215],a[40:43],v[132:135]
ds_read_b64_tr_b16 a[242:243], v35 offset:2048
MM v[132:135],a[216:219],a[48:51],v[132:135]
ds_read_b64_tr_b16 a[244:245], v35 offset:4096
buffer_load_dwordx4 v19, s[44:47], s12 offen offset:1024 sc1 lds
MM v[132:135],a[220:223],a[56:59],v[132:135]
ds_read_b64_tr_b16 a[246:247], v35 offset:6144
s_add_u32 m0, s19, 106496
MM v[164:167],a[220:223],a[60:63],v[164:167]
ds_read_b64_tr_b16 a[248:249], v35 offset:16384
s_add_u32 s20, s12, 128
MM v[164:167],a[216:219],a[52:55],v[164:167]
ds_read_b64_tr_b16 a[250:251], v35 offset:18432
MM v[164:167],a[212:215],a[44:47],v[164:167]
ds_read_b64_tr_b16 a[252:253], v35 offset:20480
buffer_load_dwordx4 v18, s[44:47], s20 offen offset:0 sc1 lds
MM v[164:167],a[208:211],a[36:39],v[164:167]
ds_read_b64_tr_b16 a[254:255], v35 offset:22528
s_waitcnt vmcnt(63) lgkmcnt(8)
MM v[136:139],a[224:227],a[32:35],v[136:139]
ds_read_b64_tr_b16 a[192:193], v32 offset:8192
buffer_load_dwordx4 a[8:11], v16, s[36:39], s11 offen sc1
MM v[136:139],a[228:231],a[40:43],v[136:139]
ds_read_b64_tr_b16 a[194:195], v32 offset:10240
MM v[136:139],a[232:235],a[48:51],v[136:139]
ds_read_b64_tr_b16 a[196:197], v32 offset:12288
buffer_load_dwordx4 a[12:15], v17, s[36:39], s11 offen sc1
MM v[136:139],a[236:239],a[56:59],v[136:139]
ds_read_b64_tr_b16 a[198:199], v32 offset:14336
s_add_u32 s11, s11, 8192
MM v[168:171],a[236:239],a[60:63],v[168:171]
ds_read_b64_tr_b16 a[200:201], v32 offset:24576
buffer_load_dwordx4 v19, s[44:47], s20 offen offset:1024 sc1 lds
MM v[168:171],a[232:235],a[52:55],v[168:171]
ds_read_b64_tr_b16 a[202:203], v32 offset:26624
s_add_u32 s12, s12, 81920
MM v[168:171],a[228:231],a[44:47],v[168:171]
ds_read_b64_tr_b16 a[204:205], v32 offset:28672
s_mov_b32 s12, s27
MM v[168:171],a[224:227],a[36:39],v[168:171]
ds_read_b64_tr_b16 a[206:207], v32 offset:30720
s_add_u32 m0, s19, 114688
s_waitcnt lgkmcnt(8)
MM v[140:143],a[240:243],a[32:35],v[140:143]
ds_read_b64_tr_b16 a[208:209], v33 offset:8192
buffer_load_dwordx4 v18, s[48:51], s12 offen offset:0 sc1 lds
MM v[140:143],a[244:247],a[40:43],v[140:143]
ds_read_b64_tr_b16 a[210:211], v33 offset:10240
MM v[140:143],a[248:251],a[48:51],v[140:143]
ds_read_b64_tr_b16 a[212:213], v33 offset:12288
buffer_load_dwordx4 v19, s[48:51], s12 offen offset:1024 sc1 lds
MM v[140:143],a[252:255],a[56:59],v[140:143]
ds_read_b64_tr_b16 a[214:215], v33 offset:14336
s_add_u32 m0, s19, 122880
MM v[172:175],a[252:255],a[60:63],v[172:175]
ds_read_b64_tr_b16 a[216:217], v33 offset:24576
s_add_u32 s20, s12, 128
MM v[172:175],a[248:251],a[52:55],v[172:175]
ds_read_b64_tr_b16 a[218:219], v33 offset:26624
MM v[172:175],a[244:247],a[44:47],v[172:175]
ds_read_b64_tr_b16 a[220:221], v33 offset:28672
buffer_load_dwordx4 v18, s[48:51], s20 offen offset:0 sc1 lds
MM v[172:175],a[240:243],a[36:39],v[172:175]
ds_read_b64_tr_b16 a[222:223], v33 offset:30720
s_waitcnt vmcnt(63) lgkmcnt(8)
MM v[144:147],a[192:195],a[32:35],v[144:147]
ds_read_b64_tr_b16 a[224:225], v34 offset:8192
buffer_load_dwordx4 v19, s[48:51], s20 offen offset:1024 sc1 lds
MM v[144:147],a[196:199],a[40:43],v[144:147]
ds_read_b64_tr_b16 a[226:227], v34 offset:10240
s_add_u32 s12, s12, 81920
MM v[144:147],a[200:203],a[48:51],v[144:147]
ds_read_b64_tr_b16 a[228:229], v34 offset:12288
MM v[144:147],a[204:207],a[56:59],v[144:147]
ds_read_b64_tr_b16 a[230:231], v34 offset:14336
MM v[176:179],a[204:207],a[60:63],v[176:179]
ds_read_b64_tr_b16 a[232:233], v34 offset:24576
MM v[176:179],a[200:203],a[52:55],v[176:179]
ds_read_b64_tr_b16 a[234:235], v34 offset:26624
MM v[176:179],a[196:199],a[44:47],v[176:179]
ds_read_b64_tr_b16 a[236:237], v34 offset:28672
MM v[176:179],a[192:195],a[36:39],v[176:179]
ds_read_b64_tr_b16 a[238:239], v34 offset:30720
s_waitcnt lgkmcnt(8)
MM v[148:151],a[208:211],a[32:35],v[148:151]
ds_read_b64_tr_b16 a[240:241], v35 offset:8192
MM v[148:151],a[212:215],a[40:43],v[148:151]
ds_read_b64_tr_b16 a[242:243], v35 offset:10240
MM v[148:151],a[216:219],a[48:51],v[148:151]
ds_read_b64_tr_b16 a[244:245], v35 offset:12288
MM v[148:151],a[220:223],a[56:59],v[148:151]
ds_read_b64_tr_b16 a[246:247], v35 offset:14336
MM v[180:183],a[220:223],a[60:63],v[180:183]
ds_read_b64_tr_b16 a[248:249], v35 offset:24576
MM v[180:183],a[216:219],a[52:55],v[180:183]
ds_read_b64_tr_b16 a[250:251], v35 offset:26624
MM v[180:183],a[212:215],a[44:47],v[180:183]
ds_read_b64_tr_b16 a[252:253], v35 offset:28672
MM v[180:183],a[208:211],a[36:39],v[180:183]
ds_read_b64_tr_b16 a[254:255], v35 offset:30720
s_waitcnt vmcnt(63) lgkmcnt(8)
MM v[152:155],a[224:227],a[32:35],v[152:155]
v_mov_b32 v116, -1
MM v[152:155],a[228:231],a[40:43],v[152:155]
v_mov_b32 v117, -1
MM v[152:155],a[232:235],a[48:51],v[152:155]
s_waitcnt vmcnt(24) lgkmcnt(0)
s_barrier
ds_read_b64_tr_b16 a[192:193], v32 offset:32768
ds_read_b64_tr_b16 a[194:195], v32 offset:34816
MM v[152:155],a[236:239],a[56:59],v[152:155]
ds_read_b64_tr_b16 a[196:197], v32 offset:36864
ds_read_b64_tr_b16 a[198:199], v32 offset:38912
MM v[184:187],a[236:239],a[60:63],v[184:187]
ds_read_b64_tr_b16 a[200:201], v32 offset:49152
v_mov_b32 v118, -1
MM v[184:187],a[232:235],a[52:55],v[184:187]
ds_read_b64_tr_b16 a[202:203], v32 offset:51200
v_mov_b32 v119, -1
MM v[184:187],a[228:231],a[44:47],v[184:187]
ds_read_b64_tr_b16 a[204:205], v32 offset:53248
s_add_u32 s67, s17, 32768
MM v[184:187],a[224:227],a[36:39],v[184:187]
ds_read_b64_tr_b16 a[206:207], v32 offset:55296
s_add_u32 s68, s16, 32768
s_waitcnt lgkmcnt(8)
MM v[156:159],a[240:243],a[32:35],v[156:159]
ds_read_b64_tr_b16 a[208:209], v33 offset:32768
s_add_u32 m0, s19, 0
MM v[156:159],a[244:247],a[40:43],v[156:159]
ds_read_b64_tr_b16 a[210:211], v33 offset:34816
MM v[156:159],a[248:251],a[48:51],v[156:159]
ds_read_b64_tr_b16 a[212:213], v33 offset:36864
buffer_load_dwordx4 v18, s[48:51], s12 offen offset:0 sc1 lds
MM v[156:159],a[252:255],a[56:59],v[156:159]
ds_read_b64_tr_b16 a[214:215], v33 offset:38912
MM v[188:191],a[252:255],a[60:63],v[188:191]
ds_read_b64_tr_b16 a[216:217], v33 offset:49152
buffer_load_dwordx4 v19, s[48:51], s12 offen offset:1024 sc1 lds
MM v[188:191],a[248:251],a[52:55],v[188:191]
ds_read_b64_tr_b16 a[218:219], v33 offset:51200
s_add_u32 m0, s19, 8192
MM v[188:191],a[244:247],a[44:47],v[188:191]
ds_read_b64_tr_b16 a[220:221], v33 offset:53248
s_add_u32 s20, s12, 128
MM v[188:191],a[240:243],a[36:39],v[188:191]
ds_read_b64_tr_b16 a[222:223], v33 offset:55296
s_waitcnt vmcnt(47) lgkmcnt(8)
MM v[128:131],a[192:195],a[128:131],v[128:131]
ds_read_b64_tr_b16 a[224:225], v34 offset:32768
buffer_store_dwordx4 v[116:119], v1, s[32:35], s67 offen offset:0 sc0 sc1
MM v[128:131],a[196:199],a[136:139],v[128:131]
ds_read_b64_tr_b16 a[226:227], v34 offset:34816
MM v[128:131],a[200:203],a[144:147],v[128:131]
ds_read_b64_tr_b16 a[228:229], v34 offset:36864
buffer_store_dwordx4 v[116:119], v1, s[32:35], s68 offen offset:0 sc0 sc1
MM v[128:131],a[204:207],a[152:155],v[128:131]
ds_read_b64_tr_b16 a[230:231], v34 offset:38912
MM v[160:163],a[204:207],a[156:159],v[160:163]
ds_read_b64_tr_b16 a[232:233], v34 offset:49152
buffer_load_dwordx4 v18, s[48:51], s20 offen offset:0 sc1 lds
MM v[160:163],a[200:203],a[148:151],v[160:163]
ds_read_b64_tr_b16 a[234:235], v34 offset:51200
MM v[160:163],a[196:199],a[140:143],v[160:163]
ds_read_b64_tr_b16 a[236:237], v34 offset:53248
buffer_load_dwordx4 v19, s[48:51], s20 offen offset:1024 sc1 lds
MM v[160:163],a[192:195],a[132:135],v[160:163]
ds_read_b64_tr_b16 a[238:239], v34 offset:55296
s_add_u32 s12, s12, 81920
s_waitcnt lgkmcnt(8)
MM v[132:135],a[208:211],a[128:131],v[132:135]
ds_read_b64_tr_b16 a[240:241], v35 offset:32768
s_add_u32 m0, s19, 16384
MM v[132:135],a[212:215],a[136:139],v[132:135]
ds_read_b64_tr_b16 a[242:243], v35 offset:34816
MM v[132:135],a[216:219],a[144:147],v[132:135]
ds_read_b64_tr_b16 a[244:245], v35 offset:36864
buffer_load_dwordx4 v18, s[48:51], s12 offen offset:0 sc1 lds
MM v[132:135],a[220:223],a[152:155],v[132:135]
ds_read_b64_tr_b16 a[246:247], v35 offset:38912
MM v[164:167],a[220:223],a[156:159],v[164:167]
ds_read_b64_tr_b16 a[248:249], v35 offset:49152
buffer_load_dwordx4 v19, s[48:51], s12 offen offset:1024 sc1 lds
MM v[164:167],a[216:219],a[148:151],v[164:167]
ds_read_b64_tr_b16 a[250:251], v35 offset:51200
s_add_u32 m0, s19, 24576
MM v[164:167],a[212:215],a[140:143],v[164:167]
ds_read_b64_tr_b16 a[252:253], v35 offset:53248
s_add_u32 s20, s12, 128
MM v[164:167],a[208:211],a[132:135],v[164:167]
ds_read_b64_tr_b16 a[254:255], v35 offset:55296
s_waitcnt vmcnt(53) lgkmcnt(8)
MM v[136:139],a[224:227],a[128:131],v[136:139]
ds_read_b64_tr_b16 a[192:193], v32 offset:40960
buffer_store_dwordx4 v[116:119], v1, s[32:35], s67 offen offset:1024 sc0 sc1
MM v[136:139],a[228:231],a[136:139],v[136:139]
ds_read_b64_tr_b16 a[194:195], v32 offset:43008
MM v[136:139],a[232:235],a[144:147],v[136:139]
ds_read_b64_tr_b16 a[196:197], v32 offset:45056
buffer_store_dwordx4 v[116:119], v1, s[32:35], s68 offen offset:1024 sc0 sc1
MM v[136:139],a[236:239],a[152:155],v[136:139]
ds_read_b64_tr_b16 a[198:199], v32 offset:47104
MM v[168:171],a[236:239],a[156:159],v[168:171]
ds_read_b64_tr_b16 a[200:201], v32 offset:57344
buffer_load_dwordx4 v18, s[48:51], s20 offen offset:0 sc1 lds
MM v[168:171],a[232:235],a[148:151],v[168:171]
ds_read_b64_tr_b16 a[202:203], v32 offset:59392
MM v[168:171],a[228:231],a[140:143],v[168:171]
ds_read_b64_tr_b16 a[204:205], v32 offset:61440
buffer_load_dwordx4 v19, s[48:51], s20 offen offset:1024 sc1 lds
MM v[168:171],a[224:227],a[132:135],v[168:171]
ds_read_b64_tr_b16 a[206:207], v32 offset:63488
s_add_u32 s12, s12, 81920
s_waitcnt lgkmcnt(8)
MM v[140:143],a[240:243],a[128:131],v[140:143]
ds_read_b64_tr_b16 a[208:209], v33 offset:40960
MM v[140:143],a[244:247],a[136:139],v[140:143]
ds_read_b64_tr_b16 a[210:211], v33 offset:43008
MM v[140:143],a[248:251],a[144:147],v[140:143]
ds_read_b64_tr_b16 a[212:213], v33 offset:45056
MM v[140:143],a[252:255],a[152:155],v[140:143]
ds_read_b64_tr_b16 a[214:215], v33 offset:47104
MM v[172:175],a[252:255],a[156:159],v[172:175]
ds_read_b64_tr_b16 a[216:217], v33 offset:57344
MM v[172:175],a[248:251],a[148:151],v[172:175]
ds_read_b64_tr_b16 a[218:219], v33 offset:59392
MM v[172:175],a[244:247],a[140:143],v[172:175]
ds_read_b64_tr_b16 a[220:221], v33 offset:61440
MM v[172:175],a[240:243],a[132:135],v[172:175]
ds_read_b64_tr_b16 a[222:223], v33 offset:63488
s_waitcnt vmcnt(57) lgkmcnt(8)
MM v[144:147],a[192:195],a[128:131],v[144:147]
ds_read_b64_tr_b16 a[224:225], v34 offset:40960
buffer_store_dwordx4 v[116:119], v1, s[32:35], s67 offen offset:2048 sc0 sc1
MM v[144:147],a[196:199],a[136:139],v[144:147]
ds_read_b64_tr_b16 a[226:227], v34 offset:43008
MM v[144:147],a[200:203],a[144:147],v[144:147]
ds_read_b64_tr_b16 a[228:229], v34 offset:45056
buffer_store_dwordx4 v[116:119], v1, s[32:35], s68 offen offset:2048 sc0 sc1
MM v[144:147],a[204:207],a[152:155],v[144:147]
ds_read_b64_tr_b16 a[230:231], v34 offset:47104
MM v[176:179],a[204:207],a[156:159],v[176:179]
ds_read_b64_tr_b16 a[232:233], v34 offset:57344
MM v[176:179],a[200:203],a[148:151],v[176:179]
ds_read_b64_tr_b16 a[234:235], v34 offset:59392
MM v[176:179],a[196:199],a[140:143],v[176:179]
ds_read_b64_tr_b16 a[236:237], v34 offset:61440
MM v[176:179],a[192:195],a[132:135],v[176:179]
ds_read_b64_tr_b16 a[238:239], v34 offset:63488
s_waitcnt lgkmcnt(8)
MM v[148:151],a[208:211],a[128:131],v[148:151]
ds_read_b64_tr_b16 a[240:241], v35 offset:40960
MM v[148:151],a[212:215],a[136:139],v[148:151]
ds_read_b64_tr_b16 a[242:243], v35 offset:43008
MM v[148:151],a[216:219],a[144:147],v[148:151]
ds_read_b64_tr_b16 a[244:245], v35 offset:45056
MM v[148:151],a[220:223],a[152:155],v[148:151]
ds_read_b64_tr_b16 a[246:247], v35 offset:47104
MM v[180:183],a[220:223],a[156:159],v[180:183]
ds_read_b64_tr_b16 a[248:249], v35 offset:57344
MM v[180:183],a[216:219],a[148:151],v[180:183]
ds_read_b64_tr_b16 a[250:251], v35 offset:59392
MM v[180:183],a[212:215],a[140:143],v[180:183]
ds_read_b64_tr_b16 a[252:253], v35 offset:61440
MM v[180:183],a[208:211],a[132:135],v[180:183]
ds_read_b64_tr_b16 a[254:255], v35 offset:63488
s_waitcnt vmcnt(59) lgkmcnt(8)
MM v[152:155],a[224:227],a[128:131],v[152:155]
buffer_store_dwordx4 v[116:119], v1, s[32:35], s67 offen offset:3072 sc0 sc1
MM v[152:155],a[228:231],a[136:139],v[152:155]
MM v[152:155],a[232:235],a[144:147],v[152:155]
s_waitcnt vmcnt(25) lgkmcnt(0)
s_barrier
ds_read_b64_tr_b16 a[192:193], v36 offset:0
ds_read_b64_tr_b16 a[194:195], v36 offset:2048
MM v[152:155],a[236:239],a[152:155],v[152:155]
ds_read_b64_tr_b16 a[196:197], v36 offset:4096
ds_read_b64_tr_b16 a[198:199], v36 offset:6144
MM v[184:187],a[236:239],a[156:159],v[184:187]
ds_read_b64_tr_b16 a[200:201], v36 offset:16384
buffer_store_dwordx4 v[116:119], v1, s[32:35], s68 offen offset:3072 sc0 sc1
MM v[184:187],a[232:235],a[148:151],v[184:187]
ds_read_b64_tr_b16 a[202:203], v36 offset:18432
s_add_u32 m0, s19, 32768
MM v[184:187],a[228:231],a[140:143],v[184:187]
ds_read_b64_tr_b16 a[204:205], v36 offset:20480
buffer_load_dwordx4 v18, s[48:51], s12 offen offset:0 sc1 lds
MM v[184:187],a[224:227],a[132:135],v[184:187]
ds_read_b64_tr_b16 a[206:207], v36 offset:22528
s_waitcnt lgkmcnt(8)
MM v[156:159],a[240:243],a[128:131],v[156:159]
ds_read_b64_tr_b16 a[208:209], v37 offset:0
buffer_load_dwordx4 v19, s[48:51], s12 offen offset:1024 sc1 lds
MM v[156:159],a[244:247],a[136:139],v[156:159]
ds_read_b64_tr_b16 a[210:211], v37 offset:2048
s_add_u32 m0, s19, 40960
MM v[156:159],a[248:251],a[144:147],v[156:159]
ds_read_b64_tr_b16 a[212:213], v37 offset:4096
s_add_u32 s20, s12, 128
MM v[156:159],a[252:255],a[152:155],v[156:159]
ds_read_b64_tr_b16 a[214:215], v37 offset:6144
MM v[188:191],a[252:255],a[156:159],v[188:191]
ds_read_b64_tr_b16 a[216:217], v37 offset:16384
buffer_load_dwordx4 v18, s[48:51], s20 offen offset:0 sc1 lds
MM v[188:191],a[248:251],a[148:151],v[188:191]
ds_read_b64_tr_b16 a[218:219], v37 offset:18432
MM v[188:191],a[244:247],a[140:143],v[188:191]
ds_read_b64_tr_b16 a[220:221], v37 offset:20480
buffer_load_dwordx4 v19, s[48:51], s20 offen offset:1024 sc1 lds
MM v[188:191],a[240:243],a[132:135],v[188:191]
ds_read_b64_tr_b16 a[222:223], v37 offset:22528
s_add_u32 s12, s12, 81920
s_waitcnt vmcnt(36) lgkmcnt(8)
MM v[128:131],a[192:195],a[160:163],v[128:131]
ds_read_b64_tr_b16 a[224:225], v38 offset:0
buffer_load_dwordx4 v[96:99], v20, s[52:55], s13 offen offset:0 sc1
MM v[128:131],a[196:199],a[168:171],v[128:131]
ds_read_b64_tr_b16 a[226:227], v38 offset:2048
MM v[128:131],a[200:203],a[176:179],v[128:131]
ds_read_b64_tr_b16 a[228:229], v38 offset:4096
buffer_load_dwordx4 v[100:103], v20, s[52:55], s13 offen offset:1280 sc1
MM v[128:131],a[204:207],a[184:187],v[128:131]
ds_read_b64_tr_b16 a[230:231], v38 offset:6144
MM v[160:163],a[204:207],a[188:191],v[160:163]
ds_read_b64_tr_b16 a[232:233], v38 offset:16384
buffer_load_dwordx4 v[24:27], v200, s[32:35], s76 offen sc0 sc1
MM v[160:163],a[200:203],a[180:183],v[160:163]
ds_read_b64_tr_b16 a[234:235], v38 offset:18432
s_add_u32 m0, s19, 49152
MM v[160:163],a[196:199],a[172:175],v[160:163]
ds_read_b64_tr_b16 a[236:237], v38 offset:20480
buffer_load_dwordx4 v18, s[48:51], s12 offen offset:0 sc1 lds
MM v[160:163],a[192:195],a[164:167],v[160:163]
ds_read_b64_tr_b16 a[238:239], v38 offset:22528
s_waitcnt lgkmcnt(8)
MM v[132:135],a[208:211],a[160:163],v[132:135]
ds_read_b64_tr_b16 a[240:241], v39 offset:0
buffer_load_dwordx4 v19, s[48:51], s12 offen offset:1024 sc1 lds
MM v[132:135],a[212:215],a[168:171],v[132:135]
ds_read_b64_tr_b16 a[242:243], v39 offset:2048
s_add_u32 m0, s19, 57344
MM v[132:135],a[216:219],a[176:179],v[132:135]
ds_read_b64_tr_b16 a[244:245], v39 offset:4096
s_add_u32 s20, s12, 128
MM v[132:135],a[220:223],a[184:187],v[132:135]
ds_read_b64_tr_b16 a[246:247], v39 offset:6144
MM v[164:167],a[220:223],a[188:191],v[164:167]
ds_read_b64_tr_b16 a[248:249], v39 offset:16384
buffer_load_dwordx4 v18, s[48:51], s20 offen offset:0 sc1 lds
MM v[164:167],a[216:219],a[180:183],v[164:167]
ds_read_b64_tr_b16 a[250:251], v39 offset:18432
MM v[164:167],a[212:215],a[172:175],v[164:167]
ds_read_b64_tr_b16 a[252:253], v39 offset:20480
buffer_load_dwordx4 v19, s[48:51], s20 offen offset:1024 sc1 lds
MM v[164:167],a[208:211],a[164:167],v[164:167]
ds_read_b64_tr_b16 a[254:255], v39 offset:22528
s_add_u32 s12, s12, 81920
s_waitcnt vmcnt(43) lgkmcnt(8)
MM v[136:139],a[224:227],a[160:163],v[136:139]
ds_read_b64_tr_b16 a[192:193], v36 offset:8192
buffer_load_dwordx4 v[104:107], v20, s[52:55], s13 offen offset:2560 sc1
MM v[136:139],a[228:231],a[168:171],v[136:139]
ds_read_b64_tr_b16 a[194:195], v36 offset:10240
MM v[136:139],a[232:235],a[176:179],v[136:139]
ds_read_b64_tr_b16 a[196:197], v36 offset:12288
buffer_load_dwordx4 v[108:111], v20, s[52:55], s13 offen offset:3840 sc1
MM v[136:139],a[236:239],a[184:187],v[136:139]
ds_read_b64_tr_b16 a[198:199], v36 offset:14336
MM v[168:171],a[236:239],a[188:191],v[168:171]
ds_read_b64_tr_b16 a[200:201], v36 offset:24576
MM v[168:171],a[232:235],a[180:183],v[168:171]
ds_read_b64_tr_b16 a[202:203], v36 offset:26624
MM v[168:171],a[228:231],a[172:175],v[168:171]
ds_read_b64_tr_b16 a[204:205], v36 offset:28672
MM v[168:171],a[224:227],a[164:167],v[168:171]
ds_read_b64_tr_b16 a[206:207], v36 offset:30720
s_waitcnt lgkmcnt(8)
MM v[140:143],a[240:243],a[160:163],v[140:143]
ds_read_b64_tr_b16 a[208:209], v37 offset:8192
MM v[140:143],a[244:247],a[168:171],v[140:143]
ds_read_b64_tr_b16 a[210:211], v37 offset:10240
MM v[140:143],a[248:251],a[176:179],v[140:143]
ds_read_b64_tr_b16 a[212:213], v37 offset:12288
MM v[140:143],a[252:255],a[184:187],v[140:143]
ds_read_b64_tr_b16 a[214:215], v37 offset:14336
MM v[172:175],a[252:255],a[188:191],v[172:175]
ds_read_b64_tr_b16 a[216:217], v37 offset:24576
MM v[172:175],a[248:251],a[180:183],v[172:175]
ds_read_b64_tr_b16 a[218:219], v37 offset:26624
MM v[172:175],a[244:247],a[172:175],v[172:175]
ds_read_b64_tr_b16 a[220:221], v37 offset:28672
MM v[172:175],a[240:243],a[164:167],v[172:175]
ds_read_b64_tr_b16 a[222:223], v37 offset:30720
s_waitcnt vmcnt(45) lgkmcnt(8)
MM v[144:147],a[192:195],a[160:163],v[144:147]
ds_read_b64_tr_b16 a[224:225], v38 offset:8192
MM v[144:147],a[196:199],a[168:171],v[144:147]
ds_read_b64_tr_b16 a[226:227], v38 offset:10240
MM v[144:147],a[200:203],a[176:179],v[144:147]
ds_read_b64_tr_b16 a[228:229], v38 offset:12288
MM v[144:147],a[204:207],a[184:187],v[144:147]
ds_read_b64_tr_b16 a[230:231], v38 offset:14336
MM v[176:179],a[204:207],a[188:191],v[176:179]
ds_read_b64_tr_b16 a[232:233], v38 offset:24576
MM v[176:179],a[200:203],a[180:183],v[176:179]
ds_read_b64_tr_b16 a[234:235], v38 offset:26624
MM v[176:179],a[196:199],a[172:175],v[176:179]
ds_read_b64_tr_b16 a[236:237], v38 offset:28672
MM v[176:179],a[192:195],a[164:167],v[176:179]
ds_read_b64_tr_b16 a[238:239], v38 offset:30720
s_waitcnt lgkmcnt(8)
MM v[148:151],a[208:211],a[160:163],v[148:151]
ds_read_b64_tr_b16 a[240:241], v39 offset:8192
MM v[148:151],a[212:215],a[168:171],v[148:151]
ds_read_b64_tr_b16 a[242:243], v39 offset:10240
MM v[148:151],a[216:219],a[176:179],v[148:151]
ds_read_b64_tr_b16 a[244:245], v39 offset:12288
MM v[148:151],a[220:223],a[184:187],v[148:151]
ds_read_b64_tr_b16 a[246:247], v39 offset:14336
MM v[180:183],a[220:223],a[188:191],v[180:183]
ds_read_b64_tr_b16 a[248:249], v39 offset:24576
MM v[180:183],a[216:219],a[180:183],v[180:183]
ds_read_b64_tr_b16 a[250:251], v39 offset:26624
MM v[180:183],a[212:215],a[172:175],v[180:183]
ds_read_b64_tr_b16 a[252:253], v39 offset:28672
MM v[180:183],a[208:211],a[164:167],v[180:183]
ds_read_b64_tr_b16 a[254:255], v39 offset:30720
s_waitcnt vmcnt(6) lgkmcnt(8)
v_xor_b32 v24, v24, v61
v_xor_b32 v25, v25, v61
v_xor_b32 v26, v26, v61
v_xor_b32 v27, v27, v61
v_or3_b32 v24, v24, v25, v26
v_or_b32 v24, v24, v27
v_cmp_ne_u32 vcc, 0, v24
s_nop 1
s_cbranch_vccnz L_sl_37
L_ok_38:
MM v[152:155],a[224:227],a[160:163],v[152:155]
s_mov_b32 s11, s26
MM v[152:155],a[228:231],a[168:171],v[152:155]
MM v[152:155],a[232:235],a[176:179],v[152:155]
s_waitcnt vmcnt(29) lgkmcnt(0)
s_barrier
ds_read_b64_tr_b16 a[192:193], v36 offset:32768
ds_read_b64_tr_b16 a[194:195], v36 offset:34816
MM v[152:155],a[236:239],a[184:187],v[152:155]
ds_read_b64_tr_b16 a[196:197], v36 offset:36864
ds_read_b64_tr_b16 a[198:199], v36 offset:38912
MM v[184:187],a[236:239],a[188:191],v[184:187]
ds_read_b64_tr_b16 a[200:201], v37 offset:32768
buffer_load_dwordx4 a[16:19], v16, s[40:43], s11 offen sc1
MM v[184:187],a[232:235],a[180:183],v[184:187]
ds_read_b64_tr_b16 a[202:203], v37 offset:34816
MM v[184:187],a[228:231],a[172:175],v[184:187]
ds_read_b64_tr_b16 a[204:205], v37 offset:36864
buffer_load_dwordx4 a[20:23], v17, s[40:43], s11 offen sc1
MM v[184:187],a[224:227],a[164:167],v[184:187]
ds_read_b64_tr_b16 a[206:207], v37 offset:38912
s_add_u32 s11, s11, 8192
s_waitcnt lgkmcnt(8)
MM v[156:159],a[240:243],a[160:163],v[156:159]
ds_read_b64_tr_b16 a[208:209], v38 offset:32768
buffer_load_dwordx4 a[24:27], v16, s[40:43], s11 offen sc1
MM v[156:159],a[244:247],a[168:171],v[156:159]
ds_read_b64_tr_b16 a[210:211], v38 offset:34816
MM v[156:159],a[248:251],a[176:179],v[156:159]
ds_read_b64_tr_b16 a[212:213], v38 offset:36864
buffer_load_dwordx4 a[28:31], v17, s[40:43], s11 offen sc1
MM v[156:159],a[252:255],a[184:187],v[156:159]
ds_read_b64_tr_b16 a[214:215], v38 offset:38912
s_add_u32 s11, s11, 8192
MM v[188:191],a[252:255],a[188:191],v[188:191]
ds_read_b64_tr_b16 a[216:217], v39 offset:32768
buffer_load_dwordx4 a[32:35], v16, s[40:43], s11 offen sc1
MM v[188:191],a[248:251],a[180:183],v[188:191]
ds_read_b64_tr_b16 a[218:219], v39 offset:34816
MM v[188:191],a[244:247],a[172:175],v[188:191]
ds_read_b64_tr_b16 a[220:221], v39 offset:36864
buffer_load_dwordx4 a[36:39], v17, s[40:43], s11 offen sc1
MM v[188:191],a[240:243],a[164:167],v[188:191]
ds_read_b64_tr_b16 a[222:223], v39 offset:38912
s_add_u32 s11, s11, 8192
s_waitcnt vmcnt(40) lgkmcnt(8)
MM v[128:131],a[192:195],a[0:3],v[128:131]
ds_read_b64_tr_b16 a[224:225], v36 offset:40960
buffer_load_dwordx4 a[40:43], v16, s[40:43], s11 offen sc1
MM v[128:131],a[196:199],a[8:11],v[128:131]
ds_read_b64_tr_b16 a[226:227], v36 offset:43008
MM v[160:163],a[196:199],a[12:15],v[160:163]
ds_read_b64_tr_b16 a[228:229], v36 offset:45056
buffer_load_dwordx4 a[44:47], v17, s[40:43], s11 offen sc1
MM v[160:163],a[192:195],a[4:7],v[160:163]
ds_read_b64_tr_b16 a[230:231], v36 offset:47104
s_add_u32 s11, s11, 8192
MM v[132:135],a[200:203],a[0:3],v[132:135]
ds_read_b64_tr_b16 a[232:233], v37 offset:40960
buffer_load_dwordx4 a[48:51], v16, s[40:43], s11 offen sc1
MM v[132:135],a[204:207],a[8:11],v[132:135]
ds_read_b64_tr_b16 a[234:235], v37 offset:43008
MM v[164:167],a[204:207],a[12:15],v[164:167]
ds_read_b64_tr_b16 a[236:237], v37 offset:45056
buffer_load_dwordx4 a[52:55], v17, s[40:43], s11 offen sc1
MM v[164:167],a[200:203],a[4:7],v[164:167]
ds_read_b64_tr_b16 a[238:239], v37 offset:47104
s_add_u32 s11, s11, 8192
s_waitcnt lgkmcnt(8)
MM v[136:139],a[208:211],a[0:3],v[136:139]
ds_read_b64_tr_b16 a[240:241], v38 offset:40960
buffer_load_dwordx4 a[56:59], v16, s[40:43], s11 offen sc1
MM v[136:139],a[212:215],a[8:11],v[136:139]
ds_read_b64_tr_b16 a[242:243], v38 offset:43008
MM v[168:171],a[212:215],a[12:15],v[168:171]
ds_read_b64_tr_b16 a[244:245], v38 offset:45056
buffer_load_dwordx4 a[60:63], v17, s[40:43], s11 offen sc1
MM v[168:171],a[208:211],a[4:7],v[168:171]
ds_read_b64_tr_b16 a[246:247], v38 offset:47104
s_add_u32 s11, s11, 8192
MM v[140:143],a[216:219],a[0:3],v[140:143]
ds_read_b64_tr_b16 a[248:249], v39 offset:40960
s_add_u32 m0, s19, 65536
MM v[140:143],a[220:223],a[8:11],v[140:143]
ds_read_b64_tr_b16 a[250:251], v39 offset:43008
MM v[172:175],a[220:223],a[12:15],v[172:175]
ds_read_b64_tr_b16 a[252:253], v39 offset:45056
buffer_load_dwordx4 v18, s[48:51], s12 offen offset:0 sc1 lds
MM v[172:175],a[216:219],a[4:7],v[172:175]
ds_read_b64_tr_b16 a[254:255], v39 offset:47104
s_waitcnt vmcnt(47) lgkmcnt(8)
MM v[144:147],a[224:227],a[0:3],v[144:147]
ds_read_b64_tr_b16 a[192:193], v36 offset:49152
buffer_load_dwordx4 a[128:131], v16, s[40:43], s11 offen sc1
MM v[144:147],a[228:231],a[8:11],v[144:147]
ds_read_b64_tr_b16 a[194:195], v36 offset:51200
MM v[176:179],a[228:231],a[12:15],v[176:179]
ds_read_b64_tr_b16 a[196:197], v36 offset:53248
buffer_load_dwordx4 a[132:135], v17, s[40:43], s11 offen sc1
MM v[176:179],a[224:227],a[4:7],v[176:179]
ds_read_b64_tr_b16 a[198:199], v36 offset:55296
s_add_u32 s11, s11, 8192
MM v[148:151],a[232:235],a[0:3],v[148:151]
ds_read_b64_tr_b16 a[200:201], v37 offset:49152
buffer_load_dwordx4 a[136:139], v16, s[40:43], s11 offen sc1
MM v[148:151],a[236:239],a[8:11],v[148:151]
ds_read_b64_tr_b16 a[202:203], v37 offset:51200
MM v[180:183],a[236:239],a[12:15],v[180:183]
ds_read_b64_tr_b16 a[204:205], v37 offset:53248
buffer_load_dwordx4 a[140:143], v17, s[40:43], s11 offen sc1
MM v[180:183],a[232:235],a[4:7],v[180:183]
ds_read_b64_tr_b16 a[206:207], v37 offset:55296
s_add_u32 s11, s11, 8192
s_waitcnt lgkmcnt(8)
MM v[152:155],a[240:243],a[0:3],v[152:155]
ds_read_b64_tr_b16 a[208:209], v38 offset:49152
buffer_load_dwordx4 a[144:147], v16, s[40:43], s11 offen sc1
MM v[152:155],a[244:247],a[8:11],v[152:155]
ds_read_b64_tr_b16 a[210:211], v38 offset:51200
MM v[184:187],a[244:247],a[12:15],v[184:187]
ds_read_b64_tr_b16 a[212:213], v38 offset:53248
buffer_load_dwordx4 a[148:151], v17, s[40:43], s11 offen sc1
MM v[184:187],a[240:243],a[4:7],v[184:187]
ds_read_b64_tr_b16 a[214:215], v38 offset:55296
s_add_u32 s11, s11, 8192
MM v[156:159],a[248:251],a[0:3],v[156:159]
ds_read_b64_tr_b16 a[216:217], v39 offset:49152
buffer_load_dwordx4 v19, s[48:51], s12 offen offset:1024 sc1 lds
MM v[156:159],a[252:255],a[8:11],v[156:159]
ds_read_b64_tr_b16 a[218:219], v39 offset:51200
s_add_u32 m0, s19, 73728
MM v[188:191],a[252:255],a[12:15],v[188:191]
ds_read_b64_tr_b16 a[220:221], v39 offset:53248
s_add_u32 s20, s12, 128
MM v[188:191],a[248:251],a[4:7],v[188:191]
ds_read_b64_tr_b16 a[222:223], v39 offset:55296
s_waitcnt vmcnt(16) lgkmcnt(8)
MM v[192:195],a[192:195],a[16:19],0
ds_read_b64_tr_b16 a[224:225], v36 offset:57344
buffer_load_dwordx4 a[152:155], v16, s[40:43], s11 offen sc1
MM v[192:195],a[196:199],a[24:27],v[192:195]
ds_read_b64_tr_b16 a[226:227], v36 offset:59392
MM v[224:227],a[196:199],a[28:31],0
ds_read_b64_tr_b16 a[228:229], v36 offset:61440
buffer_load_dwordx4 a[156:159], v17, s[40:43], s11 offen sc1
MM v[224:227],a[192:195],a[20:23],v[224:227]
ds_read_b64_tr_b16 a[230:231], v36 offset:63488
s_add_u32 s11, s11, 8192
MM v[196:199],a[200:203],a[16:19],0
ds_read_b64_tr_b16 a[232:233], v37 offset:57344
buffer_load_dwordx4 a[160:163], v16, s[40:43], s11 offen sc1
MM v[196:199],a[204:207],a[24:27],v[196:199]
ds_read_b64_tr_b16 a[234:235], v37 offset:59392
MM v[228:231],a[204:207],a[28:31],0
ds_read_b64_tr_b16 a[236:237], v37 offset:61440
buffer_load_dwordx4 a[164:167], v17, s[40:43], s11 offen sc1
MM v[228:231],a[200:203],a[20:23],v[228:231]
ds_read_b64_tr_b16 a[238:239], v37 offset:63488
s_add_u32 s11, s11, 8192
s_waitcnt lgkmcnt(8)
MM v[200:203],a[208:211],a[16:19],0
ds_read_b64_tr_b16 a[240:241], v38 offset:57344
buffer_load_dwordx4 v18, s[48:51], s20 offen offset:0 sc1 lds
MM v[200:203],a[212:215],a[24:27],v[200:203]
ds_read_b64_tr_b16 a[242:243], v38 offset:59392
MM v[232:235],a[212:215],a[28:31],0
ds_read_b64_tr_b16 a[244:245], v38 offset:61440
buffer_load_dwordx4 v19, s[48:51], s20 offen offset:1024 sc1 lds
MM v[232:235],a[208:211],a[20:23],v[232:235]
ds_read_b64_tr_b16 a[246:247], v38 offset:63488
s_add_u32 s12, s12, 81920
MM v[204:207],a[216:219],a[16:19],0
ds_read_b64_tr_b16 a[248:249], v39 offset:57344
s_add_u32 m0, s19, 81920
MM v[204:207],a[220:223],a[24:27],v[204:207]
ds_read_b64_tr_b16 a[250:251], v39 offset:59392
MM v[236:239],a[220:223],a[28:31],0
ds_read_b64_tr_b16 a[252:253], v39 offset:61440
buffer_load_dwordx4 v18, s[48:51], s12 offen offset:0 sc1 lds
MM v[236:239],a[216:219],a[20:23],v[236:239]
ds_read_b64_tr_b16 a[254:255], v39 offset:63488
s_waitcnt vmcnt(23) lgkmcnt(8)
MM v[208:211],a[224:227],a[16:19],0
buffer_load_dwordx4 a[168:171], v16, s[40:43], s11 offen sc1
CV v160,v160,v161
CV v161,v162,v163
MM v[208:211],a[228:231],a[24:27],v[208:211]
CV v162,v164,v165
CV v163,v166,v167
MM v[240:243],a[228:231],a[28:31],0
s_waitcnt vmcnt(45) lgkmcnt(0)
s_barrier
ds_read_b64_tr_b16 a[192:193], v32 offset:0
ds_read_b64_tr_b16 a[194:195], v32 offset:2048
CV v164,v168,v169
CV v165,v170,v171
MM v[240:243],a[224:227],a[20:23],v[240:243]
ds_read_b64_tr_b16 a[196:197], v32 offset:4096
ds_read_b64_tr_b16 a[198:199], v32 offset:6144
CV v166,v172,v173
CV v167,v174,v175
MM v[212:215],a[232:235],a[16:19],0
ds_read_b64_tr_b16 a[200:201], v32 offset:16384
buffer_load_dwordx4 a[172:175], v17, s[40:43], s11 offen sc1
CV v168,v176,v177
CV v169,v178,v179
MM v[212:215],a[236:239],a[24:27],v[212:215]
ds_read_b64_tr_b16 a[202:203], v32 offset:18432
s_add_u32 s11, s11, 8192
CV v170,v180,v181
CV v171,v182,v183
MM v[244:247],a[236:239],a[28:31],0
ds_read_b64_tr_b16 a[204:205], v32 offset:20480
buffer_load_dwordx4 v19, s[48:51], s12 offen offset:1024 sc1 lds
CV v172,v184,v185
CV v173,v186,v187
MM v[244:247],a[232:235],a[20:23],v[244:247]
ds_read_b64_tr_b16 a[206:207], v32 offset:22528
s_add_u32 m0, s19, 90112
CV v174,v188,v189
CV v175,v190,v191
s_waitcnt lgkmcnt(8)
MM v[216:219],a[240:243],a[16:19],0
ds_read_b64_tr_b16 a[208:209], v33 offset:0
s_add_u32 s20, s12, 128
CV v112,v128,v129
CV v113,v130,v131
MM v[216:219],a[244:247],a[24:27],v[216:219]
ds_read_b64_tr_b16 a[210:211], v33 offset:2048
CV v114,v132,v133
CV v115,v134,v135
MM v[248:251],a[244:247],a[28:31],0
ds_read_b64_tr_b16 a[212:213], v33 offset:4096
buffer_load_dwordx4 v18, s[48:51], s20 offen offset:0 sc1 lds
CV v116,v136,v137
CV v117,v138,v139
MM v[248:251],a[240:243],a[20:23],v[248:251]
ds_read_b64_tr_b16 a[214:215], v33 offset:6144
CV v118,v140,v141
CV v119,v142,v143
MM v[220:223],a[248:251],a[16:19],0
ds_read_b64_tr_b16 a[216:217], v33 offset:16384
buffer_load_dwordx4 v19, s[48:51], s20 offen offset:1024 sc1 lds
CV v120,v144,v145
CV v121,v146,v147
MM v[220:223],a[252:255],a[24:27],v[220:223]
ds_read_b64_tr_b16 a[218:219], v33 offset:18432
s_add_u32 s12, s12, 81920
CV v122,v148,v149
CV v123,v150,v151
MM v[252:255],a[252:255],a[28:31],0
ds_read_b64_tr_b16 a[220:221], v33 offset:20480
s_add_u32 m0, s19, 98304
CV v124,v152,v153
CV v125,v154,v155
MM v[252:255],a[248:251],a[20:23],v[252:255]
ds_read_b64_tr_b16 a[222:223], v33 offset:22528
CV v126,v156,v157
CV v127,v158,v159
s_waitcnt vmcnt(20) lgkmcnt(8)
MM v[192:195],a[192:195],a[32:35],v[192:195]
ds_read_b64_tr_b16 a[224:225], v34 offset:0
buffer_load_dwordx4 a[176:179], v16, s[40:43], s11 offen sc1
MM v[192:195],a[196:199],a[40:43],v[192:195]
ds_read_b64_tr_b16 a[226:227], v34 offset:2048
MM v[192:195],a[200:203],a[48:51],v[192:195]
ds_read_b64_tr_b16 a[228:229], v34 offset:4096
buffer_load_dwordx4 a[180:183], v17, s[40:43], s11 offen sc1
MM v[192:195],a[204:207],a[56:59],v[192:195]
ds_read_b64_tr_b16 a[230:231], v34 offset:6144
s_add_u32 s11, s11, 8192
MM v[224:227],a[204:207],a[60:63],v[224:227]
ds_read_b64_tr_b16 a[232:233], v34 offset:16384
buffer_store_dwordx4 v[160:163], v1, s[32:35], s16 offen offset:0 sc0 sc1
MM v[224:227],a[200:203],a[52:55],v[224:227]
ds_read_b64_tr_b16 a[234:235], v34 offset:18432
MM v[224:227],a[196:199],a[44:47],v[224:227]
ds_read_b64_tr_b16 a[236:237], v34 offset:20480
buffer_store_dwordx4 v[112:115], v1, s[32:35], s17 offen offset:0 sc0 sc1
MM v[224:227],a[192:195],a[36:39],v[224:227]
ds_read_b64_tr_b16 a[238:239], v34 offset:22528
s_waitcnt lgkmcnt(8)
MM v[196:199],a[208:211],a[32:35],v[196:199]
ds_read_b64_tr_b16 a[240:241], v35 offset:0
buffer_load_dwordx4 v18, s[48:51], s12 offen offset:0 sc1 lds
MM v[196:199],a[212:215],a[40:43],v[196:199]
ds_read_b64_tr_b16 a[242:243], v35 offset:2048
MM v[196:199],a[216:219],a[48:51],v[196:199]
ds_read_b64_tr_b16 a[244:245], v35 offset:4096
buffer_load_dwordx4 v19, s[48:51], s12 offen offset:1024 sc1 lds
MM v[196:199],a[220:223],a[56:59],v[196:199]
ds_read_b64_tr_b16 a[246:247], v35 offset:6144
s_add_u32 m0, s19, 106496
MM v[228:231],a[220:223],a[60:63],v[228:231]
ds_read_b64_tr_b16 a[248:249], v35 offset:16384
s_add_u32 s20, s12, 128
MM v[228:231],a[216:219],a[52:55],v[228:231]
ds_read_b64_tr_b16 a[250:251], v35 offset:18432
MM v[228:231],a[212:215],a[44:47],v[228:231]
ds_read_b64_tr_b16 a[252:253], v35 offset:20480
buffer_load_dwordx4 v18, s[48:51], s20 offen offset:0 sc1 lds
MM v[228:231],a[208:211],a[36:39],v[228:231]
ds_read_b64_tr_b16 a[254:255], v35 offset:22528
s_waitcnt vmcnt(27) lgkmcnt(8)
MM v[200:203],a[224:227],a[32:35],v[200:203]
ds_read_b64_tr_b16 a[192:193], v32 offset:8192
buffer_load_dwordx4 a[184:187], v16, s[40:43], s11 offen sc1
MM v[200:203],a[228:231],a[40:43],v[200:203]
ds_read_b64_tr_b16 a[194:195], v32 offset:10240
MM v[200:203],a[232:235],a[48:51],v[200:203]
ds_read_b64_tr_b16 a[196:197], v32 offset:12288
buffer_load_dwordx4 a[188:191], v17, s[40:43], s11 offen sc1
MM v[200:203],a[236:239],a[56:59],v[200:203]
ds_read_b64_tr_b16 a[198:199], v32 offset:14336
s_add_u32 s11, s11, 8192
MM v[232:235],a[236:239],a[60:63],v[232:235]
ds_read_b64_tr_b16 a[200:201], v32 offset:24576
buffer_store_dwordx4 v[164:167], v1, s[32:35], s16 offen offset:1024 sc0 sc1
MM v[232:235],a[232:235],a[52:55],v[232:235]
ds_read_b64_tr_b16 a[202:203], v32 offset:26624
MM v[232:235],a[228:231],a[44:47],v[232:235]
ds_read_b64_tr_b16 a[204:205], v32 offset:28672
buffer_store_dwordx4 v[116:119], v1, s[32:35], s17 offen offset:1024 sc0 sc1
MM v[232:235],a[224:227],a[36:39],v[232:235]
ds_read_b64_tr_b16 a[206:207], v32 offset:30720
s_waitcnt lgkmcnt(8)
MM v[204:207],a[240:243],a[32:35],v[204:207]
ds_read_b64_tr_b16 a[208:209], v33 offset:8192
buffer_load_dwordx4 v19, s[48:51], s20 offen offset:1024 sc1 lds
MM v[204:207],a[244:247],a[40:43],v[204:207]
ds_read_b64_tr_b16 a[210:211], v33 offset:10240
s_add_u32 s12, s12, 81920
MM v[204:207],a[248:251],a[48:51],v[204:207]
ds_read_b64_tr_b16 a[212:213], v33 offset:12288
s_add_u32 m0, s19, 114688
MM v[204:207],a[252:255],a[56:59],v[204:207]
ds_read_b64_tr_b16 a[214:215], v33 offset:14336
MM v[236:239],a[252:255],a[60:63],v[236:239]
ds_read_b64_tr_b16 a[216:217], v33 offset:24576
buffer_load_dwordx4 v18, s[48:51], s12 offen offset:0 sc1 lds
MM v[236:239],a[248:251],a[52:55],v[236:239]
ds_read_b64_tr_b16 a[218:219], v33 offset:26624
MM v[236:239],a[244:247],a[44:47],v[236:239]
ds_read_b64_tr_b16 a[220:221], v33 offset:28672
buffer_load_dwordx4 v19, s[48:51], s12 offen offset:1024 sc1 lds
MM v[236:239],a[240:243],a[36:39],v[236:239]
ds_read_b64_tr_b16 a[222:223], v33 offset:30720
s_add_u32 m0, s19, 122880
s_waitcnt vmcnt(34) lgkmcnt(8)
MM v[208:211],a[192:195],a[32:35],v[208:211]
ds_read_b64_tr_b16 a[224:225], v34 offset:8192
buffer_load_dwordx4 a[0:3], v16, s[40:43], s11 offen sc1
MM v[208:211],a[196:199],a[40:43],v[208:211]
ds_read_b64_tr_b16 a[226:227], v34 offset:10240
MM v[208:211],a[200:203],a[48:51],v[208:211]
ds_read_b64_tr_b16 a[228:229], v34 offset:12288
buffer_load_dwordx4 a[4:7], v17, s[40:43], s11 offen sc1
MM v[208:211],a[204:207],a[56:59],v[208:211]
ds_read_b64_tr_b16 a[230:231], v34 offset:14336
s_add_u32 s11, s11, 8192
MM v[240:243],a[204:207],a[60:63],v[240:243]
ds_read_b64_tr_b16 a[232:233], v34 offset:24576
buffer_store_dwordx4 v[168:171], v1, s[32:35], s16 offen offset:2048 sc0 sc1
MM v[240:243],a[200:203],a[52:55],v[240:243]
ds_read_b64_tr_b16 a[234:235], v34 offset:26624
MM v[240:243],a[196:199],a[44:47],v[240:243]
ds_read_b64_tr_b16 a[236:237], v34 offset:28672
buffer_store_dwordx4 v[120:123], v1, s[32:35], s17 offen offset:2048 sc0 sc1
MM v[240:243],a[192:195],a[36:39],v[240:243]
ds_read_b64_tr_b16 a[238:239], v34 offset:30720
s_add_u32 s20, s12, 128
s_waitcnt lgkmcnt(8)
MM v[212:215],a[208:211],a[32:35],v[212:215]
ds_read_b64_tr_b16 a[240:241], v35 offset:8192
buffer_load_dwordx4 v18, s[48:51], s20 offen offset:0 sc1 lds
MM v[212:215],a[212:215],a[40:43],v[212:215]
ds_read_b64_tr_b16 a[242:243], v35 offset:10240
MM v[212:215],a[216:219],a[48:51],v[212:215]
ds_read_b64_tr_b16 a[244:245], v35 offset:12288
buffer_load_dwordx4 v19, s[48:51], s20 offen offset:1024 sc1 lds
MM v[212:215],a[220:223],a[56:59],v[212:215]
ds_read_b64_tr_b16 a[246:247], v35 offset:14336
s_add_u32 s12, s12, 81920
MM v[244:247],a[220:223],a[60:63],v[244:247]
ds_read_b64_tr_b16 a[248:249], v35 offset:24576
MM v[244:247],a[216:219],a[52:55],v[244:247]
ds_read_b64_tr_b16 a[250:251], v35 offset:26624
MM v[244:247],a[212:215],a[44:47],v[244:247]
ds_read_b64_tr_b16 a[252:253], v35 offset:28672
MM v[244:247],a[208:211],a[36:39],v[244:247]
ds_read_b64_tr_b16 a[254:255], v35 offset:30720
s_waitcnt vmcnt(40) lgkmcnt(8)
MM v[216:219],a[224:227],a[32:35],v[216:219]
buffer_load_dwordx4 a[8:11], v16, s[40:43], s11 offen sc1
MM v[216:219],a[228:231],a[40:43],v[216:219]
MM v[216:219],a[232:235],a[48:51],v[216:219]
s_waitcnt vmcnt(55) lgkmcnt(0)
s_barrier
ds_read_b64_tr_b16 a[192:193], v32 offset:32768
ds_read_b64_tr_b16 a[194:195], v32 offset:34816
MM v[216:219],a[236:239],a[56:59],v[216:219]
ds_read_b64_tr_b16 a[196:197], v32 offset:36864
ds_read_b64_tr_b16 a[198:199], v32 offset:38912
MM v[248:251],a[236:239],a[60:63],v[248:251]
ds_read_b64_tr_b16 a[200:201], v32 offset:49152
buffer_load_dwordx4 a[12:15], v17, s[40:43], s11 offen sc1
MM v[248:251],a[232:235],a[52:55],v[248:251]
ds_read_b64_tr_b16 a[202:203], v32 offset:51200
s_add_u32 s11, s11, 8192
MM v[248:251],a[228:231],a[44:47],v[248:251]
ds_read_b64_tr_b16 a[204:205], v32 offset:53248
buffer_store_dwordx4 v[172:175], v1, s[32:35], s16 offen offset:3072 sc0 sc1
MM v[248:251],a[224:227],a[36:39],v[248:251]
ds_read_b64_tr_b16 a[206:207], v32 offset:55296
s_waitcnt lgkmcnt(8)
MM v[220:223],a[240:243],a[32:35],v[220:223]
ds_read_b64_tr_b16 a[208:209], v33 offset:32768
buffer_store_dwordx4 v[124:127], v1, s[32:35], s17 offen offset:3072 sc0 sc1
MM v[220:223],a[244:247],a[40:43],v[220:223]
ds_read_b64_tr_b16 a[210:211], v33 offset:34816
s_add_u32 m0, s19, 0
MM v[220:223],a[248:251],a[48:51],v[220:223]
ds_read_b64_tr_b16 a[212:213], v33 offset:36864
buffer_load_dwordx4 v18, s[48:51], s12 offen offset:0 sc1 lds
MM v[220:223],a[252:255],a[56:59],v[220:223]
ds_read_b64_tr_b16 a[214:215], v33 offset:38912
MM v[252:255],a[252:255],a[60:63],v[252:255]
ds_read_b64_tr_b16 a[216:217], v33 offset:49152
buffer_load_dwordx4 v19, s[48:51], s12 offen offset:1024 sc1 lds
MM v[252:255],a[248:251],a[52:55],v[252:255]
ds_read_b64_tr_b16 a[218:219], v33 offset:51200
s_add_u32 m0, s19, 8192
MM v[252:255],a[244:247],a[44:47],v[252:255]
ds_read_b64_tr_b16 a[220:221], v33 offset:53248
s_add_u32 s20, s12, 128
MM v[252:255],a[240:243],a[36:39],v[252:255]
ds_read_b64_tr_b16 a[222:223], v33 offset:55296
s_waitcnt vmcnt(36) lgkmcnt(8)
MM v[192:195],a[192:195],a[128:131],v[192:195]
ds_read_b64_tr_b16 a[224:225], v34 offset:32768
buffer_load_dwordx4 a[16:19], v16, s[40:43], s11 offen sc1
MM v[192:195],a[196:199],a[136:139],v[192:195]
ds_read_b64_tr_b16 a[226:227], v34 offset:34816
MM v[192:195],a[200:203],a[144:147],v[192:195]
ds_read_b64_tr_b16 a[228:229], v34 offset:36864
buffer_load_dwordx4 a[20:23], v17, s[40:43], s11 offen sc1
MM v[192:195],a[204:207],a[152:155],v[192:195]
ds_read_b64_tr_b16 a[230:231], v34 offset:38912
s_add_u32 s11, s11, 8192
MM v[224:227],a[204:207],a[156:159],v[224:227]
ds_read_b64_tr_b16 a[232:233], v34 offset:49152
buffer_load_dwordx4 v18, s[48:51], s20 offen offset:0 sc1 lds
MM v[224:227],a[200:203],a[148:151],v[224:227]
ds_read_b64_tr_b16 a[234:235], v34 offset:51200
MM v[224:227],a[196:199],a[140:143],v[224:227]
ds_read_b64_tr_b16 a[236:237], v34 offset:53248
buffer_load_dwordx4 v19, s[48:51], s20 offen offset:1024 sc1 lds
MM v[224:227],a[192:195],a[132:135],v[224:227]
ds_read_b64_tr_b16 a[238:239], v34 offset:55296
s_add_u32 s12, s12, 81920
s_waitcnt lgkmcnt(8)
MM v[196:199],a[208:211],a[128:131],v[196:199]
ds_read_b64_tr_b16 a[240:241], v35 offset:32768
s_add_u32 m0, s19, 16384
MM v[196:199],a[212:215],a[136:139],v[196:199]
ds_read_b64_tr_b16 a[242:243], v35 offset:34816
MM v[196:199],a[216:219],a[144:147],v[196:199]
ds_read_b64_tr_b16 a[244:245], v35 offset:36864
buffer_load_dwordx4 v18, s[48:51], s12 offen offset:0 sc1 lds
MM v[196:199],a[220:223],a[152:155],v[196:199]
ds_read_b64_tr_b16 a[246:247], v35 offset:38912
MM v[228:231],a[220:223],a[156:159],v[228:231]
ds_read_b64_tr_b16 a[248:249], v35 offset:49152
buffer_load_dwordx4 v19, s[48:51], s12 offen offset:1024 sc1 lds
MM v[228:231],a[216:219],a[148:151],v[228:231]
ds_read_b64_tr_b16 a[250:251], v35 offset:51200
s_add_u32 m0, s19, 24576
MM v[228:231],a[212:215],a[140:143],v[228:231]
ds_read_b64_tr_b16 a[252:253], v35 offset:53248
s_add_u32 s20, s12, 128
MM v[228:231],a[208:211],a[132:135],v[228:231]
ds_read_b64_tr_b16 a[254:255], v35 offset:55296
s_waitcnt vmcnt(42) lgkmcnt(8)
MM v[200:203],a[224:227],a[128:131],v[200:203]
ds_read_b64_tr_b16 a[192:193], v32 offset:40960
buffer_load_dwordx4 a[24:27], v16, s[40:43], s11 offen sc1
MM v[200:203],a[228:231],a[136:139],v[200:203]
ds_read_b64_tr_b16 a[194:195], v32 offset:43008
MM v[200:203],a[232:235],a[144:147],v[200:203]
ds_read_b64_tr_b16 a[196:197], v32 offset:45056
buffer_load_dwordx4 a[28:31], v17, s[40:43], s11 offen sc1
MM v[200:203],a[236:239],a[152:155],v[200:203]
ds_read_b64_tr_b16 a[198:199], v32 offset:47104
s_add_u32 s11, s11, 8192
MM v[232:235],a[236:239],a[156:159],v[232:235]
ds_read_b64_tr_b16 a[200:201], v32 offset:57344
buffer_load_dwordx4 v18, s[48:51], s20 offen offset:0 sc1 lds
MM v[232:235],a[232:235],a[148:151],v[232:235]
ds_read_b64_tr_b16 a[202:203], v32 offset:59392
MM v[232:235],a[228:231],a[140:143],v[232:235]
ds_read_b64_tr_b16 a[204:205], v32 offset:61440
buffer_load_dwordx4 v19, s[48:51], s20 offen offset:1024 sc1 lds
MM v[232:235],a[224:227],a[132:135],v[232:235]
ds_read_b64_tr_b16 a[206:207], v32 offset:63488
s_add_u32 s12, s12, 81920
s_waitcnt lgkmcnt(8)
MM v[204:207],a[240:243],a[128:131],v[204:207]
ds_read_b64_tr_b16 a[208:209], v33 offset:40960
MM v[204:207],a[244:247],a[136:139],v[204:207]
ds_read_b64_tr_b16 a[210:211], v33 offset:43008
MM v[204:207],a[248:251],a[144:147],v[204:207]
ds_read_b64_tr_b16 a[212:213], v33 offset:45056
MM v[204:207],a[252:255],a[152:155],v[204:207]
ds_read_b64_tr_b16 a[214:215], v33 offset:47104
MM v[236:239],a[252:255],a[156:159],v[236:239]
ds_read_b64_tr_b16 a[216:217], v33 offset:57344
MM v[236:239],a[248:251],a[148:151],v[236:239]
ds_read_b64_tr_b16 a[218:219], v33 offset:59392
MM v[236:239],a[244:247],a[140:143],v[236:239]
ds_read_b64_tr_b16 a[220:221], v33 offset:61440
MM v[236:239],a[240:243],a[132:135],v[236:239]
ds_read_b64_tr_b16 a[222:223], v33 offset:63488
s_waitcnt vmcnt(46) lgkmcnt(8)
MM v[208:211],a[192:195],a[128:131],v[208:211]
ds_read_b64_tr_b16 a[224:225], v34 offset:40960
buffer_load_dwordx4 a[32:35], v16, s[40:43], s11 offen sc1
MM v[208:211],a[196:199],a[136:139],v[208:211]
ds_read_b64_tr_b16 a[226:227], v34 offset:43008
MM v[208:211],a[200:203],a[144:147],v[208:211]
ds_read_b64_tr_b16 a[228:229], v34 offset:45056
buffer_load_dwordx4 a[36:39], v17, s[40:43], s11 offen sc1
MM v[208:211],a[204:207],a[152:155],v[208:211]
ds_read_b64_tr_b16 a[230:231], v34 offset:47104
s_add_u32 s11, s11, 8192
MM v[240:243],a[204:207],a[156:159],v[240:243]
ds_read_b64_tr_b16 a[232:233], v34 offset:57344
MM v[240:243],a[200:203],a[148:151],v[240:243]
ds_read_b64_tr_b16 a[234:235], v34 offset:59392
MM v[240:243],a[196:199],a[140:143],v[240:243]
ds_read_b64_tr_b16 a[236:237], v34 offset:61440
MM v[240:243],a[192:195],a[132:135],v[240:243]
ds_read_b64_tr_b16 a[238:239], v34 offset:63488
s_waitcnt lgkmcnt(8)
MM v[212:215],a[208:211],a[128:131],v[212:215]
ds_read_b64_tr_b16 a[240:241], v35 offset:40960
MM v[212:215],a[212:215],a[136:139],v[212:215]
ds_read_b64_tr_b16 a[242:243], v35 offset:43008
MM v[212:215],a[216:219],a[144:147],v[212:215]
ds_read_b64_tr_b16 a[244:245], v35 offset:45056
MM v[212:215],a[220:223],a[152:155],v[212:215]
ds_read_b64_tr_b16 a[246:247], v35 offset:47104
MM v[244:247],a[220:223],a[156:159],v[244:247]
ds_read_b64_tr_b16 a[248:249], v35 offset:57344
MM v[244:247],a[216:219],a[148:151],v[244:247]
ds_read_b64_tr_b16 a[250:251], v35 offset:59392
MM v[244:247],a[212:215],a[140:143],v[244:247]
ds_read_b64_tr_b16 a[252:253], v35 offset:61440
MM v[244:247],a[208:211],a[132:135],v[244:247]
ds_read_b64_tr_b16 a[254:255], v35 offset:63488
s_waitcnt vmcnt(48) lgkmcnt(8)
MM v[216:219],a[224:227],a[128:131],v[216:219]
buffer_load_dwordx4 a[40:43], v16, s[40:43], s11 offen sc1
MM v[216:219],a[228:231],a[136:139],v[216:219]
MM v[216:219],a[232:235],a[144:147],v[216:219]
s_waitcnt vmcnt(39) lgkmcnt(0)
s_barrier
ds_read_b64_tr_b16 a[192:193], v36 offset:0
ds_read_b64_tr_b16 a[194:195], v36 offset:2048
MM v[216:219],a[236:239],a[152:155],v[216:219]
ds_read_b64_tr_b16 a[196:197], v36 offset:4096
ds_read_b64_tr_b16 a[198:199], v36 offset:6144
MM v[248:251],a[236:239],a[156:159],v[248:251]
ds_read_b64_tr_b16 a[200:201], v36 offset:16384
buffer_load_dwordx4 a[44:47], v17, s[40:43], s11 offen sc1
MM v[248:251],a[232:235],a[148:151],v[248:251]
ds_read_b64_tr_b16 a[202:203], v36 offset:18432
s_add_u32 s11, s11, 8192
MM v[248:251],a[228:231],a[140:143],v[248:251]
ds_read_b64_tr_b16 a[204:205], v36 offset:20480
s_add_u32 m0, s19, 32768
MM v[248:251],a[224:227],a[132:135],v[248:251]
ds_read_b64_tr_b16 a[206:207], v36 offset:22528
s_waitcnt lgkmcnt(8)
MM v[220:223],a[240:243],a[128:131],v[220:223]
ds_read_b64_tr_b16 a[208:209], v37 offset:0
buffer_load_dwordx4 v18, s[48:51], s12 offen offset:0 sc1 lds
MM v[220:223],a[244:247],a[136:139],v[220:223]
ds_read_b64_tr_b16 a[210:211], v37 offset:2048
MM v[220:223],a[248:251],a[144:147],v[220:223]
ds_read_b64_tr_b16 a[212:213], v37 offset:4096
buffer_load_dwordx4 v19, s[48:51], s12 offen offset:1024 sc1 lds
MM v[220:223],a[252:255],a[152:155],v[220:223]
ds_read_b64_tr_b16 a[214:215], v37 offset:6144
s_add_u32 m0, s19, 40960
MM v[252:255],a[252:255],a[156:159],v[252:255]
ds_read_b64_tr_b16 a[216:217], v37 offset:16384
s_add_u32 s20, s12, 128
MM v[252:255],a[248:251],a[148:151],v[252:255]
ds_read_b64_tr_b16 a[218:219], v37 offset:18432
MM v[252:255],a[244:247],a[140:143],v[252:255]
ds_read_b64_tr_b16 a[220:221], v37 offset:20480
buffer_load_dwordx4 v18, s[48:51], s20 offen offset:0 sc1 lds
MM v[252:255],a[240:243],a[132:135],v[252:255]
ds_read_b64_tr_b16 a[222:223], v37 offset:22528
s_waitcnt vmcnt(34) lgkmcnt(8)
MM v[192:195],a[192:195],a[160:163],v[192:195]
ds_read_b64_tr_b16 a[224:225], v38 offset:0
buffer_load_dwordx4 a[48:51], v16, s[40:43], s11 offen sc1
MM v[192:195],a[196:199],a[168:171],v[192:195]
ds_read_b64_tr_b16 a[226:227], v38 offset:2048
MM v[192:195],a[200:203],a[176:179],v[192:195]
ds_read_b64_tr_b16 a[228:229], v38 offset:4096
buffer_load_dwordx4 a[52:55], v17, s[40:43], s11 offen sc1
MM v[192:195],a[204:207],a[184:187],v[192:195]
ds_read_b64_tr_b16 a[230:231], v38 offset:6144
s_add_u32 s11, s11, 8192
MM v[224:227],a[204:207],a[188:191],v[224:227]
ds_read_b64_tr_b16 a[232:233], v38 offset:16384
buffer_load_dwordx4 v19, s[48:51], s20 offen offset:1024 sc1 lds
MM v[224:227],a[200:203],a[180:183],v[224:227]
ds_read_b64_tr_b16 a[234:235], v38 offset:18432
s_add_u32 s12, s12, 81920
MM v[224:227],a[196:199],a[172:175],v[224:227]
ds_read_b64_tr_b16 a[236:237], v38 offset:20480
s_add_u32 m0, s19, 49152
MM v[224:227],a[192:195],a[164:167],v[224:227]
ds_read_b64_tr_b16 a[238:239], v38 offset:22528
s_waitcnt lgkmcnt(8)
MM v[196:199],a[208:211],a[160:163],v[196:199]
ds_read_b64_tr_b16 a[240:241], v39 offset:0
buffer_load_dwordx4 v18, s[48:51], s12 offen offset:0 sc1 lds
MM v[196:199],a[212:215],a[168:171],v[196:199]
ds_read_b64_tr_b16 a[242:243], v39 offset:2048
MM v[196:199],a[216:219],a[176:179],v[196:199]
ds_read_b64_tr_b16 a[244:245], v39 offset:4096
buffer_load_dwordx4 v19, s[48:51], s12 offen offset:1024 sc1 lds
MM v[196:199],a[220:223],a[184:187],v[196:199]
ds_read_b64_tr_b16 a[246:247], v39 offset:6144
s_add_u32 m0, s19, 57344
MM v[228:231],a[220:223],a[188:191],v[228:231]
ds_read_b64_tr_b16 a[248:249], v39 offset:16384
s_add_u32 s20, s12, 128
MM v[228:231],a[216:219],a[180:183],v[228:231]
ds_read_b64_tr_b16 a[250:251], v39 offset:18432
MM v[228:231],a[212:215],a[172:175],v[228:231]
ds_read_b64_tr_b16 a[252:253], v39 offset:20480
buffer_load_dwordx4 v18, s[48:51], s20 offen offset:0 sc1 lds
MM v[228:231],a[208:211],a[164:167],v[228:231]
ds_read_b64_tr_b16 a[254:255], v39 offset:22528
s_waitcnt vmcnt(40) lgkmcnt(8)
MM v[200:203],a[224:227],a[160:163],v[200:203]
ds_read_b64_tr_b16 a[192:193], v36 offset:8192
buffer_load_dwordx4 a[56:59], v16, s[40:43], s11 offen sc1
MM v[200:203],a[228:231],a[168:171],v[200:203]
ds_read_b64_tr_b16 a[194:195], v36 offset:10240
MM v[200:203],a[232:235],a[176:179],v[200:203]
ds_read_b64_tr_b16 a[196:197], v36 offset:12288
buffer_load_dwordx4 a[60:63], v17, s[40:43], s11 offen sc1
MM v[200:203],a[236:239],a[184:187],v[200:203]
ds_read_b64_tr_b16 a[198:199], v36 offset:14336
s_add_u32 s11, s11, 8192
MM v[232:235],a[236:239],a[188:191],v[232:235]
ds_read_b64_tr_b16 a[200:201], v36 offset:24576
buffer_load_dwordx4 v19, s[48:51], s20 offen offset:1024 sc1 lds
MM v[232:235],a[232:235],a[180:183],v[232:235]
ds_read_b64_tr_b16 a[202:203], v36 offset:26624
s_add_u32 s12, s12, 81920
MM v[232:235],a[228:231],a[172:175],v[232:235]
ds_read_b64_tr_b16 a[204:205], v36 offset:28672
MM v[232:235],a[224:227],a[164:167],v[232:235]
ds_read_b64_tr_b16 a[206:207], v36 offset:30720
s_waitcnt lgkmcnt(8)
MM v[204:207],a[240:243],a[160:163],v[204:207]
ds_read_b64_tr_b16 a[208:209], v37 offset:8192
MM v[204:207],a[244:247],a[168:171],v[204:207]
ds_read_b64_tr_b16 a[210:211], v37 offset:10240
MM v[204:207],a[248:251],a[176:179],v[204:207]
ds_read_b64_tr_b16 a[212:213], v37 offset:12288
MM v[204:207],a[252:255],a[184:187],v[204:207]
ds_read_b64_tr_b16 a[214:215], v37 offset:14336
MM v[236:239],a[252:255],a[188:191],v[236:239]
ds_read_b64_tr_b16 a[216:217], v37 offset:24576
MM v[236:239],a[248:251],a[180:183],v[236:239]
ds_read_b64_tr_b16 a[218:219], v37 offset:26624
MM v[236:239],a[244:247],a[172:175],v[236:239]
ds_read_b64_tr_b16 a[220:221], v37 offset:28672
MM v[236:239],a[240:243],a[164:167],v[236:239]
ds_read_b64_tr_b16 a[222:223], v37 offset:30720
s_waitcnt vmcnt(28) lgkmcnt(8)
MM v[208:211],a[192:195],a[160:163],v[208:211]
ds_read_b64_tr_b16 a[224:225], v38 offset:8192
buffer_load_dwordx4 a[128:131], v16, s[40:43], s11 offen sc1
MM v[208:211],a[196:199],a[168:171],v[208:211]
ds_read_b64_tr_b16 a[226:227], v38 offset:10240
MM v[208:211],a[200:203],a[176:179],v[208:211]
ds_read_b64_tr_b16 a[228:229], v38 offset:12288
buffer_load_dwordx4 a[132:135], v17, s[40:43], s11 offen sc1
MM v[208:211],a[204:207],a[184:187],v[208:211]
ds_read_b64_tr_b16 a[230:231], v38 offset:14336
s_add_u32 s11, s11, 8192
MM v[240:243],a[204:207],a[188:191],v[240:243]
ds_read_b64_tr_b16 a[232:233], v38 offset:24576
buffer_store_dword v61, v60, s[32:35], s56 offen sc0 sc1
MM v[240:243],a[200:203],a[180:183],v[240:243]
ds_read_b64_tr_b16 a[234:235], v38 offset:26624
s_add_u32 s56, s56, 512
MM v[240:243],a[196:199],a[172:175],v[240:243]
ds_read_b64_tr_b16 a[236:237], v38 offset:28672
s_add_u32 s17, s17, 32768
MM v[240:243],a[192:195],a[164:167],v[240:243]
ds_read_b64_tr_b16 a[238:239], v38 offset:30720
s_add_u32 s16, s16, 32768
s_waitcnt lgkmcnt(8)
MM v[212:215],a[208:211],a[160:163],v[212:215]
ds_read_b64_tr_b16 a[240:241], v39 offset:8192
MM v[212:215],a[212:215],a[168:171],v[212:215]
ds_read_b64_tr_b16 a[242:243], v39 offset:10240
MM v[212:215],a[216:219],a[176:179],v[212:215]
ds_read_b64_tr_b16 a[244:245], v39 offset:12288
MM v[212:215],a[220:223],a[184:187],v[212:215]
ds_read_b64_tr_b16 a[246:247], v39 offset:14336
MM v[244:247],a[220:223],a[188:191],v[244:247]
ds_read_b64_tr_b16 a[248:249], v39 offset:24576
MM v[244:247],a[216:219],a[180:183],v[244:247]
ds_read_b64_tr_b16 a[250:251], v39 offset:26624
MM v[244:247],a[212:215],a[172:175],v[244:247]
ds_read_b64_tr_b16 a[252:253], v39 offset:28672
MM v[244:247],a[208:211],a[164:167],v[244:247]
ds_read_b64_tr_b16 a[254:255], v39 offset:30720
s_waitcnt vmcnt(46) lgkmcnt(8)
MM v[216:219],a[224:227],a[160:163],v[216:219]
buffer_load_dwordx4 a[136:139], v16, s[40:43], s11 offen sc1
MM v[216:219],a[228:231],a[168:171],v[216:219]
MM v[216:219],a[232:235],a[176:179],v[216:219]
s_waitcnt vmcnt(36) lgkmcnt(0)
s_barrier
ds_read_b64_tr_b16 a[192:193], v36 offset:32768
ds_read_b64_tr_b16 a[194:195], v36 offset:34816
MM v[216:219],a[236:239],a[184:187],v[216:219]
ds_read_b64_tr_b16 a[196:197], v36 offset:36864
ds_read_b64_tr_b16 a[198:199], v36 offset:38912
MM v[248:251],a[236:239],a[188:191],v[248:251]
ds_read_b64_tr_b16 a[200:201], v36 offset:49152
buffer_load_dwordx4 a[140:143], v17, s[40:43], s11 offen sc1
MM v[248:251],a[232:235],a[180:183],v[248:251]
ds_read_b64_tr_b16 a[202:203], v36 offset:51200
s_add_u32 s11, s11, 8192
MM v[248:251],a[228:231],a[172:175],v[248:251]
ds_read_b64_tr_b16 a[204:205], v36 offset:53248
s_add_u32 m0, s19, 65536
MM v[248:251],a[224:227],a[164:167],v[248:251]
ds_read_b64_tr_b16 a[206:207], v36 offset:55296
s_waitcnt lgkmcnt(8)
MM v[220:223],a[240:243],a[160:163],v[220:223]
ds_read_b64_tr_b16 a[208:209], v37 offset:32768
buffer_load_dwordx4 v18, s[48:51], s12 offen offset:0 sc1 lds
MM v[220:223],a[244:247],a[168:171],v[220:223]
ds_read_b64_tr_b16 a[210:211], v37 offset:34816
MM v[220:223],a[248:251],a[176:179],v[220:223]
ds_read_b64_tr_b16 a[212:213], v37 offset:36864
buffer_load_dwordx4 v19, s[48:51], s12 offen offset:1024 sc1 lds
MM v[220:223],a[252:255],a[184:187],v[220:223]
ds_read_b64_tr_b16 a[214:215], v37 offset:38912
s_add_u32 m0, s19, 73728
MM v[252:255],a[252:255],a[188:191],v[252:255]
ds_read_b64_tr_b16 a[216:217], v37 offset:49152
s_add_u32 s20, s12, 128
MM v[252:255],a[248:251],a[180:183],v[252:255]
ds_read_b64_tr_b16 a[218:219], v37 offset:51200
MM v[252:255],a[244:247],a[172:175],v[252:255]
ds_read_b64_tr_b16 a[220:221], v37 offset:53248
buffer_load_dwordx4 v18, s[48:51], s20 offen offset:0 sc1 lds
MM v[252:255],a[240:243],a[164:167],v[252:255]
ds_read_b64_tr_b16 a[222:223], v37 offset:55296
s_waitcnt vmcnt(26) lgkmcnt(8)
MM v[192:195],a[192:195],a[0:3],v[192:195]
ds_read_b64_tr_b16 a[224:225], v38 offset:32768
buffer_load_dwordx4 a[144:147], v16, s[40:43], s11 offen sc1
MM v[192:195],a[196:199],a[8:11],v[192:195]
ds_read_b64_tr_b16 a[226:227], v38 offset:34816
MM v[192:195],a[200:203],a[16:19],v[192:195]
ds_read_b64_tr_b16 a[228:229], v38 offset:36864
buffer_load_dwordx4 a[148:151], v17, s[40:43], s11 offen sc1
MM v[192:195],a[204:207],a[24:27],v[192:195]
ds_read_b64_tr_b16 a[230:231], v38 offset:38912
s_add_u32 s11, s11, 8192
MM v[224:227],a[204:207],a[28:31],v[224:227]
ds_read_b64_tr_b16 a[232:233], v38 offset:49152
buffer_load_dwordx4 v19, s[48:51], s20 offen offset:1024 sc1 lds
MM v[224:227],a[200:203],a[20:23],v[224:227]
ds_read_b64_tr_b16 a[234:235], v38 offset:51200
s_add_u32 s12, s12, 81920
MM v[224:227],a[196:199],a[12:15],v[224:227]
ds_read_b64_tr_b16 a[236:237], v38 offset:53248
s_add_u32 m0, s19, 81920
MM v[224:227],a[192:195],a[4:7],v[224:227]
ds_read_b64_tr_b16 a[238:239], v38 offset:55296
s_waitcnt lgkmcnt(8)
MM v[196:199],a[208:211],a[0:3],v[196:199]
ds_read_b64_tr_b16 a[240:241], v39 offset:32768
buffer_load_dwordx4 v18, s[48:51], s12 offen offset:0 sc1 lds
MM v[196:199],a[212:215],a[8:11],v[196:199]
ds_read_b64_tr_b16 a[242:243], v39 offset:34816
MM v[196:199],a[216:219],a[16:19],v[196:199]
ds_read_b64_tr_b16 a[244:245], v39 offset:36864
buffer_load_dwordx4 v19, s[48:51], s12 offen offset:1024 sc1 lds
MM v[196:199],a[220:223],a[24:27],v[196:199]
ds_read_b64_tr_b16 a[246:247], v39 offset:38912
s_add_u32 m0, s19, 90112
MM v[228:231],a[220:223],a[28:31],v[228:231]
ds_read_b64_tr_b16 a[248:249], v39 offset:49152
s_add_u32 s20, s12, 128
MM v[228:231],a[216:219],a[20:23],v[228:231]
ds_read_b64_tr_b16 a[250:251], v39 offset:51200
MM v[228:231],a[212:215],a[12:15],v[228:231]
ds_read_b64_tr_b16 a[252:253], v39 offset:53248
buffer_load_dwordx4 v18, s[48:51], s20 offen offset:0 sc1 lds
MM v[228:231],a[208:211],a[4:7],v[228:231]
ds_read_b64_tr_b16 a[254:255], v39 offset:55296
s_waitcnt vmcnt(32) lgkmcnt(8)
MM v[200:203],a[224:227],a[0:3],v[200:203]
ds_read_b64_tr_b16 a[192:193], v36 offset:40960
buffer_load_dwordx4 a[152:155], v16, s[40:43], s11 offen sc1
MM v[200:203],a[228:231],a[8:11],v[200:203]
ds_read_b64_tr_b16 a[194:195], v36 offset:43008
MM v[200:203],a[232:235],a[16:19],v[200:203]
ds_read_b64_tr_b16 a[196:197], v36 offset:45056
buffer_load_dwordx4 a[156:159], v17, s[40:43], s11 offen sc1
MM v[200:203],a[236:239],a[24:27],v[200:203]
ds_read_b64_tr_b16 a[198:199], v36 offset:47104
s_add_u32 s11, s11, 8192
MM v[232:235],a[236:239],a[28:31],v[232:235]
ds_read_b64_tr_b16 a[200:201], v36 offset:57344
buffer_load_dword v24, v22, s[32:35], s75 offen sc0 sc1
MM v[232:235],a[232:235],a[20:23],v[232:235]
ds_read_b64_tr_b16 a[202:203], v36 offset:59392
MM v[232:235],a[228:231],a[12:15],v[232:235]
ds_read_b64_tr_b16 a[204:205], v36 offset:61440
buffer_load_dwordx4 v19, s[48:51], s20 offen offset:1024 sc1 lds
MM v[232:235],a[224:227],a[4:7],v[232:235]
ds_read_b64_tr_b16 a[206:207], v36 offset:63488
s_add_u32 s12, s12, 81920
s_waitcnt lgkmcnt(8)
MM v[204:207],a[240:243],a[0:3],v[204:207]
ds_read_b64_tr_b16 a[208:209], v37 offset:40960
MM v[204:207],a[244:247],a[8:11],v[204:207]
ds_read_b64_tr_b16 a[210:211], v37 offset:43008
MM v[204:207],a[248:251],a[16:19],v[204:207]
ds_read_b64_tr_b16 a[212:213], v37 offset:45056
MM v[204:207],a[252:255],a[24:27],v[204:207]
ds_read_b64_tr_b16 a[214:215], v37 offset:47104
MM v[236:239],a[252:255],a[28:31],v[236:239]
ds_read_b64_tr_b16 a[216:217], v37 offset:57344
MM v[236:239],a[248:251],a[20:23],v[236:239]
ds_read_b64_tr_b16 a[218:219], v37 offset:59392
MM v[236:239],a[244:247],a[12:15],v[236:239]
ds_read_b64_tr_b16 a[220:221], v37 offset:61440
MM v[236:239],a[240:243],a[4:7],v[236:239]
ds_read_b64_tr_b16 a[222:223], v37 offset:63488
s_waitcnt vmcnt(36) lgkmcnt(8)
MM v[208:211],a[192:195],a[0:3],v[208:211]
ds_read_b64_tr_b16 a[224:225], v38 offset:40960
buffer_load_dwordx4 a[160:163], v16, s[40:43], s11 offen sc1
MM v[208:211],a[196:199],a[8:11],v[208:211]
ds_read_b64_tr_b16 a[226:227], v38 offset:43008
MM v[208:211],a[200:203],a[16:19],v[208:211]
ds_read_b64_tr_b16 a[228:229], v38 offset:45056
buffer_load_dwordx4 a[164:167], v17, s[40:43], s11 offen sc1
MM v[208:211],a[204:207],a[24:27],v[208:211]
ds_read_b64_tr_b16 a[230:231], v38 offset:47104
s_add_u32 s11, s11, 8192
MM v[240:243],a[204:207],a[28:31],v[240:243]
ds_read_b64_tr_b16 a[232:233], v38 offset:57344
MM v[240:243],a[200:203],a[20:23],v[240:243]
ds_read_b64_tr_b16 a[234:235], v38 offset:59392
MM v[240:243],a[196:199],a[12:15],v[240:243]
ds_read_b64_tr_b16 a[236:237], v38 offset:61440
MM v[240:243],a[192:195],a[4:7],v[240:243]
ds_read_b64_tr_b16 a[238:239], v38 offset:63488
s_waitcnt lgkmcnt(8)
MM v[212:215],a[208:211],a[0:3],v[212:215]
ds_read_b64_tr_b16 a[240:241], v39 offset:40960
MM v[212:215],a[212:215],a[8:11],v[212:215]
ds_read_b64_tr_b16 a[242:243], v39 offset:43008
MM v[212:215],a[216:219],a[16:19],v[212:215]
ds_read_b64_tr_b16 a[244:245], v39 offset:45056
MM v[212:215],a[220:223],a[24:27],v[212:215]
ds_read_b64_tr_b16 a[246:247], v39 offset:47104
MM v[244:247],a[220:223],a[28:31],v[244:247]
ds_read_b64_tr_b16 a[248:249], v39 offset:57344
MM v[244:247],a[216:219],a[20:23],v[244:247]
ds_read_b64_tr_b16 a[250:251], v39 offset:59392
MM v[244:247],a[212:215],a[12:15],v[244:247]
ds_read_b64_tr_b16 a[252:253], v39 offset:61440
MM v[244:247],a[208:211],a[4:7],v[244:247]
ds_read_b64_tr_b16 a[254:255], v39 offset:63488
s_waitcnt vmcnt(38) lgkmcnt(8)
MM v[216:219],a[224:227],a[0:3],v[216:219]
buffer_load_dwordx4 a[168:171], v16, s[40:43], s11 offen sc1
MM v[216:219],a[228:231],a[8:11],v[216:219]
MM v[216:219],a[232:235],a[16:19],v[216:219]
s_waitcnt vmcnt(37) lgkmcnt(0)
s_barrier
ds_read_b64_tr_b16 a[192:193], v32 offset:0
ds_read_b64_tr_b16 a[194:195], v32 offset:2048
MM v[216:219],a[236:239],a[24:27],v[216:219]
ds_read_b64_tr_b16 a[196:197], v32 offset:4096
ds_read_b64_tr_b16 a[198:199], v32 offset:6144
MM v[248:251],a[236:239],a[28:31],v[248:251]
ds_read_b64_tr_b16 a[200:201], v32 offset:16384
buffer_load_dwordx4 a[172:175], v17, s[40:43], s11 offen sc1
MM v[248:251],a[232:235],a[20:23],v[248:251]
ds_read_b64_tr_b16 a[202:203], v32 offset:18432
s_add_u32 s11, s11, 8192
MM v[248:251],a[228:231],a[12:15],v[248:251]
ds_read_b64_tr_b16 a[204:205], v32 offset:20480
s_add_u32 m0, s19, 98304
MM v[248:251],a[224:227],a[4:7],v[248:251]
ds_read_b64_tr_b16 a[206:207], v32 offset:22528
s_waitcnt lgkmcnt(8)
MM v[220:223],a[240:243],a[0:3],v[220:223]
ds_read_b64_tr_b16 a[208:209], v33 offset:0
buffer_load_dwordx4 v18, s[48:51], s12 offen offset:0 sc1 lds
MM v[220:223],a[244:247],a[8:11],v[220:223]
ds_read_b64_tr_b16 a[210:211], v33 offset:2048
MM v[220:223],a[248:251],a[16:19],v[220:223]
ds_read_b64_tr_b16 a[212:213], v33 offset:4096
buffer_load_dwordx4 v19, s[48:51], s12 offen offset:1024 sc1 lds
MM v[220:223],a[252:255],a[24:27],v[220:223]
ds_read_b64_tr_b16 a[214:215], v33 offset:6144
s_add_u32 m0, s19, 106496
MM v[252:255],a[252:255],a[28:31],v[252:255]
ds_read_b64_tr_b16 a[216:217], v33 offset:16384
s_add_u32 s20, s12, 128
MM v[252:255],a[248:251],a[20:23],v[252:255]
ds_read_b64_tr_b16 a[218:219], v33 offset:18432
MM v[252:255],a[244:247],a[12:15],v[252:255]
ds_read_b64_tr_b16 a[220:221], v33 offset:20480
buffer_load_dwordx4 v18, s[48:51], s20 offen offset:0 sc1 lds
MM v[252:255],a[240:243],a[4:7],v[252:255]
ds_read_b64_tr_b16 a[222:223], v33 offset:22528
s_waitcnt vmcnt(26) lgkmcnt(8)
MM v[192:195],a[192:195],a[32:35],v[192:195]
ds_read_b64_tr_b16 a[224:225], v34 offset:0
buffer_load_dwordx4 a[176:179], v16, s[40:43], s11 offen sc1
MM v[192:195],a[196:199],a[40:43],v[192:195]
ds_read_b64_tr_b16 a[226:227], v34 offset:2048
MM v[192:195],a[200:203],a[48:51],v[192:195]
ds_read_b64_tr_b16 a[228:229], v34 offset:4096
buffer_load_dwordx4 a[180:183], v17, s[40:43], s11 offen sc1
MM v[192:195],a[204:207],a[56:59],v[192:195]
ds_read_b64_tr_b16 a[230:231], v34 offset:6144
s_add_u32 s11, s11, 8192
MM v[224:227],a[204:207],a[60:63],v[224:227]
ds_read_b64_tr_b16 a[232:233], v34 offset:16384
buffer_load_dwordx4 v19, s[48:51], s20 offen offset:1024 sc1 lds
MM v[224:227],a[200:203],a[52:55],v[224:227]
ds_read_b64_tr_b16 a[234:235], v34 offset:18432
s_add_u32 s12, s12, 81920
MM v[224:227],a[196:199],a[44:47],v[224:227]
ds_read_b64_tr_b16 a[236:237], v34 offset:20480
s_add_u32 m0, s19, 114688
MM v[224:227],a[192:195],a[36:39],v[224:227]
ds_read_b64_tr_b16 a[238:239], v34 offset:22528
s_waitcnt lgkmcnt(8)
MM v[196:199],a[208:211],a[32:35],v[196:199]
ds_read_b64_tr_b16 a[240:241], v35 offset:0
buffer_load_dwordx4 v18, s[48:51], s12 offen offset:0 sc1 lds
MM v[196:199],a[212:215],a[40:43],v[196:199]
ds_read_b64_tr_b16 a[242:243], v35 offset:2048
MM v[196:199],a[216:219],a[48:51],v[196:199]
ds_read_b64_tr_b16 a[244:245], v35 offset:4096
buffer_load_dwordx4 v19, s[48:51], s12 offen offset:1024 sc1 lds
MM v[196:199],a[220:223],a[56:59],v[196:199]
ds_read_b64_tr_b16 a[246:247], v35 offset:6144
s_add_u32 m0, s19, 122880
MM v[228:231],a[220:223],a[60:63],v[228:231]
ds_read_b64_tr_b16 a[248:249], v35 offset:16384
s_add_u32 s20, s12, 128
MM v[228:231],a[216:219],a[52:55],v[228:231]
ds_read_b64_tr_b16 a[250:251], v35 offset:18432
MM v[228:231],a[212:215],a[44:47],v[228:231]
ds_read_b64_tr_b16 a[252:253], v35 offset:20480
buffer_load_dwordx4 v18, s[48:51], s20 offen offset:0 sc1 lds
MM v[228:231],a[208:211],a[36:39],v[228:231]
ds_read_b64_tr_b16 a[254:255], v35 offset:22528
s_waitcnt vmcnt(32) lgkmcnt(8)
MM v[200:203],a[224:227],a[32:35],v[200:203]
ds_read_b64_tr_b16 a[192:193], v32 offset:8192
buffer_load_dwordx4 a[184:187], v16, s[40:43], s11 offen sc1
MM v[200:203],a[228:231],a[40:43],v[200:203]
ds_read_b64_tr_b16 a[194:195], v32 offset:10240
MM v[200:203],a[232:235],a[48:51],v[200:203]
ds_read_b64_tr_b16 a[196:197], v32 offset:12288
buffer_load_dwordx4 a[188:191], v17, s[40:43], s11 offen sc1
MM v[200:203],a[236:239],a[56:59],v[200:203]
ds_read_b64_tr_b16 a[198:199], v32 offset:14336
s_add_u32 s11, s11, 8192
MM v[232:235],a[236:239],a[60:63],v[232:235]
ds_read_b64_tr_b16 a[200:201], v32 offset:24576
buffer_load_dwordx4 v19, s[48:51], s20 offen offset:1024 sc1 lds
MM v[232:235],a[232:235],a[52:55],v[232:235]
ds_read_b64_tr_b16 a[202:203], v32 offset:26624
s_add_u32 s12, s12, 81920
MM v[232:235],a[228:231],a[44:47],v[232:235]
ds_read_b64_tr_b16 a[204:205], v32 offset:28672
MM v[232:235],a[224:227],a[36:39],v[232:235]
ds_read_b64_tr_b16 a[206:207], v32 offset:30720
s_waitcnt lgkmcnt(8)
MM v[204:207],a[240:243],a[32:35],v[204:207]
ds_read_b64_tr_b16 a[208:209], v33 offset:8192
MM v[204:207],a[244:247],a[40:43],v[204:207]
ds_read_b64_tr_b16 a[210:211], v33 offset:10240
MM v[204:207],a[248:251],a[48:51],v[204:207]
ds_read_b64_tr_b16 a[212:213], v33 offset:12288
MM v[204:207],a[252:255],a[56:59],v[204:207]
ds_read_b64_tr_b16 a[214:215], v33 offset:14336
MM v[236:239],a[252:255],a[60:63],v[236:239]
ds_read_b64_tr_b16 a[216:217], v33 offset:24576
MM v[236:239],a[248:251],a[52:55],v[236:239]
ds_read_b64_tr_b16 a[218:219], v33 offset:26624
MM v[236:239],a[244:247],a[44:47],v[236:239]
ds_read_b64_tr_b16 a[220:221], v33 offset:28672
MM v[236:239],a[240:243],a[36:39],v[236:239]
ds_read_b64_tr_b16 a[222:223], v33 offset:30720
s_waitcnt vmcnt(17) lgkmcnt(8)
v_xor_b32 v24, v24, v61
v_cmp_ne_u32 vcc, 0, v24
s_nop 1
s_cbranch_vccnz L_sl_39
L_ok_40:
MM v[208:211],a[192:195],a[32:35],v[208:211]
ds_read_b64_tr_b16 a[224:225], v34 offset:8192
buffer_load_dwordx4 a[0:3], v16, s[40:43], s11 offen sc1
MM v[208:211],a[196:199],a[40:43],v[208:211]
ds_read_b64_tr_b16 a[226:227], v34 offset:10240
MM v[208:211],a[200:203],a[48:51],v[208:211]
ds_read_b64_tr_b16 a[228:229], v34 offset:12288
buffer_load_dwordx4 a[4:7], v17, s[40:43], s11 offen sc1
MM v[208:211],a[204:207],a[56:59],v[208:211]
ds_read_b64_tr_b16 a[230:231], v34 offset:14336
s_add_u32 s11, s11, 8192
MM v[240:243],a[204:207],a[60:63],v[240:243]
ds_read_b64_tr_b16 a[232:233], v34 offset:24576
buffer_load_dwordx4 v[160:163], v1, s[32:35], s21 offen offset:0 sc1
MM v[240:243],a[200:203],a[52:55],v[240:243]
ds_read_b64_tr_b16 a[234:235], v34 offset:26624
MM v[240:243],a[196:199],a[44:47],v[240:243]
ds_read_b64_tr_b16 a[236:237], v34 offset:28672
buffer_load_dwordx4 v[176:179], v1, s[32:35], s62 offen offset:0 sc1
MM v[240:243],a[192:195],a[36:39],v[240:243]
ds_read_b64_tr_b16 a[238:239], v34 offset:30720
s_waitcnt lgkmcnt(8)
MM v[212:215],a[208:211],a[32:35],v[212:215]
ds_read_b64_tr_b16 a[240:241], v35 offset:8192
MM v[212:215],a[212:215],a[40:43],v[212:215]
ds_read_b64_tr_b16 a[242:243], v35 offset:10240
MM v[212:215],a[216:219],a[48:51],v[212:215]
ds_read_b64_tr_b16 a[244:245], v35 offset:12288
MM v[212:215],a[220:223],a[56:59],v[212:215]
ds_read_b64_tr_b16 a[246:247], v35 offset:14336
MM v[244:247],a[220:223],a[60:63],v[244:247]
ds_read_b64_tr_b16 a[248:249], v35 offset:24576
MM v[244:247],a[216:219],a[52:55],v[244:247]
ds_read_b64_tr_b16 a[250:251], v35 offset:26624
MM v[244:247],a[212:215],a[44:47],v[244:247]
ds_read_b64_tr_b16 a[252:253], v35 offset:28672
MM v[244:247],a[208:211],a[36:39],v[244:247]
ds_read_b64_tr_b16 a[254:255], v35 offset:30720
s_waitcnt vmcnt(39) lgkmcnt(8)
MM v[216:219],a[224:227],a[32:35],v[216:219]
buffer_load_dwordx4 a[8:11], v16, s[40:43], s11 offen sc1
MM v[216:219],a[228:231],a[40:43],v[216:219]
MM v[216:219],a[232:235],a[48:51],v[216:219]
s_waitcnt vmcnt(39) lgkmcnt(0)
s_barrier
ds_read_b64_tr_b16 a[192:193], v32 offset:32768
ds_read_b64_tr_b16 a[194:195], v32 offset:34816
MM v[216:219],a[236:239],a[56:59],v[216:219]
ds_read_b64_tr_b16 a[196:197], v32 offset:36864
ds_read_b64_tr_b16 a[198:199], v32 offset:38912
MM v[248:251],a[236:239],a[60:63],v[248:251]
ds_read_b64_tr_b16 a[200:201], v32 offset:49152
buffer_load_dwordx4 a[12:15], v17, s[40:43], s11 offen sc1
MM v[248:251],a[232:235],a[52:55],v[248:251]
ds_read_b64_tr_b16 a[202:203], v32 offset:51200
s_add_u32 s11, s11, 8192
MM v[248:251],a[228:231],a[44:47],v[248:251]
ds_read_b64_tr_b16 a[204:205], v32 offset:53248
buffer_load_dwordx4 v[164:167], v1, s[32:35], s21 offen offset:1024 sc1
MM v[248:251],a[224:227],a[36:39],v[248:251]
ds_read_b64_tr_b16 a[206:207], v32 offset:55296
s_waitcnt lgkmcnt(8)
MM v[220:223],a[240:243],a[32:35],v[220:223]
ds_read_b64_tr_b16 a[208:209], v33 offset:32768
buffer_load_dwordx4 v[180:183], v1, s[32:35], s62 offen offset:1024 sc1
MM v[220:223],a[244:247],a[40:43],v[220:223]
ds_read_b64_tr_b16 a[210:211], v33 offset:34816
s_add_u32 m0, s19, 0
MM v[220:223],a[248:251],a[48:51],v[220:223]
ds_read_b64_tr_b16 a[212:213], v33 offset:36864
buffer_load_dwordx4 v18, s[48:51], s12 offen offset:0 sc1 lds
MM v[220:223],a[252:255],a[56:59],v[220:223]
ds_read_b64_tr_b16 a[214:215], v33 offset:38912
MM v[252:255],a[252:255],a[60:63],v[252:255]
ds_read_b64_tr_b16 a[216:217], v33 offset:49152
buffer_load_dwordx4 v19, s[48:51], s12 offen offset:1024 sc1 lds
MM v[252:255],a[248:251],a[52:55],v[252:255]
ds_read_b64_tr_b16 a[218:219], v33 offset:51200
s_add_u32 m0, s19, 8192
MM v[252:255],a[244:247],a[44:47],v[252:255]
ds_read_b64_tr_b16 a[220:221], v33 offset:53248
s_add_u32 s20, s12, 128
MM v[252:255],a[240:243],a[36:39],v[252:255]
ds_read_b64_tr_b16 a[222:223], v33 offset:55296
s_waitcnt vmcnt(28) lgkmcnt(8)
MM v[192:195],a[192:195],a[128:131],v[192:195]
ds_read_b64_tr_b16 a[224:225], v34 offset:32768
buffer_load_dwordx4 a[16:19], v16, s[40:43], s11 offen sc1
MM v[192:195],a[196:199],a[136:139],v[192:195]
ds_read_b64_tr_b16 a[226:227], v34 offset:34816
MM v[192:195],a[200:203],a[144:147],v[192:195]
ds_read_b64_tr_b16 a[228:229], v34 offset:36864
buffer_load_dwordx4 a[20:23], v17, s[40:43], s11 offen sc1
MM v[192:195],a[204:207],a[152:155],v[192:195]
ds_read_b64_tr_b16 a[230:231], v34 offset:38912
s_add_u32 s11, s11, 8192
MM v[224:227],a[204:207],a[156:159],v[224:227]
ds_read_b64_tr_b16 a[232:233], v34 offset:49152
buffer_load_dwordx4 v[168:171], v1, s[32:35], s21 offen offset:2048 sc1
MM v[224:227],a[200:203],a[148:151],v[224:227]
ds_read_b64_tr_b16 a[234:235], v34 offset:51200
MM v[224:227],a[196:199],a[140:143],v[224:227]
ds_read_b64_tr_b16 a[236:237], v34 offset:53248
buffer_load_dwordx4 v[184:187], v1, s[32:35], s62 offen offset:2048 sc1
MM v[224:227],a[192:195],a[132:135],v[224:227]
ds_read_b64_tr_b16 a[238:239], v34 offset:55296
s_waitcnt lgkmcnt(8)
MM v[196:199],a[208:211],a[128:131],v[196:199]
ds_read_b64_tr_b16 a[240:241], v35 offset:32768
buffer_load_dwordx4 v18, s[48:51], s20 offen offset:0 sc1 lds
MM v[196:199],a[212:215],a[136:139],v[196:199]
ds_read_b64_tr_b16 a[242:243], v35 offset:34816
MM v[196:199],a[216:219],a[144:147],v[196:199]
ds_read_b64_tr_b16 a[244:245], v35 offset:36864
buffer_load_dwordx4 v19, s[48:51], s20 offen offset:1024 sc1 lds
MM v[196:199],a[220:223],a[152:155],v[196:199]
ds_read_b64_tr_b16 a[246:247], v35 offset:38912
s_add_u32 s12, s12, 81920
MM v[228:231],a[220:223],a[156:159],v[228:231]
ds_read_b64_tr_b16 a[248:249], v35 offset:49152
s_add_u32 m0, s19, 16384
MM v[228:231],a[216:219],a[148:151],v[228:231]
ds_read_b64_tr_b16 a[250:251], v35 offset:51200
MM v[228:231],a[212:215],a[140:143],v[228:231]
ds_read_b64_tr_b16 a[252:253], v35 offset:53248
buffer_load_dwordx4 v18, s[48:51], s12 offen offset:0 sc1 lds
MM v[228:231],a[208:211],a[132:135],v[228:231]
ds_read_b64_tr_b16 a[254:255], v35 offset:55296
s_waitcnt vmcnt(35) lgkmcnt(8)
MM v[200:203],a[224:227],a[128:131],v[200:203]
ds_read_b64_tr_b16 a[192:193], v32 offset:40960
buffer_load_dwordx4 a[24:27], v16, s[40:43], s11 offen sc1
MM v[200:203],a[228:231],a[136:139],v[200:203]
ds_read_b64_tr_b16 a[194:195], v32 offset:43008
MM v[200:203],a[232:235],a[144:147],v[200:203]
ds_read_b64_tr_b16 a[196:197], v32 offset:45056
buffer_load_dwordx4 a[28:31], v17, s[40:43], s11 offen sc1
MM v[200:203],a[236:239],a[152:155],v[200:203]
ds_read_b64_tr_b16 a[198:199], v32 offset:47104
s_add_u32 s11, s11, 8192
MM v[232:235],a[236:239],a[156:159],v[232:235]
ds_read_b64_tr_b16 a[200:201], v32 offset:57344
buffer_load_dwordx4 v[172:175], v1, s[32:35], s21 offen offset:3072 sc1
MM v[232:235],a[232:235],a[148:151],v[232:235]
ds_read_b64_tr_b16 a[202:203], v32 offset:59392
MM v[232:235],a[228:231],a[140:143],v[232:235]
ds_read_b64_tr_b16 a[204:205], v32 offset:61440
buffer_load_dwordx4 v[188:191], v1, s[32:35], s62 offen offset:3072 sc1
MM v[232:235],a[224:227],a[132:135],v[232:235]
ds_read_b64_tr_b16 a[206:207], v32 offset:63488
s_waitcnt lgkmcnt(8)
MM v[204:207],a[240:243],a[128:131],v[204:207]
ds_read_b64_tr_b16 a[208:209], v33 offset:40960
buffer_load_dwordx4 v19, s[48:51], s12 offen offset:1024 sc1 lds
MM v[204:207],a[244:247],a[136:139],v[204:207]
ds_read_b64_tr_b16 a[210:211], v33 offset:43008
s_add_u32 m0, s19, 24576
MM v[204:207],a[248:251],a[144:147],v[204:207]
ds_read_b64_tr_b16 a[212:213], v33 offset:45056
s_add_u32 s20, s12, 128
MM v[204:207],a[252:255],a[152:155],v[204:207]
ds_read_b64_tr_b16 a[214:215], v33 offset:47104
MM v[236:239],a[252:255],a[156:159],v[236:239]
ds_read_b64_tr_b16 a[216:217], v33 offset:57344
buffer_load_dwordx4 v18, s[48:51], s20 offen offset:0 sc1 lds
MM v[236:239],a[248:251],a[148:151],v[236:239]
ds_read_b64_tr_b16 a[218:219], v33 offset:59392
MM v[236:239],a[244:247],a[140:143],v[236:239]
ds_read_b64_tr_b16 a[220:221], v33 offset:61440
buffer_load_dwordx4 v19, s[48:51], s20 offen offset:1024 sc1 lds
MM v[236:239],a[240:243],a[132:135],v[236:239]
ds_read_b64_tr_b16 a[222:223], v33 offset:63488
s_add_u32 s12, s12, 81920
s_waitcnt vmcnt(42) lgkmcnt(8)
MM v[208:211],a[192:195],a[128:131],v[208:211]
ds_read_b64_tr_b16 a[224:225], v34 offset:40960
buffer_load_dwordx4 a[32:35], v16, s[40:43], s11 offen sc1
MM v[208:211],a[196:199],a[136:139],v[208:211]
ds_read_b64_tr_b16 a[226:227], v34 offset:43008
MM v[208:211],a[200:203],a[144:147],v[208:211]
ds_read_b64_tr_b16 a[228:229], v34 offset:45056
buffer_load_dwordx4 a[36:39], v17, s[40:43], s11 offen sc1
MM v[208:211],a[204:207],a[152:155],v[208:211]
ds_read_b64_tr_b16 a[230:231], v34 offset:47104
s_add_u32 s11, s11, 8192
MM v[240:243],a[204:207],a[156:159],v[240:243]
ds_read_b64_tr_b16 a[232:233], v34 offset:57344
MM v[240:243],a[200:203],a[148:151],v[240:243]
ds_read_b64_tr_b16 a[234:235], v34 offset:59392
MM v[240:243],a[196:199],a[140:143],v[240:243]
ds_read_b64_tr_b16 a[236:237], v34 offset:61440
MM v[240:243],a[192:195],a[132:135],v[240:243]
ds_read_b64_tr_b16 a[238:239], v34 offset:63488
s_waitcnt lgkmcnt(8)
MM v[212:215],a[208:211],a[128:131],v[212:215]
ds_read_b64_tr_b16 a[240:241], v35 offset:40960
MM v[212:215],a[212:215],a[136:139],v[212:215]
ds_read_b64_tr_b16 a[242:243], v35 offset:43008
MM v[212:215],a[216:219],a[144:147],v[212:215]
ds_read_b64_tr_b16 a[244:245], v35 offset:45056
MM v[212:215],a[220:223],a[152:155],v[212:215]
ds_read_b64_tr_b16 a[246:247], v35 offset:47104
MM v[244:247],a[220:223],a[156:159],v[244:247]
ds_read_b64_tr_b16 a[248:249], v35 offset:57344
MM v[244:247],a[216:219],a[148:151],v[244:247]
ds_read_b64_tr_b16 a[250:251], v35 offset:59392
MM v[244:247],a[212:215],a[140:143],v[244:247]
ds_read_b64_tr_b16 a[252:253], v35 offset:61440
MM v[244:247],a[208:211],a[132:135],v[244:247]
ds_read_b64_tr_b16 a[254:255], v35 offset:63488
s_waitcnt vmcnt(44) lgkmcnt(8)
MM v[216:219],a[224:227],a[128:131],v[216:219]
buffer_load_dwordx4 a[40:43], v16, s[40:43], s11 offen sc1
MM v[216:219],a[228:231],a[136:139],v[216:219]
MM v[216:219],a[232:235],a[144:147],v[216:219]
s_waitcnt vmcnt(43) lgkmcnt(0)
s_barrier
ds_read_b64_tr_b16 a[192:193], v36 offset:0
ds_read_b64_tr_b16 a[194:195], v36 offset:2048
MM v[216:219],a[236:239],a[152:155],v[216:219]
ds_read_b64_tr_b16 a[196:197], v36 offset:4096
ds_read_b64_tr_b16 a[198:199], v36 offset:6144
MM v[248:251],a[236:239],a[156:159],v[248:251]
ds_read_b64_tr_b16 a[200:201], v36 offset:16384
buffer_load_dwordx4 a[44:47], v17, s[40:43], s11 offen sc1
MM v[248:251],a[232:235],a[148:151],v[248:251]
ds_read_b64_tr_b16 a[202:203], v36 offset:18432
s_add_u32 s11, s11, 8192
MM v[248:251],a[228:231],a[140:143],v[248:251]
ds_read_b64_tr_b16 a[204:205], v36 offset:20480
s_add_u32 m0, s19, 32768
MM v[248:251],a[224:227],a[132:135],v[248:251]
ds_read_b64_tr_b16 a[206:207], v36 offset:22528
s_waitcnt lgkmcnt(8)
MM v[220:223],a[240:243],a[128:131],v[220:223]
ds_read_b64_tr_b16 a[208:209], v37 offset:0
buffer_load_dwordx4 v18, s[48:51], s12 offen offset:0 sc1 lds
MM v[220:223],a[244:247],a[136:139],v[220:223]
ds_read_b64_tr_b16 a[210:211], v37 offset:2048
MM v[220:223],a[248:251],a[144:147],v[220:223]
ds_read_b64_tr_b16 a[212:213], v37 offset:4096
buffer_load_dwordx4 v19, s[48:51], s12 offen offset:1024 sc1 lds
MM v[220:223],a[252:255],a[152:155],v[220:223]
ds_read_b64_tr_b16 a[214:215], v37 offset:6144
s_add_u32 m0, s19, 40960
MM v[252:255],a[252:255],a[156:159],v[252:255]
ds_read_b64_tr_b16 a[216:217], v37 offset:16384
s_add_u32 s20, s12, 128
MM v[252:255],a[248:251],a[148:151],v[252:255]
ds_read_b64_tr_b16 a[218:219], v37 offset:18432
MM v[252:255],a[244:247],a[140:143],v[252:255]
ds_read_b64_tr_b16 a[220:221], v37 offset:20480
buffer_load_dwordx4 v18, s[48:51], s20 offen offset:0 sc1 lds
MM v[252:255],a[240:243],a[132:135],v[252:255]
ds_read_b64_tr_b16 a[222:223], v37 offset:22528
s_waitcnt vmcnt(32) lgkmcnt(8)
MM v[192:195],a[192:195],a[160:163],v[192:195]
ds_read_b64_tr_b16 a[224:225], v38 offset:0
buffer_load_dwordx4 a[48:51], v16, s[40:43], s11 offen sc1
MM v[192:195],a[196:199],a[168:171],v[192:195]
ds_read_b64_tr_b16 a[226:227], v38 offset:2048
MM v[192:195],a[200:203],a[176:179],v[192:195]
ds_read_b64_tr_b16 a[228:229], v38 offset:4096
buffer_load_dwordx4 a[52:55], v17, s[40:43], s11 offen sc1
MM v[192:195],a[204:207],a[184:187],v[192:195]
ds_read_b64_tr_b16 a[230:231], v38 offset:6144
s_add_u32 s11, s11, 8192
MM v[224:227],a[204:207],a[188:191],v[224:227]
ds_read_b64_tr_b16 a[232:233], v38 offset:16384
buffer_load_dwordx4 v19, s[48:51], s20 offen offset:1024 sc1 lds
MM v[224:227],a[200:203],a[180:183],v[224:227]
ds_read_b64_tr_b16 a[234:235], v38 offset:18432
s_add_u32 s12, s12, 81920
MM v[224:227],a[196:199],a[172:175],v[224:227]
ds_read_b64_tr_b16 a[236:237], v38 offset:20480
s_add_u32 m0, s19, 49152
MM v[224:227],a[192:195],a[164:167],v[224:227]
ds_read_b64_tr_b16 a[238:239], v38 offset:22528
s_waitcnt lgkmcnt(8)
MM v[196:199],a[208:211],a[160:163],v[196:199]
ds_read_b64_tr_b16 a[240:241], v39 offset:0
buffer_load_dwordx4 v18, s[48:51], s12 offen offset:0 sc1 lds
MM v[196:199],a[212:215],a[168:171],v[196:199]
ds_read_b64_tr_b16 a[242:243], v39 offset:2048
MM v[196:199],a[216:219],a[176:179],v[196:199]
ds_read_b64_tr_b16 a[244:245], v39 offset:4096
buffer_load_dwordx4 v19, s[48:51], s12 offen offset:1024 sc1 lds
MM v[196:199],a[220:223],a[184:187],v[196:199]
ds_read_b64_tr_b16 a[246:247], v39 offset:6144
s_add_u32 m0, s19, 57344
MM v[228:231],a[220:223],a[188:191],v[228:231]
ds_read_b64_tr_b16 a[248:249], v39 offset:16384
s_add_u32 s20, s12, 128
MM v[228:231],a[216:219],a[180:183],v[228:231]
ds_read_b64_tr_b16 a[250:251], v39 offset:18432
MM v[228:231],a[212:215],a[172:175],v[228:231]
ds_read_b64_tr_b16 a[252:253], v39 offset:20480
buffer_load_dwordx4 v18, s[48:51], s20 offen offset:0 sc1 lds
MM v[228:231],a[208:211],a[164:167],v[228:231]
ds_read_b64_tr_b16 a[254:255], v39 offset:22528
s_waitcnt vmcnt(38) lgkmcnt(8)
MM v[200:203],a[224:227],a[160:163],v[200:203]
ds_read_b64_tr_b16 a[192:193], v36 offset:8192
buffer_load_dwordx4 a[56:59], v16, s[40:43], s11 offen sc1
MM v[200:203],a[228:231],a[168:171],v[200:203]
ds_read_b64_tr_b16 a[194:195], v36 offset:10240
MM v[200:203],a[232:235],a[176:179],v[200:203]
ds_read_b64_tr_b16 a[196:197], v36 offset:12288
buffer_load_dwordx4 a[60:63], v17, s[40:43], s11 offen sc1
MM v[200:203],a[236:239],a[184:187],v[200:203]
ds_read_b64_tr_b16 a[198:199], v36 offset:14336
s_add_u32 s11, s11, 8192
MM v[232:235],a[236:239],a[188:191],v[232:235]
ds_read_b64_tr_b16 a[200:201], v36 offset:24576
buffer_load_dwordx4 v19, s[48:51], s20 offen offset:1024 sc1 lds
MM v[232:235],a[232:235],a[180:183],v[232:235]
ds_read_b64_tr_b16 a[202:203], v36 offset:26624
s_add_u32 s12, s12, 81920
MM v[232:235],a[228:231],a[172:175],v[232:235]
ds_read_b64_tr_b16 a[204:205], v36 offset:28672
MM v[232:235],a[224:227],a[164:167],v[232:235]
ds_read_b64_tr_b16 a[206:207], v36 offset:30720
s_waitcnt lgkmcnt(8)
MM v[204:207],a[240:243],a[160:163],v[204:207]
ds_read_b64_tr_b16 a[208:209], v37 offset:8192
MM v[204:207],a[244:247],a[168:171],v[204:207]
ds_read_b64_tr_b16 a[210:211], v37 offset:10240
MM v[204:207],a[248:251],a[176:179],v[204:207]
ds_read_b64_tr_b16 a[212:213], v37 offset:12288
MM v[204:207],a[252:255],a[184:187],v[204:207]
ds_read_b64_tr_b16 a[214:215], v37 offset:14336
MM v[236:239],a[252:255],a[188:191],v[236:239]
ds_read_b64_tr_b16 a[216:217], v37 offset:24576
MM v[236:239],a[248:251],a[180:183],v[236:239]
ds_read_b64_tr_b16 a[218:219], v37 offset:26624
MM v[236:239],a[244:247],a[172:175],v[236:239]
ds_read_b64_tr_b16 a[220:221], v37 offset:28672
MM v[236:239],a[240:243],a[164:167],v[236:239]
ds_read_b64_tr_b16 a[222:223], v37 offset:30720
s_waitcnt vmcnt(41) lgkmcnt(8)
MM v[208:211],a[192:195],a[160:163],v[208:211]
ds_read_b64_tr_b16 a[224:225], v38 offset:8192
buffer_load_dwordx4 a[128:131], v16, s[40:43], s11 offen sc1
MM v[208:211],a[196:199],a[168:171],v[208:211]
ds_read_b64_tr_b16 a[226:227], v38 offset:10240
MM v[208:211],a[200:203],a[176:179],v[208:211]
ds_read_b64_tr_b16 a[228:229], v38 offset:12288
buffer_load_dwordx4 a[132:135], v17, s[40:43], s11 offen sc1
MM v[208:211],a[204:207],a[184:187],v[208:211]
ds_read_b64_tr_b16 a[230:231], v38 offset:14336
s_add_u32 s11, s11, 8192
MM v[240:243],a[204:207],a[188:191],v[240:243]
ds_read_b64_tr_b16 a[232:233], v38 offset:24576
MM v[240:243],a[200:203],a[180:183],v[240:243]
ds_read_b64_tr_b16 a[234:235], v38 offset:26624
MM v[240:243],a[196:199],a[172:175],v[240:243]
ds_read_b64_tr_b16 a[236:237], v38 offset:28672
MM v[240:243],a[192:195],a[164:167],v[240:243]
ds_read_b64_tr_b16 a[238:239], v38 offset:30720
s_waitcnt lgkmcnt(8)
MM v[212:215],a[208:211],a[160:163],v[212:215]
ds_read_b64_tr_b16 a[240:241], v39 offset:8192
MM v[212:215],a[212:215],a[168:171],v[212:215]
ds_read_b64_tr_b16 a[242:243], v39 offset:10240
MM v[212:215],a[216:219],a[176:179],v[212:215]
ds_read_b64_tr_b16 a[244:245], v39 offset:12288
MM v[212:215],a[220:223],a[184:187],v[212:215]
ds_read_b64_tr_b16 a[246:247], v39 offset:14336
MM v[244:247],a[220:223],a[188:191],v[244:247]
ds_read_b64_tr_b16 a[248:249], v39 offset:24576
MM v[244:247],a[216:219],a[180:183],v[244:247]
ds_read_b64_tr_b16 a[250:251], v39 offset:26624
MM v[244:247],a[212:215],a[172:175],v[244:247]
ds_read_b64_tr_b16 a[252:253], v39 offset:28672
MM v[244:247],a[208:211],a[164:167],v[244:247]
ds_read_b64_tr_b16 a[254:255], v39 offset:30720
s_waitcnt vmcnt(43) lgkmcnt(8)
MM v[216:219],a[224:227],a[160:163],v[216:219]
buffer_load_dwordx4 a[136:139], v16, s[40:43], s11 offen sc1
MM v[216:219],a[228:231],a[168:171],v[216:219]
MM v[216:219],a[232:235],a[176:179],v[216:219]
s_waitcnt vmcnt(43) lgkmcnt(0)
s_barrier
ds_read_b64_tr_b16 a[192:193], v36 offset:32768
ds_read_b64_tr_b16 a[194:195], v36 offset:34816
MM v[216:219],a[236:239],a[184:187],v[216:219]
ds_read_b64_tr_b16 a[196:197], v36 offset:36864
ds_read_b64_tr_b16 a[198:199], v36 offset:38912
MM v[248:251],a[236:239],a[188:191],v[248:251]
ds_read_b64_tr_b16 a[200:201], v36 offset:49152
buffer_load_dwordx4 a[140:143], v17, s[40:43], s11 offen sc1
MM v[248:251],a[232:235],a[180:183],v[248:251]
ds_read_b64_tr_b16 a[202:203], v36 offset:51200
s_add_u32 s11, s11, 8192
MM v[248:251],a[228:231],a[172:175],v[248:251]
ds_read_b64_tr_b16 a[204:205], v36 offset:53248
s_add_u32 m0, s19, 65536
MM v[248:251],a[224:227],a[164:167],v[248:251]
ds_read_b64_tr_b16 a[206:207], v36 offset:55296
s_waitcnt lgkmcnt(8)
MM v[220:223],a[240:243],a[160:163],v[220:223]
ds_read_b64_tr_b16 a[208:209], v37 offset:32768
buffer_load_dwordx4 v18, s[48:51], s12 offen offset:0 sc1 lds
MM v[220:223],a[244:247],a[168:171],v[220:223]
ds_read_b64_tr_b16 a[210:211], v37 offset:34816
MM v[220:223],a[248:251],a[176:179],v[220:223]
ds_read_b64_tr_b16 a[212:213], v37 offset:36864
buffer_load_dwordx4 v19, s[48:51], s12 offen offset:1024 sc1 lds
MM v[220:223],a[252:255],a[184:187],v[220:223]
ds_read_b64_tr_b16 a[214:215], v37 offset:38912
s_add_u32 m0, s19, 73728
MM v[252:255],a[252:255],a[188:191],v[252:255]
ds_read_b64_tr_b16 a[216:217], v37 offset:49152
s_add_u32 s20, s12, 128
MM v[252:255],a[248:251],a[180:183],v[252:255]
ds_read_b64_tr_b16 a[218:219], v37 offset:51200
MM v[252:255],a[244:247],a[172:175],v[252:255]
ds_read_b64_tr_b16 a[220:221], v37 offset:53248
buffer_load_dwordx4 v18, s[48:51], s20 offen offset:0 sc1 lds
MM v[252:255],a[240:243],a[164:167],v[252:255]
ds_read_b64_tr_b16 a[222:223], v37 offset:55296
s_waitcnt vmcnt(26) lgkmcnt(8)
MM v[192:195],a[192:195],a[0:3],v[192:195]
ds_read_b64_tr_b16 a[224:225], v38 offset:32768
buffer_load_dwordx4 a[144:147], v16, s[40:43], s11 offen sc1
MM v[192:195],a[196:199],a[8:11],v[192:195]
ds_read_b64_tr_b16 a[226:227], v38 offset:34816
MM v[192:195],a[200:203],a[16:19],v[192:195]
ds_read_b64_tr_b16 a[228:229], v38 offset:36864
buffer_load_dwordx4 a[148:151], v17, s[40:43], s11 offen sc1
MM v[192:195],a[204:207],a[24:27],v[192:195]
ds_read_b64_tr_b16 a[230:231], v38 offset:38912
s_add_u32 s11, s11, 8192
MM v[224:227],a[204:207],a[28:31],v[224:227]
ds_read_b64_tr_b16 a[232:233], v38 offset:49152
buffer_load_dwordx4 v19, s[48:51], s20 offen offset:1024 sc1 lds
MM v[224:227],a[200:203],a[20:23],v[224:227]
ds_read_b64_tr_b16 a[234:235], v38 offset:51200
s_add_u32 s12, s12, 81920
MM v[224:227],a[196:199],a[12:15],v[224:227]
ds_read_b64_tr_b16 a[236:237], v38 offset:53248
s_add_u32 s21, s21, 32768
MM v[224:227],a[192:195],a[4:7],v[224:227]
ds_read_b64_tr_b16 a[238:239], v38 offset:55296
s_add_u32 s62, s62, 32768
s_waitcnt lgkmcnt(8)
MM v[196:199],a[208:211],a[0:3],v[196:199]
ds_read_b64_tr_b16 a[240:241], v39 offset:32768
MM v[196:199],a[212:215],a[8:11],v[196:199]
ds_read_b64_tr_b16 a[242:243], v39 offset:34816
MM v[196:199],a[216:219],a[16:19],v[196:199]
ds_read_b64_tr_b16 a[244:245], v39 offset:36864
MM v[196:199],a[220:223],a[24:27],v[196:199]
ds_read_b64_tr_b16 a[246:247], v39 offset:38912
MM v[228:231],a[220:223],a[28:31],v[228:231]
ds_read_b64_tr_b16 a[248:249], v39 offset:49152
MM v[228:231],a[216:219],a[20:23],v[228:231]
ds_read_b64_tr_b16 a[250:251], v39 offset:51200
MM v[228:231],a[212:215],a[12:15],v[228:231]
ds_read_b64_tr_b16 a[252:253], v39 offset:53248
MM v[228:231],a[208:211],a[4:7],v[228:231]
ds_read_b64_tr_b16 a[254:255], v39 offset:55296
s_waitcnt vmcnt(31) lgkmcnt(8)
MM v[200:203],a[224:227],a[0:3],v[200:203]
ds_read_b64_tr_b16 a[192:193], v36 offset:40960
buffer_load_dwordx4 a[152:155], v16, s[40:43], s11 offen sc1
MM v[200:203],a[228:231],a[8:11],v[200:203]
ds_read_b64_tr_b16 a[194:195], v36 offset:43008
MM v[200:203],a[232:235],a[16:19],v[200:203]
ds_read_b64_tr_b16 a[196:197], v36 offset:45056
buffer_load_dwordx4 a[156:159], v17, s[40:43], s11 offen sc1
MM v[200:203],a[236:239],a[24:27],v[200:203]
ds_read_b64_tr_b16 a[198:199], v36 offset:47104
s_add_u32 s11, s11, 8192
MM v[232:235],a[236:239],a[28:31],v[232:235]
ds_read_b64_tr_b16 a[200:201], v36 offset:57344
MM v[232:235],a[232:235],a[20:23],v[232:235]
ds_read_b64_tr_b16 a[202:203], v36 offset:59392
MM v[232:235],a[228:231],a[12:15],v[232:235]
ds_read_b64_tr_b16 a[204:205], v36 offset:61440
MM v[232:235],a[224:227],a[4:7],v[232:235]
ds_read_b64_tr_b16 a[206:207], v36 offset:63488
s_waitcnt lgkmcnt(8)
MM v[204:207],a[240:243],a[0:3],v[204:207]
ds_read_b64_tr_b16 a[208:209], v37 offset:40960
MM v[204:207],a[244:247],a[8:11],v[204:207]
ds_read_b64_tr_b16 a[210:211], v37 offset:43008
MM v[204:207],a[248:251],a[16:19],v[204:207]
ds_read_b64_tr_b16 a[212:213], v37 offset:45056
MM v[204:207],a[252:255],a[24:27],v[204:207]
ds_read_b64_tr_b16 a[214:215], v37 offset:47104
MM v[236:239],a[252:255],a[28:31],v[236:239]
ds_read_b64_tr_b16 a[216:217], v37 offset:57344
MM v[236:239],a[248:251],a[20:23],v[236:239]
ds_read_b64_tr_b16 a[218:219], v37 offset:59392
MM v[236:239],a[244:247],a[12:15],v[236:239]
ds_read_b64_tr_b16 a[220:221], v37 offset:61440
MM v[236:239],a[240:243],a[4:7],v[236:239]
ds_read_b64_tr_b16 a[222:223], v37 offset:63488
s_waitcnt vmcnt(33) lgkmcnt(8)
MM v[208:211],a[192:195],a[0:3],v[208:211]
ds_read_b64_tr_b16 a[224:225], v38 offset:40960
buffer_load_dwordx4 a[160:163], v16, s[40:43], s11 offen sc1
MM v[208:211],a[196:199],a[8:11],v[208:211]
ds_read_b64_tr_b16 a[226:227], v38 offset:43008
MM v[208:211],a[200:203],a[16:19],v[208:211]
ds_read_b64_tr_b16 a[228:229], v38 offset:45056
buffer_load_dwordx4 a[164:167], v17, s[40:43], s11 offen sc1
MM v[208:211],a[204:207],a[24:27],v[208:211]
ds_read_b64_tr_b16 a[230:231], v38 offset:47104
s_add_u32 s11, s11, 8192
MM v[240:243],a[204:207],a[28:31],v[240:243]
ds_read_b64_tr_b16 a[232:233], v38 offset:57344
MM v[240:243],a[200:203],a[20:23],v[240:243]
ds_read_b64_tr_b16 a[234:235], v38 offset:59392
MM v[240:243],a[196:199],a[12:15],v[240:243]
ds_read_b64_tr_b16 a[236:237], v38 offset:61440
MM v[240:243],a[192:195],a[4:7],v[240:243]
ds_read_b64_tr_b16 a[238:239], v38 offset:63488
s_waitcnt lgkmcnt(8)
MM v[212:215],a[208:211],a[0:3],v[212:215]
ds_read_b64_tr_b16 a[240:241], v39 offset:40960
MM v[212:215],a[212:215],a[8:11],v[212:215]
ds_read_b64_tr_b16 a[242:243], v39 offset:43008
MM v[212:215],a[216:219],a[16:19],v[212:215]
ds_read_b64_tr_b16 a[244:245], v39 offset:45056
MM v[212:215],a[220:223],a[24:27],v[212:215]
ds_read_b64_tr_b16 a[246:247], v39 offset:47104
MM v[244:247],a[220:223],a[28:31],v[244:247]
ds_read_b64_tr_b16 a[248:249], v39 offset:57344
MM v[244:247],a[216:219],a[20:23],v[244:247]
ds_read_b64_tr_b16 a[250:251], v39 offset:59392
MM v[244:247],a[212:215],a[12:15],v[244:247]
ds_read_b64_tr_b16 a[252:253], v39 offset:61440
MM v[244:247],a[208:211],a[4:7],v[244:247]
ds_read_b64_tr_b16 a[254:255], v39 offset:63488
s_waitcnt vmcnt(35) lgkmcnt(8)
MM v[216:219],a[224:227],a[0:3],v[216:219]
buffer_load_dwordx4 a[168:171], v16, s[40:43], s11 offen sc1
MM v[216:219],a[228:231],a[8:11],v[216:219]
MM v[216:219],a[232:235],a[16:19],v[216:219]
s_waitcnt vmcnt(31) lgkmcnt(0)
s_barrier
ds_read_b64_tr_b16 a[192:193], v32 offset:0
ds_read_b64_tr_b16 a[194:195], v32 offset:2048
MM v[216:219],a[236:239],a[24:27],v[216:219]
ds_read_b64_tr_b16 a[196:197], v32 offset:4096
ds_read_b64_tr_b16 a[198:199], v32 offset:6144
MM v[248:251],a[236:239],a[28:31],v[248:251]
ds_read_b64_tr_b16 a[200:201], v32 offset:16384
buffer_load_dwordx4 a[172:175], v17, s[40:43], s11 offen sc1
MM v[248:251],a[232:235],a[20:23],v[248:251]
ds_read_b64_tr_b16 a[202:203], v32 offset:18432
s_add_u32 s11, s11, 8192
MM v[248:251],a[228:231],a[12:15],v[248:251]
ds_read_b64_tr_b16 a[204:205], v32 offset:20480
MM v[248:251],a[224:227],a[4:7],v[248:251]
ds_read_b64_tr_b16 a[206:207], v32 offset:22528
s_waitcnt lgkmcnt(8)
MM v[220:223],a[240:243],a[0:3],v[220:223]
ds_read_b64_tr_b16 a[208:209], v33 offset:0
MM v[220:223],a[244:247],a[8:11],v[220:223]
ds_read_b64_tr_b16 a[210:211], v33 offset:2048
MM v[220:223],a[248:251],a[16:19],v[220:223]
ds_read_b64_tr_b16 a[212:213], v33 offset:4096
MM v[220:223],a[252:255],a[24:27],v[220:223]
ds_read_b64_tr_b16 a[214:215], v33 offset:6144
MM v[252:255],a[252:255],a[28:31],v[252:255]
ds_read_b64_tr_b16 a[216:217], v33 offset:16384
MM v[252:255],a[248:251],a[20:23],v[252:255]
ds_read_b64_tr_b16 a[218:219], v33 offset:18432
MM v[252:255],a[244:247],a[12:15],v[252:255]
ds_read_b64_tr_b16 a[220:221], v33 offset:20480
MM v[252:255],a[240:243],a[4:7],v[252:255]
ds_read_b64_tr_b16 a[222:223], v33 offset:22528
s_waitcnt vmcnt(17) lgkmcnt(8)
MM v[192:195],a[192:195],a[32:35],v[192:195]
ds_read_b64_tr_b16 a[224:225], v34 offset:0
MM v[192:195],a[196:199],a[40:43],v[192:195]
ds_read_b64_tr_b16 a[226:227], v34 offset:2048
MM v[192:195],a[200:203],a[48:51],v[192:195]
ds_read_b64_tr_b16 a[228:229], v34 offset:4096
MM v[192:195],a[204:207],a[56:59],v[192:195]
ds_read_b64_tr_b16 a[230:231], v34 offset:6144
MM v[224:227],a[204:207],a[60:63],v[224:227]
ds_read_b64_tr_b16 a[232:233], v34 offset:16384
MM v[224:227],a[200:203],a[52:55],v[224:227]
ds_read_b64_tr_b16 a[234:235], v34 offset:18432
MM v[224:227],a[196:199],a[44:47],v[224:227]
ds_read_b64_tr_b16 a[236:237], v34 offset:20480
MM v[224:227],a[192:195],a[36:39],v[224:227]
ds_read_b64_tr_b16 a[238:239], v34 offset:22528
s_waitcnt lgkmcnt(8)
MM v[196:199],a[208:211],a[32:35],v[196:199]
ds_read_b64_tr_b16 a[240:241], v35 offset:0
MM v[196:199],a[212:215],a[40:43],v[196:199]
ds_read_b64_tr_b16 a[242:243], v35 offset:2048
MM v[196:199],a[216:219],a[48:51],v[196:199]
ds_read_b64_tr_b16 a[244:245], v35 offset:4096
MM v[196:199],a[220:223],a[56:59],v[196:199]
ds_read_b64_tr_b16 a[246:247], v35 offset:6144
MM v[228:231],a[220:223],a[60:63],v[228:231]
ds_read_b64_tr_b16 a[248:249], v35 offset:16384
MM v[228:231],a[216:219],a[52:55],v[228:231]
ds_read_b64_tr_b16 a[250:251], v35 offset:18432
MM v[228:231],a[212:215],a[44:47],v[228:231]
ds_read_b64_tr_b16 a[252:253], v35 offset:20480
MM v[228:231],a[208:211],a[36:39],v[228:231]
ds_read_b64_tr_b16 a[254:255], v35 offset:22528
s_waitcnt vmcnt(17) lgkmcnt(8)
MM v[200:203],a[224:227],a[32:35],v[200:203]
ds_read_b64_tr_b16 a[192:193], v32 offset:8192
MM v[200:203],a[228:231],a[40:43],v[200:203]
ds_read_b64_tr_b16 a[194:195], v32 offset:10240
MM v[200:203],a[232:235],a[48:51],v[200:203]
ds_read_b64_tr_b16 a[196:197], v32 offset:12288
MM v[200:203],a[236:239],a[56:59],v[200:203]
ds_read_b64_tr_b16 a[198:199], v32 offset:14336
MM v[232:235],a[236:239],a[60:63],v[232:235]
ds_read_b64_tr_b16 a[200:201], v32 offset:24576
MM v[232:235],a[232:235],a[52:55],v[232:235]
ds_read_b64_tr_b16 a[202:203], v32 offset:26624
MM v[232:235],a[228:231],a[44:47],v[232:235]
ds_read_b64_tr_b16 a[204:205], v32 offset:28672
MM v[232:235],a[224:227],a[36:39],v[232:235]
ds_read_b64_tr_b16 a[206:207], v32 offset:30720
s_waitcnt lgkmcnt(8)
MM v[204:207],a[240:243],a[32:35],v[204:207]
ds_read_b64_tr_b16 a[208:209], v33 offset:8192
MM v[204:207],a[244:247],a[40:43],v[204:207]
ds_read_b64_tr_b16 a[210:211], v33 offset:10240
MM v[204:207],a[248:251],a[48:51],v[204:207]
ds_read_b64_tr_b16 a[212:213], v33 offset:12288
MM v[204:207],a[252:255],a[56:59],v[204:207]
ds_read_b64_tr_b16 a[214:215], v33 offset:14336
MM v[236:239],a[252:255],a[60:63],v[236:239]
ds_read_b64_tr_b16 a[216:217], v33 offset:24576
MM v[236:239],a[248:251],a[52:55],v[236:239]
ds_read_b64_tr_b16 a[218:219], v33 offset:26624
MM v[236:239],a[244:247],a[44:47],v[236:239]
ds_read_b64_tr_b16 a[220:221], v33 offset:28672
MM v[236:239],a[240:243],a[36:39],v[236:239]
ds_read_b64_tr_b16 a[222:223], v33 offset:30720
s_waitcnt vmcnt(17) lgkmcnt(8)
MM v[208:211],a[192:195],a[32:35],v[208:211]
ds_read_b64_tr_b16 a[224:225], v34 offset:8192
MM v[208:211],a[196:199],a[40:43],v[208:211]
ds_read_b64_tr_b16 a[226:227], v34 offset:10240
MM v[208:211],a[200:203],a[48:51],v[208:211]
ds_read_b64_tr_b16 a[228:229], v34 offset:12288
MM v[208:211],a[204:207],a[56:59],v[208:211]
ds_read_b64_tr_b16 a[230:231], v34 offset:14336
MM v[240:243],a[204:207],a[60:63],v[240:243]
ds_read_b64_tr_b16 a[232:233], v34 offset:24576
MM v[240:243],a[200:203],a[52:55],v[240:243]
ds_read_b64_tr_b16 a[234:235], v34 offset:26624
MM v[240:243],a[196:199],a[44:47],v[240:243]
ds_read_b64_tr_b16 a[236:237], v34 offset:28672
MM v[240:243],a[192:195],a[36:39],v[240:243]
ds_read_b64_tr_b16 a[238:239], v34 offset:30720
s_waitcnt lgkmcnt(8)
MM v[212:215],a[208:211],a[32:35],v[212:215]
ds_read_b64_tr_b16 a[240:241], v35 offset:8192
MM v[212:215],a[212:215],a[40:43],v[212:215]
ds_read_b64_tr_b16 a[242:243], v35 offset:10240
MM v[212:215],a[216:219],a[48:51],v[212:215]
ds_read_b64_tr_b16 a[244:245], v35 offset:12288
MM v[212:215],a[220:223],a[56:59],v[212:215]
ds_read_b64_tr_b16 a[246:247], v35 offset:14336
MM v[244:247],a[220:223],a[60:63],v[244:247]
ds_read_b64_tr_b16 a[248:249], v35 offset:24576
MM v[244:247],a[216:219],a[52:55],v[244:247]
ds_read_b64_tr_b16 a[250:251], v35 offset:26624
MM v[244:247],a[212:215],a[44:47],v[244:247]
ds_read_b64_tr_b16 a[252:253], v35 offset:28672
MM v[244:247],a[208:211],a[36:39],v[244:247]
ds_read_b64_tr_b16 a[254:255], v35 offset:30720
s_waitcnt vmcnt(17) lgkmcnt(8)
MM v[216:219],a[224:227],a[32:35],v[216:219]
MM v[216:219],a[228:231],a[40:43],v[216:219]
MM v[216:219],a[232:235],a[48:51],v[216:219]
s_waitcnt vmcnt(16) lgkmcnt(0)
s_barrier
ds_read_b64_tr_b16 a[192:193], v32 offset:32768
ds_read_b64_tr_b16 a[194:195], v32 offset:34816
MM v[216:219],a[236:239],a[56:59],v[216:219]
ds_read_b64_tr_b16 a[196:197], v32 offset:36864
ds_read_b64_tr_b16 a[198:199], v32 offset:38912
MM v[248:251],a[236:239],a[60:63],v[248:251]
ds_read_b64_tr_b16 a[200:201], v33 offset:32768
MM v[248:251],a[232:235],a[52:55],v[248:251]
ds_read_b64_tr_b16 a[202:203], v33 offset:34816
MM v[248:251],a[228:231],a[44:47],v[248:251]
ds_read_b64_tr_b16 a[204:205], v33 offset:36864
MM v[248:251],a[224:227],a[36:39],v[248:251]
ds_read_b64_tr_b16 a[206:207], v33 offset:38912
s_waitcnt lgkmcnt(8)
MM v[220:223],a[240:243],a[32:35],v[220:223]
ds_read_b64_tr_b16 a[208:209], v34 offset:32768
MM v[220:223],a[244:247],a[40:43],v[220:223]
ds_read_b64_tr_b16 a[210:211], v34 offset:34816
MM v[220:223],a[248:251],a[48:51],v[220:223]
ds_read_b64_tr_b16 a[212:213], v34 offset:36864
MM v[220:223],a[252:255],a[56:59],v[220:223]
ds_read_b64_tr_b16 a[214:215], v34 offset:38912
MM v[252:255],a[252:255],a[60:63],v[252:255]
ds_read_b64_tr_b16 a[216:217], v35 offset:32768
MM v[252:255],a[248:251],a[52:55],v[252:255]
ds_read_b64_tr_b16 a[218:219], v35 offset:34816
MM v[252:255],a[244:247],a[44:47],v[252:255]
ds_read_b64_tr_b16 a[220:221], v35 offset:36864
MM v[252:255],a[240:243],a[36:39],v[252:255]
ds_read_b64_tr_b16 a[222:223], v35 offset:38912
s_waitcnt vmcnt(12) lgkmcnt(8)
MM v[192:195],a[192:195],a[128:131],v[192:195]
ds_read_b64_tr_b16 a[224:225], v32 offset:40960
MM v[192:195],a[196:199],a[136:139],v[192:195]
ds_read_b64_tr_b16 a[226:227], v32 offset:43008
MM v[224:227],a[196:199],a[140:143],v[224:227]
ds_read_b64_tr_b16 a[228:229], v32 offset:45056
MM v[224:227],a[192:195],a[132:135],v[224:227]
ds_read_b64_tr_b16 a[230:231], v32 offset:47104
MM v[196:199],a[200:203],a[128:131],v[196:199]
ds_read_b64_tr_b16 a[232:233], v33 offset:40960
MM v[196:199],a[204:207],a[136:139],v[196:199]
ds_read_b64_tr_b16 a[234:235], v33 offset:43008
MM v[228:231],a[204:207],a[140:143],v[228:231]
ds_read_b64_tr_b16 a[236:237], v33 offset:45056
MM v[228:231],a[200:203],a[132:135],v[228:231]
ds_read_b64_tr_b16 a[238:239], v33 offset:47104
s_waitcnt lgkmcnt(8)
MM v[200:203],a[208:211],a[128:131],v[200:203]
ds_read_b64_tr_b16 a[240:241], v34 offset:40960
MM v[200:203],a[212:215],a[136:139],v[200:203]
ds_read_b64_tr_b16 a[242:243], v34 offset:43008
MM v[232:235],a[212:215],a[140:143],v[232:235]
ds_read_b64_tr_b16 a[244:245], v34 offset:45056
MM v[232:235],a[208:211],a[132:135],v[232:235]
ds_read_b64_tr_b16 a[246:247], v34 offset:47104
MM v[204:207],a[216:219],a[128:131],v[204:207]
ds_read_b64_tr_b16 a[248:249], v35 offset:40960
MM v[204:207],a[220:223],a[136:139],v[204:207]
ds_read_b64_tr_b16 a[250:251], v35 offset:43008
MM v[236:239],a[220:223],a[140:143],v[236:239]
ds_read_b64_tr_b16 a[252:253], v35 offset:45056
MM v[236:239],a[216:219],a[132:135],v[236:239]
ds_read_b64_tr_b16 a[254:255], v35 offset:47104
s_waitcnt vmcnt(12) lgkmcnt(8)
MM v[208:211],a[224:227],a[128:131],v[208:211]
ds_read_b64_tr_b16 a[192:193], v32 offset:49152
MM v[208:211],a[228:231],a[136:139],v[208:211]
ds_read_b64_tr_b16 a[194:195], v32 offset:51200
MM v[240:243],a[228:231],a[140:143],v[240:243]
ds_read_b64_tr_b16 a[196:197], v32 offset:53248
MM v[240:243],a[224:227],a[132:135],v[240:243]
ds_read_b64_tr_b16 a[198:199], v32 offset:55296
MM v[212:215],a[232:235],a[128:131],v[212:215]
ds_read_b64_tr_b16 a[200:201], v33 offset:49152
MM v[212:215],a[236:239],a[136:139],v[212:215]
ds_read_b64_tr_b16 a[202:203], v33 offset:51200
MM v[244:247],a[236:239],a[140:143],v[244:247]
ds_read_b64_tr_b16 a[204:205], v33 offset:53248
MM v[244:247],a[232:235],a[132:135],v[244:247]
ds_read_b64_tr_b16 a[206:207], v33 offset:55296
s_waitcnt lgkmcnt(8)
MM v[216:219],a[240:243],a[128:131],v[216:219]
ds_read_b64_tr_b16 a[208:209], v34 offset:49152
MM v[216:219],a[244:247],a[136:139],v[216:219]
ds_read_b64_tr_b16 a[210:211], v34 offset:51200
MM v[248:251],a[244:247],a[140:143],v[248:251]
ds_read_b64_tr_b16 a[212:213], v34 offset:53248
MM v[248:251],a[240:243],a[132:135],v[248:251]
ds_read_b64_tr_b16 a[214:215], v34 offset:55296
MM v[220:223],a[248:251],a[128:131],v[220:223]
ds_read_b64_tr_b16 a[216:217], v35 offset:49152
MM v[220:223],a[252:255],a[136:139],v[220:223]
ds_read_b64_tr_b16 a[218:219], v35 offset:51200
MM v[252:255],a[252:255],a[140:143],v[252:255]
ds_read_b64_tr_b16 a[220:221], v35 offset:53248
MM v[252:255],a[248:251],a[132:135],v[252:255]
ds_read_b64_tr_b16 a[222:223], v35 offset:55296
s_cmp_eq_u32 s8, 0
s_cbranch_scc1 L_p4done
s_waitcnt vmcnt(4) lgkmcnt(8)
MM v[192:195],a[192:195],a[144:147],v[192:195]
ds_read_b64_tr_b16 a[224:225], v32 offset:57344
MM v[192:195],a[196:199],a[152:155],v[192:195]
ds_read_b64_tr_b16 a[226:227], v32 offset:59392
MM v[224:227],a[196:199],a[156:159],v[224:227]
ds_read_b64_tr_b16 a[228:229], v32 offset:61440
MM v[224:227],a[192:195],a[148:151],v[224:227]
ds_read_b64_tr_b16 a[230:231], v32 offset:63488
MM v[196:199],a[200:203],a[144:147],v[196:199]
ds_read_b64_tr_b16 a[232:233], v33 offset:57344
MM v[196:199],a[204:207],a[152:155],v[196:199]
ds_read_b64_tr_b16 a[234:235], v33 offset:59392
MM v[228:231],a[204:207],a[156:159],v[228:231]
ds_read_b64_tr_b16 a[236:237], v33 offset:61440
MM v[228:231],a[200:203],a[148:151],v[228:231]
ds_read_b64_tr_b16 a[238:239], v33 offset:63488
s_waitcnt lgkmcnt(8)
MM v[200:203],a[208:211],a[144:147],v[200:203]
ds_read_b64_tr_b16 a[240:241], v34 offset:57344
MM v[200:203],a[212:215],a[152:155],v[200:203]
ds_read_b64_tr_b16 a[242:243], v34 offset:59392
MM v[232:235],a[212:215],a[156:159],v[232:235]
ds_read_b64_tr_b16 a[244:245], v34 offset:61440
MM v[232:235],a[208:211],a[148:151],v[232:235]
ds_read_b64_tr_b16 a[246:247], v34 offset:63488
MM v[204:207],a[216:219],a[144:147],v[204:207]
ds_read_b64_tr_b16 a[248:249], v35 offset:57344
MM v[204:207],a[220:223],a[152:155],v[204:207]
ds_read_b64_tr_b16 a[250:251], v35 offset:59392
MM v[236:239],a[220:223],a[156:159],v[236:239]
ds_read_b64_tr_b16 a[252:253], v35 offset:61440
MM v[236:239],a[216:219],a[148:151],v[236:239]
ds_read_b64_tr_b16 a[254:255], v35 offset:63488
s_waitcnt vmcnt(4) lgkmcnt(8)
MM v[208:211],a[224:227],a[144:147],v[208:211]
MM v[208:211],a[228:231],a[152:155],v[208:211]
MM v[240:243],a[228:231],a[156:159],v[240:243]
s_waitcnt vmcnt(6) lgkmcnt(0)
s_barrier
ds_read_b64_tr_b16 a[192:193], v36 offset:0
ds_read_b64_tr_b16 a[194:195], v36 offset:2048
MM v[240:243],a[224:227],a[148:151],v[240:243]
ds_read_b64_tr_b16 a[196:197], v36 offset:4096
ds_read_b64_tr_b16 a[198:199], v36 offset:6144
MM v[212:215],a[232:235],a[144:147],v[212:215]
ds_read_b64_tr_b16 a[200:201], v37 offset:0
MM v[212:215],a[236:239],a[152:155],v[212:215]
ds_read_b64_tr_b16 a[202:203], v37 offset:2048
MM v[244:247],a[236:239],a[156:159],v[244:247]
ds_read_b64_tr_b16 a[204:205], v37 offset:4096
MM v[244:247],a[232:235],a[148:151],v[244:247]
ds_read_b64_tr_b16 a[206:207], v37 offset:6144
s_waitcnt lgkmcnt(8)
MM v[216:219],a[240:243],a[144:147],v[216:219]
ds_read_b64_tr_b16 a[208:209], v38 offset:0
MM v[216:219],a[244:247],a[152:155],v[216:219]
ds_read_b64_tr_b16 a[210:211], v38 offset:2048
MM v[248:251],a[244:247],a[156:159],v[248:251]
ds_read_b64_tr_b16 a[212:213], v38 offset:4096
MM v[248:251],a[240:243],a[148:151],v[248:251]
ds_read_b64_tr_b16 a[214:215], v38 offset:6144
MM v[220:223],a[248:251],a[144:147],v[220:223]
ds_read_b64_tr_b16 a[216:217], v39 offset:0
MM v[220:223],a[252:255],a[152:155],v[220:223]
ds_read_b64_tr_b16 a[218:219], v39 offset:2048
MM v[252:255],a[252:255],a[156:159],v[252:255]
ds_read_b64_tr_b16 a[220:221], v39 offset:4096
MM v[252:255],a[248:251],a[148:151],v[252:255]
ds_read_b64_tr_b16 a[222:223], v39 offset:6144
s_waitcnt vmcnt(0) lgkmcnt(8)
MM v[192:195],a[192:195],a[160:163],v[192:195]
ds_read_b64_tr_b16 a[224:225], v36 offset:8192
MM v[192:195],a[196:199],a[168:171],v[192:195]
ds_read_b64_tr_b16 a[226:227], v36 offset:10240
MM v[224:227],a[196:199],a[172:175],v[224:227]
ds_read_b64_tr_b16 a[228:229], v36 offset:12288
MM v[224:227],a[192:195],a[164:167],v[224:227]
ds_read_b64_tr_b16 a[230:231], v36 offset:14336
MM v[196:199],a[200:203],a[160:163],v[196:199]
ds_read_b64_tr_b16 a[232:233], v37 offset:8192
MM v[196:199],a[204:207],a[168:171],v[196:199]
ds_read_b64_tr_b16 a[234:235], v37 offset:10240
MM v[228:231],a[204:207],a[172:175],v[228:231]
ds_read_b64_tr_b16 a[236:237], v37 offset:12288
MM v[228:231],a[200:203],a[164:167],v[228:231]
ds_read_b64_tr_b16 a[238:239], v37 offset:14336
s_waitcnt lgkmcnt(8)
MM v[200:203],a[208:211],a[160:163],v[200:203]
ds_read_b64_tr_b16 a[240:241], v38 offset:8192
MM v[200:203],a[212:215],a[168:171],v[200:203]
ds_read_b64_tr_b16 a[242:243], v38 offset:10240
MM v[232:235],a[212:215],a[172:175],v[232:235]
ds_read_b64_tr_b16 a[244:245], v38 offset:12288
MM v[232:235],a[208:211],a[164:167],v[232:235]
ds_read_b64_tr_b16 a[246:247], v38 offset:14336
MM v[204:207],a[216:219],a[160:163],v[204:207]
ds_read_b64_tr_b16 a[248:249], v39 offset:8192
MM v[204:207],a[220:223],a[168:171],v[204:207]
ds_read_b64_tr_b16 a[250:251], v39 offset:10240
MM v[236:239],a[220:223],a[172:175],v[236:239]
ds_read_b64_tr_b16 a[252:253], v39 offset:12288
MM v[236:239],a[216:219],a[164:167],v[236:239]
ds_read_b64_tr_b16 a[254:255], v39 offset:14336
s_waitcnt vmcnt(0) lgkmcnt(8)
MM v[208:211],a[224:227],a[160:163],v[208:211]
MM v[208:211],a[228:231],a[168:171],v[208:211]
MM v[240:243],a[228:231],a[172:175],v[240:243]
MM v[240:243],a[224:227],a[164:167],v[240:243]
MM v[212:215],a[232:235],a[160:163],v[212:215]
MM v[212:215],a[236:239],a[168:171],v[212:215]
MM v[244:247],a[236:239],a[172:175],v[244:247]
MM v[244:247],a[232:235],a[164:167],v[244:247]
s_waitcnt lgkmcnt(0)
MM v[216:219],a[240:243],a[160:163],v[216:219]
MM v[216:219],a[244:247],a[168:171],v[216:219]
MM v[248:251],a[244:247],a[172:175],v[248:251]
MM v[248:251],a[240:243],a[164:167],v[248:251]
MM v[220:223],a[248:251],a[160:163],v[220:223]
MM v[220:223],a[252:255],a[168:171],v[220:223]
MM v[252:255],a[252:255],a[172:175],v[252:255]
MM v[252:255],a[248:251],a[164:167],v[252:255]
L_p4done:
s_nop 7
CV v224,v224,v225
CV v225,v226,v227
CV v226,v228,v229
CV v227,v230,v231
v_min_u32 v224, -2, v224
v_min_u32 v225, -2, v225
v_min_u32 v226, -2, v226
v_min_u32 v227, -2, v227
buffer_store_dwordx4 v[224:227], v1, s[32:35], s16 offen offset:0 sc0 sc1
CV v228,v232,v233
CV v229,v234,v235
CV v230,v236,v237
CV v231,v238,v239
v_min_u32 v228, -2, v228
v_min_u32 v229, -2, v229
v_min_u32 v230, -2, v230
v_min_u32 v231, -2, v231
buffer_store_dwordx4 v[228:231], v1, s[32:35], s16 offen offset:1024 sc0 sc1
CV v232,v240,v241
CV v233,v242,v243
CV v234,v244,v245
CV v235,v246,v247
v_min_u32 v232, -2, v232
v_min_u32 v233, -2, v233
v_min_u32 v234, -2, v234
v_min_u32 v235, -2, v235
buffer_store_dwordx4 v[232:235], v1, s[32:35], s16 offen offset:2048 sc0 sc1
CV v236,v248,v249
CV v237,v250,v251
CV v238,v252,v253
CV v239,v254,v255
v_min_u32 v236, -2, v236
v_min_u32 v237, -2, v237
v_min_u32 v238, -2, v238
v_min_u32 v239, -2, v239
buffer_store_dwordx4 v[236:239], v1, s[32:35], s16 offen offset:3072 sc0 sc1
s_cmp_lg_u32 s8, 0
s_cbranch_scc1 L_fin
CV v112,v192,v193
CV v113,v194,v195
CV v114,v196,v197
CV v115,v198,v199
v_min_u32 v112, -2, v112
v_min_u32 v113, -2, v113
v_min_u32 v114, -2, v114
v_min_u32 v115, -2, v115
buffer_store_dwordx4 v[112:115], v1, s[32:35], s17 offen offset:0 sc0 sc1
CV v116,v200,v201
CV v117,v202,v203
CV v118,v204,v205
CV v119,v206,v207
v_min_u32 v116, -2, v116
v_min_u32 v117, -2, v117
v_min_u32 v118, -2, v118
v_min_u32 v119, -2, v119
buffer_store_dwordx4 v[116:119], v1, s[32:35], s17 offen offset:1024 sc0 sc1
CV v120,v208,v209
CV v121,v210,v211
CV v122,v212,v213
CV v123,v214,v215
v_min_u32 v120, -2, v120
v_min_u32 v121, -2, v121
v_min_u32 v122, -2, v122
v_min_u32 v123, -2, v123
buffer_store_dwordx4 v[120:123], v1, s[32:35], s17 offen offset:2048 sc0 sc1
CV v124,v216,v217
CV v125,v218,v219
CV v126,v220,v221
CV v127,v222,v223
v_min_u32 v124, -2, v124
v_min_u32 v125, -2, v125
v_min_u32 v126, -2, v126
v_min_u32 v127, -2, v127
buffer_store_dwordx4 v[124:127], v1, s[32:35], s17 offen offset:3072 sc0 sc1
s_endpgm
L_fin:
s_mov_b32 s63, 0x40000
v_lshlrev_b32 v40, 16, v160
v_and_b32 v41, s65, v160
v_lshlrev_b32 v42, 16, v161
v_and_b32 v43, s65, v161
v_add_f32 v128, v128, v40
v_add_f32 v129, v129, v41
v_add_f32 v130, v130, v42
v_add_f32 v131, v131, v43
v_lshlrev_b32 v40, 16, v176
v_and_b32 v41, s65, v176
v_lshlrev_b32 v42, 16, v177
v_and_b32 v43, s65, v177
v_add_f32 v128, v128, v40
v_add_f32 v129, v129, v41
v_add_f32 v130, v130, v42
v_add_f32 v131, v131, v43
CV v40,v128,v129
v_lshlrev_b32 v128, 16, v40
v_and_b32 v129, s65, v40
CV v40,v130,v131
v_lshlrev_b32 v130, 16, v40
v_and_b32 v131, s65, v40
v_mul_f32 v40, s64, v128
v_mul_f32 v41, s64, v129
v_mul_f32 v42, s64, v130
v_mul_f32 v43, s64, v131
v_exp_f32 v40, v40
v_exp_f32 v41, v41
v_exp_f32 v42, v42
v_exp_f32 v43, v43
v_add_f32 v40, 1.0, v40
v_add_f32 v41, 1.0, v41
v_add_f32 v42, 1.0, v42
v_add_f32 v43, 1.0, v43
v_rcp_f32 v40, v40
v_rcp_f32 v41, v41
v_rcp_f32 v42, v42
v_rcp_f32 v43, v43
v_mul_f32 v128, v128, v40
v_mul_f32 v129, v129, v41
v_mul_f32 v130, v130, v42
v_mul_f32 v131, v131, v43
CV v40,v128,v129
v_lshlrev_b32 v128, 16, v40
v_and_b32 v129, s65, v40
CV v40,v130,v131
v_lshlrev_b32 v130, 16, v40
v_and_b32 v131, s65, v40
v_lshlrev_b32 v44, 16, v162
v_and_b32 v45, s65, v162
v_lshlrev_b32 v46, 16, v163
v_and_b32 v47, s65, v163
v_add_f32 v132, v132, v44
v_add_f32 v133, v133, v45
v_add_f32 v134, v134, v46
v_add_f32 v135, v135, v47
v_lshlrev_b32 v44, 16, v178
v_and_b32 v45, s65, v178
v_lshlrev_b32 v46, 16, v179
v_and_b32 v47, s65, v179
v_add_f32 v132, v132, v44
v_add_f32 v133, v133, v45
v_add_f32 v134, v134, v46
v_add_f32 v135, v135, v47
CV v44,v132,v133
v_lshlrev_b32 v132, 16, v44
v_and_b32 v133, s65, v44
CV v44,v134,v135
v_lshlrev_b32 v134, 16, v44
v_and_b32 v135, s65, v44
v_mul_f32 v44, s64, v132
v_mul_f32 v45, s64, v133
v_mul_f32 v46, s64, v134
v_mul_f32 v47, s64, v135
v_exp_f32 v44, v44
v_exp_f32 v45, v45
v_exp_f32 v46, v46
v_exp_f32 v47, v47
v_add_f32 v44, 1.0, v44
v_add_f32 v45, 1.0, v45
v_add_f32 v46, 1.0, v46
v_add_f32 v47, 1.0, v47
v_rcp_f32 v44, v44
v_rcp_f32 v45, v45
v_rcp_f32 v46, v46
v_rcp_f32 v47, v47
v_mul_f32 v132, v132, v44
v_mul_f32 v133, v133, v45
v_mul_f32 v134, v134, v46
v_mul_f32 v135, v135, v47
CV v44,v132,v133
v_lshlrev_b32 v132, 16, v44
v_and_b32 v133, s65, v44
CV v44,v134,v135
v_lshlrev_b32 v134, 16, v44
v_and_b32 v135, s65, v44
v_lshlrev_b32 v40, 16, v164
v_and_b32 v41, s65, v164
v_lshlrev_b32 v42, 16, v165
v_and_b32 v43, s65, v165
v_add_f32 v136, v136, v40
v_add_f32 v137, v137, v41
v_add_f32 v138, v138, v42
v_add_f32 v139, v139, v43
v_lshlrev_b32 v40, 16, v180
v_and_b32 v41, s65, v180
v_lshlrev_b32 v42, 16, v181
v_and_b32 v43, s65, v181
v_add_f32 v136, v136, v40
v_add_f32 v137, v137, v41
v_add_f32 v138, v138, v42
v_add_f32 v139, v139, v43
CV v40,v136,v137
v_lshlrev_b32 v136, 16, v40
v_and_b32 v137, s65, v40
CV v40,v138,v139
v_lshlrev_b32 v138, 16, v40
v_and_b32 v139, s65, v40
v_mul_f32 v40, s64, v136
v_mul_f32 v41, s64, v137
v_mul_f32 v42, s64, v138
v_mul_f32 v43, s64, v139
v_exp_f32 v40, v40
v_exp_f32 v41, v41
v_exp_f32 v42, v42
v_exp_f32 v43, v43
v_add_f32 v40, 1.0, v40
v_add_f32 v41, 1.0, v41
v_add_f32 v42, 1.0, v42
v_add_f32 v43, 1.0, v43
v_rcp_f32 v40, v40
v_rcp_f32 v41, v41
v_rcp_f32 v42, v42
v_rcp_f32 v43, v43
v_mul_f32 v136, v136, v40
v_mul_f32 v137, v137, v41
v_mul_f32 v138, v138, v42
v_mul_f32 v139, v139, v43
CV v40,v136,v137
v_lshlrev_b32 v136, 16, v40
v_and_b32 v137, s65, v40
CV v40,v138,v139
v_lshlrev_b32 v138, 16, v40
v_and_b32 v139, s65, v40
v_lshlrev_b32 v44, 16, v166
v_and_b32 v45, s65, v166
v_lshlrev_b32 v46, 16, v167
v_and_b32 v47, s65, v167
v_add_f32 v140, v140, v44
v_add_f32 v141, v141, v45
v_add_f32 v142, v142, v46
v_add_f32 v143, v143, v47
v_lshlrev_b32 v44, 16, v182
v_and_b32 v45, s65, v182
v_lshlrev_b32 v46, 16, v183
v_and_b32 v47, s65, v183
v_add_f32 v140, v140, v44
v_add_f32 v141, v141, v45
v_add_f32 v142, v142, v46
v_add_f32 v143, v143, v47
CV v44,v140,v141
v_lshlrev_b32 v140, 16, v44
v_and_b32 v141, s65, v44
CV v44,v142,v143
v_lshlrev_b32 v142, 16, v44
v_and_b32 v143, s65, v44
v_mul_f32 v44, s64, v140
v_mul_f32 v45, s64, v141
v_mul_f32 v46, s64, v142
v_mul_f32 v47, s64, v143
v_exp_f32 v44, v44
v_exp_f32 v45, v45
v_exp_f32 v46, v46
v_exp_f32 v47, v47
v_add_f32 v44, 1.0, v44
v_add_f32 v45, 1.0, v45
v_add_f32 v46, 1.0, v46
v_add_f32 v47, 1.0, v47
v_rcp_f32 v44, v44
v_rcp_f32 v45, v45
v_rcp_f32 v46, v46
v_rcp_f32 v47, v47
v_mul_f32 v140, v140, v44
v_mul_f32 v141, v141, v45
v_mul_f32 v142, v142, v46
v_mul_f32 v143, v143, v47
CV v44,v140,v141
v_lshlrev_b32 v140, 16, v44
v_and_b32 v141, s65, v44
CV v44,v142,v143
v_lshlrev_b32 v142, 16, v44
v_and_b32 v143, s65, v44
v_lshlrev_b32 v40, 16, v168
v_and_b32 v41, s65, v168
v_lshlrev_b32 v42, 16, v169
v_and_b32 v43, s65, v169
v_add_f32 v144, v144, v40
v_add_f32 v145, v145, v41
v_add_f32 v146, v146, v42
v_add_f32 v147, v147, v43
v_lshlrev_b32 v40, 16, v184
v_and_b32 v41, s65, v184
v_lshlrev_b32 v42, 16, v185
v_and_b32 v43, s65, v185
v_add_f32 v144, v144, v40
v_add_f32 v145, v145, v41
v_add_f32 v146, v146, v42
v_add_f32 v147, v147, v43
buffer_load_dwordx4 v[64:67], v1, s[32:35], s21 offen offset:0 sc0 sc1
buffer_load_dwordx4 v[80:83], v1, s[32:35], s62 offen offset:0 sc0 sc1
buffer_load_dwordx4 v[68:71], v1, s[32:35], s21 offen offset:1024 sc0 sc1
buffer_load_dwordx4 v[84:87], v1, s[32:35], s62 offen offset:1024 sc0 sc1
buffer_load_dwordx4 v[72:75], v1, s[32:35], s21 offen offset:2048 sc0 sc1
buffer_load_dwordx4 v[88:91], v1, s[32:35], s62 offen offset:2048 sc0 sc1
buffer_load_dwordx4 v[76:79], v1, s[32:35], s21 offen offset:3072 sc0 sc1
buffer_load_dwordx4 v[92:95], v1, s[32:35], s62 offen offset:3072 sc0 sc1
CV v40,v144,v145
v_lshlrev_b32 v144, 16, v40
v_and_b32 v145, s65, v40
CV v40,v146,v147
v_lshlrev_b32 v146, 16, v40
v_and_b32 v147, s65, v40
v_mul_f32 v40, s64, v144
v_mul_f32 v41, s64, v145
v_mul_f32 v42, s64, v146
v_mul_f32 v43, s64, v147
v_exp_f32 v40, v40
v_exp_f32 v41, v41
v_exp_f32 v42, v42
v_exp_f32 v43, v43
v_add_f32 v40, 1.0, v40
v_add_f32 v41, 1.0, v41
v_add_f32 v42, 1.0, v42
v_add_f32 v43, 1.0, v43
v_rcp_f32 v40, v40
v_rcp_f32 v41, v41
v_rcp_f32 v42, v42
v_rcp_f32 v43, v43
v_mul_f32 v144, v144, v40
v_mul_f32 v145, v145, v41
v_mul_f32 v146, v146, v42
v_mul_f32 v147, v147, v43
CV v40,v144,v145
v_lshlrev_b32 v144, 16, v40
v_and_b32 v145, s65, v40
CV v40,v146,v147
v_lshlrev_b32 v146, 16, v40
v_and_b32 v147, s65, v40
v_lshlrev_b32 v44, 16, v170
v_and_b32 v45, s65, v170
v_lshlrev_b32 v46, 16, v171
v_and_b32 v47, s65, v171
v_add_f32 v148, v148, v44
v_add_f32 v149, v149, v45
v_add_f32 v150, v150, v46
v_add_f32 v151, v151, v47
v_lshlrev_b32 v44, 16, v186
v_and_b32 v45, s65, v186
v_lshlrev_b32 v46, 16, v187
v_and_b32 v47, s65, v187
v_add_f32 v148, v148, v44
v_add_f32 v149, v149, v45
v_add_f32 v150, v150, v46
v_add_f32 v151, v151, v47
CV v44,v148,v149
v_lshlrev_b32 v148, 16, v44
v_and_b32 v149, s65, v44
CV v44,v150,v151
v_lshlrev_b32 v150, 16, v44
v_and_b32 v151, s65, v44
v_mul_f32 v44, s64, v148
v_mul_f32 v45, s64, v149
v_mul_f32 v46, s64, v150
v_mul_f32 v47, s64, v151
v_exp_f32 v44, v44
v_exp_f32 v45, v45
v_exp_f32 v46, v46
v_exp_f32 v47, v47
v_add_f32 v44, 1.0, v44
v_add_f32 v45, 1.0, v45
v_add_f32 v46, 1.0, v46
v_add_f32 v47, 1.0, v47
v_rcp_f32 v44, v44
v_rcp_f32 v45, v45
v_rcp_f32 v46, v46
v_rcp_f32 v47, v47
v_mul_f32 v148, v148, v44
v_mul_f32 v149, v149, v45
v_mul_f32 v150, v150, v46
v_mul_f32 v151, v151, v47
CV v44,v148,v149
v_lshlrev_b32 v148, 16, v44
v_and_b32 v149, s65, v44
CV v44,v150,v151
v_lshlrev_b32 v150, 16, v44
v_and_b32 v151, s65, v44
v_lshlrev_b32 v40, 16, v172
v_and_b32 v41, s65, v172
v_lshlrev_b32 v42, 16, v173
v_and_b32 v43, s65, v173
v_add_f32 v152, v152, v40
v_add_f32 v153, v153, v41
v_add_f32 v154, v154, v42
v_add_f32 v155, v155, v43
v_lshlrev_b32 v40, 16, v188
v_and_b32 v41, s65, v188
v_lshlrev_b32 v42, 16, v189
v_and_b32 v43, s65, v189
v_add_f32 v152, v152, v40
v_add_f32 v153, v153, v41
v_add_f32 v154, v154, v42
v_add_f32 v155, v155, v43
CV v40,v152,v153
v_lshlrev_b32 v152, 16, v40
v_and_b32 v153, s65, v40
CV v40,v154,v155
v_lshlrev_b32 v154, 16, v40
v_and_b32 v155, s65, v40
v_mul_f32 v40, s64, v152
v_mul_f32 v41, s64, v153
v_mul_f32 v42, s64, v154
v_mul_f32 v43, s64, v155
v_exp_f32 v40, v40
v_exp_f32 v41, v41
v_exp_f32 v42, v42
v_exp_f32 v43, v43
v_add_f32 v40, 1.0, v40
v_add_f32 v41, 1.0, v41
v_add_f32 v42, 1.0, v42
v_add_f32 v43, 1.0, v43
v_rcp_f32 v40, v40
v_rcp_f32 v41, v41
v_rcp_f32 v42, v42
v_rcp_f32 v43, v43
v_mul_f32 v152, v152, v40
v_mul_f32 v153, v153, v41
v_mul_f32 v154, v154, v42
v_mul_f32 v155, v155, v43
CV v40,v152,v153
v_lshlrev_b32 v152, 16, v40
v_and_b32 v153, s65, v40
CV v40,v154,v155
v_lshlrev_b32 v154, 16, v40
v_and_b32 v155, s65, v40
v_lshlrev_b32 v44, 16, v174
v_and_b32 v45, s65, v174
v_lshlrev_b32 v46, 16, v175
v_and_b32 v47, s65, v175
v_add_f32 v156, v156, v44
v_add_f32 v157, v157, v45
v_add_f32 v158, v158, v46
v_add_f32 v159, v159, v47
v_lshlrev_b32 v44, 16, v190
v_and_b32 v45, s65, v190
v_lshlrev_b32 v46, 16, v191
v_and_b32 v47, s65, v191
v_add_f32 v156, v156, v44
v_add_f32 v157, v157, v45
v_add_f32 v158, v158, v46
v_add_f32 v159, v159, v47
CV v44,v156,v157
v_lshlrev_b32 v156, 16, v44
v_and_b32 v157, s65, v44
CV v44,v158,v159
v_lshlrev_b32 v158, 16, v44
v_and_b32 v159, s65, v44
v_mul_f32 v44, s64, v156
v_mul_f32 v45, s64, v157
v_mul_f32 v46, s64, v158
v_mul_f32 v47, s64, v159
v_exp_f32 v44, v44
v_exp_f32 v45, v45
v_exp_f32 v46, v46
v_exp_f32 v47, v47
v_add_f32 v44, 1.0, v44
v_add_f32 v45, 1.0, v45
v_add_f32 v46, 1.0, v46
v_add_f32 v47, 1.0, v47
v_rcp_f32 v44, v44
v_rcp_f32 v45, v45
v_rcp_f32 v46, v46
v_rcp_f32 v47, v47
v_mul_f32 v156, v156, v44
v_mul_f32 v157, v157, v45
v_mul_f32 v158, v158, v46
v_mul_f32 v159, v159, v47
CV v44,v156,v157
v_lshlrev_b32 v156, 16, v44
v_and_b32 v157, s65, v44
CV v44,v158,v159
v_lshlrev_b32 v158, 16, v44
v_and_b32 v159, s65, v44
v_lshlrev_b32 v160, 16, v96
v_and_b32 v161, s65, v96
v_lshlrev_b32 v162, 16, v97
v_and_b32 v163, s65, v97
v_lshlrev_b32 v164, 16, v98
v_and_b32 v165, s65, v98
v_lshlrev_b32 v166, 16, v99
v_and_b32 v167, s65, v99
v_lshlrev_b32 v168, 16, v100
v_and_b32 v169, s65, v100
v_lshlrev_b32 v170, 16, v101
v_and_b32 v171, s65, v101
v_lshlrev_b32 v172, 16, v102
v_and_b32 v173, s65, v102
v_lshlrev_b32 v174, 16, v103
v_and_b32 v175, s65, v103
v_lshlrev_b32 v176, 16, v104
v_and_b32 v177, s65, v104
v_lshlrev_b32 v178, 16, v105
v_and_b32 v179, s65, v105
v_lshlrev_b32 v180, 16, v106
v_and_b32 v181, s65, v106
v_lshlrev_b32 v182, 16, v107
v_and_b32 v183, s65, v107
v_lshlrev_b32 v184, 16, v108
v_and_b32 v185, s65, v108
v_lshlrev_b32 v186, 16, v109
v_and_b32 v187, s65, v109
v_lshlrev_b32 v188, 16, v110
v_and_b32 v189, s65, v110
v_lshlrev_b32 v190, 16, v111
v_and_b32 v191, s65, v111
s_branch L_rx2
L_rx:
buffer_load_dwordx4 v[64:67], v1, s[32:35], s21 offen offset:0 sc0 sc1
buffer_load_dwordx4 v[80:83], v1, s[32:35], s62 offen offset:0 sc0 sc1
buffer_load_dwordx4 v[68:71], v1, s[32:35], s21 offen offset:1024 sc0 sc1
buffer_load_dwordx4 v[84:87], v1, s[32:35], s62 offen offset:1024 sc0 sc1
buffer_load_dwordx4 v[72:75], v1, s[32:35], s21 offen offset:2048 sc0 sc1
buffer_load_dwordx4 v[88:91], v1, s[32:35], s62 offen offset:2048 sc0 sc1
buffer_load_dwordx4 v[76:79], v1, s[32:35], s21 offen offset:3072 sc0 sc1
buffer_load_dwordx4 v[92:95], v1, s[32:35], s62 offen offset:3072 sc0 sc1
L_rx2:
s_waitcnt vmcnt(4)
v_max3_u32 v40, v64, v65, v66
v_max_u32 v40, v40, v67
v_max3_u32 v40, v40, v80, v81
v_max3_u32 v40, v40, v82, v83
v_max3_u32 v40, v40, v68, v69
v_max3_u32 v40, v40, v70, v71
v_max3_u32 v40, v40, v84, v85
v_max3_u32 v40, v40, v86, v87
s_waitcnt vmcnt(0)
v_max3_u32 v40, v40, v72, v73
v_max3_u32 v40, v40, v74, v75
v_max3_u32 v40, v40, v88, v89
v_max3_u32 v40, v40, v90, v91
v_max3_u32 v40, v40, v76, v77
v_max3_u32 v40, v40, v78, v79
v_max3_u32 v40, v40, v92, v93
v_max3_u32 v40, v40, v94, v95
v_cmp_eq_u32 vcc, -1, v40
s_sub_u32 s63, s63, 1
s_cbranch_scc1 L_rxok
s_cbranch_vccnz L_rx
L_rxok:
v_lshlrev_b32 v40, 16, v64
v_and_b32 v41, s65, v64
v_lshlrev_b32 v42, 16, v65
v_and_b32 v43, s65, v65
v_add_f32 v192, v192, v40
v_add_f32 v193, v193, v41
v_add_f32 v194, v194, v42
v_add_f32 v195, v195, v43
v_lshlrev_b32 v40, 16, v80
v_and_b32 v41, s65, v80
v_lshlrev_b32 v42, 16, v81
v_and_b32 v43, s65, v81
v_add_f32 v192, v192, v40
v_add_f32 v193, v193, v41
v_add_f32 v194, v194, v42
v_add_f32 v195, v195, v43
CV v56,v192,v193
v_lshlrev_b32 v192, 16, v56
v_and_b32 v193, s65, v56
CV v56,v194,v195
v_lshlrev_b32 v194, 16, v56
v_and_b32 v195, s65, v56
v_mul_f32 v192, v192, v128
v_mul_f32 v193, v193, v129
v_mul_f32 v194, v194, v130
v_mul_f32 v195, v195, v131
CV v96,v192,v193
CV v97,v194,v195
ds_write_b64 v21, v[96:97] offset:32768
v_lshlrev_b32 v40, 16, v66
v_and_b32 v41, s65, v66
v_lshlrev_b32 v42, 16, v67
v_and_b32 v43, s65, v67
v_add_f32 v196, v196, v40
v_add_f32 v197, v197, v41
v_add_f32 v198, v198, v42
v_add_f32 v199, v199, v43
v_lshlrev_b32 v40, 16, v82
v_and_b32 v41, s65, v82
v_lshlrev_b32 v42, 16, v83
v_and_b32 v43, s65, v83
v_add_f32 v196, v196, v40
v_add_f32 v197, v197, v41
v_add_f32 v198, v198, v42
v_add_f32 v199, v199, v43
CV v56,v196,v197
v_lshlrev_b32 v196, 16, v56
v_and_b32 v197, s65, v56
CV v56,v198,v199
v_lshlrev_b32 v198, 16, v56
v_and_b32 v199, s65, v56
v_mul_f32 v196, v196, v132
v_mul_f32 v197, v197, v133
v_mul_f32 v198, v198, v134
v_mul_f32 v199, v199, v135
CV v98,v196,v197
CV v99,v198,v199
ds_write_b64 v21, v[98:99] offset:32800
v_lshlrev_b32 v40, 16, v68
v_and_b32 v41, s65, v68
v_lshlrev_b32 v42, 16, v69
v_and_b32 v43, s65, v69
v_add_f32 v200, v200, v40
v_add_f32 v201, v201, v41
v_add_f32 v202, v202, v42
v_add_f32 v203, v203, v43
v_lshlrev_b32 v40, 16, v84
v_and_b32 v41, s65, v84
v_lshlrev_b32 v42, 16, v85
v_and_b32 v43, s65, v85
v_add_f32 v200, v200, v40
v_add_f32 v201, v201, v41
v_add_f32 v202, v202, v42
v_add_f32 v203, v203, v43
CV v56,v200,v201
v_lshlrev_b32 v200, 16, v56
v_and_b32 v201, s65, v56
CV v56,v202,v203
v_lshlrev_b32 v202, 16, v56
v_and_b32 v203, s65, v56
v_mul_f32 v200, v200, v136
v_mul_f32 v201, v201, v137
v_mul_f32 v202, v202, v138
v_mul_f32 v203, v203, v139
CV v100,v200,v201
CV v101,v202,v203
ds_write_b64 v21, v[100:101] offset:32832
v_lshlrev_b32 v40, 16, v70
v_and_b32 v41, s65, v70
v_lshlrev_b32 v42, 16, v71
v_and_b32 v43, s65, v71
v_add_f32 v204, v204, v40
v_add_f32 v205, v205, v41
v_add_f32 v206, v206, v42
v_add_f32 v207, v207, v43
v_lshlrev_b32 v40, 16, v86
v_and_b32 v41, s65, v86
v_lshlrev_b32 v42, 16, v87
v_and_b32 v43, s65, v87
v_add_f32 v204, v204, v40
v_add_f32 v205, v205, v41
v_add_f32 v206, v206, v42
v_add_f32 v207, v207, v43
CV v56,v204,v205
v_lshlrev_b32 v204, 16, v56
v_and_b32 v205, s65, v56
CV v56,v206,v207
v_lshlrev_b32 v206, 16, v56
v_and_b32 v207, s65, v56
v_mul_f32 v204, v204, v140
v_mul_f32 v205, v205, v141
v_mul_f32 v206, v206, v142
v_mul_f32 v207, v207, v143
CV v102,v204,v205
CV v103,v206,v207
ds_write_b64 v21, v[102:103] offset:32864
v_lshlrev_b32 v40, 16, v72
v_and_b32 v41, s65, v72
v_lshlrev_b32 v42, 16, v73
v_and_b32 v43, s65, v73
v_add_f32 v208, v208, v40
v_add_f32 v209, v209, v41
v_add_f32 v210, v210, v42
v_add_f32 v211, v211, v43
v_lshlrev_b32 v40, 16, v88
v_and_b32 v41, s65, v88
v_lshlrev_b32 v42, 16, v89
v_and_b32 v43, s65, v89
v_add_f32 v208, v208, v40
v_add_f32 v209, v209, v41
v_add_f32 v210, v210, v42
v_add_f32 v211, v211, v43
CV v56,v208,v209
v_lshlrev_b32 v208, 16, v56
v_and_b32 v209, s65, v56
CV v56,v210,v211
v_lshlrev_b32 v210, 16, v56
v_and_b32 v211, s65, v56
v_mul_f32 v208, v208, v144
v_mul_f32 v209, v209, v145
v_mul_f32 v210, v210, v146
v_mul_f32 v211, v211, v147
CV v104,v208,v209
CV v105,v210,v211
ds_write_b64 v21, v[104:105] offset:32896
v_lshlrev_b32 v40, 16, v74
v_and_b32 v41, s65, v74
v_lshlrev_b32 v42, 16, v75
v_and_b32 v43, s65, v75
v_add_f32 v212, v212, v40
v_add_f32 v213, v213, v41
v_add_f32 v214, v214, v42
v_add_f32 v215, v215, v43
v_lshlrev_b32 v40, 16, v90
v_and_b32 v41, s65, v90
v_lshlrev_b32 v42, 16, v91
v_and_b32 v43, s65, v91
v_add_f32 v212, v212, v40
v_add_f32 v213, v213, v41
v_add_f32 v214, v214, v42
v_add_f32 v215, v215, v43
CV v56,v212,v213
v_lshlrev_b32 v212, 16, v56
v_and_b32 v213, s65, v56
CV v56,v214,v215
v_lshlrev_b32 v214, 16, v56
v_and_b32 v215, s65, v56
v_mul_f32 v212, v212, v148
v_mul_f32 v213, v213, v149
v_mul_f32 v214, v214, v150
v_mul_f32 v215, v215, v151
CV v106,v212,v213
CV v107,v214,v215
ds_write_b64 v21, v[106:107] offset:32928
v_lshlrev_b32 v40, 16, v76
v_and_b32 v41, s65, v76
v_lshlrev_b32 v42, 16, v77
v_and_b32 v43, s65, v77
v_add_f32 v216, v216, v40
v_add_f32 v217, v217, v41
v_add_f32 v218, v218, v42
v_add_f32 v219, v219, v43
v_lshlrev_b32 v40, 16, v92
v_and_b32 v41, s65, v92
v_lshlrev_b32 v42, 16, v93
v_and_b32 v43, s65, v93
v_add_f32 v216, v216, v40
v_add_f32 v217, v217, v41
v_add_f32 v218, v218, v42
v_add_f32 v219, v219, v43
CV v56,v216,v217
v_lshlrev_b32 v216, 16, v56
v_and_b32 v217, s65, v56
CV v56,v218,v219
v_lshlrev_b32 v218, 16, v56
v_and_b32 v219, s65, v56
v_mul_f32 v216, v216, v152
v_mul_f32 v217, v217, v153
v_mul_f32 v218, v218, v154
v_mul_f32 v219, v219, v155
CV v108,v216,v217
CV v109,v218,v219
ds_write_b64 v21, v[108:109] offset:32960
v_lshlrev_b32 v40, 16, v78
v_and_b32 v41, s65, v78
v_lshlrev_b32 v42, 16, v79
v_and_b32 v43, s65, v79
v_add_f32 v220, v220, v40
v_add_f32 v221, v221, v41
v_add_f32 v222, v222, v42
v_add_f32 v223, v223, v43
v_lshlrev_b32 v40, 16, v94
v_and_b32 v41, s65, v94
v_lshlrev_b32 v42, 16, v95
v_and_b32 v43, s65, v95
v_add_f32 v220, v220, v40
v_add_f32 v221, v221, v41
v_add_f32 v222, v222, v42
v_add_f32 v223, v223, v43
CV v56,v220,v221
v_lshlrev_b32 v220, 16, v56
v_and_b32 v221, s65, v56
CV v56,v222,v223
v_lshlrev_b32 v222, 16, v56
v_and_b32 v223, s65, v56
v_mul_f32 v220, v220, v156
v_mul_f32 v221, v221, v157
v_mul_f32 v222, v222, v158
v_mul_f32 v223, v223, v159
CV v110,v220,v221
CV v111,v222,v223
ds_write_b64 v21, v[110:111] offset:32992
ds_read_b128 v[64:67], v23 offset:32768
ds_read_b128 v[68:71], v23 offset:33040
ds_read_b128 v[72:75], v23 offset:33312
ds_read_b128 v[76:79], v23 offset:33584
s_waitcnt lgkmcnt(3)
v_lshlrev_b32 v40, 16, v64
v_and_b32 v41, s65, v64
v_add_f32 v40, v40, v160
v_add_f32 v41, v41, v161
CV v80,v40,v41
v_lshlrev_b32 v40, 16, v65
v_and_b32 v41, s65, v65
v_add_f32 v40, v40, v162
v_add_f32 v41, v41, v163
CV v81,v40,v41
v_lshlrev_b32 v40, 16, v66
v_and_b32 v41, s65, v66
v_add_f32 v40, v40, v164
v_add_f32 v41, v41, v165
CV v82,v40,v41
v_lshlrev_b32 v40, 16, v67
v_and_b32 v41, s65, v67
v_add_f32 v40, v40, v166
v_add_f32 v41, v41, v167
CV v83,v40,v41
buffer_store_dwordx4 v[80:83], v20, s[4:7], s13 offen offset:0 sc0 sc1
s_waitcnt lgkmcnt(2)
v_lshlrev_b32 v40, 16, v68
v_and_b32 v41, s65, v68
v_add_f32 v40, v40, v168
v_add_f32 v41, v41, v169
CV v84,v40,v41
v_lshlrev_b32 v40, 16, v69
v_and_b32 v41, s65, v69
v_add_f32 v40, v40, v170
v_add_f32 v41, v41, v171
CV v85,v40,v41
v_lshlrev_b32 v40, 16, v70
v_and_b32 v41, s65, v70
v_add_f32 v40, v40, v172
v_add_f32 v41, v41, v173
CV v86,v40,v41
v_lshlrev_b32 v40, 16, v71
v_and_b32 v41, s65, v71
v_add_f32 v40, v40, v174
v_add_f32 v41, v41, v175
CV v87,v40,v41
buffer_store_dwordx4 v[84:87], v20, s[4:7], s13 offen offset:1280 sc0 sc1
s_waitcnt lgkmcnt(1)
v_lshlrev_b32 v40, 16, v72
v_and_b32 v41, s65, v72
v_add_f32 v40, v40, v176
v_add_f32 v41, v41, v177
CV v88,v40,v41
v_lshlrev_b32 v40, 16, v73
v_and_b32 v41, s65, v73
v_add_f32 v40, v40, v178
v_add_f32 v41, v41, v179
CV v89,v40,v41
v_lshlrev_b32 v40, 16, v74
v_and_b32 v41, s65, v74
v_add_f32 v40, v40, v180
v_add_f32 v41, v41, v181
CV v90,v40,v41
v_lshlrev_b32 v40, 16, v75
v_and_b32 v41, s65, v75
v_add_f32 v40, v40, v182
v_add_f32 v41, v41, v183
CV v91,v40,v41
buffer_store_dwordx4 v[88:91], v20, s[4:7], s13 offen offset:2560 sc0 sc1
s_waitcnt lgkmcnt(0)
v_lshlrev_b32 v40, 16, v76
v_and_b32 v41, s65, v76
v_add_f32 v40, v40, v184
v_add_f32 v41, v41, v185
CV v92,v40,v41
v_lshlrev_b32 v40, 16, v77
v_and_b32 v41, s65, v77
v_add_f32 v40, v40, v186
v_add_f32 v41, v41, v187
CV v93,v40,v41
v_lshlrev_b32 v40, 16, v78
v_and_b32 v41, s65, v78
v_add_f32 v40, v40, v188
v_add_f32 v41, v41, v189
CV v94,v40,v41
v_lshlrev_b32 v40, 16, v79
v_and_b32 v41, s65, v79
v_add_f32 v40, v40, v190
v_add_f32 v41, v41, v191
CV v95,v40,v41
buffer_store_dwordx4 v[92:95], v20, s[4:7], s13 offen offset:3840 sc0 sc1
s_endpgm
L_notile:
s_waitcnt vmcnt(0)
buffer_store_dword v61, v60, s[32:35], s78 offen sc0 sc1
L_end:
s_endpgm
L_sl_1:
s_mov_b32 s61, 0x40000
L_sp_41:
s_sleep 1
buffer_load_dwordx4 v[244:247], v1, s[32:35], s79 offen sc0 sc1
s_waitcnt vmcnt(0)
v_xor_b32 v244, v244, v61
v_xor_b32 v245, v245, v61
v_xor_b32 v246, v246, v61
v_xor_b32 v247, v247, v61
v_or3_b32 v244, v244, v245, v246
v_or_b32 v244, v244, v247
v_cmp_ne_u32 vcc, 0, v244
s_nop 1
s_cbranch_vccz L_ok_2
s_sub_u32 s61, s61, 1
s_cbranch_scc0 L_sp_41
s_branch L_ok_2
L_sl_3:
s_mov_b32 s63, 0x40000
L_sp_42:
s_sleep 1
buffer_load_dwordx4 v[20:23], v52, s[32:35], s79 offen sc0 sc1
s_waitcnt vmcnt(0)
v_xor_b32 v20, v20, v61
v_xor_b32 v21, v21, v61
v_xor_b32 v22, v22, v61
v_xor_b32 v23, v23, v61
v_or3_b32 v20, v20, v21, v22
v_or_b32 v20, v20, v23
v_cmp_ne_u32 vcc, 0, v20
s_nop 1
s_cbranch_vccz L_ok_4
s_sub_u32 s63, s63, 1
s_cbranch_scc0 L_sp_42
s_branch L_ok_4
L_sl_5:
s_mov_b32 s63, 0x40000
L_sp_43:
s_sleep 1
buffer_load_dwordx4 v[208:211], v62, s[32:35], s79 offen sc0 sc1
s_waitcnt vmcnt(0)
v_xor_b32 v208, v208, v61
v_xor_b32 v209, v209, v61
v_xor_b32 v210, v210, v61
v_xor_b32 v211, v211, v61
v_or3_b32 v208, v208, v209, v210
v_or_b32 v208, v208, v211
v_cmp_ne_u32 vcc, 0, v208
s_nop 1
s_cbranch_vccz L_ok_6
s_sub_u32 s63, s63, 1
s_cbranch_scc0 L_sp_43
s_branch L_ok_6
L_sl_19:
s_mov_b32 s63, 0x40000
L_sp_44:
s_sleep 1
buffer_load_dwordx4 v[192:195], v200, s[32:35], s79 offen sc0 sc1
s_waitcnt vmcnt(0)
v_xor_b32 v192, v192, v61
v_xor_b32 v193, v193, v61
v_xor_b32 v194, v194, v61
v_xor_b32 v195, v195, v61
v_or3_b32 v192, v192, v193, v194
v_or_b32 v192, v192, v195
v_cmp_ne_u32 vcc, 0, v192
s_nop 1
s_cbranch_vccz L_ok_20
s_sub_u32 s63, s63, 1
s_cbranch_scc0 L_sp_44
s_branch L_ok_20
L_sl_33:
s_mov_b32 s63, 0x40000
L_sp_45:
s_sleep 1
buffer_load_dwordx4 v[192:195], v200, s[32:35], s79 offen sc0 sc1
s_waitcnt vmcnt(0)
v_xor_b32 v192, v192, v61
v_xor_b32 v193, v193, v61
v_xor_b32 v194, v194, v61
v_xor_b32 v195, v195, v61
v_or3_b32 v192, v192, v193, v194
v_or_b32 v192, v192, v195
v_cmp_ne_u32 vcc, 0, v192
s_nop 1
s_cbranch_vccz L_ok_34
s_sub_u32 s63, s63, 1
s_cbranch_scc0 L_sp_45
s_branch L_ok_34
L_sl_37:
s_mov_b32 s63, 0x40000
L_sp_46:
s_sleep 1
buffer_load_dwordx4 v[24:27], v200, s[32:35], s76 offen sc0 sc1
s_waitcnt vmcnt(0)
v_xor_b32 v24, v24, v61
v_xor_b32 v25, v25, v61
v_xor_b32 v26, v26, v61
v_xor_b32 v27, v27, v61
v_or3_b32 v24, v24, v25, v26
v_or_b32 v24, v24, v27
v_cmp_ne_u32 vcc, 0, v24
s_nop 1
s_cbranch_vccz L_ok_38
s_sub_u32 s63, s63, 1
s_cbranch_scc0 L_sp_46
s_branch L_ok_38
L_sl_39:
s_mov_b32 s63, 0x40000
L_sp_47:
s_sleep 1
buffer_load_dword v24, v22, s[32:35], s75 offen sc0 sc1
s_waitcnt vmcnt(0)
v_xor_b32 v24, v24, v61
v_cmp_ne_u32 vcc, 0, v24
s_nop 1
s_cbranch_vccz L_ok_40
s_sub_u32 s63, s63, 1
s_cbranch_scc0 L_sp_47
s_branch L_ok_40
L_rs_7:
s_mov_b32 s69, 1.0
s_call_b64 s[100:101], L_rare10
s_mov_b32 s69, 1.0
s_call_b64 s[100:101], L_rare11
s_branch L_rb_8
L_rs_9:
s_mov_b32 s69, 1.0
s_call_b64 s[100:101], L_rare00
s_mov_b32 s69, 1.0
s_call_b64 s[100:101], L_rare01
s_branch L_rb_10
L_rs_11:
s_mov_b32 s69, 1.0
s_call_b64 s[100:101], L_rare10
s_mov_b32 s69, 1.0
s_call_b64 s[100:101], L_rare11
s_branch L_rb_12
L_rs_13:
s_mov_b32 s69, 1.0
s_call_b64 s[100:101], L_rare00
s_mov_b32 s69, 1.0
s_call_b64 s[100:101], L_rare01
s_branch L_rb_14
L_rs_15:
s_mov_b32 s69, 0
s_call_b64 s[100:101], L_rare10
s_mov_b32 s69, 1.0
s_call_b64 s[100:101], L_rare11
s_branch L_rb_16
L_rs_17:
s_mov_b32 s69, 1.0
s_call_b64 s[100:101], L_rare01
s_branch L_rb_18
L_rs_21:
s_mov_b32 s69, 1.0
s_call_b64 s[100:101], L_rare11
s_branch L_rb_22
L_rs_23:
s_mov_b32 s69, 1.0
s_call_b64 s[100:101], L_rare01
s_branch L_rb_24
L_rs_25:
s_mov_b32 s69, 1.0
s_call_b64 s[100:101], L_rare11
s_branch L_rb_26
L_rs_27:
s_mov_b32 s69, 1.0
s_call_b64 s[100:101], L_rare01
s_branch L_rb_28
L_rs_29:
s_mov_b32 s69, 0
s_call_b64 s[100:101], L_rare10
s_mov_b32 s69, 1.0
s_call_b64 s[100:101], L_rare11
s_branch L_rb_30
L_rs_31:
s_mov_b32 s69, 1.0
s_call_b64 s[100:101], L_rare01
s_branch L_rb_32
L_rs_35:
s_mov_b32 s69, 0
s_call_b64 s[100:101], L_rare11
s_branch L_rb_36
L_rare00:
s_nop 7
v_max3_f32 v5, v64, v65, v66
v_max3_f32 v6, v67, v72, v73
v_max3_f32 v5, v5, v74, v75
v_max3_f32 v6, v6, v80, v81
v_max3_f32 v5, v5, v82, v83
v_max3_f32 v6, v6, v88, v89
v_max3_f32 v5, v5, v90, v91
v_max_f32 v5, v5, v6
v_mov_b32 v6, v5
s_nop 1
v_permlane16_swap_b32 v5, v6
s_nop 1
v_max_f32 v5, v5, v6
v_mov_b32 v6, v5
s_nop 1
v_permlane32_swap_b32 v5, v6
s_nop 1
v_max_f32 v5, v5, v6
v_max_f32 v5, 0, v5
v_exp_f32 v6, -v5
v_sub_f32 v16, v16, v5
v_sub_f32 v17, v17, v5
v_sub_f32 v18, v18, v5
v_sub_f32 v19, v19, v5
v_sub_f32 v64, v64, v5
v_sub_f32 v65, v65, v5
v_sub_f32 v66, v66, v5
v_sub_f32 v67, v67, v5
v_sub_f32 v72, v72, v5
v_sub_f32 v73, v73, v5
v_sub_f32 v74, v74, v5
v_sub_f32 v75, v75, v5
v_sub_f32 v80, v80, v5
v_sub_f32 v81, v81, v5
v_sub_f32 v82, v82, v5
v_sub_f32 v83, v83, v5
v_sub_f32 v88, v88, v5
v_sub_f32 v89, v89, v5
v_sub_f32 v90, v90, v5
v_sub_f32 v91, v91, v5
v_sub_f32 v96, v96, v5
v_sub_f32 v97, v97, v5
v_sub_f32 v98, v98, v5
v_sub_f32 v99, v99, v5
v_sub_f32 v104, v104, v5
v_sub_f32 v105, v105, v5
v_sub_f32 v106, v106, v5
v_sub_f32 v107, v107, v5
v_sub_f32 v112, v112, v5
v_sub_f32 v113, v113, v5
v_sub_f32 v114, v114, v5
v_sub_f32 v115, v115, v5
v_sub_f32 v120, v120, v5
v_sub_f32 v121, v121, v5
v_sub_f32 v122, v122, v5
v_sub_f32 v123, v123, v5
v_mul_f32 v8, v8, v6
AR v48,a0
AR v49,a1
AR v50,a2
AR v51,a3
AR v52,a8
AR v53,a9
AR v54,a10
AR v55,a11
v_mul_f32 v48, v48, v6
v_mul_f32 v49, v49, v6
v_mul_f32 v50, v50, v6
v_mul_f32 v51, v51, v6
v_mul_f32 v52, v52, v6
v_mul_f32 v53, v53, v6
v_mul_f32 v54, v54, v6
v_mul_f32 v55, v55, v6
AW a0,v48
AW a1,v49
AW a2,v50
AW a3,v51
AW a8,v52
AW a9,v53
AW a10,v54
AW a11,v55
AR v48,a16
AR v49,a17
AR v50,a18
AR v51,a19
AR v52,a24
AR v53,a25
AR v54,a26
AR v55,a27
v_mul_f32 v48, v48, v6
v_mul_f32 v49, v49, v6
v_mul_f32 v50, v50, v6
v_mul_f32 v51, v51, v6
v_mul_f32 v52, v52, v6
v_mul_f32 v53, v53, v6
v_mul_f32 v54, v54, v6
v_mul_f32 v55, v55, v6
AW a16,v48
AW a17,v49
AW a18,v50
AW a19,v51
AW a24,v52
AW a25,v53
AW a26,v54
AW a27,v55
AR v48,a32
AR v49,a33
AR v50,a34
AR v51,a35
AR v52,a40
AR v53,a41
AR v54,a42
AR v55,a43
v_mul_f32 v48, v48, v6
v_mul_f32 v49, v49, v6
v_mul_f32 v50, v50, v6
v_mul_f32 v51, v51, v6
v_mul_f32 v52, v52, v6
v_mul_f32 v53, v53, v6
v_mul_f32 v54, v54, v6
v_mul_f32 v55, v55, v6
AW a32,v48
AW a33,v49
AW a34,v50
AW a35,v51
AW a40,v52
AW a41,v53
AW a42,v54
AW a43,v55
AR v48,a48
AR v49,a49
AR v50,a50
AR v51,a51
AR v52,a56
AR v53,a57
AR v54,a58
AR v55,a59
v_mul_f32 v48, v48, v6
v_mul_f32 v49, v49, v6
v_mul_f32 v50, v50, v6
v_mul_f32 v51, v51, v6
v_mul_f32 v52, v52, v6
v_mul_f32 v53, v53, v6
v_mul_f32 v54, v54, v6
v_mul_f32 v55, v55, v6
AW a48,v48
AW a49,v49
AW a50,v50
AW a51,v51
AW a56,v52
AW a57,v53
AW a58,v54
AW a59,v55
v_max3_f32 v5, v68, v69, v70
v_max3_f32 v6, v71, v76, v77
v_max3_f32 v5, v5, v78, v79
v_max3_f32 v6, v6, v84, v85
v_max3_f32 v5, v5, v86, v87
v_max3_f32 v6, v6, v92, v93
v_max3_f32 v5, v5, v94, v95
v_max_f32 v5, v5, v6
v_mov_b32 v6, v5
s_nop 1
v_permlane16_swap_b32 v5, v6
s_nop 1
v_max_f32 v5, v5, v6
v_mov_b32 v6, v5
s_nop 1
v_permlane32_swap_b32 v5, v6
s_nop 1
v_max_f32 v5, v5, v6
v_max_f32 v5, 0, v5
v_mul_f32 v5, s69, v5
v_exp_f32 v6, -v5
v_sub_f32 v20, v20, v5
v_sub_f32 v21, v21, v5
v_sub_f32 v22, v22, v5
v_sub_f32 v23, v23, v5
v_sub_f32 v68, v68, v5
v_sub_f32 v69, v69, v5
v_sub_f32 v70, v70, v5
v_sub_f32 v71, v71, v5
v_sub_f32 v76, v76, v5
v_sub_f32 v77, v77, v5
v_sub_f32 v78, v78, v5
v_sub_f32 v79, v79, v5
v_sub_f32 v84, v84, v5
v_sub_f32 v85, v85, v5
v_sub_f32 v86, v86, v5
v_sub_f32 v87, v87, v5
v_sub_f32 v92, v92, v5
v_sub_f32 v93, v93, v5
v_sub_f32 v94, v94, v5
v_sub_f32 v95, v95, v5
v_sub_f32 v100, v100, v5
v_sub_f32 v101, v101, v5
v_sub_f32 v102, v102, v5
v_sub_f32 v103, v103, v5
v_sub_f32 v108, v108, v5
v_sub_f32 v109, v109, v5
v_sub_f32 v110, v110, v5
v_sub_f32 v111, v111, v5
v_sub_f32 v116, v116, v5
v_sub_f32 v117, v117, v5
v_sub_f32 v118, v118, v5
v_sub_f32 v119, v119, v5
v_sub_f32 v124, v124, v5
v_sub_f32 v125, v125, v5
v_sub_f32 v126, v126, v5
v_sub_f32 v127, v127, v5
v_mul_f32 v9, v9, v6
AR v48,a4
AR v49,a5
AR v50,a6
AR v51,a7
AR v52,a12
AR v53,a13
AR v54,a14
AR v55,a15
v_mul_f32 v48, v48, v6
v_mul_f32 v49, v49, v6
v_mul_f32 v50, v50, v6
v_mul_f32 v51, v51, v6
v_mul_f32 v52, v52, v6
v_mul_f32 v53, v53, v6
v_mul_f32 v54, v54, v6
v_mul_f32 v55, v55, v6
AW a4,v48
AW a5,v49
AW a6,v50
AW a7,v51
AW a12,v52
AW a13,v53
AW a14,v54
AW a15,v55
AR v48,a20
AR v49,a21
AR v50,a22
AR v51,a23
AR v52,a28
AR v53,a29
AR v54,a30
AR v55,a31
v_mul_f32 v48, v48, v6
v_mul_f32 v49, v49, v6
v_mul_f32 v50, v50, v6
v_mul_f32 v51, v51, v6
v_mul_f32 v52, v52, v6
v_mul_f32 v53, v53, v6
v_mul_f32 v54, v54, v6
v_mul_f32 v55, v55, v6
AW a20,v48
AW a21,v49
AW a22,v50
AW a23,v51
AW a28,v52
AW a29,v53
AW a30,v54
AW a31,v55
AR v48,a36
AR v49,a37
AR v50,a38
AR v51,a39
AR v52,a44
AR v53,a45
AR v54,a46
AR v55,a47
v_mul_f32 v48, v48, v6
v_mul_f32 v49, v49, v6
v_mul_f32 v50, v50, v6
v_mul_f32 v51, v51, v6
v_mul_f32 v52, v52, v6
v_mul_f32 v53, v53, v6
v_mul_f32 v54, v54, v6
v_mul_f32 v55, v55, v6
AW a36,v48
AW a37,v49
AW a38,v50
AW a39,v51
AW a44,v52
AW a45,v53
AW a46,v54
AW a47,v55
AR v48,a52
AR v49,a53
AR v50,a54
AR v51,a55
AR v52,a60
AR v53,a61
AR v54,a62
AR v55,a63
v_mul_f32 v48, v48, v6
v_mul_f32 v49, v49, v6
v_mul_f32 v50, v50, v6
v_mul_f32 v51, v51, v6
v_mul_f32 v52, v52, v6
v_mul_f32 v53, v53, v6
v_mul_f32 v54, v54, v6
v_mul_f32 v55, v55, v6
AW a52,v48
AW a53,v49
AW a54,v50
AW a55,v51
AW a60,v52
AW a61,v53
AW a62,v54
AW a63,v55
v_exp_f32 v48, v64
v_exp_f32 v49, v65
v_exp_f32 v50, v66
v_exp_f32 v51, v67
CV v192,v48,v49
v_exp_f32 v52, v72
v_exp_f32 v53, v73
CV v193,v50,v51
v_exp_f32 v54, v74
v_exp_f32 v55, v75
CV v194,v52,v53
v_exp_f32 v48, v68
v_exp_f32 v49, v69
CV v195,v54,v55
v_exp_f32 v50, v70
v_exp_f32 v51, v71
CV v200,v48,v49
v_exp_f32 v52, v76
MM v[32:35],v[56:59],v[192:195],0
v_exp_f32 v53, v77
CV v201,v50,v51
v_exp_f32 v54, v78
v_exp_f32 v55, v79
CV v202,v52,v53
v_exp_f32 v48, v80
v_exp_f32 v49, v81
CV v203,v54,v55
v_exp_f32 v50, v82
v_exp_f32 v51, v83
CV v196,v48,v49
v_exp_f32 v52, v88
MM v[36:39],v[56:59],v[200:203],0
v_exp_f32 v53, v89
CV v197,v50,v51
v_exp_f32 v54, v90
v_exp_f32 v55, v91
CV v198,v52,v53
v_exp_f32 v48, v84
v_exp_f32 v49, v85
CV v199,v54,v55
v_exp_f32 v50, v86
v_exp_f32 v51, v87
CV v204,v48,v49
v_exp_f32 v52, v92
MM v[32:35],v[56:59],v[196:199],v[32:35]
v_exp_f32 v53, v93
CV v205,v50,v51
v_exp_f32 v54, v94
v_exp_f32 v55, v95
CV v206,v52,v53
CV v207,v54,v55
s_nop 1
MM v[36:39],v[56:59],v[204:207],v[36:39]
s_nop 7
s_setpc_b64 s[100:101]
L_rare01:
s_nop 7
v_max3_f32 v5, v128, v129, v130
v_max3_f32 v6, v131, v136, v137
v_max3_f32 v5, v5, v138, v139
v_max3_f32 v6, v6, v144, v145
v_max3_f32 v5, v5, v146, v147
v_max3_f32 v6, v6, v152, v153
v_max3_f32 v5, v5, v154, v155
v_max_f32 v5, v5, v6
v_mov_b32 v6, v5
s_nop 1
v_permlane16_swap_b32 v5, v6
s_nop 1
v_max_f32 v5, v5, v6
v_mov_b32 v6, v5
s_nop 1
v_permlane32_swap_b32 v5, v6
s_nop 1
v_max_f32 v5, v5, v6
v_max_f32 v5, 0, v5
v_exp_f32 v6, -v5
v_sub_f32 v24, v24, v5
v_sub_f32 v25, v25, v5
v_sub_f32 v26, v26, v5
v_sub_f32 v27, v27, v5
v_sub_f32 v128, v128, v5
v_sub_f32 v129, v129, v5
v_sub_f32 v130, v130, v5
v_sub_f32 v131, v131, v5
v_sub_f32 v136, v136, v5
v_sub_f32 v137, v137, v5
v_sub_f32 v138, v138, v5
v_sub_f32 v139, v139, v5
v_sub_f32 v144, v144, v5
v_sub_f32 v145, v145, v5
v_sub_f32 v146, v146, v5
v_sub_f32 v147, v147, v5
v_sub_f32 v152, v152, v5
v_sub_f32 v153, v153, v5
v_sub_f32 v154, v154, v5
v_sub_f32 v155, v155, v5
v_sub_f32 v160, v160, v5
v_sub_f32 v161, v161, v5
v_sub_f32 v162, v162, v5
v_sub_f32 v163, v163, v5
v_sub_f32 v168, v168, v5
v_sub_f32 v169, v169, v5
v_sub_f32 v170, v170, v5
v_sub_f32 v171, v171, v5
v_sub_f32 v176, v176, v5
v_sub_f32 v177, v177, v5
v_sub_f32 v178, v178, v5
v_sub_f32 v179, v179, v5
v_sub_f32 v184, v184, v5
v_sub_f32 v185, v185, v5
v_sub_f32 v186, v186, v5
v_sub_f32 v187, v187, v5
v_mul_f32 v10, v10, v6
AR v48,a64
AR v49,a65
AR v50,a66
AR v51,a67
AR v52,a72
AR v53,a73
AR v54,a74
AR v55,a75
v_mul_f32 v48, v48, v6
v_mul_f32 v49, v49, v6
v_mul_f32 v50, v50, v6
v_mul_f32 v51, v51, v6
v_mul_f32 v52, v52, v6
v_mul_f32 v53, v53, v6
v_mul_f32 v54, v54, v6
v_mul_f32 v55, v55, v6
AW a64,v48
AW a65,v49
AW a66,v50
AW a67,v51
AW a72,v52
AW a73,v53
AW a74,v54
AW a75,v55
AR v48,a80
AR v49,a81
AR v50,a82
AR v51,a83
AR v52,a88
AR v53,a89
AR v54,a90
AR v55,a91
v_mul_f32 v48, v48, v6
v_mul_f32 v49, v49, v6
v_mul_f32 v50, v50, v6
v_mul_f32 v51, v51, v6
v_mul_f32 v52, v52, v6
v_mul_f32 v53, v53, v6
v_mul_f32 v54, v54, v6
v_mul_f32 v55, v55, v6
AW a80,v48
AW a81,v49
AW a82,v50
AW a83,v51
AW a88,v52
AW a89,v53
AW a90,v54
AW a91,v55
AR v48,a96
AR v49,a97
AR v50,a98
AR v51,a99
AR v52,a104
AR v53,a105
AR v54,a106
AR v55,a107
v_mul_f32 v48, v48, v6
v_mul_f32 v49, v49, v6
v_mul_f32 v50, v50, v6
v_mul_f32 v51, v51, v6
v_mul_f32 v52, v52, v6
v_mul_f32 v53, v53, v6
v_mul_f32 v54, v54, v6
v_mul_f32 v55, v55, v6
AW a96,v48
AW a97,v49
AW a98,v50
AW a99,v51
AW a104,v52
AW a105,v53
AW a106,v54
AW a107,v55
AR v48,a112
AR v49,a113
AR v50,a114
AR v51,a115
AR v52,a120
AR v53,a121
AR v54,a122
AR v55,a123
v_mul_f32 v48, v48, v6
v_mul_f32 v49, v49, v6
v_mul_f32 v50, v50, v6
v_mul_f32 v51, v51, v6
v_mul_f32 v52, v52, v6
v_mul_f32 v53, v53, v6
v_mul_f32 v54, v54, v6
v_mul_f32 v55, v55, v6
AW a112,v48
AW a113,v49
AW a114,v50
AW a115,v51
AW a120,v52
AW a121,v53
AW a122,v54
AW a123,v55
v_max3_f32 v5, v132, v133, v134
v_max3_f32 v6, v135, v140, v141
v_max3_f32 v5, v5, v142, v143
v_max3_f32 v6, v6, v148, v149
v_max3_f32 v5, v5, v150, v151
v_max3_f32 v6, v6, v156, v157
v_max3_f32 v5, v5, v158, v159
v_max_f32 v5, v5, v6
v_mov_b32 v6, v5
s_nop 1
v_permlane16_swap_b32 v5, v6
s_nop 1
v_max_f32 v5, v5, v6
v_mov_b32 v6, v5
s_nop 1
v_permlane32_swap_b32 v5, v6
s_nop 1
v_max_f32 v5, v5, v6
v_max_f32 v5, 0, v5
v_mul_f32 v5, s69, v5
v_exp_f32 v6, -v5
v_sub_f32 v28, v28, v5
v_sub_f32 v29, v29, v5
v_sub_f32 v30, v30, v5
v_sub_f32 v31, v31, v5
v_sub_f32 v132, v132, v5
v_sub_f32 v133, v133, v5
v_sub_f32 v134, v134, v5
v_sub_f32 v135, v135, v5
v_sub_f32 v140, v140, v5
v_sub_f32 v141, v141, v5
v_sub_f32 v142, v142, v5
v_sub_f32 v143, v143, v5
v_sub_f32 v148, v148, v5
v_sub_f32 v149, v149, v5
v_sub_f32 v150, v150, v5
v_sub_f32 v151, v151, v5
v_sub_f32 v156, v156, v5
v_sub_f32 v157, v157, v5
v_sub_f32 v158, v158, v5
v_sub_f32 v159, v159, v5
v_sub_f32 v164, v164, v5
v_sub_f32 v165, v165, v5
v_sub_f32 v166, v166, v5
v_sub_f32 v167, v167, v5
v_sub_f32 v172, v172, v5
v_sub_f32 v173, v173, v5
v_sub_f32 v174, v174, v5
v_sub_f32 v175, v175, v5
v_sub_f32 v180, v180, v5
v_sub_f32 v181, v181, v5
v_sub_f32 v182, v182, v5
v_sub_f32 v183, v183, v5
v_sub_f32 v188, v188, v5
v_sub_f32 v189, v189, v5
v_sub_f32 v190, v190, v5
v_sub_f32 v191, v191, v5
v_mul_f32 v11, v11, v6
AR v48,a68
AR v49,a69
AR v50,a70
AR v51,a71
AR v52,a76
AR v53,a77
AR v54,a78
AR v55,a79
v_mul_f32 v48, v48, v6
v_mul_f32 v49, v49, v6
v_mul_f32 v50, v50, v6
v_mul_f32 v51, v51, v6
v_mul_f32 v52, v52, v6
v_mul_f32 v53, v53, v6
v_mul_f32 v54, v54, v6
v_mul_f32 v55, v55, v6
AW a68,v48
AW a69,v49
AW a70,v50
AW a71,v51
AW a76,v52
AW a77,v53
AW a78,v54
AW a79,v55
AR v48,a84
AR v49,a85
AR v50,a86
AR v51,a87
AR v52,a92
AR v53,a93
AR v54,a94
AR v55,a95
v_mul_f32 v48, v48, v6
v_mul_f32 v49, v49, v6
v_mul_f32 v50, v50, v6
v_mul_f32 v51, v51, v6
v_mul_f32 v52, v52, v6
v_mul_f32 v53, v53, v6
v_mul_f32 v54, v54, v6
v_mul_f32 v55, v55, v6
AW a84,v48
AW a85,v49
AW a86,v50
AW a87,v51
AW a92,v52
AW a93,v53
AW a94,v54
AW a95,v55
AR v48,a100
AR v49,a101
AR v50,a102
AR v51,a103
AR v52,a108
AR v53,a109
AR v54,a110
AR v55,a111
v_mul_f32 v48, v48, v6
v_mul_f32 v49, v49, v6
v_mul_f32 v50, v50, v6
v_mul_f32 v51, v51, v6
v_mul_f32 v52, v52, v6
v_mul_f32 v53, v53, v6
v_mul_f32 v54, v54, v6
v_mul_f32 v55, v55, v6
AW a100,v48
AW a101,v49
AW a102,v50
AW a103,v51
AW a108,v52
AW a109,v53
AW a110,v54
AW a111,v55
AR v48,a116
AR v49,a117
AR v50,a118
AR v51,a119
AR v52,a124
AR v53,a125
AR v54,a126
AR v55,a127
v_mul_f32 v48, v48, v6
v_mul_f32 v49, v49, v6
v_mul_f32 v50, v50, v6
v_mul_f32 v51, v51, v6
v_mul_f32 v52, v52, v6
v_mul_f32 v53, v53, v6
v_mul_f32 v54, v54, v6
v_mul_f32 v55, v55, v6
AW a116,v48
AW a117,v49
AW a118,v50
AW a119,v51
AW a124,v52
AW a125,v53
AW a126,v54
AW a127,v55
v_exp_f32 v48, v128
v_exp_f32 v49, v129
v_exp_f32 v50, v130
v_exp_f32 v51, v131
CV v224,v48,v49
v_exp_f32 v52, v136
v_exp_f32 v53, v137
CV v225,v50,v51
v_exp_f32 v54, v138
v_exp_f32 v55, v139
CV v226,v52,v53
v_exp_f32 v48, v132
v_exp_f32 v49, v133
CV v227,v54,v55
v_exp_f32 v50, v134
v_exp_f32 v51, v135
CV v232,v48,v49
v_exp_f32 v52, v140
MM v[40:43],v[56:59],v[224:227],0
v_exp_f32 v53, v141
CV v233,v50,v51
v_exp_f32 v54, v142
v_exp_f32 v55, v143
CV v234,v52,v53
v_exp_f32 v48, v144
v_exp_f32 v49, v145
CV v235,v54,v55
v_exp_f32 v50, v146
v_exp_f32 v51, v147
CV v228,v48,v49
v_exp_f32 v52, v152
MM v[44:47],v[56:59],v[232:235],0
v_exp_f32 v53, v153
CV v229,v50,v51
v_exp_f32 v54, v154
v_exp_f32 v55, v155
CV v230,v52,v53
v_exp_f32 v48, v148
v_exp_f32 v49, v149
CV v231,v54,v55
v_exp_f32 v50, v150
v_exp_f32 v51, v151
CV v236,v48,v49
v_exp_f32 v52, v156
MM v[40:43],v[56:59],v[228:231],v[40:43]
v_exp_f32 v53, v157
CV v237,v50,v51
v_exp_f32 v54, v158
v_exp_f32 v55, v159
CV v238,v52,v53
CV v239,v54,v55
s_nop 1
MM v[44:47],v[56:59],v[236:239],v[44:47]
v_exp_f32 v48, v160
v_exp_f32 v49, v161
v_exp_f32 v50, v162
v_exp_f32 v51, v163
v_exp_f32 v52, v168
v_exp_f32 v53, v169
s_nop 7
s_setpc_b64 s[100:101]
L_rare10:
s_nop 7
v_max3_f32 v5, v96, v97, v98
v_max3_f32 v6, v99, v104, v105
v_max3_f32 v5, v5, v106, v107
v_max3_f32 v6, v6, v112, v113
v_max3_f32 v5, v5, v114, v115
v_max3_f32 v6, v6, v120, v121
v_max3_f32 v5, v5, v122, v123
v_max_f32 v5, v5, v6
v_mov_b32 v6, v5
s_nop 1
v_permlane16_swap_b32 v5, v6
s_nop 1
v_max_f32 v5, v5, v6
v_mov_b32 v6, v5
s_nop 1
v_permlane32_swap_b32 v5, v6
s_nop 1
v_max_f32 v5, v5, v6
v_max_f32 v5, 0, v5
v_exp_f32 v6, -v5
v_sub_f32 v16, v16, v5
v_sub_f32 v17, v17, v5
v_sub_f32 v18, v18, v5
v_sub_f32 v19, v19, v5
v_sub_f32 v64, v64, v5
v_sub_f32 v65, v65, v5
v_sub_f32 v66, v66, v5
v_sub_f32 v67, v67, v5
v_sub_f32 v72, v72, v5
v_sub_f32 v73, v73, v5
v_sub_f32 v74, v74, v5
v_sub_f32 v75, v75, v5
v_sub_f32 v80, v80, v5
v_sub_f32 v81, v81, v5
v_sub_f32 v82, v82, v5
v_sub_f32 v83, v83, v5
v_sub_f32 v88, v88, v5
v_sub_f32 v89, v89, v5
v_sub_f32 v90, v90, v5
v_sub_f32 v91, v91, v5
v_sub_f32 v96, v96, v5
v_sub_f32 v97, v97, v5
v_sub_f32 v98, v98, v5
v_sub_f32 v99, v99, v5
v_sub_f32 v104, v104, v5
v_sub_f32 v105, v105, v5
v_sub_f32 v106, v106, v5
v_sub_f32 v107, v107, v5
v_sub_f32 v112, v112, v5
v_sub_f32 v113, v113, v5
v_sub_f32 v114, v114, v5
v_sub_f32 v115, v115, v5
v_sub_f32 v120, v120, v5
v_sub_f32 v121, v121, v5
v_sub_f32 v122, v122, v5
v_sub_f32 v123, v123, v5
v_mul_f32 v8, v8, v6
AR v48,a0
AR v49,a1
AR v50,a2
AR v51,a3
AR v52,a8
AR v53,a9
AR v54,a10
AR v55,a11
v_mul_f32 v48, v48, v6
v_mul_f32 v49, v49, v6
v_mul_f32 v50, v50, v6
v_mul_f32 v51, v51, v6
v_mul_f32 v52, v52, v6
v_mul_f32 v53, v53, v6
v_mul_f32 v54, v54, v6
v_mul_f32 v55, v55, v6
AW a0,v48
AW a1,v49
AW a2,v50
AW a3,v51
AW a8,v52
AW a9,v53
AW a10,v54
AW a11,v55
AR v48,a16
AR v49,a17
AR v50,a18
AR v51,a19
AR v52,a24
AR v53,a25
AR v54,a26
AR v55,a27
v_mul_f32 v48, v48, v6
v_mul_f32 v49, v49, v6
v_mul_f32 v50, v50, v6
v_mul_f32 v51, v51, v6
v_mul_f32 v52, v52, v6
v_mul_f32 v53, v53, v6
v_mul_f32 v54, v54, v6
v_mul_f32 v55, v55, v6
AW a16,v48
AW a17,v49
AW a18,v50
AW a19,v51
AW a24,v52
AW a25,v53
AW a26,v54
AW a27,v55
AR v48,a32
AR v49,a33
AR v50,a34
AR v51,a35
AR v52,a40
AR v53,a41
AR v54,a42
AR v55,a43
v_mul_f32 v48, v48, v6
v_mul_f32 v49, v49, v6
v_mul_f32 v50, v50, v6
v_mul_f32 v51, v51, v6
v_mul_f32 v52, v52, v6
v_mul_f32 v53, v53, v6
v_mul_f32 v54, v54, v6
v_mul_f32 v55, v55, v6
AW a32,v48
AW a33,v49
AW a34,v50
AW a35,v51
AW a40,v52
AW a41,v53
AW a42,v54
AW a43,v55
AR v48,a48
AR v49,a49
AR v50,a50
AR v51,a51
AR v52,a56
AR v53,a57
AR v54,a58
AR v55,a59
v_mul_f32 v48, v48, v6
v_mul_f32 v49, v49, v6
v_mul_f32 v50, v50, v6
v_mul_f32 v51, v51, v6
v_mul_f32 v52, v52, v6
v_mul_f32 v53, v53, v6
v_mul_f32 v54, v54, v6
v_mul_f32 v55, v55, v6
AW a48,v48
AW a49,v49
AW a50,v50
AW a51,v51
AW a56,v52
AW a57,v53
AW a58,v54
AW a59,v55
v_max3_f32 v5, v100, v101, v102
v_max3_f32 v6, v103, v108, v109
v_max3_f32 v5, v5, v110, v111
v_max3_f32 v6, v6, v116, v117
v_max3_f32 v5, v5, v118, v119
v_max3_f32 v6, v6, v124, v125
v_max3_f32 v5, v5, v126, v127
v_max_f32 v5, v5, v6
v_mov_b32 v6, v5
s_nop 1
v_permlane16_swap_b32 v5, v6
s_nop 1
v_max_f32 v5, v5, v6
v_mov_b32 v6, v5
s_nop 1
v_permlane32_swap_b32 v5, v6
s_nop 1
v_max_f32 v5, v5, v6
v_max_f32 v5, 0, v5
v_mul_f32 v5, s69, v5
v_exp_f32 v6, -v5
v_sub_f32 v20, v20, v5
v_sub_f32 v21, v21, v5
v_sub_f32 v22, v22, v5
v_sub_f32 v23, v23, v5
v_sub_f32 v68, v68, v5
v_sub_f32 v69, v69, v5
v_sub_f32 v70, v70, v5
v_sub_f32 v71, v71, v5
v_sub_f32 v76, v76, v5
v_sub_f32 v77, v77, v5
v_sub_f32 v78, v78, v5
v_sub_f32 v79, v79, v5
v_sub_f32 v84, v84, v5
v_sub_f32 v85, v85, v5
v_sub_f32 v86, v86, v5
v_sub_f32 v87, v87, v5
v_sub_f32 v92, v92, v5
v_sub_f32 v93, v93, v5
v_sub_f32 v94, v94, v5
v_sub_f32 v95, v95, v5
v_sub_f32 v100, v100, v5
v_sub_f32 v101, v101, v5
v_sub_f32 v102, v102, v5
v_sub_f32 v103, v103, v5
v_sub_f32 v108, v108, v5
v_sub_f32 v109, v109, v5
v_sub_f32 v110, v110, v5
v_sub_f32 v111, v111, v5
v_sub_f32 v116, v116, v5
v_sub_f32 v117, v117, v5
v_sub_f32 v118, v118, v5
v_sub_f32 v119, v119, v5
v_sub_f32 v124, v124, v5
v_sub_f32 v125, v125, v5
v_sub_f32 v126, v126, v5
v_sub_f32 v127, v127, v5
v_mul_f32 v9, v9, v6
AR v48,a4
AR v49,a5
AR v50,a6
AR v51,a7
AR v52,a12
AR v53,a13
AR v54,a14
AR v55,a15
v_mul_f32 v48, v48, v6
v_mul_f32 v49, v49, v6
v_mul_f32 v50, v50, v6
v_mul_f32 v51, v51, v6
v_mul_f32 v52, v52, v6
v_mul_f32 v53, v53, v6
v_mul_f32 v54, v54, v6
v_mul_f32 v55, v55, v6
AW a4,v48
AW a5,v49
AW a6,v50
AW a7,v51
AW a12,v52
AW a13,v53
AW a14,v54
AW a15,v55
AR v48,a20
AR v49,a21
AR v50,a22
AR v51,a23
AR v52,a28
AR v53,a29
AR v54,a30
AR v55,a31
v_mul_f32 v48, v48, v6
v_mul_f32 v49, v49, v6
v_mul_f32 v50, v50, v6
v_mul_f32 v51, v51, v6
v_mul_f32 v52, v52, v6
v_mul_f32 v53, v53, v6
v_mul_f32 v54, v54, v6
v_mul_f32 v55, v55, v6
AW a20,v48
AW a21,v49
AW a22,v50
AW a23,v51
AW a28,v52
AW a29,v53
AW a30,v54
AW a31,v55
AR v48,a36
AR v49,a37
AR v50,a38
AR v51,a39
AR v52,a44
AR v53,a45
AR v54,a46
AR v55,a47
v_mul_f32 v48, v48, v6
v_mul_f32 v49, v49, v6
v_mul_f32 v50, v50, v6
v_mul_f32 v51, v51, v6
v_mul_f32 v52, v52, v6
v_mul_f32 v53, v53, v6
v_mul_f32 v54, v54, v6
v_mul_f32 v55, v55, v6
AW a36,v48
AW a37,v49
AW a38,v50
AW a39,v51
AW a44,v52
AW a45,v53
AW a46,v54
AW a47,v55
AR v48,a52
AR v49,a53
AR v50,a54
AR v51,a55
AR v52,a60
AR v53,a61
AR v54,a62
AR v55,a63
v_mul_f32 v48, v48, v6
v_mul_f32 v49, v49, v6
v_mul_f32 v50, v50, v6
v_mul_f32 v51, v51, v6
v_mul_f32 v52, v52, v6
v_mul_f32 v53, v53, v6
v_mul_f32 v54, v54, v6
v_mul_f32 v55, v55, v6
AW a52,v48
AW a53,v49
AW a54,v50
AW a55,v51
AW a60,v52
AW a61,v53
AW a62,v54
AW a63,v55
v_exp_f32 v48, v96
v_exp_f32 v49, v97
v_exp_f32 v50, v98
v_exp_f32 v51, v99
CV v208,v48,v49
v_exp_f32 v52, v104
v_exp_f32 v53, v105
CV v209,v50,v51
v_exp_f32 v54, v106
v_exp_f32 v55, v107
CV v210,v52,v53
v_exp_f32 v48, v100
v_exp_f32 v49, v101
CV v211,v54,v55
v_exp_f32 v50, v102
v_exp_f32 v51, v103
CV v216,v48,v49
v_exp_f32 v52, v108
MM v[32:35],v[56:59],v[208:211],0
v_exp_f32 v53, v109
CV v217,v50,v51
v_exp_f32 v54, v110
v_exp_f32 v55, v111
CV v218,v52,v53
v_exp_f32 v48, v112
v_exp_f32 v49, v113
CV v219,v54,v55
v_exp_f32 v50, v114
v_exp_f32 v51, v115
CV v212,v48,v49
v_exp_f32 v52, v120
MM v[36:39],v[56:59],v[216:219],0
v_exp_f32 v53, v121
CV v213,v50,v51
v_exp_f32 v54, v122
v_exp_f32 v55, v123
CV v214,v52,v53
v_exp_f32 v48, v116
v_exp_f32 v49, v117
CV v215,v54,v55
v_exp_f32 v50, v118
v_exp_f32 v51, v119
CV v220,v48,v49
v_exp_f32 v52, v124
MM v[32:35],v[56:59],v[212:215],v[32:35]
v_exp_f32 v53, v125
CV v221,v50,v51
v_exp_f32 v54, v126
v_exp_f32 v55, v127
CV v222,v52,v53
CV v223,v54,v55
s_nop 1
MM v[36:39],v[56:59],v[220:223],v[36:39]
s_nop 7
s_setpc_b64 s[100:101]
L_rare11:
s_nop 7
v_max3_f32 v5, v160, v161, v162
v_max3_f32 v6, v163, v168, v169
v_max3_f32 v5, v5, v170, v171
v_max3_f32 v6, v6, v176, v177
v_max3_f32 v5, v5, v178, v179
v_max3_f32 v6, v6, v184, v185
v_max3_f32 v5, v5, v186, v187
v_max_f32 v5, v5, v6
v_mov_b32 v6, v5
s_nop 1
v_permlane16_swap_b32 v5, v6
s_nop 1
v_max_f32 v5, v5, v6
v_mov_b32 v6, v5
s_nop 1
v_permlane32_swap_b32 v5, v6
s_nop 1
v_max_f32 v5, v5, v6
v_max_f32 v5, 0, v5
v_exp_f32 v6, -v5
v_sub_f32 v24, v24, v5
v_sub_f32 v25, v25, v5
v_sub_f32 v26, v26, v5
v_sub_f32 v27, v27, v5
v_sub_f32 v128, v128, v5
v_sub_f32 v129, v129, v5
v_sub_f32 v130, v130, v5
v_sub_f32 v131, v131, v5
v_sub_f32 v136, v136, v5
v_sub_f32 v137, v137, v5
v_sub_f32 v138, v138, v5
v_sub_f32 v139, v139, v5
v_sub_f32 v144, v144, v5
v_sub_f32 v145, v145, v5
v_sub_f32 v146, v146, v5
v_sub_f32 v147, v147, v5
v_sub_f32 v152, v152, v5
v_sub_f32 v153, v153, v5
v_sub_f32 v154, v154, v5
v_sub_f32 v155, v155, v5
v_sub_f32 v160, v160, v5
v_sub_f32 v161, v161, v5
v_sub_f32 v162, v162, v5
v_sub_f32 v163, v163, v5
v_sub_f32 v168, v168, v5
v_sub_f32 v169, v169, v5
v_sub_f32 v170, v170, v5
v_sub_f32 v171, v171, v5
v_sub_f32 v176, v176, v5
v_sub_f32 v177, v177, v5
v_sub_f32 v178, v178, v5
v_sub_f32 v179, v179, v5
v_sub_f32 v184, v184, v5
v_sub_f32 v185, v185, v5
v_sub_f32 v186, v186, v5
v_sub_f32 v187, v187, v5
v_mul_f32 v10, v10, v6
AR v48,a64
AR v49,a65
AR v50,a66
AR v51,a67
AR v52,a72
AR v53,a73
AR v54,a74
AR v55,a75
v_mul_f32 v48, v48, v6
v_mul_f32 v49, v49, v6
v_mul_f32 v50, v50, v6
v_mul_f32 v51, v51, v6
v_mul_f32 v52, v52, v6
v_mul_f32 v53, v53, v6
v_mul_f32 v54, v54, v6
v_mul_f32 v55, v55, v6
AW a64,v48
AW a65,v49
AW a66,v50
AW a67,v51
AW a72,v52
AW a73,v53
AW a74,v54
AW a75,v55
AR v48,a80
AR v49,a81
AR v50,a82
AR v51,a83
AR v52,a88
AR v53,a89
AR v54,a90
AR v55,a91
v_mul_f32 v48, v48, v6
v_mul_f32 v49, v49, v6
v_mul_f32 v50, v50, v6
v_mul_f32 v51, v51, v6
v_mul_f32 v52, v52, v6
v_mul_f32 v53, v53, v6
v_mul_f32 v54, v54, v6
v_mul_f32 v55, v55, v6
AW a80,v48
AW a81,v49
AW a82,v50
AW a83,v51
AW a88,v52
AW a89,v53
AW a90,v54
AW a91,v55
AR v48,a96
AR v49,a97
AR v50,a98
AR v51,a99
AR v52,a104
AR v53,a105
AR v54,a106
AR v55,a107
v_mul_f32 v48, v48, v6
v_mul_f32 v49, v49, v6
v_mul_f32 v50, v50, v6
v_mul_f32 v51, v51, v6
v_mul_f32 v52, v52, v6
v_mul_f32 v53, v53, v6
v_mul_f32 v54, v54, v6
v_mul_f32 v55, v55, v6
AW a96,v48
AW a97,v49
AW a98,v50
AW a99,v51
AW a104,v52
AW a105,v53
AW a106,v54
AW a107,v55
AR v48,a112
AR v49,a113
AR v50,a114
AR v51,a115
AR v52,a120
AR v53,a121
AR v54,a122
AR v55,a123
v_mul_f32 v48, v48, v6
v_mul_f32 v49, v49, v6
v_mul_f32 v50, v50, v6
v_mul_f32 v51, v51, v6
v_mul_f32 v52, v52, v6
v_mul_f32 v53, v53, v6
v_mul_f32 v54, v54, v6
v_mul_f32 v55, v55, v6
AW a112,v48
AW a113,v49
AW a114,v50
AW a115,v51
AW a120,v52
AW a121,v53
AW a122,v54
AW a123,v55
v_max3_f32 v5, v164, v165, v166
v_max3_f32 v6, v167, v172, v173
v_max3_f32 v5, v5, v174, v175
v_max3_f32 v6, v6, v180, v181
v_max3_f32 v5, v5, v182, v183
v_max3_f32 v6, v6, v188, v189
v_max3_f32 v5, v5, v190, v191
v_max_f32 v5, v5, v6
v_mov_b32 v6, v5
s_nop 1
v_permlane16_swap_b32 v5, v6
s_nop 1
v_max_f32 v5, v5, v6
v_mov_b32 v6, v5
s_nop 1
v_permlane32_swap_b32 v5, v6
s_nop 1
v_max_f32 v5, v5, v6
v_max_f32 v5, 0, v5
v_mul_f32 v5, s69, v5
v_exp_f32 v6, -v5
v_sub_f32 v28, v28, v5
v_sub_f32 v29, v29, v5
v_sub_f32 v30, v30, v5
v_sub_f32 v31, v31, v5
v_sub_f32 v132, v132, v5
v_sub_f32 v133, v133, v5
v_sub_f32 v134, v134, v5
v_sub_f32 v135, v135, v5
v_sub_f32 v140, v140, v5
v_sub_f32 v141, v141, v5
v_sub_f32 v142, v142, v5
v_sub_f32 v143, v143, v5
v_sub_f32 v148, v148, v5
v_sub_f32 v149, v149, v5
v_sub_f32 v150, v150, v5
v_sub_f32 v151, v151, v5
v_sub_f32 v156, v156, v5
v_sub_f32 v157, v157, v5
v_sub_f32 v158, v158, v5
v_sub_f32 v159, v159, v5
v_sub_f32 v164, v164, v5
v_sub_f32 v165, v165, v5
v_sub_f32 v166, v166, v5
v_sub_f32 v167, v167, v5
v_sub_f32 v172, v172, v5
v_sub_f32 v173, v173, v5
v_sub_f32 v174, v174, v5
v_sub_f32 v175, v175, v5
v_sub_f32 v180, v180, v5
v_sub_f32 v181, v181, v5
v_sub_f32 v182, v182, v5
v_sub_f32 v183, v183, v5
v_sub_f32 v188, v188, v5
v_sub_f32 v189, v189, v5
v_sub_f32 v190, v190, v5
v_sub_f32 v191, v191, v5
v_mul_f32 v11, v11, v6
AR v48,a68
AR v49,a69
AR v50,a70
AR v51,a71
AR v52,a76
AR v53,a77
AR v54,a78
AR v55,a79
v_mul_f32 v48, v48, v6
v_mul_f32 v49, v49, v6
v_mul_f32 v50, v50, v6
v_mul_f32 v51, v51, v6
v_mul_f32 v52, v52, v6
v_mul_f32 v53, v53, v6
v_mul_f32 v54, v54, v6
v_mul_f32 v55, v55, v6
AW a68,v48
AW a69,v49
AW a70,v50
AW a71,v51
AW a76,v52
AW a77,v53
AW a78,v54
AW a79,v55
AR v48,a84
AR v49,a85
AR v50,a86
AR v51,a87
AR v52,a92
AR v53,a93
AR v54,a94
AR v55,a95
v_mul_f32 v48, v48, v6
v_mul_f32 v49, v49, v6
v_mul_f32 v50, v50, v6
v_mul_f32 v51, v51, v6
v_mul_f32 v52, v52, v6
v_mul_f32 v53, v53, v6
v_mul_f32 v54, v54, v6
v_mul_f32 v55, v55, v6
AW a84,v48
AW a85,v49
AW a86,v50
AW a87,v51
AW a92,v52
AW a93,v53
AW a94,v54
AW a95,v55
AR v48,a100
AR v49,a101
AR v50,a102
AR v51,a103
AR v52,a108
AR v53,a109
AR v54,a110
AR v55,a111
v_mul_f32 v48, v48, v6
v_mul_f32 v49, v49, v6
v_mul_f32 v50, v50, v6
v_mul_f32 v51, v51, v6
v_mul_f32 v52, v52, v6
v_mul_f32 v53, v53, v6
v_mul_f32 v54, v54, v6
v_mul_f32 v55, v55, v6
AW a100,v48
AW a101,v49
AW a102,v50
AW a103,v51
AW a108,v52
AW a109,v53
AW a110,v54
AW a111,v55
AR v48,a116
AR v49,a117
AR v50,a118
AR v51,a119
AR v52,a124
AR v53,a125
AR v54,a126
AR v55,a127
v_mul_f32 v48, v48, v6
v_mul_f32 v49, v49, v6
v_mul_f32 v50, v50, v6
v_mul_f32 v51, v51, v6
v_mul_f32 v52, v52, v6
v_mul_f32 v53, v53, v6
v_mul_f32 v54, v54, v6
v_mul_f32 v55, v55, v6
AW a116,v48
AW a117,v49
AW a118,v50
AW a119,v51
AW a124,v52
AW a125,v53
AW a126,v54
AW a127,v55
v_exp_f32 v48, v160
v_exp_f32 v49, v161
v_exp_f32 v50, v162
v_exp_f32 v51, v163
CV v240,v48,v49
v_exp_f32 v52, v168
v_exp_f32 v53, v169
CV v241,v50,v51
v_exp_f32 v54, v170
v_exp_f32 v55, v171
CV v242,v52,v53
v_exp_f32 v48, v164
v_exp_f32 v49, v165
CV v243,v54,v55
v_exp_f32 v50, v166
v_exp_f32 v51, v167
CV v248,v48,v49
v_exp_f32 v52, v172
MM v[40:43],v[56:59],v[240:243],0
v_exp_f32 v53, v173
CV v249,v50,v51
v_exp_f32 v54, v174
v_exp_f32 v55, v175
CV v250,v52,v53
v_exp_f32 v48, v176
v_exp_f32 v49, v177
CV v251,v54,v55
v_exp_f32 v50, v178
v_exp_f32 v51, v179
CV v244,v48,v49
v_exp_f32 v52, v184
MM v[44:47],v[56:59],v[248:251],0
v_exp_f32 v53, v185
CV v245,v50,v51
v_exp_f32 v54, v186
v_exp_f32 v55, v187
CV v246,v52,v53
v_exp_f32 v48, v180
v_exp_f32 v49, v181
CV v247,v54,v55
v_exp_f32 v50, v182
v_exp_f32 v51, v183
CV v252,v48,v49
v_exp_f32 v52, v188
MM v[40:43],v[56:59],v[244:247],v[40:43]
v_exp_f32 v53, v189
CV v253,v50,v51
v_exp_f32 v54, v190
v_exp_f32 v55, v191
CV v254,v52,v53
CV v255,v54,v55
s_nop 1
MM v[44:47],v[56:59],v[252:255],v[44:47]
v_exp_f32 v48, v128
v_exp_f32 v49, v129
v_exp_f32 v50, v130
v_exp_f32 v51, v131
v_exp_f32 v52, v136
v_exp_f32 v53, v137
s_nop 7
s_setpc_b64 s[100:101]
L_codeend:
.section .rodata,"a"
.p2align 6
.amdhsa_kernel recurrent_scan__compressed_kv_cla__glu_gated_bilinear__prompt_kernel
.amdhsa_next_free_vgpr 512
.amdhsa_next_free_sgpr 102
.amdhsa_accum_offset 256
.amdhsa_group_segment_fixed_size 0
.amdhsa_kernarg_size 104
.amdhsa_user_sgpr_count 2
.amdhsa_user_sgpr_kernarg_segment_ptr 1
.amdhsa_system_sgpr_workgroup_id_x 1
.end_amdhsa_kernel
```
